```python
import torch

def _softmax(x, axis=-1):
    return torch.softmax(x, dim=axis)
def _gelu(x):
    return torch.nn.functional.gelu(x, approximate="tanh")
def _silu(x):
    return torch.nn.functional.silu(x)
def _sigmoid(x):
    return torch.sigmoid(x)
def _layernorm(x, axis=-1, eps=1e-5):
    m = x.mean(dim=axis, keepdim=True)
    v = x.var(dim=axis, keepdim=True, unbiased=False)
    return (x - m) / torch.sqrt(v + eps)
def _scatter_add(tgt, idx, src, axis=0):
    return tgt.clone().index_add_(axis, idx, src)
def _segment_sum(src, seg, n):
    out = torch.zeros((n,) + src.shape[1:], dtype=src.dtype)
    return out.index_add_(0, seg, src)
def _pad(x, pw):
    flat = tuple(v for pair in reversed(pw) for v in pair)
    return torch.nn.functional.pad(x, flat)

kernel_name = 'recurrent_scan__spectral_fnet__dense_activation_relu__prompt'

def setup_inputs():

    _w = (lambda a: (lambda t: t.to(torch.bfloat16) if t.is_floating_point() else t)(torch.as_tensor(a)))
    def _A_setup():
        B, S, D = 1, 2048, 448
        ns = torch.arange(S)[:, None] * torch.arange(S)[None, :]
        nd = torch.arange(D)[:, None] * torch.arange(D)[None, :]
        Ws_re = torch.cos(-2.0 * torch.pi * ns / S).to(float)
        Ws_im = torch.sin(-2.0 * torch.pi * ns / S).to(float)
        Wd_re = torch.cos(-2.0 * torch.pi * nd / D).to(float)
        Wd_im = torch.sin(-2.0 * torch.pi * nd / D).to(float)
        return {
            "x": _w((lambda *s: torch.randn(*s, dtype=torch.bfloat16) * 0.05)(B, S, D)),
            "dft_seq_re": _w(Ws_re),
            "dft_seq_im": _w(Ws_im),
            "dft_hid_re": _w(Wd_re),
            "dft_hid_im": _w(Wd_im),
        }
    _A_in = _A_setup()

    def _B_setup():
        B, S, D, Dff = 1, 2048, 448, 1792
        return {
            "x": _w((lambda *s: torch.randn(*s, dtype=torch.bfloat16) * 0.05)(B, S, D)),
            "w1": _w((lambda *s: torch.randn(*s, dtype=torch.bfloat16) * 0.05)(D, Dff)),
            "w2": _w((lambda *s: torch.randn(*s, dtype=torch.bfloat16) * 0.05)(Dff, D)),
        }
    _B_in = _B_setup()

    return {
        "A_x": _A_in["x"],
        "A_dft_seq_re": _A_in["dft_seq_re"],
        "A_dft_seq_im": _A_in["dft_seq_im"],
        "A_dft_hid_re": _A_in["dft_hid_re"],
        "A_dft_hid_im": _A_in["dft_hid_im"],
        "B_x": _B_in["x"],
        "B_w1": _B_in["w1"],
        "B_w2": _B_in["w2"],
    }

def reference(A_x, A_dft_seq_re, A_dft_seq_im, A_dft_hid_re, A_dft_hid_im, B_x, B_w1, B_w2):
    def _A_ref(x, dft_seq_re, dft_seq_im, dft_hid_re, dft_hid_im):
        a = torch.einsum("bsd,ed->bse", x, dft_hid_re)
        b = torch.einsum("bsd,ed->bse", x, dft_hid_im)
        y = torch.einsum("ts,bse->bte", dft_seq_re, a) - torch.einsum("ts,bse->bte", dft_seq_im, b)
        return y

    def _B_ref(x, w1, w2):
        h = torch.einsum("bsd,df->bsf", x, w1)
        zero = torch.zeros_like(h)
        h = torch.maximum(h, zero)
        return torch.einsum("bsf,fd->bsd", h, w2)

    x = A_x
    xn = _layernorm(x, axis=-1)
    s = _A_ref(xn, A_dft_seq_re, A_dft_seq_im, A_dft_hid_re, A_dft_hid_im)
    g = _silu(_B_ref(xn, B_w1, B_w2))
    return x + s * g
```

```asm
; @launch grid=(256,1,1) block=(512,1,1) lds=163840
.amdgcn_target "amdgcn-amd-amdhsa--gfx950"
.text
.globl recurrent_scan__spectral_fnet__dense_activation_relu__prompt_kernel
.p2align 8
.type recurrent_scan__spectral_fnet__dense_activation_relu__prompt_kernel,@function
recurrent_scan__spectral_fnet__dense_activation_relu__prompt_kernel:
  s_cmp_ge_u32 s2, 256
  s_cbranch_scc1 L_end
  s_load_dwordx2 s[8:9], s[0:1], 0
  s_load_dwordx2 s[12:13], s[0:1], 48
  s_load_dwordx2 s[16:17], s[0:1], 56
  s_load_dwordx2 s[24:25], s[0:1], 64
  s_load_dwordx2 s[20:21], s[0:1], 80
  s_getpc_b64 s[4:5]
L_pc:
  s_mov_b32 s6, L_end-L_pc
  s_mov_b32 s7, 0x20000
  v_lshrrev_b32 v3, 6, v0
  v_lshlrev_b32 v1, 12, v0
  s_bfe_u32 s3, s2, 327683
  s_lshl_b32 s3, s3, 7
  buffer_load_dword v235, v1, s[4:7], s3 offen
  v_readfirstlane_b32 s36, v3
  s_mov_b32 s10, 1835008
  s_mov_b32 s11, 0x20000
  s_mov_b32 s14, 1605632
  s_mov_b32 s15, 0x20000
  s_mov_b32 s18, 1605632
  s_mov_b32 s19, 0x20000
  s_mov_b32 s22, 268435456
  s_mov_b32 s23, 0x20000
  s_mov_b32 s26, 1835008
  s_mov_b32 s27, 0x20000
  v_and_b32 v0, 63, v0
  v_lshlrev_b32 v1, 4, v0
  s_lshr_b32 s43, s2, 3
  s_andn2_b32 s39, 1, s2
  s_and_b32 s44, s2, 6
  s_lshl_b32 s44, s44, 1
  s_cmp_lt_u32 s43, 4
  s_cbranch_scc1 L_dft
  s_sub_u32 s43, s43, 4
  s_mul_i32 s45, s43, 37
  s_lshr_b32 s45, s45, 8
  s_add_u32 s37, s44, s45
  s_mul_i32 s46, s45, 7
  s_sub_u32 s38, s43, s46
  s_and_b32 s46, s37, 3
  s_add_u32 s40, s38, s46
  s_and_b32 s40, s40, 1
  s_mul_i32 s40, s40, 4
  s_lshr_b32 s46, s37, 2
  s_mul_i32 s46, s46, 2
  s_add_u32 s40, s40, s46
  s_mul_i32 s46, s39, 1
  s_add_u32 s40, s40, s46
  s_mul_i32 s46, s40, 37
  s_lshr_b32 s46, s46, 8
  s_mul_i32 s46, s46, 7
  s_sub_u32 s40, s40, s46
  s_cmp_lt_u32 s36, 4
  s_cbranch_scc1 L_mfma
  s_sub_u32 s59, s36, 4
  s_lshr_b32 s44, s59, 1
  s_xor_b32 s43, s39, 1
  s_sub_u32 s46, 32, s37
  s_cmp_eq_u32 s37, 0
  s_cselect_b32 s46, 16, s46
  s_cmp_eq_u32 s43, 0
  s_cselect_b32 s45, s37, s46
  s_sub_u32 s46, 64, s45
  s_cmp_eq_u32 s45, 0
  s_cselect_b32 s46, 32, s46
  s_cmp_eq_u32 s44, 0
  s_cselect_b32 s45, s45, s46
  s_lshl_b32 s47, s59, 12
  s_lshl_b32 s49, s59, 11
  s_and_b32 s46, s59, 1
  s_lshl_b32 s46, s46, 10
  s_add_u32 s46, s46, s45
  s_mul_i32 s48, s46, 896
  s_lshl_b32 s46, s40, 7
  s_add_u32 s48, s48, s46
  s_lshl_b32 s46, s40, 2
  s_add_u32 s46, s46, s59
  s_mul_i32 s51, s46, 57344
  s_mul_i32 s46, s39, 7
  s_add_u32 s46, s46, s38
  s_lshl_b32 s46, s46, 8
  s_add_u32 s51, s51, s46
  s_mov_b32 s54, s40
  s_sub_u32 s46, 32, s37
  s_cmp_eq_u32 s37, 0
  s_cselect_b32 s46, 16, s46
  s_cmp_eq_u32 s39, 0
  s_cselect_b32 s53, s37, s46
  s_sub_u32 s46, 64, s53
  s_cmp_eq_u32 s53, 0
  s_cselect_b32 s46, 32, s46
  s_cmp_eq_u32 s44, 0
  s_cselect_b32 s53, s53, s46
  s_sub_u32 s50, s53, s45
  s_mul_i32 s50, s50, 896
  s_add_u32 s53, s48, s50
  v_lshrrev_b32 v10, 3, v0
  v_lshrrev_b32 v11, 4, v0
  v_mul_u32_u24 v12, 57344, v10
  v_xor_b32 v13, v11, v0
  v_and_b32 v13, 7, v13
  v_lshl_add_u32 v4, v13, 4, v12
  v_xor_b32 v5, 64, v4
  v_lshlrev_b32 v13, 2, v11
  v_xor_b32 v13, v13, v0
  v_and_b32 v13, 15, v13
  v_lshlrev_b32 v13, 4, v13
  v_mul_u32_u24 v12, 3584, v11
  v_add_u32 v6, v12, v13
  v_xor_b32 v7, 32, v6
  s_waitcnt lgkmcnt(0)
  s_add_u32 m0, s49, 0
  s_add_u32 s56, s48, 0
  buffer_load_dwordx4 v4, s[8:11], s56 offen lds
  s_add_u32 m0, s49, 1024
  s_add_u32 s56, s48, 458752
  buffer_load_dwordx4 v5, s[8:11], s56 offen lds
  s_add_u32 m0, s49, 8192
  s_add_u32 s56, s53, 0
  buffer_load_dwordx4 v4, s[8:11], s56 offen lds
  s_add_u32 m0, s49, 9216
  s_add_u32 s56, s53, 458752
  buffer_load_dwordx4 v5, s[8:11], s56 offen lds
  s_add_u32 m0, s47, 16384
  s_add_u32 s56, s51, 0
  buffer_load_dwordx4 v6, s[12:15], s56 offen lds
  s_add_u32 m0, s47, 17408
  s_add_u32 s56, s51, 14336
  buffer_load_dwordx4 v6, s[12:15], s56 offen lds
  s_add_u32 m0, s47, 18432
  s_add_u32 s56, s51, 28672
  buffer_load_dwordx4 v7, s[12:15], s56 offen lds
  s_add_u32 m0, s47, 19456
  s_add_u32 s56, s51, 43008
  buffer_load_dwordx4 v7, s[12:15], s56 offen lds
  s_cmp_eq_u32 s54, 6
  s_cselect_b32 s57, -6, 1
  s_add_u32 s54, s54, s57
  s_lshl_b32 s58, s57, 7
  s_add_u32 s48, s48, s58
  s_mul_i32 s58, s57, 229376
  s_add_u32 s51, s51, s58
  s_lshl_b32 s61, s37, 2
  s_add_u32 s61, s61, 10682368
  s_load_dword s41, s[20:21], s61
  s_lshr_b32 s3, s36, 2
  s_and_b32 s63, s36, 3
  s_bfe_u32 s62, s36, 0x10001
  s_and_b32 s60, s36, 1
  v_and_b32 v14, 15, v0
  v_lshrrev_b32 v13, 4, v0
  v_and_b32 v18, 1, v13
  v_and_b32 v19, 3, v0
  v_lshlrev_b32 v15, 1, v13
  v_xor_b32 v15, v15, v0
  v_and_b32 v15, 7, v15
  v_lshrrev_b32 v16, 3, v0
  v_mul_u32_u24 v16, 896, v16
  v_lshl_add_u32 v231, v15, 4, v16
  s_lshl_b32 s61, s60, 13
  s_add_u32 s61, s61, 65536
  v_lshrrev_b32 v15, 2, v0
  v_lshl_add_u32 v16, v15, 7, s61
  v_bfe_u32 v15, v0, 3, 2
  v_lshl_add_u32 v16, v15, 5, v16
  v_lshl_add_u32 v212, v19, 3, v16
  v_xor_b32 v213, 32, v212
  v_xor_b32 v214, 64, v212
  v_xor_b32 v215, 96, v212
  s_cmp_ge_u32 s38, s40
  s_cselect_b32 s45, 0, 7
  s_add_u32 s97, s38, s45
  s_sub_u32 s97, s97, s40
  s_cmp_ge_u32 s97, 5
  s_cselect_b32 s45, 5, 0
  s_sub_u32 s45, s97, s45
  s_lshl_b32 s45, s45, 4
  s_add_u32 s45, s45, s63
  s_add_u32 s45, s45, 4
  s_lshl_b32 s45, s45, 11
  s_mov_b32 s46, s3
  s_lshl_b32 s61, s46, 2
  v_lshrrev_b32 v15, 5, v0
  v_add_u32 v15, s61, v15
  v_lshrrev_b32 v16, 1, v14
  v_xor_b32 v15, v15, v16
  v_lshlrev_b32 v15, 4, v15
  v_lshl_add_u32 v15, v14, 7, v15
  v_lshl_add_u32 v15, v18, 3, v15
  v_add_u32 v222, s45, v15
  v_xor_b32 v223, 32, v222
  s_sub_u32 s45, 32, s37
  s_cmp_eq_u32 s37, 0
  s_cselect_b32 s45, 16, s45
  s_cmp_eq_u32 s39, 0
  s_cselect_b32 s42, s37, s45
  s_sub_u32 s45, 64, s42
  s_cmp_eq_u32 s42, 0
  s_cselect_b32 s45, 32, s45
  s_cmp_eq_u32 s62, 0
  s_cselect_b32 s44, s42, s45
  s_lshl_b32 s45, s60, 10
  s_add_u32 s44, s44, s45
  v_add_u32 v220, s45, v1
  v_xor_b32 v221, 1024, v220
  s_lshl_b32 s45, s38, 1
  s_add_u32 s45, s45, s46
  s_lshl_b32 s45, s45, 6
  v_lshrrev_b32 v15, 2, v0
  v_lshl_add_u32 v15, v15, 6, s44
  v_mul_u32_u24 v228, 896, v15
  v_lshl_add_u32 v228, v19, 4, v228
  v_add_u32 v228, s45, v228
  s_lshl_b32 s45, s63, 12
  s_add_u32 s45, s45, 32768
  v_add_u32 v226, s45, v1
  v_xor_b32 v227, 4096, v226
  s_lshl_b32 s45, s63, 4
  v_mov_b32 v232, s45
  s_xor_b32 s45, s63, 1
  s_lshl_b32 s98, 1, s45
  s_xor_b32 s45, s36, 4
  s_lshl_b32 s45, s45, 12
  s_add_u32 s45, s45, 65536
  v_lshlrev_b32 v15, 6, v14
  v_lshl_add_u32 v15, v13, 3, v15
  v_add_u32 v233, s45, v15
  s_xor_b32 s45, s46, s39
  s_lshl_b32 s61, s37, 1
  s_add_u32 s45, s45, s61
  s_lshl_b32 s45, s45, 1
  s_add_u32 s45, s45, s62
  s_lshl_b32 s45, s45, 1
  s_add_u32 s45, s45, s39
  s_lshl_b32 s93, s45, 1
  s_add_u32 s93, s93, s60
  s_lshl_b32 s93, s93, 7
  s_add_u32 s93, s93, 10747904
  s_mul_i32 s44, s45, 14
  s_add_u32 s44, s44, s60
  s_lshl_b32 s44, s44, 12
  s_mul_i32 s86, s38, 8192
  s_add_u32 s86, s86, s44
  s_cmp_gt_u32 s38, 0
  s_cselect_b32 s87, 0, 1
  s_mul_i32 s87, s87, 8192
  s_add_u32 s87, s87, s44
  s_cmp_gt_u32 s38, 1
  s_cselect_b32 s88, 1, 2
  s_mul_i32 s88, s88, 8192
  s_add_u32 s88, s88, s44
  s_cmp_gt_u32 s38, 2
  s_cselect_b32 s89, 2, 3
  s_mul_i32 s89, s89, 8192
  s_add_u32 s89, s89, s44
  s_cmp_gt_u32 s38, 3
  s_cselect_b32 s90, 3, 4
  s_mul_i32 s90, s90, 8192
  s_add_u32 s90, s90, s44
  s_cmp_gt_u32 s38, 4
  s_cselect_b32 s91, 4, 5
  s_mul_i32 s91, s91, 8192
  s_add_u32 s91, s91, s44
  s_cmp_gt_u32 s38, 5
  s_cselect_b32 s92, 5, 6
  s_mul_i32 s92, s92, 8192
  s_add_u32 s92, s92, s44
  s_mul_i32 s46, s39, 28
  s_add_u32 s46, s46, s59
  s_mul_i32 s46, s46, 28672
  s_lshl_b32 s45, s38, 7
  s_add_u32 s46, s46, s45
  s_mul_i32 s45, s44, 14
  s_sub_u32 s52, s46, s45
  s_lshr_b32 s3, s36, 2
  s_and_b32 s63, s36, 3
  s_bfe_u32 s62, s36, 0x10001
  s_and_b32 s60, s36, 1
  v_and_b32 v14, 15, v0
  v_lshrrev_b32 v13, 4, v0
  v_and_b32 v18, 1, v13
  v_and_b32 v19, 3, v0
  s_sub_u32 s45, 32, s37
  s_cmp_eq_u32 s37, 0
  s_cselect_b32 s45, 16, s45
  s_cmp_eq_u32 s39, 0
  s_cselect_b32 s42, s37, s45
  s_sub_u32 s45, 64, s42
  s_cmp_eq_u32 s42, 0
  s_cselect_b32 s45, 32, s45
  s_cmp_eq_u32 s62, 0
  s_cselect_b32 s44, s42, s45
  s_lshl_b32 s45, s60, 10
  s_add_u32 s44, s44, s45
  v_lshl_add_u32 v12, v14, 6, s44
  v_and_b32 v15, 31, v12
  v_lshrrev_b32 v16, 5, v12
  v_lshl_add_u32 v16, v15, 6, v16
  v_lshlrev_b32 v229, 2, v16
  s_lshl_b32 s94, s37, 2
  s_add_u32 s94, s94, s63
  s_lshl_b32 s94, s94, 7
  s_add_u32 s94, s94, 10616832
  s_sub_u32 s44, 6, s38
  s_min_u32 s44, s44, s38
  s_lshl_b32 s44, s44, 5
  s_cmp_ge_u32 s38, 4
  s_cselect_b32 s45, 1, 0
  v_lshlrev_b32 v15, 2, v18
  v_xor_b32 v15, v14, v15
  v_lshlrev_b32 v16, 10, v13
  v_xor_b32 v17, 1, v18
  v_mul_u32_u24 v20, s45, v17
  v_add_u32 v20, s44, v20
  v_add_u32 v23, 63, v18
  v_add_u32 v17, 174, v17
  v_lshl_add_u32 v21, v15, 1, v20
  v_cmp_gt_u32 vcc, 63, v21
  v_sub_u32 v22, v17, v21
  v_xor_b32 v15, 8, v15
  v_max_u32 v22, v22, v23
  v_cndmask_b32 v21, v22, v21, vcc
  v_lshl_add_u32 v224, v21, 3, v16
  v_lshl_add_u32 v21, v15, 1, v20
  v_cmp_gt_u32 vcc, 63, v21
  v_sub_u32 v22, v17, v21
  v_xor_b32 v15, 8, v15
  v_max_u32 v22, v22, v23
  v_cndmask_b32 v21, v22, v21, vcc
  v_lshl_add_u32 v225, v21, 3, v16
  s_lshl_b32 s95, s42, 2
  s_add_u32 s95, s95, s63
  s_lshl_b32 s95, s95, 14
  s_add_u32 s95, s95, 8388608
  s_lshl_b32 s61, s38, 6
  v_add_u32 v24, s61, v14
  v_and_b32 v25, 1, v0
  v_xor_b32 v26, 1, v25
  v_mul_u32_u24 v26, s45, v26
  v_add_u32 v26, s44, v26
  v_lshl_or_b32 v27, v18, 1, v25
  v_lshlrev_b32 v27, 2, v27
  v_lshlrev_b32 v28, 10, v13
  v_lshl_add_u32 v28, v25, 8, v28
  v_add_u32 v29, 0, v24
  v_sub_u32 v21, 448, v29
  v_min_u32 v29, v29, v21
  v_lshrrev_b32 v21, 1, v29
  v_sub_u32 v29, v21, v26
  v_lshrrev_b32 v30, 1, v29
  v_and_b32 v29, 1, v29
  v_sub_u32 v21, v21, v29
  v_cmp_gt_u32 vcc, 63, v21
  v_xor_b32 v30, v30, v27
  v_lshl_add_u32 v30, v30, 4, v28
  v_xor_b32 v22, 1, v29
  v_cndmask_b32 v29, v22, v29, vcc
  v_lshl_add_u32 v216, v29, 3, v30
  v_add_u32 v29, 16, v24
  v_sub_u32 v21, 448, v29
  v_min_u32 v29, v29, v21
  v_lshrrev_b32 v21, 1, v29
  v_sub_u32 v29, v21, v26
  v_lshrrev_b32 v30, 1, v29
  v_and_b32 v29, 1, v29
  v_sub_u32 v21, v21, v29
  v_cmp_gt_u32 vcc, 63, v21
  v_xor_b32 v30, v30, v27
  v_lshl_add_u32 v30, v30, 4, v28
  v_xor_b32 v22, 1, v29
  v_cndmask_b32 v29, v22, v29, vcc
  v_lshl_add_u32 v217, v29, 3, v30
  v_add_u32 v29, 32, v24
  v_sub_u32 v21, 448, v29
  v_min_u32 v29, v29, v21
  v_lshrrev_b32 v21, 1, v29
  v_sub_u32 v29, v21, v26
  s_add_u32 m0, s49, 32768
  s_add_u32 s56, s48, 0
  buffer_load_dwordx4 v4, s[8:11], s56 offen lds
  s_add_u32 s53, s48, s50
  s_add_u32 m0, s49, 33792
  s_add_u32 s56, s48, 458752
  buffer_load_dwordx4 v5, s[8:11], s56 offen lds
  s_add_u32 m0, s49, 40960
  s_add_u32 s56, s53, 0
  buffer_load_dwordx4 v4, s[8:11], s56 offen lds
  s_add_u32 m0, s49, 41984
  s_add_u32 s56, s53, 458752
  buffer_load_dwordx4 v5, s[8:11], s56 offen lds
  s_add_u32 m0, s47, 49152
  s_add_u32 s56, s51, 0
  buffer_load_dwordx4 v6, s[12:15], s56 offen lds
  s_add_u32 m0, s47, 50176
  s_add_u32 s56, s51, 14336
  buffer_load_dwordx4 v6, s[12:15], s56 offen lds
  s_add_u32 m0, s47, 51200
  s_add_u32 s56, s51, 28672
  buffer_load_dwordx4 v7, s[12:15], s56 offen lds
  s_add_u32 m0, s47, 52224
  s_add_u32 s56, s51, 43008
  buffer_load_dwordx4 v7, s[12:15], s56 offen lds
  s_cmp_eq_u32 s54, 6
  s_cselect_b32 s57, -6, 1
  s_add_u32 s54, s54, s57
  s_lshl_b32 s58, s57, 7
  s_add_u32 s48, s48, s58
  s_mul_i32 s58, s57, 229376
  s_add_u32 s51, s51, s58
  s_waitcnt vmcnt(8) lgkmcnt(0)
  s_barrier
  s_setprio 1
  s_mul_i32 s41, s41, 0x9E3779B1
  s_add_u32 s41, s41, 0x7F4A7C15
  v_mov_b32 v230, s41
  s_cmp_eq_u32 s97, 0
  s_cbranch_scc0 L_nxu0
  ds_read_b64 v[208:209], v222
  ds_read_b64 v[210:211], v223
L_nxu0:
  s_add_u32 m0, s49, 65536
  s_add_u32 s56, s48, 0
  buffer_load_dwordx4 v4, s[8:11], s56 offen lds
  s_add_u32 s53, s48, s50
  s_add_u32 m0, s49, 66560
  s_add_u32 s56, s48, 458752
  buffer_load_dwordx4 v5, s[8:11], s56 offen lds
  s_add_u32 m0, s49, 73728
  s_add_u32 s56, s53, 0
  buffer_load_dwordx4 v4, s[8:11], s56 offen lds
  s_add_u32 m0, s49, 74752
  s_add_u32 s56, s53, 458752
  buffer_load_dwordx4 v5, s[8:11], s56 offen lds
  s_add_u32 m0, s47, 81920
  s_add_u32 s56, s51, 0
  buffer_load_dwordx4 v6, s[12:15], s56 offen lds
  s_add_u32 m0, s47, 82944
  s_add_u32 s56, s51, 14336
  buffer_load_dwordx4 v6, s[12:15], s56 offen lds
  s_add_u32 m0, s47, 83968
  s_add_u32 s56, s51, 28672
  buffer_load_dwordx4 v7, s[12:15], s56 offen lds
  s_add_u32 m0, s47, 84992
  s_add_u32 s56, s51, 43008
  buffer_load_dwordx4 v7, s[12:15], s56 offen lds
  s_cmp_eq_u32 s54, 6
  s_cselect_b32 s57, -6, 1
  s_add_u32 s54, s54, s57
  s_lshl_b32 s58, s57, 7
  s_add_u32 s48, s48, s58
  s_mul_i32 s58, s57, 229376
  s_add_u32 s51, s51, s58
  s_waitcnt vmcnt(8) lgkmcnt(0)
  s_barrier
  s_cmp_eq_u32 s97, 1
  s_cbranch_scc0 L_nxu1
  ds_read_b64 v[208:209], v222
  ds_read_b64 v[210:211], v223
L_nxu1:
  s_add_u32 m0, s49, 98304
  s_add_u32 s56, s48, 0
  buffer_load_dwordx4 v4, s[8:11], s56 offen lds
  s_add_u32 s53, s48, s50
  s_add_u32 m0, s49, 99328
  s_add_u32 s56, s48, 458752
  buffer_load_dwordx4 v5, s[8:11], s56 offen lds
  s_add_u32 m0, s49, 106496
  s_add_u32 s56, s53, 0
  buffer_load_dwordx4 v4, s[8:11], s56 offen lds
  s_add_u32 m0, s49, 107520
  s_add_u32 s56, s53, 458752
  buffer_load_dwordx4 v5, s[8:11], s56 offen lds
  s_add_u32 m0, s47, 114688
  s_add_u32 s56, s51, 0
  buffer_load_dwordx4 v6, s[12:15], s56 offen lds
  s_add_u32 m0, s47, 115712
  s_add_u32 s56, s51, 14336
  buffer_load_dwordx4 v6, s[12:15], s56 offen lds
  s_add_u32 m0, s47, 116736
  s_add_u32 s56, s51, 28672
  buffer_load_dwordx4 v7, s[12:15], s56 offen lds
  s_add_u32 m0, s47, 117760
  s_add_u32 s56, s51, 43008
  buffer_load_dwordx4 v7, s[12:15], s56 offen lds
  s_cmp_eq_u32 s54, 6
  s_cselect_b32 s57, -6, 1
  s_add_u32 s54, s54, s57
  s_lshl_b32 s58, s57, 7
  s_add_u32 s48, s48, s58
  s_mul_i32 s58, s57, 229376
  s_add_u32 s51, s51, s58
  s_waitcnt vmcnt(8) lgkmcnt(0)
  s_barrier
  s_cmp_eq_u32 s97, 2
  s_cbranch_scc0 L_nxu2
  ds_read_b64 v[208:209], v222
  ds_read_b64 v[210:211], v223
L_nxu2:
  s_add_u32 m0, s49, 131072
  s_add_u32 s56, s48, 0
  buffer_load_dwordx4 v4, s[8:11], s56 offen lds
  s_add_u32 s33, s48, s50
  s_add_u32 m0, s49, 132096
  s_add_u32 s56, s48, 458752
  buffer_load_dwordx4 v5, s[8:11], s56 offen lds
  s_add_u32 m0, s47, 147456
  s_add_u32 s56, s51, 0
  buffer_load_dwordx4 v6, s[12:15], s56 offen lds
  s_add_u32 m0, s47, 148480
  s_add_u32 s56, s51, 14336
  buffer_load_dwordx4 v6, s[12:15], s56 offen lds
  s_add_u32 m0, s47, 149504
  s_add_u32 s56, s51, 28672
  buffer_load_dwordx4 v7, s[12:15], s56 offen lds
  s_add_u32 m0, s47, 150528
  s_add_u32 s56, s51, 43008
  buffer_load_dwordx4 v7, s[12:15], s56 offen lds
  s_cmp_eq_u32 s54, 6
  s_cselect_b32 s57, -6, 1
  s_add_u32 s54, s54, s57
  s_lshl_b32 s58, s57, 7
  s_add_u32 s48, s48, s58
  s_mul_i32 s58, s57, 229376
  s_add_u32 s51, s51, s58
  s_add_u32 m0, s49, 0
  s_add_u32 s56, s48, 0
  buffer_load_dwordx4 v4, s[8:11], s56 offen lds
  s_add_u32 s34, s48, s50
  s_add_u32 m0, s49, 1024
  s_add_u32 s56, s48, 458752
  buffer_load_dwordx4 v5, s[8:11], s56 offen lds
  s_waitcnt vmcnt(8) lgkmcnt(0)
  s_barrier
  s_cmp_eq_u32 s97, 3
  s_cbranch_scc0 L_nxu3
  ds_read_b64 v[208:209], v222
  ds_read_b64 v[210:211], v223
L_nxu3:
  s_add_u32 m0, s47, 16384
  s_add_u32 s56, s51, 0
  buffer_load_dwordx4 v6, s[12:15], s56 offen lds
  s_add_u32 m0, s47, 17408
  s_add_u32 s56, s51, 14336
  buffer_load_dwordx4 v6, s[12:15], s56 offen lds
  s_add_u32 m0, s47, 18432
  s_add_u32 s56, s51, 28672
  buffer_load_dwordx4 v7, s[12:15], s56 offen lds
  s_add_u32 m0, s47, 19456
  s_add_u32 s56, s51, 43008
  buffer_load_dwordx4 v7, s[12:15], s56 offen lds
  s_cmp_eq_u32 s54, 6
  s_cselect_b32 s57, -6, 1
  s_add_u32 s54, s54, s57
  s_lshl_b32 s58, s57, 7
  s_add_u32 s48, s48, s58
  s_mul_i32 s58, s57, 229376
  s_add_u32 s51, s51, s58
  s_add_u32 m0, s49, 32768
  s_add_u32 s56, s48, 0
  buffer_load_dwordx4 v4, s[8:11], s56 offen lds
  s_add_u32 s35, s48, s50
  s_add_u32 m0, s49, 33792
  s_add_u32 s56, s48, 458752
  buffer_load_dwordx4 v5, s[8:11], s56 offen lds
  s_add_u32 m0, s47, 49152
  s_add_u32 s56, s51, 0
  buffer_load_dwordx4 v6, s[12:15], s56 offen lds
  s_add_u32 m0, s47, 50176
  s_add_u32 s56, s51, 14336
  buffer_load_dwordx4 v6, s[12:15], s56 offen lds
  s_waitcnt vmcnt(10) lgkmcnt(0)
  s_barrier
  s_add_u32 m0, s47, 51200
  s_add_u32 s56, s51, 28672
  buffer_load_dwordx4 v7, s[12:15], s56 offen lds
  s_add_u32 m0, s47, 52224
  s_add_u32 s56, s51, 43008
  buffer_load_dwordx4 v7, s[12:15], s56 offen lds
  s_add_u32 m0, s49, 40960
  s_add_u32 s56, s35, 0
  buffer_load_dwordx4 v4, s[8:11], s56 offen lds
  s_add_u32 m0, s49, 41984
  s_add_u32 s56, s35, 458752
  buffer_load_dwordx4 v5, s[8:11], s56 offen lds
  s_add_u32 m0, s49, 139264
  s_add_u32 s56, s33, 0
  buffer_load_dwordx4 v4, s[8:11], s56 offen lds
  s_add_u32 m0, s49, 140288
  s_add_u32 s56, s33, 458752
  buffer_load_dwordx4 v5, s[8:11], s56 offen lds
  s_add_u32 m0, s49, 8192
  s_add_u32 s56, s34, 0
  buffer_load_dwordx4 v4, s[8:11], s56 offen lds
  s_add_u32 m0, s49, 9216
  s_add_u32 s56, s34, 458752
  buffer_load_dwordx4 v5, s[8:11], s56 offen lds
  s_waitcnt vmcnt(12)
  s_barrier
  s_mul_i32 s55, s86, 14
  s_add_u32 s55, s55, s52
  s_add_u32 m0, s47, 65536
  s_add_u32 s56, s55, 0
  buffer_load_dwordx4 v231, s[16:19], s56 offen lds
  s_add_u32 m0, s47, 66560
  s_add_u32 s56, s55, 7168
  buffer_load_dwordx4 v231, s[16:19], s56 offen lds
  s_add_u32 m0, s47, 67584
  s_add_u32 s56, s55, 14336
  buffer_load_dwordx4 v231, s[16:19], s56 offen lds
  s_add_u32 m0, s47, 68608
  s_add_u32 s56, s55, 21504
  buffer_load_dwordx4 v231, s[16:19], s56 offen lds
  s_mul_i32 s55, s87, 14
  s_add_u32 s55, s55, s52
  s_add_u32 m0, s47, 81920
  s_add_u32 s56, s55, 0
  buffer_load_dwordx4 v231, s[16:19], s56 offen lds
  s_add_u32 m0, s47, 82944
  s_add_u32 s56, s55, 7168
  buffer_load_dwordx4 v231, s[16:19], s56 offen lds
  s_add_u32 m0, s47, 83968
  s_add_u32 s56, s55, 14336
  buffer_load_dwordx4 v231, s[16:19], s56 offen lds
  s_mul_i32 s55, s88, 14
  s_add_u32 s55, s55, s52
  s_add_u32 m0, s47, 98304
  s_add_u32 s56, s55, 0
  buffer_load_dwordx4 v231, s[16:19], s56 offen lds
  s_waitcnt vmcnt(14)
  s_barrier
  s_mul_i32 s45, s37, 7
  s_add_u32 s45, s45, s38
  s_lshl_b32 s45, s45, 1
  s_add_u32 s45, s45, s39
  s_lshl_b32 s7, s45, 5
  s_add_u32 s7, s7, s59
  s_lshl_b32 s7, s7, 2
  s_add_u32 s7, s7, 10813440
  s_xor_b32 s6, s7, 128
  s_lshl_b32 s5, s45, 2
  s_add_u32 s5, s5, s59
  s_lshl_b32 s5, s5, 11
  s_add_u32 s5, s5, 16777216
  s_xor_b32 s4, s5, 8192
  s_add_u32 m0, s47, 99328
  s_add_u32 s56, s55, 7168
  buffer_load_dwordx4 v231, s[16:19], s56 offen lds
  s_add_u32 m0, s47, 100352
  s_add_u32 s56, s55, 14336
  buffer_load_dwordx4 v231, s[16:19], s56 offen lds
  s_add_u32 m0, s47, 101376
  s_add_u32 s56, s55, 21504
  buffer_load_dwordx4 v231, s[16:19], s56 offen lds
  s_mul_i32 s55, s89, 14
  s_add_u32 s55, s55, s52
  s_add_u32 m0, s47, 114688
  s_add_u32 s56, s55, 0
  buffer_load_dwordx4 v231, s[16:19], s56 offen lds
  v_lshrrev_b32 v30, 1, v29
  v_and_b32 v29, 1, v29
  v_sub_u32 v21, v21, v29
  v_cmp_gt_u32 vcc, 63, v21
  v_xor_b32 v30, v30, v27
  v_lshl_add_u32 v30, v30, 4, v28
  v_xor_b32 v22, 1, v29
  v_cndmask_b32 v29, v22, v29, vcc
  v_lshl_add_u32 v218, v29, 3, v30
  v_add_u32 v29, 48, v24
  v_sub_u32 v21, 448, v29
  v_min_u32 v29, v29, v21
  v_lshrrev_b32 v21, 1, v29
  v_sub_u32 v29, v21, v26
  v_lshrrev_b32 v30, 1, v29
  v_and_b32 v29, 1, v29
  v_sub_u32 v21, v21, v29
  v_cmp_gt_u32 vcc, 63, v21
  v_xor_b32 v30, v30, v27
  v_lshl_add_u32 v30, v30, 4, v28
  v_xor_b32 v22, 1, v29
  v_cndmask_b32 v29, v22, v29, vcc
  v_lshl_add_u32 v219, v29, 3, v30
  s_cmp_eq_u32 s62, 0
  s_cselect_b32 s29, 0x80000000, 0
  s_mov_b32 s28, 0x01000c0c
  s_cselect_b32 s28, 0x0c0c0100, s28
  s_mov_b32 s30, 0x03020c0c
  s_cselect_b32 s30, 0x0c0c0302, s30
  s_or_b32 s31, s29, 0x8000
  s_cmp_eq_u32 s42, 0
  s_cselect_b32 s28, s28, 0x03020100
  s_cselect_b32 s30, s30, 0x01000302
  s_cselect_b32 s29, 0, s29
  s_cselect_b32 s31, 0x80008000, s31
  s_cmp_ge_u32 s38, 4
  s_cselect_b32 s45, 0x80008000, 0
  s_xor_b32 s31, s31, s45
  s_cmp_eq_u32 s38, 3
  s_cselect_b32 s96, 0x80008000, 0
  v_cvt_f32_u32 v12, v12
  v_cvt_f32_u32 v16, v13
  v_mul_f32 v12, 0x3a000000, v12
  v_add_f32 v16, v16, v16
  v_mul_f32 v16, v16, v12
  v_mul_f32 v15, 0x40e00000, v12
  v_cos_f32 v25, v16
  v_sin_f32 v24, v16
  v_add_f32 v16, v16, v12
  v_cvt_pk_bf16_f32 v24, v25, v24
  s_barrier
  s_waitcnt vmcnt(12)
  s_barrier
  s_cmp_ge_u32 s97, 4
  s_cbranch_scc0 L_nxu7
  ds_read_b64 v[208:209], v222
  ds_read_b64 v[210:211], v223
L_nxu7:
  s_waitcnt lgkmcnt(0)
  s_barrier
  s_mul_i32 s55, s87, 14
  s_add_u32 s55, s55, s52
  s_add_u32 m0, s47, 84992
  s_add_u32 s56, s55, 21504
  buffer_load_dwordx4 v231, s[16:19], s56 offen lds
  s_mul_i32 s55, s89, 14
  s_add_u32 s55, s55, s52
  s_add_u32 m0, s47, 115712
  s_add_u32 s56, s55, 7168
  buffer_load_dwordx4 v231, s[16:19], s56 offen lds
  s_add_u32 m0, s47, 116736
  s_add_u32 s56, s55, 14336
  buffer_load_dwordx4 v231, s[16:19], s56 offen lds
  s_add_u32 m0, s47, 117760
  s_add_u32 s56, s55, 21504
  buffer_load_dwordx4 v231, s[16:19], s56 offen lds
  s_barrier
  s_mul_i32 s55, s90, 14
  s_add_u32 s55, s55, s52
  s_add_u32 m0, s47, 131072
  s_add_u32 s56, s55, 0
  buffer_load_dwordx4 v231, s[16:19], s56 offen lds
  s_add_u32 m0, s47, 132096
  s_add_u32 s56, s55, 7168
  buffer_load_dwordx4 v231, s[16:19], s56 offen lds
  s_add_u32 m0, s47, 133120
  s_add_u32 s56, s55, 14336
  buffer_load_dwordx4 v231, s[16:19], s56 offen lds
  s_add_u32 m0, s47, 134144
  s_add_u32 s56, s55, 21504
  buffer_load_dwordx4 v231, s[16:19], s56 offen lds
  s_mul_i32 s55, s91, 14
  s_add_u32 s55, s55, s52
  s_add_u32 m0, s47, 147456
  s_add_u32 s56, s55, 0
  buffer_load_dwordx4 v231, s[16:19], s56 offen lds
  s_add_u32 m0, s47, 148480
  s_add_u32 s56, s55, 7168
  buffer_load_dwordx4 v231, s[16:19], s56 offen lds
  s_barrier
  s_add_u32 m0, s47, 149504
  s_add_u32 s56, s55, 14336
  buffer_load_dwordx4 v231, s[16:19], s56 offen lds
  s_add_u32 m0, s47, 150528
  s_add_u32 s56, s55, 21504
  buffer_load_dwordx4 v231, s[16:19], s56 offen lds
  s_mul_i32 s55, s92, 14
  s_add_u32 s55, s55, s52
  s_add_u32 m0, s47, 16384
  s_add_u32 s56, s55, 0
  buffer_load_dwordx4 v231, s[16:19], s56 offen lds
  s_add_u32 m0, s47, 17408
  s_add_u32 s56, s55, 7168
  buffer_load_dwordx4 v231, s[16:19], s56 offen lds
  s_add_u32 m0, s47, 18432
  s_add_u32 s56, s55, 14336
  buffer_load_dwordx4 v231, s[16:19], s56 offen lds
  s_add_u32 m0, s47, 19456
  s_add_u32 s56, s55, 21504
  buffer_load_dwordx4 v231, s[16:19], s56 offen lds
  v_perm_b32 v240, v24, v24, s28
  v_perm_b32 v241, v24, v24, s30
  v_xor_b32 v240, s29, v240
  v_xor_b32 v241, s31, v241
  v_cos_f32 v25, v16
  v_sin_f32 v24, v16
  v_add_f32 v16, v16, v15
  v_cvt_pk_bf16_f32 v24, v25, v24
  v_perm_b32 v242, v24, v24, s28
  v_perm_b32 v243, v24, v24, s30
  v_xor_b32 v242, s29, v242
  v_xor_b32 v243, s31, v243
  v_cos_f32 v25, v16
  v_sin_f32 v24, v16
  v_add_f32 v16, v16, v12
  v_cvt_pk_bf16_f32 v24, v25, v24
  v_perm_b32 v244, v24, v24, s28
  v_perm_b32 v245, v24, v24, s30
  v_xor_b32 v244, s29, v244
  v_xor_b32 v245, s31, v245
  v_cos_f32 v25, v16
  v_sin_f32 v24, v16
  v_add_f32 v16, v16, v15
  v_cvt_pk_bf16_f32 v24, v25, v24
  v_perm_b32 v246, v24, v24, s28
  v_perm_b32 v247, v24, v24, s30
  v_xor_b32 v246, s29, v246
  v_xor_b32 v247, s31, v247
  v_cos_f32 v25, v16
  v_sin_f32 v24, v16
  v_add_f32 v16, v16, v12
  v_cvt_pk_bf16_f32 v24, v25, v24
  v_perm_b32 v248, v24, v24, s28
  v_perm_b32 v249, v24, v24, s30
  v_xor_b32 v248, s29, v248
  v_xor_b32 v249, s31, v249
  v_cos_f32 v25, v16
  v_sin_f32 v24, v16
  v_add_f32 v16, v16, v15
  v_cvt_pk_bf16_f32 v24, v25, v24
  v_perm_b32 v250, v24, v24, s28
  v_perm_b32 v251, v24, v24, s30
  v_xor_b32 v250, s29, v250
  v_xor_b32 v251, s31, v251
  v_cos_f32 v25, v16
  v_sin_f32 v24, v16
  v_add_f32 v16, v16, v12
  v_cvt_pk_bf16_f32 v24, v25, v24
  v_perm_b32 v252, v24, v24, s28
  v_perm_b32 v253, v24, v24, s30
  v_xor_b32 v252, s29, v252
  v_xor_b32 v253, s31, v253
  v_cos_f32 v25, v16
  v_sin_f32 v24, v16
  v_add_f32 v16, v16, v15
  v_cvt_pk_bf16_f32 v24, v25, v24
  v_perm_b32 v254, v24, v24, s28
  v_perm_b32 v255, v24, v24, s30
  v_xor_b32 v254, s29, v254
  v_xor_b32 v255, s31, v255
  s_load_dwordx8 s[28:35], s[20:21], s93 glc
  s_waitcnt vmcnt(0)
  s_barrier
  s_setprio 1
  s_mov_b32 s60, 400000
  s_mov_b32 s40, s41
  s_branch L_hrs
L_hps:
  s_sub_u32 s60, s60, 1
  s_cbranch_scc1 L_hqs
  s_load_dwordx8 s[28:35], s[20:21], s93 glc
L_hrs:
  s_waitcnt lgkmcnt(0)
  s_cmp_eq_u64 s[28:29], s[40:41]
  s_cbranch_scc0 L_hps
  s_cmp_eq_u64 s[30:31], s[40:41]
  s_cbranch_scc0 L_hps
  s_cmp_eq_u64 s[32:33], s[40:41]
  s_cbranch_scc0 L_hps
  s_cmp_eq_u32 s34, s41
  s_cbranch_scc0 L_hps
L_hqs:
  buffer_load_dwordx4 v[80:83], v220, s[20:23], s87 offen offset:0 sc1
  buffer_load_dwordx4 v[84:87], v221, s[20:23], s87 offen offset:0 sc1
  buffer_load_dwordx4 v[88:91], v220, s[20:23], s87 offen offset:2048 sc1
  buffer_load_dwordx4 v[92:95], v221, s[20:23], s87 offen offset:2048 sc1
  buffer_load_dwordx4 v[96:99], v220, s[20:23], s88 offen offset:0 sc1
  buffer_load_dwordx4 v[100:103], v221, s[20:23], s88 offen offset:0 sc1
  buffer_load_dwordx4 v[104:107], v220, s[20:23], s88 offen offset:2048 sc1
  buffer_load_dwordx4 v[108:111], v221, s[20:23], s88 offen offset:2048 sc1
  ds_read_b64_tr_b16 v[16:17], v212 offset:0
  ds_read_b64_tr_b16 v[18:19], v212 offset:2048
  ds_read_b64_tr_b16 v[20:21], v213 offset:0
  ds_read_b64_tr_b16 v[22:23], v213 offset:2048
  ds_read_b64_tr_b16 v[24:25], v214 offset:0
  ds_read_b64_tr_b16 v[26:27], v214 offset:2048
  ds_read_b64_tr_b16 v[28:29], v215 offset:0
  ds_read_b64_tr_b16 v[30:31], v215 offset:2048
  ds_read_b64_tr_b16 v[32:33], v212 offset:4096
  ds_read_b64_tr_b16 v[34:35], v212 offset:6144
  ds_read_b64_tr_b16 v[36:37], v213 offset:4096
  ds_read_b64_tr_b16 v[38:39], v213 offset:6144
  ds_read_b64_tr_b16 v[40:41], v214 offset:4096
  ds_read_b64_tr_b16 v[42:43], v214 offset:6144
  ds_read_b64_tr_b16 v[44:45], v215 offset:4096
  ds_read_b64_tr_b16 v[46:47], v215 offset:6144
  ds_read_b32 v3, v1 offset:56332
  ds_read_b128 v[176:179], v226 offset:0
  ds_read_b128 v[180:183], v226 offset:1024
  ds_read_b128 v[184:187], v226 offset:2048
  ds_read_b128 v[188:191], v226 offset:3072
  s_lshl_b32 s45, 1, s59
  s_waitcnt lgkmcnt(0)
  v_cmp_ne_u32 vcc, s41, v3
  s_and_b32 s61, vcc_lo, s45
  s_cbranch_scc0 L_fo_ok
  s_mov_b32 s60, 400000
L_fo:
  s_sleep 1
  ds_read_b32 v3, v1 offset:56332
  s_waitcnt lgkmcnt(0)
  v_cmp_ne_u32 vcc, s41, v3
  s_and_b32 s61, vcc_lo, s45
  s_cbranch_scc0 L_fo_go
  s_sub_u32 s60, s60, 1
  s_cbranch_scc0 L_fo
L_fo_go:
  ds_read_b128 v[176:179], v226 offset:0
  ds_read_b128 v[180:183], v226 offset:1024
  ds_read_b128 v[184:187], v226 offset:2048
  ds_read_b128 v[188:191], v226 offset:3072
  s_waitcnt lgkmcnt(0)
L_fo_ok:
  v_mfma_f32_16x16x32_bf16 v[144:147], v[16:19], v[176:179], 0
  v_mfma_f32_16x16x32_bf16 v[152:155], v[20:23], v[176:179], 0
  v_mfma_f32_16x16x32_bf16 v[160:163], v[24:27], v[176:179], 0
  v_mfma_f32_16x16x32_bf16 v[168:171], v[28:31], v[176:179], 0
  v_mfma_f32_16x16x32_bf16 v[148:151], v[16:19], v[180:183], 0
  v_mfma_f32_16x16x32_bf16 v[156:159], v[20:23], v[180:183], 0
  v_mfma_f32_16x16x32_bf16 v[164:167], v[24:27], v[180:183], 0
  v_mfma_f32_16x16x32_bf16 v[172:175], v[28:31], v[180:183], 0
  v_mfma_f32_16x16x32_bf16 v[144:147], v[32:35], v[184:187], v[144:147]
  v_mfma_f32_16x16x32_bf16 v[152:155], v[36:39], v[184:187], v[152:155]
  v_mfma_f32_16x16x32_bf16 v[160:163], v[40:43], v[184:187], v[160:163]
  v_mfma_f32_16x16x32_bf16 v[168:171], v[44:47], v[184:187], v[168:171]
  v_mfma_f32_16x16x32_bf16 v[148:151], v[32:35], v[188:191], v[148:151]
  v_mfma_f32_16x16x32_bf16 v[156:159], v[36:39], v[188:191], v[156:159]
  v_mfma_f32_16x16x32_bf16 v[164:167], v[40:43], v[188:191], v[164:167]
  v_mfma_f32_16x16x32_bf16 v[172:175], v[44:47], v[188:191], v[172:175]
  ds_read_b64_tr_b16 v[48:49], v212 offset:16384
  ds_read_b64_tr_b16 v[50:51], v212 offset:18432
  ds_read_b64_tr_b16 v[52:53], v213 offset:16384
  ds_read_b64_tr_b16 v[54:55], v213 offset:18432
  ds_read_b64_tr_b16 v[56:57], v214 offset:16384
  ds_read_b64_tr_b16 v[58:59], v214 offset:18432
  ds_read_b64_tr_b16 v[60:61], v215 offset:16384
  ds_read_b64_tr_b16 v[62:63], v215 offset:18432
  ds_read_b64_tr_b16 v[16:17], v212 offset:20480
  ds_read_b64_tr_b16 v[18:19], v212 offset:22528
  ds_read_b64_tr_b16 v[20:21], v213 offset:20480
  ds_read_b64_tr_b16 v[22:23], v213 offset:22528
  ds_read_b64_tr_b16 v[24:25], v214 offset:20480
  ds_read_b64_tr_b16 v[26:27], v214 offset:22528
  ds_read_b64_tr_b16 v[28:29], v215 offset:20480
  ds_read_b64_tr_b16 v[30:31], v215 offset:22528
  s_waitcnt lgkmcnt(8)
  s_waitcnt vmcnt(7)
  v_mfma_f32_16x16x32_bf16 v[144:147], v[48:51], v[80:83], v[144:147]
  ds_read_b64_tr_b16 v[32:33], v212 offset:32768
  v_mfma_f32_16x16x32_bf16 v[152:155], v[52:55], v[80:83], v[152:155]
  ds_read_b64_tr_b16 v[34:35], v212 offset:34816
  v_mfma_f32_16x16x32_bf16 v[160:163], v[56:59], v[80:83], v[160:163]
  ds_read_b64_tr_b16 v[36:37], v213 offset:32768
  v_mfma_f32_16x16x32_bf16 v[168:171], v[60:63], v[80:83], v[168:171]
  ds_read_b64_tr_b16 v[38:39], v213 offset:34816
  buffer_load_dwordx4 v[112:115], v220, s[20:23], s89 offen offset:0 sc1
  buffer_load_dwordx4 v[116:119], v221, s[20:23], s89 offen offset:0 sc1
  s_waitcnt vmcnt(8)
  v_mfma_f32_16x16x32_bf16 v[172:175], v[60:63], v[84:87], v[172:175]
  ds_read_b64_tr_b16 v[40:41], v214 offset:32768
  v_mfma_f32_16x16x32_bf16 v[164:167], v[56:59], v[84:87], v[164:167]
  ds_read_b64_tr_b16 v[42:43], v214 offset:34816
  v_mfma_f32_16x16x32_bf16 v[156:159], v[52:55], v[84:87], v[156:159]
  ds_read_b64_tr_b16 v[44:45], v215 offset:32768
  v_mfma_f32_16x16x32_bf16 v[148:151], v[48:51], v[84:87], v[148:151]
  ds_read_b64_tr_b16 v[46:47], v215 offset:34816
  buffer_load_dwordx4 v[120:123], v220, s[20:23], s89 offen offset:2048 sc1
  buffer_load_dwordx4 v[124:127], v221, s[20:23], s89 offen offset:2048 sc1
  s_waitcnt lgkmcnt(8)
  s_waitcnt vmcnt(9)
  v_mfma_f32_16x16x32_bf16 v[144:147], v[16:19], v[88:91], v[144:147]
  ds_read_b64_tr_b16 v[48:49], v212 offset:36864
  v_mfma_f32_16x16x32_bf16 v[152:155], v[20:23], v[88:91], v[152:155]
  ds_read_b64_tr_b16 v[50:51], v212 offset:38912
  v_mfma_f32_16x16x32_bf16 v[160:163], v[24:27], v[88:91], v[160:163]
  ds_read_b64_tr_b16 v[52:53], v213 offset:36864
  v_mfma_f32_16x16x32_bf16 v[168:171], v[28:31], v[88:91], v[168:171]
  ds_read_b64_tr_b16 v[54:55], v213 offset:38912
  buffer_load_dwordx4 v[128:131], v220, s[20:23], s90 offen offset:0 sc1
  s_waitcnt vmcnt(9)
  v_mfma_f32_16x16x32_bf16 v[172:175], v[28:31], v[92:95], v[172:175]
  ds_read_b64_tr_b16 v[56:57], v214 offset:36864
  v_mfma_f32_16x16x32_bf16 v[164:167], v[24:27], v[92:95], v[164:167]
  ds_read_b64_tr_b16 v[58:59], v214 offset:38912
  v_mfma_f32_16x16x32_bf16 v[156:159], v[20:23], v[92:95], v[156:159]
  ds_read_b64_tr_b16 v[60:61], v215 offset:36864
  v_mfma_f32_16x16x32_bf16 v[148:151], v[16:19], v[92:95], v[148:151]
  ds_read_b64_tr_b16 v[62:63], v215 offset:38912
  buffer_load_dwordx4 v[132:135], v221, s[20:23], s90 offen offset:0 sc1
  s_waitcnt lgkmcnt(8)
  s_waitcnt vmcnt(9)
  v_mfma_f32_16x16x32_bf16 v[144:147], v[32:35], v[96:99], v[144:147]
  ds_read_b64_tr_b16 v[16:17], v212 offset:49152
  v_mfma_f32_16x16x32_bf16 v[152:155], v[36:39], v[96:99], v[152:155]
  ds_read_b64_tr_b16 v[18:19], v212 offset:51200
  v_mfma_f32_16x16x32_bf16 v[160:163], v[40:43], v[96:99], v[160:163]
  ds_read_b64_tr_b16 v[20:21], v213 offset:49152
  v_mfma_f32_16x16x32_bf16 v[168:171], v[44:47], v[96:99], v[168:171]
  ds_read_b64_tr_b16 v[22:23], v213 offset:51200
  buffer_load_dwordx4 v[136:139], v220, s[20:23], s90 offen offset:2048 sc1
  s_waitcnt vmcnt(9)
  v_mfma_f32_16x16x32_bf16 v[172:175], v[44:47], v[100:103], v[172:175]
  ds_read_b64_tr_b16 v[24:25], v214 offset:49152
  v_mfma_f32_16x16x32_bf16 v[164:167], v[40:43], v[100:103], v[164:167]
  ds_read_b64_tr_b16 v[26:27], v214 offset:51200
  v_mfma_f32_16x16x32_bf16 v[156:159], v[36:39], v[100:103], v[156:159]
  ds_read_b64_tr_b16 v[28:29], v215 offset:49152
  v_mfma_f32_16x16x32_bf16 v[148:151], v[32:35], v[100:103], v[148:151]
  ds_read_b64_tr_b16 v[30:31], v215 offset:51200
  buffer_load_dwordx4 v[140:143], v221, s[20:23], s90 offen offset:2048 sc1
  s_waitcnt lgkmcnt(8)
  s_waitcnt vmcnt(9)
  v_mfma_f32_16x16x32_bf16 v[144:147], v[48:51], v[104:107], v[144:147]
  ds_read_b64_tr_b16 v[32:33], v212 offset:53248
  v_mfma_f32_16x16x32_bf16 v[152:155], v[52:55], v[104:107], v[152:155]
  ds_read_b64_tr_b16 v[34:35], v212 offset:55296
  v_mfma_f32_16x16x32_bf16 v[160:163], v[56:59], v[104:107], v[160:163]
  ds_read_b64_tr_b16 v[36:37], v213 offset:53248
  v_mfma_f32_16x16x32_bf16 v[168:171], v[60:63], v[104:107], v[168:171]
  ds_read_b64_tr_b16 v[38:39], v213 offset:55296
  buffer_load_dwordx4 v[80:83], v220, s[20:23], s91 offen offset:0 sc1
  s_waitcnt vmcnt(9)
  v_mfma_f32_16x16x32_bf16 v[172:175], v[60:63], v[108:111], v[172:175]
  ds_read_b64_tr_b16 v[40:41], v214 offset:53248
  v_mfma_f32_16x16x32_bf16 v[164:167], v[56:59], v[108:111], v[164:167]
  ds_read_b64_tr_b16 v[42:43], v214 offset:55296
  v_mfma_f32_16x16x32_bf16 v[156:159], v[52:55], v[108:111], v[156:159]
  ds_read_b64_tr_b16 v[44:45], v215 offset:53248
  v_mfma_f32_16x16x32_bf16 v[148:151], v[48:51], v[108:111], v[148:151]
  ds_read_b64_tr_b16 v[46:47], v215 offset:55296
  buffer_load_dwordx4 v[84:87], v221, s[20:23], s91 offen offset:0 sc1
  s_waitcnt lgkmcnt(8)
  v_add_u32 v212, 65536, v212
  v_add_u32 v213, 65536, v213
  v_add_u32 v214, 65536, v214
  v_add_u32 v215, 65536, v215
  s_waitcnt vmcnt(9)
  v_mfma_f32_16x16x32_bf16 v[144:147], v[16:19], v[112:115], v[144:147]
  ds_read_b64_tr_b16 v[48:49], v212 offset:0
  v_mfma_f32_16x16x32_bf16 v[152:155], v[20:23], v[112:115], v[152:155]
  ds_read_b64_tr_b16 v[50:51], v212 offset:2048
  v_mfma_f32_16x16x32_bf16 v[160:163], v[24:27], v[112:115], v[160:163]
  ds_read_b64_tr_b16 v[52:53], v213 offset:0
  v_mfma_f32_16x16x32_bf16 v[168:171], v[28:31], v[112:115], v[168:171]
  ds_read_b64_tr_b16 v[54:55], v213 offset:2048
  buffer_load_dwordx4 v[88:91], v220, s[20:23], s91 offen offset:2048 sc1
  s_waitcnt vmcnt(9)
  v_mfma_f32_16x16x32_bf16 v[172:175], v[28:31], v[116:119], v[172:175]
  ds_read_b64_tr_b16 v[56:57], v214 offset:0
  v_mfma_f32_16x16x32_bf16 v[164:167], v[24:27], v[116:119], v[164:167]
  ds_read_b64_tr_b16 v[58:59], v214 offset:2048
  v_mfma_f32_16x16x32_bf16 v[156:159], v[20:23], v[116:119], v[156:159]
  ds_read_b64_tr_b16 v[60:61], v215 offset:0
  v_mfma_f32_16x16x32_bf16 v[148:151], v[16:19], v[116:119], v[148:151]
  ds_read_b64_tr_b16 v[62:63], v215 offset:2048
  buffer_load_dwordx4 v[92:95], v221, s[20:23], s91 offen offset:2048 sc1
  s_waitcnt lgkmcnt(8)
  s_waitcnt vmcnt(9)
  v_mfma_f32_16x16x32_bf16 v[144:147], v[32:35], v[120:123], v[144:147]
  ds_read_b64_tr_b16 v[16:17], v212 offset:4096
  v_mfma_f32_16x16x32_bf16 v[152:155], v[36:39], v[120:123], v[152:155]
  ds_read_b64_tr_b16 v[18:19], v212 offset:6144
  v_mfma_f32_16x16x32_bf16 v[160:163], v[40:43], v[120:123], v[160:163]
  ds_read_b64_tr_b16 v[20:21], v213 offset:4096
  v_mfma_f32_16x16x32_bf16 v[168:171], v[44:47], v[120:123], v[168:171]
  ds_read_b64_tr_b16 v[22:23], v213 offset:6144
  buffer_load_dwordx4 v[96:99], v221, s[20:23], s92 offen offset:0 sc1
  s_waitcnt vmcnt(9)
  v_mfma_f32_16x16x32_bf16 v[172:175], v[44:47], v[124:127], v[172:175]
  ds_read_b64_tr_b16 v[24:25], v214 offset:4096
  v_mfma_f32_16x16x32_bf16 v[164:167], v[40:43], v[124:127], v[164:167]
  ds_read_b64_tr_b16 v[26:27], v214 offset:6144
  v_mfma_f32_16x16x32_bf16 v[156:159], v[36:39], v[124:127], v[156:159]
  ds_read_b64_tr_b16 v[28:29], v215 offset:4096
  v_mfma_f32_16x16x32_bf16 v[148:151], v[32:35], v[124:127], v[148:151]
  ds_read_b64_tr_b16 v[30:31], v215 offset:6144
  buffer_load_dwordx4 v[100:103], v221, s[20:23], s92 offen offset:2048 sc1
  s_waitcnt lgkmcnt(8)
  s_waitcnt vmcnt(9)
  v_mfma_f32_16x16x32_bf16 v[144:147], v[48:51], v[128:131], v[144:147]
  ds_read_b64_tr_b16 v[32:33], v212 offset:16384
  v_mfma_f32_16x16x32_bf16 v[152:155], v[52:55], v[128:131], v[152:155]
  ds_read_b64_tr_b16 v[34:35], v212 offset:18432
  v_mfma_f32_16x16x32_bf16 v[160:163], v[56:59], v[128:131], v[160:163]
  ds_read_b64_tr_b16 v[36:37], v213 offset:16384
  v_mfma_f32_16x16x32_bf16 v[168:171], v[60:63], v[128:131], v[168:171]
  ds_read_b64_tr_b16 v[38:39], v213 offset:18432
  buffer_load_dwordx4 v[104:107], v220, s[20:23], s92 offen offset:0 sc1
  s_waitcnt vmcnt(9)
  v_mfma_f32_16x16x32_bf16 v[172:175], v[60:63], v[132:135], v[172:175]
  ds_read_b64_tr_b16 v[40:41], v214 offset:16384
  v_mfma_f32_16x16x32_bf16 v[164:167], v[56:59], v[132:135], v[164:167]
  ds_read_b64_tr_b16 v[42:43], v214 offset:18432
  v_mfma_f32_16x16x32_bf16 v[156:159], v[52:55], v[132:135], v[156:159]
  ds_read_b64_tr_b16 v[44:45], v215 offset:16384
  v_mfma_f32_16x16x32_bf16 v[148:151], v[48:51], v[132:135], v[148:151]
  ds_read_b64_tr_b16 v[46:47], v215 offset:18432
  buffer_load_dwordx4 v[108:111], v220, s[20:23], s92 offen offset:2048 sc1
  s_waitcnt lgkmcnt(8)
  s_waitcnt vmcnt(9)
  v_mfma_f32_16x16x32_bf16 v[144:147], v[16:19], v[136:139], v[144:147]
  ds_read_b64_tr_b16 v[48:49], v212 offset:20480
  v_mfma_f32_16x16x32_bf16 v[152:155], v[20:23], v[136:139], v[152:155]
  ds_read_b64_tr_b16 v[50:51], v212 offset:22528
  v_mfma_f32_16x16x32_bf16 v[160:163], v[24:27], v[136:139], v[160:163]
  ds_read_b64_tr_b16 v[52:53], v213 offset:20480
  v_mfma_f32_16x16x32_bf16 v[168:171], v[28:31], v[136:139], v[168:171]
  ds_read_b64_tr_b16 v[54:55], v213 offset:22528
  s_waitcnt vmcnt(8)
  v_mfma_f32_16x16x32_bf16 v[172:175], v[28:31], v[140:143], v[172:175]
  ds_read_b64_tr_b16 v[56:57], v214 offset:20480
  v_mfma_f32_16x16x32_bf16 v[164:167], v[24:27], v[140:143], v[164:167]
  ds_read_b64_tr_b16 v[58:59], v214 offset:22528
  v_mfma_f32_16x16x32_bf16 v[156:159], v[20:23], v[140:143], v[156:159]
  ds_read_b64_tr_b16 v[60:61], v215 offset:20480
  v_mfma_f32_16x16x32_bf16 v[148:151], v[16:19], v[140:143], v[148:151]
  ds_read_b64_tr_b16 v[62:63], v215 offset:22528
  s_waitcnt lgkmcnt(8)
  s_barrier
  v_add_u32 v212, 4294852608, v212
  v_add_u32 v213, 4294852608, v213
  v_add_u32 v214, 4294852608, v214
  v_add_u32 v215, 4294852608, v215
  s_waitcnt vmcnt(7)
  v_mfma_f32_16x16x32_bf16 v[144:147], v[32:35], v[80:83], v[144:147]
  ds_read_b64_tr_b16 v[16:17], v212 offset:0
  v_mfma_f32_16x16x32_bf16 v[152:155], v[36:39], v[80:83], v[152:155]
  ds_read_b64_tr_b16 v[18:19], v212 offset:2048
  v_mfma_f32_16x16x32_bf16 v[160:163], v[40:43], v[80:83], v[160:163]
  ds_read_b64_tr_b16 v[20:21], v213 offset:0
  v_mfma_f32_16x16x32_bf16 v[168:171], v[44:47], v[80:83], v[168:171]
  ds_read_b64_tr_b16 v[22:23], v213 offset:2048
  s_waitcnt vmcnt(6)
  v_mfma_f32_16x16x32_bf16 v[172:175], v[44:47], v[84:87], v[172:175]
  ds_read_b64_tr_b16 v[24:25], v214 offset:0
  v_mfma_f32_16x16x32_bf16 v[164:167], v[40:43], v[84:87], v[164:167]
  ds_read_b64_tr_b16 v[26:27], v214 offset:2048
  v_mfma_f32_16x16x32_bf16 v[156:159], v[36:39], v[84:87], v[156:159]
  ds_read_b64_tr_b16 v[28:29], v215 offset:0
  v_mfma_f32_16x16x32_bf16 v[148:151], v[32:35], v[84:87], v[148:151]
  ds_read_b64_tr_b16 v[30:31], v215 offset:2048
  s_waitcnt lgkmcnt(8)
  s_waitcnt vmcnt(5)
  v_mfma_f32_16x16x32_bf16 v[144:147], v[48:51], v[88:91], v[144:147]
  ds_read_b64_tr_b16 v[32:33], v212 offset:4096
  v_mfma_f32_16x16x32_bf16 v[152:155], v[52:55], v[88:91], v[152:155]
  ds_read_b64_tr_b16 v[34:35], v212 offset:6144
  v_mfma_f32_16x16x32_bf16 v[160:163], v[56:59], v[88:91], v[160:163]
  ds_read_b64_tr_b16 v[36:37], v213 offset:4096
  v_mfma_f32_16x16x32_bf16 v[168:171], v[60:63], v[88:91], v[168:171]
  ds_read_b64_tr_b16 v[38:39], v213 offset:6144
  s_waitcnt vmcnt(4)
  v_mfma_f32_16x16x32_bf16 v[172:175], v[60:63], v[92:95], v[172:175]
  ds_read_b64_tr_b16 v[40:41], v214 offset:4096
  v_mfma_f32_16x16x32_bf16 v[164:167], v[56:59], v[92:95], v[164:167]
  ds_read_b64_tr_b16 v[42:43], v214 offset:6144
  v_mfma_f32_16x16x32_bf16 v[156:159], v[52:55], v[92:95], v[156:159]
  ds_read_b64_tr_b16 v[44:45], v215 offset:4096
  v_mfma_f32_16x16x32_bf16 v[148:151], v[48:51], v[92:95], v[148:151]
  ds_read_b64_tr_b16 v[46:47], v215 offset:6144
  s_waitcnt lgkmcnt(8)
  s_waitcnt vmcnt(3)
  v_mfma_f32_16x16x32_bf16 v[172:175], v[28:31], v[96:99], v[172:175]
  v_mfma_f32_16x16x32_bf16 v[164:167], v[24:27], v[96:99], v[164:167]
  v_mfma_f32_16x16x32_bf16 v[156:159], v[20:23], v[96:99], v[156:159]
  v_mfma_f32_16x16x32_bf16 v[148:151], v[16:19], v[96:99], v[148:151]
  s_waitcnt lgkmcnt(0)
  s_waitcnt vmcnt(2)
  v_mfma_f32_16x16x32_bf16 v[172:175], v[44:47], v[100:103], v[172:175]
  v_mfma_f32_16x16x32_bf16 v[164:167], v[40:43], v[100:103], v[164:167]
  v_mfma_f32_16x16x32_bf16 v[156:159], v[36:39], v[100:103], v[156:159]
  v_mfma_f32_16x16x32_bf16 v[148:151], v[32:35], v[100:103], v[148:151]
  s_waitcnt vmcnt(1)
  v_mfma_f32_16x16x32_bf16 v[168:171], v[28:31], v[104:107], v[168:171]
  v_mfma_f32_16x16x32_bf16 v[160:163], v[24:27], v[104:107], v[160:163]
  v_mfma_f32_16x16x32_bf16 v[152:155], v[20:23], v[104:107], v[152:155]
  v_mfma_f32_16x16x32_bf16 v[144:147], v[16:19], v[104:107], v[144:147]
  s_waitcnt vmcnt(0)
  v_mfma_f32_16x16x32_bf16 v[168:171], v[44:47], v[108:111], v[168:171]
  ds_write_b128 v227, v[172:175] offset:3072
  v_mfma_f32_16x16x32_bf16 v[160:163], v[40:43], v[108:111], v[160:163]
  ds_write_b128 v227, v[164:167] offset:2048
  v_mfma_f32_16x16x32_bf16 v[152:155], v[36:39], v[108:111], v[152:155]
  ds_write_b128 v227, v[156:159] offset:1024
  v_mfma_f32_16x16x32_bf16 v[144:147], v[32:35], v[108:111], v[144:147]
  ds_write_b128 v227, v[148:151] offset:0
  s_mov_b64 exec, 1
  ds_write_b32 v232, v230 offset:56328
  s_mov_b64 exec, -1
  ds_read_b32 v3, v1 offset:56328
  ds_read_b128 v[176:179], v226 offset:0
  ds_read_b128 v[180:183], v226 offset:1024
  ds_read_b128 v[184:187], v226 offset:2048
  ds_read_b128 v[188:191], v226 offset:3072
  s_waitcnt lgkmcnt(0)
  v_cmp_ne_u32 vcc, s41, v3
  s_and_b32 s61, vcc_lo, s98
  s_cbranch_scc0 L_fx_ok
  s_mov_b32 s60, 400000
L_fx:
  s_sleep 1
  ds_read_b32 v3, v1 offset:56328
  s_waitcnt lgkmcnt(0)
  v_cmp_ne_u32 vcc, s41, v3
  s_and_b32 s61, vcc_lo, s98
  s_cbranch_scc0 L_fx_go
  s_sub_u32 s60, s60, 1
  s_cbranch_scc0 L_fx
L_fx_go:
  ds_read_b128 v[176:179], v226 offset:0
  ds_read_b128 v[180:183], v226 offset:1024
  ds_read_b128 v[184:187], v226 offset:2048
  ds_read_b128 v[188:191], v226 offset:3072
  s_waitcnt lgkmcnt(0)
L_fx_ok:
  s_load_dwordx8 s[28:35], s[20:21], s94 glc
  s_lshl_b32 s49, s59, 12
  v_add_f32 v176, v176, v144
  v_add_f32 v177, v177, v145
  v_add_f32 v178, v178, v146
  v_add_f32 v179, v179, v147
  v_add_f32 v180, v180, v152
  v_add_f32 v181, v181, v153
  v_add_f32 v182, v182, v154
  v_add_f32 v183, v183, v155
  v_cvt_pk_bf16_f32 v192, v176, v177
  v_cvt_pk_bf16_f32 v193, v178, v179
  v_cvt_pk_bf16_f32 v194, v180, v181
  v_cvt_pk_bf16_f32 v195, v182, v183
  buffer_store_dwordx4 v[192:195], v1, s[20:23], s4 offen offset:0 sc1
  v_add_f32 v184, v184, v160
  v_add_f32 v185, v185, v161
  v_add_f32 v186, v186, v162
  v_add_f32 v187, v187, v163
  v_add_f32 v188, v188, v168
  v_add_f32 v189, v189, v169
  v_add_f32 v190, v190, v170
  v_add_f32 v191, v191, v171
  v_cvt_pk_bf16_f32 v196, v184, v185
  v_cvt_pk_bf16_f32 v197, v186, v187
  v_cvt_pk_bf16_f32 v198, v188, v189
  v_cvt_pk_bf16_f32 v199, v190, v191
  buffer_store_dwordx4 v[196:199], v1, s[20:23], s4 offen offset:1024 sc1
  v_lshlrev_b32 v64, 16, v208
  v_and_b32 v65, 0xffff0000, v208
  v_lshlrev_b32 v66, 16, v209
  v_and_b32 v67, 0xffff0000, v209
  v_lshlrev_b32 v68, 16, v210
  v_and_b32 v69, 0xffff0000, v210
  v_lshlrev_b32 v70, 16, v211
  v_and_b32 v71, 0xffff0000, v211
  s_waitcnt vmcnt(0)
  s_waitcnt vmcnt(0) lgkmcnt(0)
  s_atomic_swap s41, s[20:21], s6
  s_mov_b32 s60, 400000
  s_cmp_eq_u64 s[28:29], s[40:41]
  s_cbranch_scc0 L_dp
  s_cmp_eq_u64 s[30:31], s[40:41]
  s_cbranch_scc0 L_dp
  s_cmp_eq_u64 s[32:33], s[40:41]
  s_cbranch_scc0 L_dp
  s_cmp_eq_u64 s[34:35], s[40:41]
  s_cbranch_scc0 L_dp
  s_branch L_dq
L_dp:
  s_sub_u32 s60, s60, 1
  s_cbranch_scc1 L_dq
  s_load_dwordx8 s[28:35], s[20:21], s94 glc
  s_waitcnt lgkmcnt(0)
  s_cmp_eq_u64 s[28:29], s[40:41]
  s_cbranch_scc0 L_dp
  s_cmp_eq_u64 s[30:31], s[40:41]
  s_cbranch_scc0 L_dp
  s_cmp_eq_u64 s[32:33], s[40:41]
  s_cbranch_scc0 L_dp
  s_cmp_eq_u64 s[34:35], s[40:41]
  s_cbranch_scc0 L_dp
L_dq:
  s_add_u32 m0, s49, 0
  s_add_u32 s47, s95, 0
  buffer_load_dwordx4 v224, s[20:23], s47 offen sc1 lds
  s_add_u32 m0, s49, 1024
  s_add_u32 s47, s95, 4096
  buffer_load_dwordx4 v225, s[20:23], s47 offen sc1 lds
  s_add_u32 m0, s49, 2048
  s_add_u32 s47, s95, 8192
  buffer_load_dwordx4 v224, s[20:23], s47 offen sc1 lds
  s_add_u32 m0, s49, 3072
  s_add_u32 s47, s95, 12288
  buffer_load_dwordx4 v225, s[20:23], s47 offen sc1 lds
L_dgo:
  s_load_dword s47, s[20:21], s7 glc
  s_mov_b32 s48, 10485760
  s_add_u32 m0, s49, 51200
  s_mov_b32 s60, 400000
  s_waitcnt vmcnt(0)
  s_mov_b64 exec, 1
  ds_write_b32 v232, v230 offset:56324
  s_mov_b64 exec, -1
  s_mov_b32 s60, 400000
L_pp:
  s_waitcnt lgkmcnt(0)
  s_cmp_eq_u32 s47, s41
  s_cbranch_scc1 L_pq
  s_load_dword s47, s[20:21], s7 glc
  s_sub_u32 s60, s60, 1
  s_cbranch_scc0 L_pp
L_pq:
  buffer_load_dwordx4 v1, s[20:23], s5 offen sc1 lds
  buffer_load_dwordx4 v[132:135], v1, s[20:23], s5 offen offset:1024 sc1
  s_mov_b32 s46, 0
  ds_read_b32 v3, v1 offset:56324
  s_waitcnt lgkmcnt(0)
  v_cmp_ne_u32 vcc, s41, v3
  s_and_b32 s61, vcc_lo, 15
  s_cbranch_scc0 L_fd_ok
  s_mov_b32 s60, 400000
L_fd:
  s_sleep 1
  ds_read_b32 v3, v1 offset:56324
  s_waitcnt lgkmcnt(0)
  v_cmp_ne_u32 vcc, s41, v3
  s_and_b32 s61, vcc_lo, 15
  s_cbranch_scc0 L_fd_go
  s_sub_u32 s60, s60, 1
  s_cbranch_scc0 L_fd
L_fd_go:
L_fd_ok:
  buffer_load_dword v72, v229, s[20:23], s48 offen sc1
  ds_read_b64 v[80:81], v216 offset:0
  ds_read_b64 v[82:83], v216 offset:512
  ds_read_b64 v[84:85], v217 offset:0
  ds_read_b64 v[86:87], v217 offset:512
  ds_read_b64 v[88:89], v216 offset:4096
  ds_read_b64 v[90:91], v216 offset:4608
  ds_read_b64 v[92:93], v217 offset:4096
  ds_read_b64 v[94:95], v217 offset:4608
  ds_read_b64 v[96:97], v216 offset:8192
  ds_read_b64 v[98:99], v216 offset:8704
  ds_read_b64 v[100:101], v217 offset:8192
  ds_read_b64 v[102:103], v217 offset:8704
  ds_read_b64 v[104:105], v216 offset:12288
  ds_read_b64 v[106:107], v216 offset:12800
  ds_read_b64 v[108:109], v217 offset:12288
  ds_read_b64 v[110:111], v217 offset:12800
  ds_read_b64 v[16:17], v218 offset:0
  ds_read_b64 v[18:19], v218 offset:512
  ds_read_b64 v[20:21], v219 offset:0
  ds_read_b64 v[22:23], v219 offset:512
  ds_read_b64 v[24:25], v218 offset:4096
  ds_read_b64 v[26:27], v218 offset:4608
  ds_read_b64 v[28:29], v219 offset:4096
  ds_read_b64 v[30:31], v219 offset:4608
  ds_read_b64 v[32:33], v218 offset:8192
  ds_read_b64 v[34:35], v218 offset:8704
  ds_read_b64 v[36:37], v219 offset:8192
  ds_read_b64 v[38:39], v219 offset:8704
  ds_read_b64 v[40:41], v218 offset:12288
  ds_read_b64 v[42:43], v218 offset:12800
  ds_read_b64 v[44:45], v219 offset:12288
  ds_read_b64 v[46:47], v219 offset:12800
  s_waitcnt lgkmcnt(15)
  v_mfma_f32_16x16x32_bf16 v[120:123], v[80:83], v[240:243], 0
  v_mfma_f32_16x16x32_bf16 v[124:127], v[84:87], v[240:243], 0
  v_mfma_f32_16x16x32_bf16 v[120:123], v[88:91], v[244:247], v[120:123]
  v_mfma_f32_16x16x32_bf16 v[124:127], v[92:95], v[244:247], v[124:127]
  v_mfma_f32_16x16x32_bf16 v[120:123], v[96:99], v[248:251], v[120:123]
  v_mfma_f32_16x16x32_bf16 v[124:127], v[100:103], v[248:251], v[124:127]
  v_mfma_f32_16x16x32_bf16 v[120:123], v[104:107], v[252:255], v[120:123]
  v_mfma_f32_16x16x32_bf16 v[124:127], v[108:111], v[252:255], v[124:127]
  v_xor_b32 v241, s96, v241
  v_xor_b32 v243, s96, v243
  v_xor_b32 v245, s96, v245
  v_xor_b32 v247, s96, v247
  v_xor_b32 v249, s96, v249
  v_xor_b32 v251, s96, v251
  v_xor_b32 v253, s96, v253
  v_xor_b32 v255, s96, v255
  ds_write_b128 v226, v[120:123] offset:16384
  ds_write_b128 v226, v[124:127] offset:17408
  s_waitcnt lgkmcnt(2)
  v_mfma_f32_16x16x32_bf16 v[112:115], v[16:19], v[240:243], 0
  v_mfma_f32_16x16x32_bf16 v[116:119], v[20:23], v[240:243], 0
  v_mfma_f32_16x16x32_bf16 v[112:115], v[24:27], v[244:247], v[112:115]
  v_mfma_f32_16x16x32_bf16 v[116:119], v[28:31], v[244:247], v[116:119]
  v_mfma_f32_16x16x32_bf16 v[112:115], v[32:35], v[248:251], v[112:115]
  v_mfma_f32_16x16x32_bf16 v[116:119], v[36:39], v[248:251], v[116:119]
  v_mfma_f32_16x16x32_bf16 v[112:115], v[40:43], v[252:255], v[112:115]
  v_mfma_f32_16x16x32_bf16 v[116:119], v[44:47], v[252:255], v[116:119]
  s_waitcnt vmcnt(0)
  ds_write_b32 v226, v72 offset:19456
  v_lshlrev_b32 v200, 16, v132
  v_and_b32 v201, 0xffff0000, v132
  v_lshlrev_b32 v202, 16, v133
  v_and_b32 v203, 0xffff0000, v133
  v_lshlrev_b32 v204, 16, v134
  v_and_b32 v205, 0xffff0000, v134
  v_lshlrev_b32 v206, 16, v135
  v_and_b32 v207, 0xffff0000, v135
  s_waitcnt lgkmcnt(0)
  s_barrier
  ds_read_b128 v[176:179], v226 offset:32768
  ds_read_b128 v[180:183], v226 offset:33792
  ds_read_b128 v[184:187], v226 offset:34816
  ds_read_b128 v[188:191], v226 offset:35840
  v_add_u32 v226, 32768, v226
  s_waitcnt lgkmcnt(2)
  v_pk_add_f32 v[192:193], v[200:201], v[176:177]
  v_pk_add_f32 v[194:195], v[202:203], v[178:179]
  v_pk_add_f32 v[196:197], v[204:205], v[180:181]
  v_pk_add_f32 v[198:199], v[206:207], v[182:183]
  s_waitcnt lgkmcnt(0)
  v_pk_add_f32 v[192:193], v[192:193], v[184:185]
  v_pk_add_f32 v[194:195], v[194:195], v[186:187]
  v_pk_add_f32 v[196:197], v[196:197], v[188:189]
  v_pk_add_f32 v[198:199], v[198:199], v[190:191]
L_fin:
  v_mul_f32 v74, 0xbfb8aa3b, v72
  v_pk_mul_f32 v[200:201], v[192:193], v[74:75] op_sel_hi:[1,0]
  v_pk_mul_f32 v[202:203], v[194:195], v[74:75] op_sel_hi:[1,0]
  v_pk_mul_f32 v[204:205], v[196:197], v[74:75] op_sel_hi:[1,0]
  v_pk_mul_f32 v[206:207], v[198:199], v[74:75] op_sel_hi:[1,0]
  v_exp_f32 v200, v200
  v_exp_f32 v201, v201
  v_pk_mul_f32 v[192:193], v[192:193], v[72:73] op_sel_hi:[1,0]
  v_exp_f32 v202, v202
  v_exp_f32 v203, v203
  v_pk_mul_f32 v[194:195], v[194:195], v[72:73] op_sel_hi:[1,0]
  v_exp_f32 v204, v204
  v_exp_f32 v205, v205
  v_pk_mul_f32 v[196:197], v[196:197], v[72:73] op_sel_hi:[1,0]
  v_exp_f32 v206, v206
  v_exp_f32 v207, v207
  v_pk_mul_f32 v[198:199], v[198:199], v[72:73] op_sel_hi:[1,0]
  v_pk_add_f32 v[200:201], v[200:201], 1.0 op_sel_hi:[1,0]
  v_pk_add_f32 v[202:203], v[202:203], 1.0 op_sel_hi:[1,0]
  v_pk_add_f32 v[204:205], v[204:205], 1.0 op_sel_hi:[1,0]
  v_pk_add_f32 v[206:207], v[206:207], 1.0 op_sel_hi:[1,0]
  s_waitcnt lgkmcnt(0)
  v_rcp_f32 v200, v200
  v_rcp_f32 v201, v201
  v_pk_mul_f32 v[192:193], v[192:193], v[112:113]
  v_rcp_f32 v202, v202
  v_rcp_f32 v203, v203
  v_pk_mul_f32 v[194:195], v[194:195], v[114:115]
  v_rcp_f32 v204, v204
  v_rcp_f32 v205, v205
  v_pk_mul_f32 v[196:197], v[196:197], v[116:117]
  v_rcp_f32 v206, v206
  v_rcp_f32 v207, v207
  v_pk_mul_f32 v[198:199], v[198:199], v[118:119]
  v_pk_fma_f32 v[64:65], v[192:193], v[200:201], v[64:65]
  v_pk_fma_f32 v[66:67], v[194:195], v[202:203], v[66:67]
  v_pk_fma_f32 v[68:69], v[196:197], v[204:205], v[68:69]
  v_pk_fma_f32 v[70:71], v[198:199], v[206:207], v[70:71]
  v_cvt_pk_bf16_f32 v24, v64, v65
  v_cvt_pk_bf16_f32 v25, v66, v67
  v_cvt_pk_bf16_f32 v26, v68, v69
  v_cvt_pk_bf16_f32 v27, v70, v71
  ds_write_b64 v233, v[24:25]
  ds_write_b64 v233, v[26:27] offset:32
  ds_read_b128 v[28:31], v226
  s_waitcnt lgkmcnt(0)
  buffer_store_dwordx4 v[28:31], v228, s[24:27], 0 offen
  s_or_b32 s47, s39, s38
  s_xor_b32 s46, s36, 4
  s_or_b32 s47, s47, s46
  s_cbranch_scc1 L_noep
  s_lshl_b32 s47, s37, 2
  s_add_u32 s47, s47, 10682368
  v_mov_b32 v3, 0
  s_mov_b64 exec, 1
  buffer_store_dword v230, v3, s[20:23], s47 offen
  s_mov_b64 exec, -1
L_noep:
  s_endpgm
L_mfma:
  s_getpc_b64 s[4:5]
  s_add_u32 s4, s4, dft_tables@rel32@lo+4
  s_addc_u32 s5, s5, dft_tables@rel32@hi+12
  s_mov_b32 s6, 139264
  v_lshlrev_b32 v15, 7, v0
  s_waitcnt lgkmcnt(0)
  s_cmp_eq_u32 s36, 3
  s_cbranch_scc0 L_ntmt
  s_mov_b32 exec_lo, 0x1f
  s_mov_b32 exec_hi, 0
  s_mul_i32 s61, s2, 640
  buffer_load_dword v235, v15, s[4:7], s61 offen
  s_mov_b64 exec, -1
L_ntmt:
  s_lshl_b32 s61, s37, 2
  s_add_u32 s61, s61, 10682368
  s_load_dword s41, s[20:21], s61
  s_lshr_b32 s3, s36, 2
  s_and_b32 s63, s36, 3
  s_bfe_u32 s62, s36, 0x10001
  s_and_b32 s60, s36, 1
  v_and_b32 v14, 15, v0
  v_lshrrev_b32 v13, 4, v0
  v_and_b32 v18, 1, v13
  v_and_b32 v19, 3, v0
  v_lshlrev_b32 v15, 1, v13
  v_xor_b32 v15, v15, v0
  v_and_b32 v15, 7, v15
  v_lshrrev_b32 v16, 3, v0
  v_mul_u32_u24 v16, 896, v16
  v_lshl_add_u32 v231, v15, 4, v16
  s_lshl_b32 s61, s60, 13
  s_add_u32 s61, s61, 65536
  v_lshrrev_b32 v15, 2, v0
  v_lshl_add_u32 v16, v15, 7, s61
  v_bfe_u32 v15, v0, 3, 2
  v_lshl_add_u32 v16, v15, 5, v16
  v_lshl_add_u32 v212, v19, 3, v16
  v_xor_b32 v213, 32, v212
  v_xor_b32 v214, 64, v212
  v_xor_b32 v215, 96, v212
  s_cmp_ge_u32 s38, s40
  s_cselect_b32 s45, 0, 7
  s_add_u32 s97, s38, s45
  s_sub_u32 s97, s97, s40
  s_cmp_ge_u32 s97, 5
  s_cselect_b32 s45, 5, 0
  s_sub_u32 s45, s97, s45
  s_lshl_b32 s45, s45, 4
  s_add_u32 s45, s45, s63
  s_add_u32 s45, s45, 4
  s_lshl_b32 s45, s45, 11
  s_mov_b32 s46, s3
  s_lshl_b32 s61, s46, 2
  v_lshrrev_b32 v15, 5, v0
  v_add_u32 v15, s61, v15
  v_lshrrev_b32 v16, 1, v14
  v_xor_b32 v15, v15, v16
  v_lshlrev_b32 v15, 4, v15
  v_lshl_add_u32 v15, v14, 7, v15
  v_lshl_add_u32 v15, v18, 3, v15
  v_add_u32 v222, s45, v15
  v_xor_b32 v223, 32, v222
  s_sub_u32 s45, 32, s37
  s_cmp_eq_u32 s37, 0
  s_cselect_b32 s45, 16, s45
  s_cmp_eq_u32 s39, 0
  s_cselect_b32 s42, s37, s45
  s_sub_u32 s45, 64, s42
  s_cmp_eq_u32 s42, 0
  s_cselect_b32 s45, 32, s45
  s_cmp_eq_u32 s62, 0
  s_cselect_b32 s44, s42, s45
  s_lshl_b32 s45, s60, 10
  s_add_u32 s44, s44, s45
  v_add_u32 v220, s45, v1
  v_xor_b32 v221, 1024, v220
  s_lshl_b32 s45, s38, 1
  s_add_u32 s45, s45, s46
  s_lshl_b32 s45, s45, 6
  v_lshrrev_b32 v15, 2, v0
  v_lshl_add_u32 v15, v15, 6, s44
  v_mul_u32_u24 v228, 896, v15
  v_lshl_add_u32 v228, v19, 4, v228
  v_add_u32 v228, s45, v228
  s_lshl_b32 s45, s63, 12
  s_add_u32 s45, s45, 32768
  v_add_u32 v226, s45, v1
  v_xor_b32 v227, 4096, v226
  s_lshl_b32 s45, s63, 4
  v_mov_b32 v232, s45
  s_xor_b32 s45, s63, 1
  s_lshl_b32 s98, 1, s45
  s_xor_b32 s45, s36, 4
  s_lshl_b32 s45, s45, 12
  s_add_u32 s45, s45, 65536
  v_lshlrev_b32 v15, 6, v14
  v_lshl_add_u32 v15, v13, 3, v15
  v_add_u32 v233, s45, v15
  s_xor_b32 s45, s46, s39
  s_lshl_b32 s61, s37, 1
  s_add_u32 s45, s45, s61
  s_lshl_b32 s45, s45, 1
  s_add_u32 s45, s45, s62
  s_lshl_b32 s45, s45, 1
  s_add_u32 s45, s45, s39
  s_lshl_b32 s93, s45, 1
  s_add_u32 s93, s93, s60
  s_lshl_b32 s93, s93, 7
  s_add_u32 s93, s93, 10747904
  s_mul_i32 s44, s45, 14
  s_add_u32 s44, s44, s60
  s_lshl_b32 s44, s44, 12
  s_mul_i32 s86, s38, 8192
  s_add_u32 s86, s86, s44
  s_cmp_gt_u32 s38, 0
  s_cselect_b32 s87, 0, 1
  s_mul_i32 s87, s87, 8192
  s_add_u32 s87, s87, s44
  s_cmp_gt_u32 s38, 1
  s_cselect_b32 s88, 1, 2
  s_mul_i32 s88, s88, 8192
  s_add_u32 s88, s88, s44
  s_cmp_gt_u32 s38, 2
  s_cselect_b32 s89, 2, 3
  s_mul_i32 s89, s89, 8192
  s_add_u32 s89, s89, s44
  s_cmp_gt_u32 s38, 3
  s_cselect_b32 s90, 3, 4
  s_mul_i32 s90, s90, 8192
  s_add_u32 s90, s90, s44
  s_cmp_gt_u32 s38, 4
  s_cselect_b32 s91, 4, 5
  s_mul_i32 s91, s91, 8192
  s_add_u32 s91, s91, s44
  s_cmp_gt_u32 s38, 5
  s_cselect_b32 s92, 5, 6
  s_mul_i32 s92, s92, 8192
  s_add_u32 s92, s92, s44
  s_lshr_b32 s47, s36, 1
  s_and_b32 s48, s36, 1
  v_lshrrev_b32 v15, 1, v14
  v_xor_b32 v15, v15, v13
  v_lshlrev_b32 v15, 4, v15
  v_lshl_add_u32 v15, v14, 7, v15
  s_lshl_b32 s49, s36, 11
  v_add_u32 v4, s49, v15
  v_xor_b32 v5, 64, v4
  v_xor_b32 v6, 2048, v4
  v_xor_b32 v7, 2048, v5
  v_bfe_u32 v15, v0, 2, 2
  v_lshl_add_u32 v16, v13, 3, v15
  v_lshlrev_b32 v16, 8, v16
  v_lshl_or_b32 v15, v15, 1, v18
  s_lshl_b32 s49, s48, 1
  s_add_u32 s49, s49, s47
  s_lshl_b32 s50, s49, 1
  v_xor_b32 v15, s50, v15
  v_lshl_add_u32 v16, v15, 5, v16
  v_lshl_add_u32 v16, v19, 3, v16
  v_add_u32 v8, 16384, v16
  v_xor_b32 v9, 32, v8
  v_xor_b32 v10, 64, v8
  v_xor_b32 v11, 96, v8
  v_cmp_eq_u32 vcc, 0, v14
  v_mov_b32 v16, 0x3f803f80
  v_mov_b32 v17, 0
  v_cndmask_b32 v160, v17, v16, vcc
  v_mov_b32 v161, v160
  v_mov_b32 v162, v160
  v_mov_b32 v163, v160
  s_lshl_b32 s50, s36, 12
  s_add_u32 s50, s50, 50176
  v_lshl_add_u32 v12, v0, 2, s50
  v_xor_b32 v14, 4096, v12
  v_xor_b32 v15, 8192, v12
  s_lshl_b32 s52, s37, 1
  s_add_u32 s52, s52, s39
  s_xor_b32 s52, s52, 1
  s_lshl_b32 s52, s52, 1
  s_add_u32 s52, s52, s47
  s_mul_i32 s53, s39, 7
  s_add_u32 s53, s53, s38
  s_lshl_b32 s53, s53, 1
  s_add_u32 s53, s53, s48
  s_mul_i32 s54, s52, 28
  s_add_u32 s54, s54, s53
  s_lshl_b32 s54, s54, 2
  s_add_u32 s54, s54, s36
  s_lshl_b32 s54, s54, 10
  s_xor_b32 s55, s54, 1024
  s_xor_b32 s56, s54, 2048
  s_xor_b32 s57, s54, 3072
  s_lshl_b32 s50, s39, 1
  s_add_u32 s50, s50, s48
  s_lshl_b32 s50, s50, 5
  s_add_u32 s50, s50, s38
  s_lshl_b32 s50, s50, 2
  s_lshl_b32 s52, s52, 9
  s_add_u32 s52, s52, s50
  s_add_u32 s52, s52, 10747904
  s_xor_b32 s53, s52, 1024
  s_lshl_b32 s58, s39, 1
  s_sub_u32 s58, s58, 1
  s_mul_i32 s58, s58, 229376
  s_mov_b32 s50, 0
  s_waitcnt lgkmcnt(0)
  s_mul_i32 s41, s41, 0x9E3779B1
  s_add_u32 s41, s41, 0x7F4A7C15
  v_mov_b32 v230, s41
  s_mov_b32 s50, 0xffff0000
  v_mov_b32 v241, 0
  v_mov_b32 v243, 0
  v_mov_b32 v245, 0
  v_mov_b32 v247, 0
  v_mov_b32 v249, 0
  v_mov_b32 v251, 0
  s_barrier
  ds_read_b128 v[16:19], v4 offset:0
  ds_read_b64_tr_b16 v[32:33], v8 offset:0
  ds_read_b64_tr_b16 v[34:35], v8 offset:1024
  ds_read_b128 v[24:27], v6 offset:0
  ds_read_b128 v[20:23], v4 offset:8192
  ds_read_b128 v[28:31], v6 offset:8192
  ds_read_b64_tr_b16 v[36:37], v9 offset:0
  ds_read_b64_tr_b16 v[38:39], v9 offset:1024
  ds_read_b64_tr_b16 v[40:41], v10 offset:0
  ds_read_b64_tr_b16 v[42:43], v10 offset:1024
  ds_read_b64_tr_b16 v[44:45], v11 offset:0
  ds_read_b64_tr_b16 v[46:47], v11 offset:1024
  s_cmp_eq_u32 s97, 0
  s_cbranch_scc0 L_nxm0
  ds_read_b64 v[208:209], v222
  ds_read_b64 v[210:211], v223
L_nxm0:
  s_waitcnt lgkmcnt(0)
  v_mfma_f32_16x16x32_bf16 v[80:83], v[32:35], v[16:19], 0
  ds_read_b128 v[48:51], v5 offset:0
  v_mfma_f32_16x16x32_bf16 v[88:91], v[32:35], v[24:27], 0
  ds_read_b64_tr_b16 v[64:65], v8 offset:8192
  v_mfma_f32_16x16x32_bf16 v[84:87], v[32:35], v[20:23], 0
  ds_read_b64_tr_b16 v[66:67], v8 offset:9216
  v_mfma_f32_16x16x32_bf16 v[92:95], v[32:35], v[28:31], 0
  ds_read_b128 v[56:59], v7 offset:0
  v_mfma_f32_16x16x32_bf16 v[108:111], v[36:39], v[28:31], 0
  ds_read_b128 v[52:55], v5 offset:8192
  v_mfma_f32_16x16x32_bf16 v[100:103], v[36:39], v[20:23], 0
  ds_read_b128 v[60:63], v7 offset:8192
  v_mfma_f32_16x16x32_bf16 v[104:107], v[36:39], v[24:27], 0
  ds_read_b64_tr_b16 v[68:69], v9 offset:8192
  v_mfma_f32_16x16x32_bf16 v[96:99], v[36:39], v[16:19], 0
  ds_read_b64_tr_b16 v[70:71], v9 offset:9216
  v_mfma_f32_16x16x32_bf16 v[112:115], v[40:43], v[16:19], 0
  ds_read_b64_tr_b16 v[72:73], v10 offset:8192
  v_mfma_f32_16x16x32_bf16 v[120:123], v[40:43], v[24:27], 0
  ds_read_b64_tr_b16 v[74:75], v10 offset:9216
  v_mfma_f32_16x16x32_bf16 v[116:119], v[40:43], v[20:23], 0
  ds_read_b64_tr_b16 v[76:77], v11 offset:8192
  v_mfma_f32_16x16x32_bf16 v[124:127], v[40:43], v[28:31], 0
  ds_read_b64_tr_b16 v[78:79], v11 offset:9216
  v_mfma_f32_16x16x32_bf16 v[140:143], v[44:47], v[28:31], 0
  v_mfma_f32_16x16x32_bf16 v[132:135], v[44:47], v[20:23], 0
  v_mfma_f32_16x16x32_bf16 v[136:139], v[44:47], v[24:27], 0
  v_mfma_f32_16x16x32_bf16 v[128:131], v[44:47], v[16:19], 0
  v_mfma_f32_16x16x32_bf16 v[144:147], v[160:163], v[16:19], 0
  v_mfma_f32_16x16x32_bf16 v[148:151], v[160:163], v[20:23], 0
  v_mfma_f32_16x16x32_bf16 v[152:155], v[160:163], v[32:35], 0
  v_mfma_f32_16x16x32_bf16 v[156:159], v[160:163], v[36:39], 0
  s_waitcnt lgkmcnt(0)
  v_mfma_f32_16x16x32_bf16 v[80:83], v[64:67], v[48:51], v[80:83]
  v_mfma_f32_16x16x32_bf16 v[88:91], v[64:67], v[56:59], v[88:91]
  v_mfma_f32_16x16x32_bf16 v[84:87], v[64:67], v[52:55], v[84:87]
  v_mfma_f32_16x16x32_bf16 v[92:95], v[64:67], v[60:63], v[92:95]
  v_mfma_f32_16x16x32_bf16 v[108:111], v[68:71], v[60:63], v[108:111]
  v_mfma_f32_16x16x32_bf16 v[100:103], v[68:71], v[52:55], v[100:103]
  v_mfma_f32_16x16x32_bf16 v[104:107], v[68:71], v[56:59], v[104:107]
  s_barrier
  v_mfma_f32_16x16x32_bf16 v[96:99], v[68:71], v[48:51], v[96:99]
  ds_read_b128 v[16:19], v4 offset:32768
  v_mfma_f32_16x16x32_bf16 v[112:115], v[72:75], v[48:51], v[112:115]
  ds_read_b64_tr_b16 v[32:33], v8 offset:32768
  v_mfma_f32_16x16x32_bf16 v[120:123], v[72:75], v[56:59], v[120:123]
  ds_read_b64_tr_b16 v[34:35], v8 offset:33792
  v_mfma_f32_16x16x32_bf16 v[116:119], v[72:75], v[52:55], v[116:119]
  ds_read_b128 v[24:27], v6 offset:32768
  v_mfma_f32_16x16x32_bf16 v[124:127], v[72:75], v[60:63], v[124:127]
  ds_read_b128 v[20:23], v4 offset:40960
  v_mfma_f32_16x16x32_bf16 v[140:143], v[76:79], v[60:63], v[140:143]
  ds_read_b128 v[28:31], v6 offset:40960
  v_mfma_f32_16x16x32_bf16 v[132:135], v[76:79], v[52:55], v[132:135]
  ds_read_b64_tr_b16 v[36:37], v9 offset:32768
  v_mfma_f32_16x16x32_bf16 v[136:139], v[76:79], v[56:59], v[136:139]
  ds_read_b64_tr_b16 v[38:39], v9 offset:33792
  v_mfma_f32_16x16x32_bf16 v[128:131], v[76:79], v[48:51], v[128:131]
  ds_read_b64_tr_b16 v[40:41], v10 offset:32768
  v_mfma_f32_16x16x32_bf16 v[144:147], v[160:163], v[48:51], v[144:147]
  ds_read_b64_tr_b16 v[42:43], v10 offset:33792
  v_mfma_f32_16x16x32_bf16 v[148:151], v[160:163], v[52:55], v[148:151]
  ds_read_b64_tr_b16 v[44:45], v11 offset:32768
  v_mfma_f32_16x16x32_bf16 v[152:155], v[160:163], v[64:67], v[152:155]
  ds_read_b64_tr_b16 v[46:47], v11 offset:33792
  v_mfma_f32_16x16x32_bf16 v[156:159], v[160:163], v[68:71], v[156:159]
  s_cmp_eq_u32 s97, 1
  s_cbranch_scc0 L_nxm2
  ds_read_b64 v[208:209], v222
  ds_read_b64 v[210:211], v223
L_nxm2:
  s_waitcnt lgkmcnt(0)
  v_mfma_f32_16x16x32_bf16 v[80:83], v[32:35], v[16:19], v[80:83]
  ds_read_b128 v[48:51], v5 offset:32768
  v_mfma_f32_16x16x32_bf16 v[88:91], v[32:35], v[24:27], v[88:91]
  ds_read_b64_tr_b16 v[64:65], v8 offset:40960
  v_mfma_f32_16x16x32_bf16 v[84:87], v[32:35], v[20:23], v[84:87]
  ds_read_b64_tr_b16 v[66:67], v8 offset:41984
  v_mfma_f32_16x16x32_bf16 v[92:95], v[32:35], v[28:31], v[92:95]
  ds_read_b128 v[56:59], v7 offset:32768
  v_mfma_f32_16x16x32_bf16 v[108:111], v[36:39], v[28:31], v[108:111]
  ds_read_b128 v[52:55], v5 offset:40960
  v_mfma_f32_16x16x32_bf16 v[100:103], v[36:39], v[20:23], v[100:103]
  ds_read_b128 v[60:63], v7 offset:40960
  v_mfma_f32_16x16x32_bf16 v[104:107], v[36:39], v[24:27], v[104:107]
  ds_read_b64_tr_b16 v[68:69], v9 offset:40960
  v_mfma_f32_16x16x32_bf16 v[96:99], v[36:39], v[16:19], v[96:99]
  ds_read_b64_tr_b16 v[70:71], v9 offset:41984
  v_mfma_f32_16x16x32_bf16 v[112:115], v[40:43], v[16:19], v[112:115]
  ds_read_b64_tr_b16 v[72:73], v10 offset:40960
  v_mfma_f32_16x16x32_bf16 v[120:123], v[40:43], v[24:27], v[120:123]
  ds_read_b64_tr_b16 v[74:75], v10 offset:41984
  v_mfma_f32_16x16x32_bf16 v[116:119], v[40:43], v[20:23], v[116:119]
  ds_read_b64_tr_b16 v[76:77], v11 offset:40960
  v_mfma_f32_16x16x32_bf16 v[124:127], v[40:43], v[28:31], v[124:127]
  ds_read_b64_tr_b16 v[78:79], v11 offset:41984
  v_mfma_f32_16x16x32_bf16 v[140:143], v[44:47], v[28:31], v[140:143]
  v_mfma_f32_16x16x32_bf16 v[132:135], v[44:47], v[20:23], v[132:135]
  v_mfma_f32_16x16x32_bf16 v[136:139], v[44:47], v[24:27], v[136:139]
  v_mfma_f32_16x16x32_bf16 v[128:131], v[44:47], v[16:19], v[128:131]
  v_mfma_f32_16x16x32_bf16 v[144:147], v[160:163], v[16:19], v[144:147]
  v_mfma_f32_16x16x32_bf16 v[148:151], v[160:163], v[20:23], v[148:151]
  v_mfma_f32_16x16x32_bf16 v[152:155], v[160:163], v[32:35], v[152:155]
  v_mfma_f32_16x16x32_bf16 v[156:159], v[160:163], v[36:39], v[156:159]
  s_waitcnt lgkmcnt(0)
  v_mfma_f32_16x16x32_bf16 v[80:83], v[64:67], v[48:51], v[80:83]
  v_mfma_f32_16x16x32_bf16 v[88:91], v[64:67], v[56:59], v[88:91]
  v_mfma_f32_16x16x32_bf16 v[84:87], v[64:67], v[52:55], v[84:87]
  v_mfma_f32_16x16x32_bf16 v[92:95], v[64:67], v[60:63], v[92:95]
  v_mfma_f32_16x16x32_bf16 v[108:111], v[68:71], v[60:63], v[108:111]
  v_mfma_f32_16x16x32_bf16 v[100:103], v[68:71], v[52:55], v[100:103]
  v_mfma_f32_16x16x32_bf16 v[104:107], v[68:71], v[56:59], v[104:107]
  v_add_u32 v4, 65536, v4
  v_add_u32 v5, 65536, v5
  v_add_u32 v6, 65536, v6
  v_add_u32 v7, 65536, v7
  v_add_u32 v8, 65536, v8
  v_add_u32 v9, 65536, v9
  v_add_u32 v10, 65536, v10
  v_add_u32 v11, 65536, v11
  s_barrier
  v_mfma_f32_16x16x32_bf16 v[96:99], v[68:71], v[48:51], v[96:99]
  ds_read_b128 v[16:19], v4 offset:0
  v_mfma_f32_16x16x32_bf16 v[112:115], v[72:75], v[48:51], v[112:115]
  ds_read_b64_tr_b16 v[32:33], v8 offset:0
  v_mfma_f32_16x16x32_bf16 v[120:123], v[72:75], v[56:59], v[120:123]
  ds_read_b64_tr_b16 v[34:35], v8 offset:1024
  v_mfma_f32_16x16x32_bf16 v[116:119], v[72:75], v[52:55], v[116:119]
  ds_read_b128 v[24:27], v6 offset:0
  v_mfma_f32_16x16x32_bf16 v[124:127], v[72:75], v[60:63], v[124:127]
  ds_read_b128 v[20:23], v4 offset:8192
  v_mfma_f32_16x16x32_bf16 v[140:143], v[76:79], v[60:63], v[140:143]
  ds_read_b128 v[28:31], v6 offset:8192
  v_mfma_f32_16x16x32_bf16 v[132:135], v[76:79], v[52:55], v[132:135]
  ds_read_b64_tr_b16 v[36:37], v9 offset:0
  v_mfma_f32_16x16x32_bf16 v[136:139], v[76:79], v[56:59], v[136:139]
  ds_read_b64_tr_b16 v[38:39], v9 offset:1024
  v_mfma_f32_16x16x32_bf16 v[128:131], v[76:79], v[48:51], v[128:131]
  ds_read_b64_tr_b16 v[40:41], v10 offset:0
  v_mfma_f32_16x16x32_bf16 v[144:147], v[160:163], v[48:51], v[144:147]
  ds_read_b64_tr_b16 v[42:43], v10 offset:1024
  v_mfma_f32_16x16x32_bf16 v[148:151], v[160:163], v[52:55], v[148:151]
  ds_read_b64_tr_b16 v[44:45], v11 offset:0
  v_mfma_f32_16x16x32_bf16 v[152:155], v[160:163], v[64:67], v[152:155]
  ds_read_b64_tr_b16 v[46:47], v11 offset:1024
  v_mfma_f32_16x16x32_bf16 v[156:159], v[160:163], v[68:71], v[156:159]
  s_cmp_eq_u32 s97, 2
  s_cbranch_scc0 L_nxm4
  ds_read_b64 v[208:209], v222
  ds_read_b64 v[210:211], v223
L_nxm4:
  s_waitcnt lgkmcnt(0)
  v_mfma_f32_16x16x32_bf16 v[80:83], v[32:35], v[16:19], v[80:83]
  ds_read_b128 v[48:51], v5 offset:0
  v_mfma_f32_16x16x32_bf16 v[88:91], v[32:35], v[24:27], v[88:91]
  ds_read_b64_tr_b16 v[64:65], v8 offset:8192
  v_mfma_f32_16x16x32_bf16 v[84:87], v[32:35], v[20:23], v[84:87]
  ds_read_b64_tr_b16 v[66:67], v8 offset:9216
  v_mfma_f32_16x16x32_bf16 v[92:95], v[32:35], v[28:31], v[92:95]
  ds_read_b128 v[56:59], v7 offset:0
  v_mfma_f32_16x16x32_bf16 v[108:111], v[36:39], v[28:31], v[108:111]
  ds_read_b128 v[52:55], v5 offset:8192
  v_mfma_f32_16x16x32_bf16 v[100:103], v[36:39], v[20:23], v[100:103]
  ds_read_b128 v[60:63], v7 offset:8192
  v_mfma_f32_16x16x32_bf16 v[104:107], v[36:39], v[24:27], v[104:107]
  ds_read_b64_tr_b16 v[68:69], v9 offset:8192
  v_mfma_f32_16x16x32_bf16 v[96:99], v[36:39], v[16:19], v[96:99]
  ds_read_b64_tr_b16 v[70:71], v9 offset:9216
  v_mfma_f32_16x16x32_bf16 v[112:115], v[40:43], v[16:19], v[112:115]
  ds_read_b64_tr_b16 v[72:73], v10 offset:8192
  v_mfma_f32_16x16x32_bf16 v[120:123], v[40:43], v[24:27], v[120:123]
  ds_read_b64_tr_b16 v[74:75], v10 offset:9216
  v_mfma_f32_16x16x32_bf16 v[116:119], v[40:43], v[20:23], v[116:119]
  ds_read_b64_tr_b16 v[76:77], v11 offset:8192
  v_mfma_f32_16x16x32_bf16 v[124:127], v[40:43], v[28:31], v[124:127]
  ds_read_b64_tr_b16 v[78:79], v11 offset:9216
  v_mfma_f32_16x16x32_bf16 v[140:143], v[44:47], v[28:31], v[140:143]
  v_mfma_f32_16x16x32_bf16 v[132:135], v[44:47], v[20:23], v[132:135]
  v_mfma_f32_16x16x32_bf16 v[136:139], v[44:47], v[24:27], v[136:139]
  v_mfma_f32_16x16x32_bf16 v[128:131], v[44:47], v[16:19], v[128:131]
  v_mfma_f32_16x16x32_bf16 v[144:147], v[160:163], v[16:19], v[144:147]
  v_mfma_f32_16x16x32_bf16 v[148:151], v[160:163], v[20:23], v[148:151]
  v_mfma_f32_16x16x32_bf16 v[152:155], v[160:163], v[32:35], v[152:155]
  v_mfma_f32_16x16x32_bf16 v[156:159], v[160:163], v[36:39], v[156:159]
  s_waitcnt lgkmcnt(0)
  v_mfma_f32_16x16x32_bf16 v[80:83], v[64:67], v[48:51], v[80:83]
  v_mfma_f32_16x16x32_bf16 v[88:91], v[64:67], v[56:59], v[88:91]
  v_mfma_f32_16x16x32_bf16 v[84:87], v[64:67], v[52:55], v[84:87]
  v_mfma_f32_16x16x32_bf16 v[92:95], v[64:67], v[60:63], v[92:95]
  v_mfma_f32_16x16x32_bf16 v[108:111], v[68:71], v[60:63], v[108:111]
  v_mfma_f32_16x16x32_bf16 v[100:103], v[68:71], v[52:55], v[100:103]
  v_mfma_f32_16x16x32_bf16 v[104:107], v[68:71], v[56:59], v[104:107]
  s_barrier
  v_mfma_f32_16x16x32_bf16 v[96:99], v[68:71], v[48:51], v[96:99]
  ds_read_b128 v[16:19], v4 offset:32768
  v_mfma_f32_16x16x32_bf16 v[112:115], v[72:75], v[48:51], v[112:115]
  ds_read_b64_tr_b16 v[32:33], v8 offset:32768
  v_mfma_f32_16x16x32_bf16 v[120:123], v[72:75], v[56:59], v[120:123]
  ds_read_b64_tr_b16 v[34:35], v8 offset:33792
  v_mfma_f32_16x16x32_bf16 v[116:119], v[72:75], v[52:55], v[116:119]
  ds_read_b128 v[24:27], v6 offset:32768
  v_mfma_f32_16x16x32_bf16 v[124:127], v[72:75], v[60:63], v[124:127]
  ds_read_b128 v[20:23], v4 offset:40960
  v_mfma_f32_16x16x32_bf16 v[140:143], v[76:79], v[60:63], v[140:143]
  ds_read_b128 v[28:31], v6 offset:40960
  v_mfma_f32_16x16x32_bf16 v[132:135], v[76:79], v[52:55], v[132:135]
  ds_read_b64_tr_b16 v[36:37], v9 offset:32768
  v_mfma_f32_16x16x32_bf16 v[136:139], v[76:79], v[56:59], v[136:139]
  ds_read_b64_tr_b16 v[38:39], v9 offset:33792
  v_mfma_f32_16x16x32_bf16 v[128:131], v[76:79], v[48:51], v[128:131]
  ds_read_b64_tr_b16 v[40:41], v10 offset:32768
  v_mfma_f32_16x16x32_bf16 v[144:147], v[160:163], v[48:51], v[144:147]
  ds_read_b64_tr_b16 v[42:43], v10 offset:33792
  v_mfma_f32_16x16x32_bf16 v[148:151], v[160:163], v[52:55], v[148:151]
  ds_read_b64_tr_b16 v[44:45], v11 offset:32768
  v_mfma_f32_16x16x32_bf16 v[152:155], v[160:163], v[64:67], v[152:155]
  ds_read_b64_tr_b16 v[46:47], v11 offset:33792
  v_mfma_f32_16x16x32_bf16 v[156:159], v[160:163], v[68:71], v[156:159]
  s_cmp_eq_u32 s97, 3
  s_cbranch_scc0 L_nxm6
  ds_read_b64 v[208:209], v222
  ds_read_b64 v[210:211], v223
L_nxm6:
  s_waitcnt lgkmcnt(0)
  v_mfma_f32_16x16x32_bf16 v[80:83], v[32:35], v[16:19], v[80:83]
  ds_read_b128 v[48:51], v5 offset:32768
  v_mfma_f32_16x16x32_bf16 v[88:91], v[32:35], v[24:27], v[88:91]
  ds_read_b64_tr_b16 v[64:65], v8 offset:40960
  v_mfma_f32_16x16x32_bf16 v[84:87], v[32:35], v[20:23], v[84:87]
  ds_read_b64_tr_b16 v[66:67], v8 offset:41984
  v_mfma_f32_16x16x32_bf16 v[92:95], v[32:35], v[28:31], v[92:95]
  ds_read_b128 v[56:59], v7 offset:32768
  v_mfma_f32_16x16x32_bf16 v[108:111], v[36:39], v[28:31], v[108:111]
  ds_read_b128 v[52:55], v5 offset:40960
  v_mfma_f32_16x16x32_bf16 v[100:103], v[36:39], v[20:23], v[100:103]
  ds_read_b128 v[60:63], v7 offset:40960
  v_mfma_f32_16x16x32_bf16 v[104:107], v[36:39], v[24:27], v[104:107]
  ds_read_b64_tr_b16 v[68:69], v9 offset:40960
  v_mfma_f32_16x16x32_bf16 v[96:99], v[36:39], v[16:19], v[96:99]
  ds_read_b64_tr_b16 v[70:71], v9 offset:41984
  v_mfma_f32_16x16x32_bf16 v[112:115], v[40:43], v[16:19], v[112:115]
  ds_read_b64_tr_b16 v[72:73], v10 offset:40960
  v_mfma_f32_16x16x32_bf16 v[120:123], v[40:43], v[24:27], v[120:123]
  ds_read_b64_tr_b16 v[74:75], v10 offset:41984
  v_mfma_f32_16x16x32_bf16 v[116:119], v[40:43], v[20:23], v[116:119]
  ds_read_b64_tr_b16 v[76:77], v11 offset:40960
  v_mfma_f32_16x16x32_bf16 v[124:127], v[40:43], v[28:31], v[124:127]
  ds_read_b64_tr_b16 v[78:79], v11 offset:41984
  v_mfma_f32_16x16x32_bf16 v[140:143], v[44:47], v[28:31], v[140:143]
  v_mfma_f32_16x16x32_bf16 v[132:135], v[44:47], v[20:23], v[132:135]
  v_mfma_f32_16x16x32_bf16 v[136:139], v[44:47], v[24:27], v[136:139]
  v_mfma_f32_16x16x32_bf16 v[128:131], v[44:47], v[16:19], v[128:131]
  v_mfma_f32_16x16x32_bf16 v[144:147], v[160:163], v[16:19], v[144:147]
  v_mfma_f32_16x16x32_bf16 v[148:151], v[160:163], v[20:23], v[148:151]
  v_mfma_f32_16x16x32_bf16 v[152:155], v[160:163], v[32:35], v[152:155]
  v_mfma_f32_16x16x32_bf16 v[156:159], v[160:163], v[36:39], v[156:159]
  s_waitcnt lgkmcnt(0)
  v_mfma_f32_16x16x32_bf16 v[80:83], v[64:67], v[48:51], v[80:83]
  v_mfma_f32_16x16x32_bf16 v[88:91], v[64:67], v[56:59], v[88:91]
  v_mfma_f32_16x16x32_bf16 v[84:87], v[64:67], v[52:55], v[84:87]
  v_mfma_f32_16x16x32_bf16 v[92:95], v[64:67], v[60:63], v[92:95]
  v_mfma_f32_16x16x32_bf16 v[108:111], v[68:71], v[60:63], v[108:111]
  v_mfma_f32_16x16x32_bf16 v[100:103], v[68:71], v[52:55], v[100:103]
  v_mfma_f32_16x16x32_bf16 v[104:107], v[68:71], v[56:59], v[104:107]
  v_add_u32 v4, 65536, v4
  v_add_u32 v5, 65536, v5
  v_add_u32 v6, 65536, v6
  v_add_u32 v7, 65536, v7
  v_add_u32 v8, 65536, v8
  v_add_u32 v9, 65536, v9
  v_add_u32 v10, 65536, v10
  v_add_u32 v11, 65536, v11
  s_barrier
  v_mfma_f32_16x16x32_bf16 v[96:99], v[68:71], v[48:51], v[96:99]
  ds_read_b128 v[16:19], v4 offset:0
  v_mfma_f32_16x16x32_bf16 v[112:115], v[72:75], v[48:51], v[112:115]
  ds_read_b64_tr_b16 v[32:33], v8 offset:0
  v_mfma_f32_16x16x32_bf16 v[120:123], v[72:75], v[56:59], v[120:123]
  ds_read_b64_tr_b16 v[34:35], v8 offset:1024
  v_mfma_f32_16x16x32_bf16 v[116:119], v[72:75], v[52:55], v[116:119]
  ds_read_b128 v[24:27], v6 offset:0
  v_mfma_f32_16x16x32_bf16 v[124:127], v[72:75], v[60:63], v[124:127]
  ds_read_b64_tr_b16 v[36:37], v9 offset:0
  v_mfma_f32_16x16x32_bf16 v[140:143], v[76:79], v[60:63], v[140:143]
  ds_read_b64_tr_b16 v[38:39], v9 offset:1024
  v_mfma_f32_16x16x32_bf16 v[132:135], v[76:79], v[52:55], v[132:135]
  ds_read_b64_tr_b16 v[40:41], v10 offset:0
  v_mfma_f32_16x16x32_bf16 v[136:139], v[76:79], v[56:59], v[136:139]
  ds_read_b64_tr_b16 v[42:43], v10 offset:1024
  v_mfma_f32_16x16x32_bf16 v[128:131], v[76:79], v[48:51], v[128:131]
  ds_read_b64_tr_b16 v[44:45], v11 offset:0
  v_mfma_f32_16x16x32_bf16 v[144:147], v[160:163], v[48:51], v[144:147]
  ds_read_b64_tr_b16 v[46:47], v11 offset:1024
  v_mfma_f32_16x16x32_bf16 v[148:151], v[160:163], v[52:55], v[148:151]
  v_mfma_f32_16x16x32_bf16 v[152:155], v[160:163], v[64:67], v[152:155]
  v_mfma_f32_16x16x32_bf16 v[156:159], v[160:163], v[68:71], v[156:159]
  s_waitcnt lgkmcnt(4)
  v_mfma_f32_16x16x32_bf16 v[80:83], v[32:35], v[16:19], v[80:83]
  ds_read_b128 v[48:51], v5 offset:0
  v_mfma_f32_16x16x32_bf16 v[88:91], v[32:35], v[24:27], v[88:91]
  ds_read_b64_tr_b16 v[64:65], v8 offset:8192
  v_mfma_f32_16x16x32_bf16 v[104:107], v[36:39], v[24:27], v[104:107]
  ds_read_b64_tr_b16 v[66:67], v8 offset:9216
  v_mfma_f32_16x16x32_bf16 v[96:99], v[36:39], v[16:19], v[96:99]
  ds_read_b128 v[56:59], v7 offset:0
  s_waitcnt lgkmcnt(4)
  v_mfma_f32_16x16x32_bf16 v[112:115], v[40:43], v[16:19], v[112:115]
  ds_read_b64_tr_b16 v[68:69], v9 offset:8192
  v_mfma_f32_16x16x32_bf16 v[120:123], v[40:43], v[24:27], v[120:123]
  ds_read_b64_tr_b16 v[70:71], v9 offset:9216
  v_mfma_f32_16x16x32_bf16 v[136:139], v[44:47], v[24:27], v[136:139]
  ds_read_b64_tr_b16 v[72:73], v10 offset:8192
  v_mfma_f32_16x16x32_bf16 v[128:131], v[44:47], v[16:19], v[128:131]
  ds_read_b64_tr_b16 v[74:75], v10 offset:9216
  v_mfma_f32_16x16x32_bf16 v[144:147], v[160:163], v[16:19], v[144:147]
  ds_read_b64_tr_b16 v[76:77], v11 offset:8192
  v_mfma_f32_16x16x32_bf16 v[152:155], v[160:163], v[32:35], v[152:155]
  ds_read_b64_tr_b16 v[78:79], v11 offset:9216
  v_mfma_f32_16x16x32_bf16 v[156:159], v[160:163], v[36:39], v[156:159]
  s_waitcnt lgkmcnt(7)
  v_mfma_f32_16x16x32_bf16 v[80:83], v[64:67], v[48:51], v[80:83]
  v_add_u32 v4, 4294836224, v4
  v_add_u32 v5, 4294836224, v5
  v_add_u32 v6, 4294836224, v6
  v_add_u32 v7, 4294836224, v7
  v_add_u32 v8, 4294836224, v8
  v_add_u32 v9, 4294836224, v9
  v_add_u32 v10, 4294836224, v10
  v_add_u32 v11, 4294836224, v11
  s_barrier
  s_waitcnt lgkmcnt(2)
  v_mfma_f32_16x16x32_bf16 v[88:91], v[64:67], v[56:59], v[88:91]
  ds_read_b128 v[16:19], v4 offset:0
  v_mfma_f32_16x16x32_bf16 v[104:107], v[68:71], v[56:59], v[104:107]
  ds_read_b64_tr_b16 v[32:33], v8 offset:0
  v_mfma_f32_16x16x32_bf16 v[96:99], v[68:71], v[48:51], v[96:99]
  ds_read_b64_tr_b16 v[34:35], v8 offset:1024
  v_mfma_f32_16x16x32_bf16 v[112:115], v[72:75], v[48:51], v[112:115]
  ds_read_b128 v[24:27], v6 offset:0
  s_waitcnt lgkmcnt(4)
  v_mfma_f32_16x16x32_bf16 v[120:123], v[72:75], v[56:59], v[120:123]
  ds_read_b64_tr_b16 v[36:37], v9 offset:0
  v_mfma_f32_16x16x32_bf16 v[136:139], v[76:79], v[56:59], v[136:139]
  ds_read_b64_tr_b16 v[38:39], v9 offset:1024
  v_mfma_f32_16x16x32_bf16 v[128:131], v[76:79], v[48:51], v[128:131]
  ds_read_b64_tr_b16 v[40:41], v10 offset:0
  v_mfma_f32_16x16x32_bf16 v[144:147], v[160:163], v[48:51], v[144:147]
  ds_read_b64_tr_b16 v[42:43], v10 offset:1024
  v_mfma_f32_16x16x32_bf16 v[152:155], v[160:163], v[64:67], v[152:155]
  ds_read_b64_tr_b16 v[44:45], v11 offset:0
  v_mfma_f32_16x16x32_bf16 v[156:159], v[160:163], v[68:71], v[156:159]
  ds_read_b64_tr_b16 v[46:47], v11 offset:1024
  s_waitcnt lgkmcnt(4)
  v_mfma_f32_16x16x32_bf16 v[80:83], v[32:35], v[16:19], v[80:83]
  ds_read_b128 v[48:51], v5 offset:0
  v_mfma_f32_16x16x32_bf16 v[88:91], v[32:35], v[24:27], v[88:91]
  ds_read_b64_tr_b16 v[64:65], v8 offset:8192
  v_mfma_f32_16x16x32_bf16 v[104:107], v[36:39], v[24:27], v[104:107]
  ds_read_b64_tr_b16 v[66:67], v8 offset:9216
  v_mfma_f32_16x16x32_bf16 v[96:99], v[36:39], v[16:19], v[96:99]
  ds_read_b128 v[56:59], v7 offset:0
  s_waitcnt lgkmcnt(4)
  v_mfma_f32_16x16x32_bf16 v[112:115], v[40:43], v[16:19], v[112:115]
  ds_read_b64_tr_b16 v[68:69], v9 offset:8192
  v_mfma_f32_16x16x32_bf16 v[120:123], v[40:43], v[24:27], v[120:123]
  ds_read_b64_tr_b16 v[70:71], v9 offset:9216
  v_mfma_f32_16x16x32_bf16 v[136:139], v[44:47], v[24:27], v[136:139]
  ds_read_b64_tr_b16 v[72:73], v10 offset:8192
  v_mfma_f32_16x16x32_bf16 v[128:131], v[44:47], v[16:19], v[128:131]
  ds_read_b64_tr_b16 v[74:75], v10 offset:9216
  v_mfma_f32_16x16x32_bf16 v[144:147], v[160:163], v[16:19], v[144:147]
  ds_read_b64_tr_b16 v[76:77], v11 offset:8192
  v_mfma_f32_16x16x32_bf16 v[152:155], v[160:163], v[32:35], v[152:155]
  ds_read_b64_tr_b16 v[78:79], v11 offset:9216
  v_mfma_f32_16x16x32_bf16 v[156:159], v[160:163], v[36:39], v[156:159]
  s_waitcnt lgkmcnt(7)
  v_mfma_f32_16x16x32_bf16 v[80:83], v[64:67], v[48:51], v[80:83]
  s_barrier
  s_waitcnt lgkmcnt(2)
  v_mfma_f32_16x16x32_bf16 v[88:91], v[64:67], v[56:59], v[88:91]
  ds_read_b128 v[16:19], v4 offset:32768
  v_mfma_f32_16x16x32_bf16 v[104:107], v[68:71], v[56:59], v[104:107]
  ds_read_b64_tr_b16 v[32:33], v8 offset:32768
  v_mfma_f32_16x16x32_bf16 v[96:99], v[68:71], v[48:51], v[96:99]
  ds_read_b64_tr_b16 v[34:35], v8 offset:33792
  v_mfma_f32_16x16x32_bf16 v[112:115], v[72:75], v[48:51], v[112:115]
  ds_read_b128 v[24:27], v6 offset:32768
  s_waitcnt lgkmcnt(4)
  v_mfma_f32_16x16x32_bf16 v[120:123], v[72:75], v[56:59], v[120:123]
  ds_read_b64_tr_b16 v[36:37], v9 offset:32768
  v_mfma_f32_16x16x32_bf16 v[136:139], v[76:79], v[56:59], v[136:139]
  ds_read_b64_tr_b16 v[38:39], v9 offset:33792
  v_mfma_f32_16x16x32_bf16 v[128:131], v[76:79], v[48:51], v[128:131]
  ds_read_b64_tr_b16 v[40:41], v10 offset:32768
  v_mfma_f32_16x16x32_bf16 v[144:147], v[160:163], v[48:51], v[144:147]
  ds_read_b64_tr_b16 v[42:43], v10 offset:33792
  v_mfma_f32_16x16x32_bf16 v[152:155], v[160:163], v[64:67], v[152:155]
  ds_read_b64_tr_b16 v[44:45], v11 offset:32768
  v_mfma_f32_16x16x32_bf16 v[156:159], v[160:163], v[68:71], v[156:159]
  ds_read_b64_tr_b16 v[46:47], v11 offset:33792
  s_waitcnt lgkmcnt(4)
  v_mfma_f32_16x16x32_bf16 v[80:83], v[32:35], v[16:19], v[80:83]
  ds_read_b128 v[48:51], v5 offset:32768
  v_mfma_f32_16x16x32_bf16 v[88:91], v[32:35], v[24:27], v[88:91]
  ds_read_b64_tr_b16 v[64:65], v8 offset:40960
  v_mfma_f32_16x16x32_bf16 v[104:107], v[36:39], v[24:27], v[104:107]
  ds_read_b64_tr_b16 v[66:67], v8 offset:41984
  v_mfma_f32_16x16x32_bf16 v[96:99], v[36:39], v[16:19], v[96:99]
  ds_read_b128 v[56:59], v7 offset:32768
  s_waitcnt lgkmcnt(4)
  v_mfma_f32_16x16x32_bf16 v[112:115], v[40:43], v[16:19], v[112:115]
  ds_read_b64_tr_b16 v[68:69], v9 offset:40960
  v_mfma_f32_16x16x32_bf16 v[120:123], v[40:43], v[24:27], v[120:123]
  ds_read_b64_tr_b16 v[70:71], v9 offset:41984
  v_mfma_f32_16x16x32_bf16 v[136:139], v[44:47], v[24:27], v[136:139]
  ds_read_b64_tr_b16 v[72:73], v10 offset:40960
  v_mfma_f32_16x16x32_bf16 v[128:131], v[44:47], v[16:19], v[128:131]
  ds_read_b64_tr_b16 v[74:75], v10 offset:41984
  v_mfma_f32_16x16x32_bf16 v[144:147], v[160:163], v[16:19], v[144:147]
  ds_read_b64_tr_b16 v[76:77], v11 offset:40960
  v_mfma_f32_16x16x32_bf16 v[152:155], v[160:163], v[32:35], v[152:155]
  ds_read_b64_tr_b16 v[78:79], v11 offset:41984
  v_mfma_f32_16x16x32_bf16 v[156:159], v[160:163], v[36:39], v[156:159]
  s_waitcnt lgkmcnt(4)
  v_mfma_f32_16x16x32_bf16 v[144:147], v[160:163], v[48:51], v[144:147]
  v_mfma_f32_16x16x32_bf16 v[152:155], v[160:163], v[64:67], v[152:155]
  v_mfma_f32_16x16x32_bf16 v[156:159], v[160:163], v[68:71], v[156:159]
  v_mfma_f32_16x16x32_bf16 v[80:83], v[64:67], v[48:51], v[80:83]
  s_waitcnt lgkmcnt(2)
  v_mfma_f32_16x16x32_bf16 v[88:91], v[64:67], v[56:59], v[88:91]
  v_mfma_f32_16x16x32_bf16 v[104:107], v[68:71], v[56:59], v[104:107]
  v_mfma_f32_16x16x32_bf16 v[96:99], v[68:71], v[48:51], v[96:99]
  v_mfma_f32_16x16x32_bf16 v[112:115], v[72:75], v[48:51], v[112:115]
  s_waitcnt lgkmcnt(0)
  v_mfma_f32_16x16x32_bf16 v[120:123], v[72:75], v[56:59], v[120:123]
  v_mfma_f32_16x16x32_bf16 v[136:139], v[76:79], v[56:59], v[136:139]
  v_mfma_f32_16x16x32_bf16 v[128:131], v[76:79], v[48:51], v[128:131]
  ds_write_b32 v12, v144 offset:34816
  ds_write_b32 v12, v152 offset:35072
  ds_write_b32 v12, v156 offset:35328
  v_cvt_pk_bf16_f32 v244, v152, v152
  v_and_b32 v244, s50, v244
  v_sub_f32 v244, v152, v244
  v_cvt_pk_bf16_f32 v244, v152, v244
  v_cvt_pk_bf16_f32 v246, v156, v156
  v_and_b32 v246, s50, v246
  v_sub_f32 v246, v156, v246
  v_cvt_pk_bf16_f32 v246, v156, v246
  v_mul_f32 v167, 0xbb124925, v144
  v_cvt_pk_bf16_f32 v240, v167, v167
  s_waitcnt lgkmcnt(0)
  s_barrier
  v_mfma_f32_16x16x16_bf16 v[80:83], v[244:245], v[240:241], v[80:83]
  v_mfma_f32_16x16x16_bf16 v[96:99], v[246:247], v[240:241], v[96:99]
  ds_read_b32 v164, v14 offset:34816
  ds_read_b32 v165, v15 offset:35072
  ds_read_b32 v166, v15 offset:35328
  s_nop 3
  v_cvt_pk_bf16_f32 v192, v80, v81
  v_cvt_pk_bf16_f32 v193, v82, v83
  v_cvt_pk_bf16_f32 v194, v96, v97
  v_cvt_pk_bf16_f32 v195, v98, v99
  v_pk_max_i16 v192, v192, 0
  v_pk_max_i16 v193, v193, 0
  v_pk_max_i16 v194, v194, 0
  v_pk_max_i16 v195, v195, 0
  buffer_store_dwordx4 v[192:195], v1, s[20:23], s54 offen sc1
  s_waitcnt lgkmcnt(0)
  v_mul_f32 v167, 0xbb124925, v164
  v_cvt_pk_bf16_f32 v242, v167, v167
  v_cvt_pk_bf16_f32 v248, v165, v165
  v_and_b32 v248, s50, v248
  v_sub_f32 v248, v165, v248
  v_cvt_pk_bf16_f32 v248, v165, v248
  v_mfma_f32_16x16x16_bf16 v[88:91], v[244:245], v[242:243], v[88:91]
  v_mfma_f32_16x16x16_bf16 v[104:107], v[246:247], v[242:243], v[104:107]
  v_cvt_pk_bf16_f32 v250, v166, v166
  v_and_b32 v250, s50, v250
  v_sub_f32 v250, v166, v250
  v_cvt_pk_bf16_f32 v250, v166, v250
  s_nop 1
  v_mfma_f32_16x16x16_bf16 v[112:115], v[248:249], v[240:241], v[112:115]
  v_mfma_f32_16x16x16_bf16 v[128:131], v[250:251], v[240:241], v[128:131]
  v_mfma_f32_16x16x16_bf16 v[120:123], v[248:249], v[242:243], v[120:123]
  v_mfma_f32_16x16x16_bf16 v[136:139], v[250:251], v[242:243], v[136:139]
  v_cvt_pk_bf16_f32 v196, v88, v89
  v_cvt_pk_bf16_f32 v197, v90, v91
  v_cvt_pk_bf16_f32 v198, v104, v105
  v_cvt_pk_bf16_f32 v199, v106, v107
  v_pk_max_i16 v196, v196, 0
  v_pk_max_i16 v197, v197, 0
  v_pk_max_i16 v198, v198, 0
  v_pk_max_i16 v199, v199, 0
  buffer_store_dwordx4 v[196:199], v1, s[20:23], s55 offen sc1
  v_cvt_pk_bf16_f32 v200, v112, v113
  v_cvt_pk_bf16_f32 v201, v114, v115
  v_cvt_pk_bf16_f32 v202, v128, v129
  v_cvt_pk_bf16_f32 v203, v130, v131
  v_pk_max_i16 v200, v200, 0
  v_pk_max_i16 v201, v201, 0
  v_pk_max_i16 v202, v202, 0
  v_pk_max_i16 v203, v203, 0
  buffer_store_dwordx4 v[200:203], v1, s[20:23], s56 offen sc1
  s_barrier
  ds_read_b128 v[20:23], v4 offset:40960
  ds_read_b128 v[28:31], v6 offset:40960
  v_cvt_pk_bf16_f32 v204, v120, v121
  v_cvt_pk_bf16_f32 v205, v122, v123
  v_cvt_pk_bf16_f32 v206, v136, v137
  v_cvt_pk_bf16_f32 v207, v138, v139
  v_pk_max_i16 v204, v204, 0
  v_pk_max_i16 v205, v205, 0
  v_pk_max_i16 v206, v206, 0
  v_pk_max_i16 v207, v207, 0
  buffer_store_dwordx4 v[204:207], v1, s[20:23], s57 offen sc1
  s_add_u32 s54, s54, s58
  s_add_u32 s55, s55, s58
  s_add_u32 s56, s56, s58
  s_add_u32 s57, s57, s58
  s_cmp_ge_u32 s97, 4
  s_cbranch_scc0 L_nxm14
  ds_read_b64 v[208:209], v222
  ds_read_b64 v[210:211], v223
L_nxm14:
  s_waitcnt lgkmcnt(0)
  v_mfma_f32_16x16x32_bf16 v[84:87], v[32:35], v[20:23], v[84:87]
  ds_read_b128 v[52:55], v5 offset:40960
  v_mfma_f32_16x16x32_bf16 v[92:95], v[32:35], v[28:31], v[92:95]
  ds_read_b128 v[60:63], v7 offset:40960
  v_mfma_f32_16x16x32_bf16 v[108:111], v[36:39], v[28:31], v[108:111]
  v_mfma_f32_16x16x32_bf16 v[100:103], v[36:39], v[20:23], v[100:103]
  v_mfma_f32_16x16x32_bf16 v[116:119], v[40:43], v[20:23], v[116:119]
  v_mfma_f32_16x16x32_bf16 v[124:127], v[40:43], v[28:31], v[124:127]
  v_mfma_f32_16x16x32_bf16 v[140:143], v[44:47], v[28:31], v[140:143]
  v_mfma_f32_16x16x32_bf16 v[132:135], v[44:47], v[20:23], v[132:135]
  v_mfma_f32_16x16x32_bf16 v[148:151], v[160:163], v[20:23], v[148:151]
  v_add_u32 v4, 131072, v4
  v_add_u32 v5, 131072, v5
  v_add_u32 v6, 131072, v6
  v_add_u32 v7, 131072, v7
  v_add_u32 v8, 131072, v8
  v_add_u32 v9, 131072, v9
  v_add_u32 v10, 131072, v10
  v_add_u32 v11, 131072, v11
  s_waitcnt lgkmcnt(0)
  v_mfma_f32_16x16x32_bf16 v[84:87], v[64:67], v[52:55], v[84:87]
  ds_read_b128 v[20:23], v4 offset:8192
  ds_read_b64_tr_b16 v[32:33], v8 offset:0
  v_mfma_f32_16x16x32_bf16 v[92:95], v[64:67], v[60:63], v[92:95]
  ds_read_b64_tr_b16 v[34:35], v8 offset:1024
  v_mfma_f32_16x16x32_bf16 v[108:111], v[68:71], v[60:63], v[108:111]
  ds_read_b128 v[28:31], v6 offset:8192
  v_mfma_f32_16x16x32_bf16 v[100:103], v[68:71], v[52:55], v[100:103]
  ds_read_b64_tr_b16 v[36:37], v9 offset:0
  v_mfma_f32_16x16x32_bf16 v[116:119], v[72:75], v[52:55], v[116:119]
  ds_read_b64_tr_b16 v[38:39], v9 offset:1024
  v_mfma_f32_16x16x32_bf16 v[124:127], v[72:75], v[60:63], v[124:127]
  ds_read_b64_tr_b16 v[40:41], v10 offset:0
  v_mfma_f32_16x16x32_bf16 v[140:143], v[76:79], v[60:63], v[140:143]
  ds_read_b64_tr_b16 v[42:43], v10 offset:1024
  v_mfma_f32_16x16x32_bf16 v[132:135], v[76:79], v[52:55], v[132:135]
  ds_read_b64_tr_b16 v[44:45], v11 offset:0
  v_mfma_f32_16x16x32_bf16 v[148:151], v[160:163], v[52:55], v[148:151]
  ds_read_b64_tr_b16 v[46:47], v11 offset:1024
  s_barrier
  s_waitcnt lgkmcnt(4)
  v_mfma_f32_16x16x32_bf16 v[84:87], v[32:35], v[20:23], v[84:87]
  ds_read_b128 v[52:55], v5 offset:8192
  ds_read_b64_tr_b16 v[64:65], v8 offset:8192
  v_mfma_f32_16x16x32_bf16 v[92:95], v[32:35], v[28:31], v[92:95]
  ds_read_b64_tr_b16 v[66:67], v8 offset:9216
  v_mfma_f32_16x16x32_bf16 v[108:111], v[36:39], v[28:31], v[108:111]
  ds_read_b128 v[60:63], v7 offset:8192
  v_mfma_f32_16x16x32_bf16 v[100:103], v[36:39], v[20:23], v[100:103]
  ds_read_b64_tr_b16 v[68:69], v9 offset:8192
  s_waitcnt lgkmcnt(5)
  v_mfma_f32_16x16x32_bf16 v[116:119], v[40:43], v[20:23], v[116:119]
  ds_read_b64_tr_b16 v[70:71], v9 offset:9216
  v_mfma_f32_16x16x32_bf16 v[124:127], v[40:43], v[28:31], v[124:127]
  ds_read_b64_tr_b16 v[72:73], v10 offset:8192
  v_mfma_f32_16x16x32_bf16 v[140:143], v[44:47], v[28:31], v[140:143]
  ds_read_b64_tr_b16 v[74:75], v10 offset:9216
  v_mfma_f32_16x16x32_bf16 v[132:135], v[44:47], v[20:23], v[132:135]
  ds_read_b64_tr_b16 v[76:77], v11 offset:8192
  v_mfma_f32_16x16x32_bf16 v[148:151], v[160:163], v[20:23], v[148:151]
  ds_read_b64_tr_b16 v[78:79], v11 offset:9216
  v_add_u32 v4, 4294836224, v4
  v_add_u32 v5, 4294836224, v5
  v_add_u32 v6, 4294836224, v6
  v_add_u32 v7, 4294836224, v7
  v_add_u32 v8, 4294836224, v8
  v_add_u32 v9, 4294836224, v9
  v_add_u32 v10, 4294836224, v10
  v_add_u32 v11, 4294836224, v11
  s_waitcnt lgkmcnt(4)
  v_mfma_f32_16x16x32_bf16 v[84:87], v[64:67], v[52:55], v[84:87]
  ds_read_b128 v[20:23], v4 offset:8192
  ds_read_b64_tr_b16 v[32:33], v8 offset:0
  v_mfma_f32_16x16x32_bf16 v[92:95], v[64:67], v[60:63], v[92:95]
  ds_read_b64_tr_b16 v[34:35], v8 offset:1024
  v_mfma_f32_16x16x32_bf16 v[108:111], v[68:71], v[60:63], v[108:111]
  ds_read_b128 v[28:31], v6 offset:8192
  v_mfma_f32_16x16x32_bf16 v[100:103], v[68:71], v[52:55], v[100:103]
  ds_read_b64_tr_b16 v[36:37], v9 offset:0
  s_waitcnt lgkmcnt(5)
  v_mfma_f32_16x16x32_bf16 v[116:119], v[72:75], v[52:55], v[116:119]
  ds_read_b64_tr_b16 v[38:39], v9 offset:1024
  v_mfma_f32_16x16x32_bf16 v[124:127], v[72:75], v[60:63], v[124:127]
  ds_read_b64_tr_b16 v[40:41], v10 offset:0
  v_mfma_f32_16x16x32_bf16 v[140:143], v[76:79], v[60:63], v[140:143]
  ds_read_b64_tr_b16 v[42:43], v10 offset:1024
  v_mfma_f32_16x16x32_bf16 v[132:135], v[76:79], v[52:55], v[132:135]
  ds_read_b64_tr_b16 v[44:45], v11 offset:0
  v_mfma_f32_16x16x32_bf16 v[148:151], v[160:163], v[52:55], v[148:151]
  ds_read_b64_tr_b16 v[46:47], v11 offset:1024
  s_barrier
  s_waitcnt lgkmcnt(4)
  v_mfma_f32_16x16x32_bf16 v[84:87], v[32:35], v[20:23], v[84:87]
  ds_read_b128 v[52:55], v5 offset:8192
  ds_read_b64_tr_b16 v[64:65], v8 offset:8192
  v_mfma_f32_16x16x32_bf16 v[92:95], v[32:35], v[28:31], v[92:95]
  ds_read_b64_tr_b16 v[66:67], v8 offset:9216
  v_mfma_f32_16x16x32_bf16 v[108:111], v[36:39], v[28:31], v[108:111]
  ds_read_b128 v[60:63], v7 offset:8192
  v_mfma_f32_16x16x32_bf16 v[100:103], v[36:39], v[20:23], v[100:103]
  ds_read_b64_tr_b16 v[68:69], v9 offset:8192
  s_waitcnt lgkmcnt(5)
  v_mfma_f32_16x16x32_bf16 v[116:119], v[40:43], v[20:23], v[116:119]
  ds_read_b64_tr_b16 v[70:71], v9 offset:9216
  v_mfma_f32_16x16x32_bf16 v[124:127], v[40:43], v[28:31], v[124:127]
  ds_read_b64_tr_b16 v[72:73], v10 offset:8192
  v_mfma_f32_16x16x32_bf16 v[140:143], v[44:47], v[28:31], v[140:143]
  ds_read_b64_tr_b16 v[74:75], v10 offset:9216
  v_mfma_f32_16x16x32_bf16 v[132:135], v[44:47], v[20:23], v[132:135]
  ds_read_b64_tr_b16 v[76:77], v11 offset:8192
  v_mfma_f32_16x16x32_bf16 v[148:151], v[160:163], v[20:23], v[148:151]
  ds_read_b64_tr_b16 v[78:79], v11 offset:9216
  s_waitcnt lgkmcnt(4)
  v_mfma_f32_16x16x32_bf16 v[148:151], v[160:163], v[52:55], v[148:151]
  v_mfma_f32_16x16x32_bf16 v[84:87], v[64:67], v[52:55], v[84:87]
  v_mfma_f32_16x16x32_bf16 v[92:95], v[64:67], v[60:63], v[92:95]
  v_mfma_f32_16x16x32_bf16 v[108:111], v[68:71], v[60:63], v[108:111]
  s_waitcnt lgkmcnt(0)
  v_mfma_f32_16x16x32_bf16 v[100:103], v[68:71], v[52:55], v[100:103]
  v_mfma_f32_16x16x32_bf16 v[116:119], v[72:75], v[52:55], v[116:119]
  v_mfma_f32_16x16x32_bf16 v[124:127], v[72:75], v[60:63], v[124:127]
  v_mfma_f32_16x16x32_bf16 v[140:143], v[76:79], v[60:63], v[140:143]
  v_mfma_f32_16x16x32_bf16 v[132:135], v[76:79], v[52:55], v[132:135]
  ds_write_b32 v12, v148 offset:0
  ds_read_b32 v164, v12
  v_mul_f32 v167, 0xbb124925, v148
  v_cvt_pk_bf16_f32 v240, v167, v167
  s_waitcnt vmcnt(0)
  s_atomic_swap s41, s[20:21], s52
  s_waitcnt lgkmcnt(1)
  s_barrier
  v_mfma_f32_16x16x16_bf16 v[84:87], v[244:245], v[240:241], v[84:87]
  v_mfma_f32_16x16x16_bf16 v[100:103], v[246:247], v[240:241], v[100:103]
  v_mfma_f32_16x16x16_bf16 v[116:119], v[248:249], v[240:241], v[116:119]
  v_mfma_f32_16x16x16_bf16 v[132:135], v[250:251], v[240:241], v[132:135]
  ds_read_b32 v164, v14
  ds_read_b32 v165, v12
  s_lshl_b32 s51, s47, 11
  v_add_u32 v2, s51, v226
  v_xor_b32 v3, 2048, v2
  v_cvt_pk_bf16_f32 v176, v84, v85
  v_cvt_pk_bf16_f32 v177, v86, v87
  v_cvt_pk_bf16_f32 v178, v100, v101
  v_cvt_pk_bf16_f32 v179, v102, v103
  v_pk_max_i16 v176, v176, 0
  v_pk_max_i16 v177, v177, 0
  v_pk_max_i16 v178, v178, 0
  v_pk_max_i16 v179, v179, 0
  buffer_store_dwordx4 v[176:179], v1, s[20:23], s54 offen sc1
  s_waitcnt lgkmcnt(1)
  v_mul_f32 v167, 0xbb124925, v164
  v_cvt_pk_bf16_f32 v242, v167, v167
  s_nop 1
  v_mfma_f32_16x16x16_bf16 v[92:95], v[244:245], v[242:243], v[92:95]
  v_mfma_f32_16x16x16_bf16 v[108:111], v[246:247], v[242:243], v[108:111]
  v_mfma_f32_16x16x16_bf16 v[124:127], v[248:249], v[242:243], v[124:127]
  v_mfma_f32_16x16x16_bf16 v[140:143], v[250:251], v[242:243], v[140:143]
  v_cvt_pk_bf16_f32 v184, v116, v117
  v_cvt_pk_bf16_f32 v185, v118, v119
  v_cvt_pk_bf16_f32 v186, v132, v133
  v_cvt_pk_bf16_f32 v187, v134, v135
  v_pk_max_i16 v184, v184, 0
  v_pk_max_i16 v185, v185, 0
  v_pk_max_i16 v186, v186, 0
  v_pk_max_i16 v187, v187, 0
  buffer_store_dwordx4 v[184:187], v1, s[20:23], s56 offen sc1
  v_cvt_pk_bf16_f32 v180, v92, v93
  v_cvt_pk_bf16_f32 v181, v94, v95
  v_cvt_pk_bf16_f32 v182, v108, v109
  v_cvt_pk_bf16_f32 v183, v110, v111
  v_pk_max_i16 v180, v180, 0
  v_pk_max_i16 v181, v181, 0
  v_pk_max_i16 v182, v182, 0
  v_pk_max_i16 v183, v183, 0
  buffer_store_dwordx4 v[180:183], v1, s[20:23], s55 offen sc1
  v_cvt_pk_bf16_f32 v188, v124, v125
  v_cvt_pk_bf16_f32 v189, v126, v127
  v_cvt_pk_bf16_f32 v190, v140, v141
  v_cvt_pk_bf16_f32 v191, v142, v143
  v_pk_max_i16 v188, v188, 0
  v_pk_max_i16 v189, v189, 0
  v_pk_max_i16 v190, v190, 0
  v_pk_max_i16 v191, v191, 0
  buffer_store_dwordx4 v[188:191], v1, s[20:23], s57 offen sc1
  s_barrier
  ds_write_b128 v2, v[192:195] offset:0
  ds_write_b128 v2, v[196:199] offset:1024
  ds_write_b128 v3, v[200:203] offset:0
  ds_write_b128 v3, v[204:207] offset:1024
  s_mov_b64 exec, 1
  ds_write_b32 v232, v230 offset:56332
  s_mov_b64 exec, -1
  s_cmp_eq_u32 s47, 0
  s_cbranch_scc1 L_ow0
  v_swap_b32 v176, v184
  v_swap_b32 v177, v185
  v_swap_b32 v178, v186
  v_swap_b32 v179, v187
  v_swap_b32 v180, v188
  v_swap_b32 v181, v189
  v_swap_b32 v182, v190
  v_swap_b32 v183, v191
L_ow0:
  ds_read_b64_tr_b16 v[16:17], v212 offset:0
  ds_read_b64_tr_b16 v[18:19], v212 offset:2048
  ds_read_b64_tr_b16 v[20:21], v213 offset:0
  ds_read_b64_tr_b16 v[22:23], v213 offset:2048
  ds_read_b64_tr_b16 v[24:25], v214 offset:0
  ds_read_b64_tr_b16 v[26:27], v214 offset:2048
  ds_read_b64_tr_b16 v[28:29], v215 offset:0
  ds_read_b64_tr_b16 v[30:31], v215 offset:2048
  ds_read_b64_tr_b16 v[32:33], v212 offset:4096
  ds_read_b64_tr_b16 v[34:35], v212 offset:6144
  ds_read_b64_tr_b16 v[36:37], v213 offset:4096
  ds_read_b64_tr_b16 v[38:39], v213 offset:6144
  ds_read_b64_tr_b16 v[40:41], v214 offset:4096
  ds_read_b64_tr_b16 v[42:43], v214 offset:6144
  ds_read_b64_tr_b16 v[44:45], v215 offset:4096
  ds_read_b64_tr_b16 v[46:47], v215 offset:6144
  v_lshlrev_b32 v64, 16, v208
  v_and_b32 v65, 0xffff0000, v208
  v_lshlrev_b32 v66, 16, v209
  v_and_b32 v67, 0xffff0000, v209
  v_lshlrev_b32 v68, 16, v210
  v_and_b32 v69, 0xffff0000, v210
  v_lshlrev_b32 v70, 16, v211
  v_and_b32 v71, 0xffff0000, v211
  s_waitcnt vmcnt(0) lgkmcnt(0)
  s_atomic_swap s41, s[20:21], s53
  v_mfma_f32_16x16x32_bf16 v[144:147], v[16:19], v[176:179], 0
  v_mfma_f32_16x16x32_bf16 v[152:155], v[20:23], v[176:179], 0
  v_mfma_f32_16x16x32_bf16 v[160:163], v[24:27], v[176:179], 0
  v_mfma_f32_16x16x32_bf16 v[168:171], v[28:31], v[176:179], 0
  v_mfma_f32_16x16x32_bf16 v[148:151], v[16:19], v[180:183], 0
  v_mfma_f32_16x16x32_bf16 v[156:159], v[20:23], v[180:183], 0
  v_mfma_f32_16x16x32_bf16 v[164:167], v[24:27], v[180:183], 0
  v_mfma_f32_16x16x32_bf16 v[172:175], v[28:31], v[180:183], 0
  v_mfma_f32_16x16x32_bf16 v[144:147], v[32:35], v[184:187], v[144:147]
  v_mfma_f32_16x16x32_bf16 v[152:155], v[36:39], v[184:187], v[152:155]
  v_mfma_f32_16x16x32_bf16 v[160:163], v[40:43], v[184:187], v[160:163]
  v_mfma_f32_16x16x32_bf16 v[168:171], v[44:47], v[184:187], v[168:171]
  v_mfma_f32_16x16x32_bf16 v[148:151], v[32:35], v[188:191], v[148:151]
  v_mfma_f32_16x16x32_bf16 v[156:159], v[36:39], v[188:191], v[156:159]
  v_mfma_f32_16x16x32_bf16 v[164:167], v[40:43], v[188:191], v[164:167]
  v_mfma_f32_16x16x32_bf16 v[172:175], v[44:47], v[188:191], v[172:175]
  s_mov_b32 s60, 400000
  s_mov_b32 s40, s41
L_hpk:
  s_sub_u32 s60, s60, 1
  s_cbranch_scc1 L_hqk
  s_load_dwordx8 s[28:35], s[20:21], s93 glc
L_hrk:
  s_waitcnt lgkmcnt(0)
  s_cmp_eq_u64 s[28:29], s[40:41]
  s_cbranch_scc0 L_hpk
  s_cmp_eq_u64 s[30:31], s[40:41]
  s_cbranch_scc0 L_hpk
  s_cmp_eq_u64 s[32:33], s[40:41]
  s_cbranch_scc0 L_hpk
  s_cmp_eq_u32 s34, s41
  s_cbranch_scc0 L_hpk
L_hqk:
  s_barrier
  buffer_load_dwordx4 v[80:83], v220, s[20:23], s87 offen offset:0 sc1
  buffer_load_dwordx4 v[84:87], v221, s[20:23], s87 offen offset:0 sc1
  buffer_load_dwordx4 v[88:91], v220, s[20:23], s87 offen offset:2048 sc1
  buffer_load_dwordx4 v[92:95], v221, s[20:23], s87 offen offset:2048 sc1
  buffer_load_dwordx4 v[96:99], v220, s[20:23], s88 offen offset:0 sc1
  buffer_load_dwordx4 v[100:103], v221, s[20:23], s88 offen offset:0 sc1
  buffer_load_dwordx4 v[104:107], v220, s[20:23], s88 offen offset:2048 sc1
  buffer_load_dwordx4 v[108:111], v221, s[20:23], s88 offen offset:2048 sc1
  buffer_load_dwordx4 v[112:115], v220, s[20:23], s89 offen offset:0 sc1
  buffer_load_dwordx4 v[116:119], v221, s[20:23], s89 offen offset:0 sc1
  buffer_load_dwordx4 v[120:123], v220, s[20:23], s89 offen offset:2048 sc1
  buffer_load_dwordx4 v[124:127], v221, s[20:23], s89 offen offset:2048 sc1
  ds_read_b64_tr_b16 v[48:49], v212 offset:16384
  ds_read_b64_tr_b16 v[50:51], v212 offset:18432
  ds_read_b64_tr_b16 v[52:53], v213 offset:16384
  ds_read_b64_tr_b16 v[54:55], v213 offset:18432
  ds_read_b64_tr_b16 v[56:57], v214 offset:16384
  ds_read_b64_tr_b16 v[58:59], v214 offset:18432
  ds_read_b64_tr_b16 v[60:61], v215 offset:16384
  ds_read_b64_tr_b16 v[62:63], v215 offset:18432
  ds_read_b64_tr_b16 v[16:17], v212 offset:20480
  ds_read_b64_tr_b16 v[18:19], v212 offset:22528
  ds_read_b64_tr_b16 v[20:21], v213 offset:20480
  ds_read_b64_tr_b16 v[22:23], v213 offset:22528
  ds_read_b64_tr_b16 v[24:25], v214 offset:20480
  ds_read_b64_tr_b16 v[26:27], v214 offset:22528
  ds_read_b64_tr_b16 v[28:29], v215 offset:20480
  ds_read_b64_tr_b16 v[30:31], v215 offset:22528
  s_waitcnt lgkmcnt(8)
  s_waitcnt vmcnt(11)
  v_mfma_f32_16x16x32_bf16 v[144:147], v[48:51], v[80:83], v[144:147]
  ds_read_b64_tr_b16 v[32:33], v212 offset:32768
  v_mfma_f32_16x16x32_bf16 v[152:155], v[52:55], v[80:83], v[152:155]
  ds_read_b64_tr_b16 v[34:35], v212 offset:34816
  v_mfma_f32_16x16x32_bf16 v[160:163], v[56:59], v[80:83], v[160:163]
  ds_read_b64_tr_b16 v[36:37], v213 offset:32768
  v_mfma_f32_16x16x32_bf16 v[168:171], v[60:63], v[80:83], v[168:171]
  ds_read_b64_tr_b16 v[38:39], v213 offset:34816
  s_waitcnt vmcnt(10)
  v_mfma_f32_16x16x32_bf16 v[172:175], v[60:63], v[84:87], v[172:175]
  ds_read_b64_tr_b16 v[40:41], v214 offset:32768
  v_mfma_f32_16x16x32_bf16 v[164:167], v[56:59], v[84:87], v[164:167]
  ds_read_b64_tr_b16 v[42:43], v214 offset:34816
  v_mfma_f32_16x16x32_bf16 v[156:159], v[52:55], v[84:87], v[156:159]
  ds_read_b64_tr_b16 v[44:45], v215 offset:32768
  v_mfma_f32_16x16x32_bf16 v[148:151], v[48:51], v[84:87], v[148:151]
  ds_read_b64_tr_b16 v[46:47], v215 offset:34816
  s_waitcnt lgkmcnt(8)
  s_waitcnt vmcnt(9)
  v_mfma_f32_16x16x32_bf16 v[144:147], v[16:19], v[88:91], v[144:147]
  ds_read_b64_tr_b16 v[48:49], v212 offset:36864
  v_mfma_f32_16x16x32_bf16 v[152:155], v[20:23], v[88:91], v[152:155]
  ds_read_b64_tr_b16 v[50:51], v212 offset:38912
  v_mfma_f32_16x16x32_bf16 v[160:163], v[24:27], v[88:91], v[160:163]
  ds_read_b64_tr_b16 v[52:53], v213 offset:36864
  v_mfma_f32_16x16x32_bf16 v[168:171], v[28:31], v[88:91], v[168:171]
  ds_read_b64_tr_b16 v[54:55], v213 offset:38912
  s_waitcnt vmcnt(8)
  v_mfma_f32_16x16x32_bf16 v[172:175], v[28:31], v[92:95], v[172:175]
  ds_read_b64_tr_b16 v[56:57], v214 offset:36864
  v_mfma_f32_16x16x32_bf16 v[164:167], v[24:27], v[92:95], v[164:167]
  ds_read_b64_tr_b16 v[58:59], v214 offset:38912
  v_mfma_f32_16x16x32_bf16 v[156:159], v[20:23], v[92:95], v[156:159]
  ds_read_b64_tr_b16 v[60:61], v215 offset:36864
  v_mfma_f32_16x16x32_bf16 v[148:151], v[16:19], v[92:95], v[148:151]
  ds_read_b64_tr_b16 v[62:63], v215 offset:38912
  s_waitcnt lgkmcnt(8)
  s_mov_b64 exec, 1
  ds_write_b32 v232, v230 offset:52236
  s_mov_b64 exec, -1
  s_waitcnt vmcnt(7)
  v_mfma_f32_16x16x32_bf16 v[144:147], v[32:35], v[96:99], v[144:147]
  ds_read_b64_tr_b16 v[16:17], v212 offset:49152
  v_mfma_f32_16x16x32_bf16 v[152:155], v[36:39], v[96:99], v[152:155]
  ds_read_b64_tr_b16 v[18:19], v212 offset:51200
  v_mfma_f32_16x16x32_bf16 v[160:163], v[40:43], v[96:99], v[160:163]
  ds_read_b64_tr_b16 v[20:21], v213 offset:49152
  v_mfma_f32_16x16x32_bf16 v[168:171], v[44:47], v[96:99], v[168:171]
  ds_read_b64_tr_b16 v[22:23], v213 offset:51200
  buffer_load_dwordx4 v[128:131], v220, s[20:23], s90 offen offset:0 sc1
  s_waitcnt vmcnt(7)
  v_mfma_f32_16x16x32_bf16 v[172:175], v[44:47], v[100:103], v[172:175]
  ds_read_b64_tr_b16 v[24:25], v214 offset:49152
  v_mfma_f32_16x16x32_bf16 v[164:167], v[40:43], v[100:103], v[164:167]
  ds_read_b64_tr_b16 v[26:27], v214 offset:51200
  v_mfma_f32_16x16x32_bf16 v[156:159], v[36:39], v[100:103], v[156:159]
  ds_read_b64_tr_b16 v[28:29], v215 offset:49152
  v_mfma_f32_16x16x32_bf16 v[148:151], v[32:35], v[100:103], v[148:151]
  ds_read_b64_tr_b16 v[30:31], v215 offset:51200
  buffer_load_dwordx4 v[132:135], v221, s[20:23], s90 offen offset:0 sc1
  s_waitcnt lgkmcnt(8)
  s_waitcnt vmcnt(7)
  v_mfma_f32_16x16x32_bf16 v[144:147], v[48:51], v[104:107], v[144:147]
  ds_read_b64_tr_b16 v[32:33], v212 offset:53248
  v_mfma_f32_16x16x32_bf16 v[152:155], v[52:55], v[104:107], v[152:155]
  ds_read_b64_tr_b16 v[34:35], v212 offset:55296
  v_mfma_f32_16x16x32_bf16 v[160:163], v[56:59], v[104:107], v[160:163]
  ds_read_b64_tr_b16 v[36:37], v213 offset:53248
  v_mfma_f32_16x16x32_bf16 v[168:171], v[60:63], v[104:107], v[168:171]
  ds_read_b64_tr_b16 v[38:39], v213 offset:55296
  buffer_load_dwordx4 v[136:139], v220, s[20:23], s90 offen offset:2048 sc1
  s_waitcnt vmcnt(7)
  v_mfma_f32_16x16x32_bf16 v[172:175], v[60:63], v[108:111], v[172:175]
  ds_read_b64_tr_b16 v[40:41], v214 offset:53248
  v_mfma_f32_16x16x32_bf16 v[164:167], v[56:59], v[108:111], v[164:167]
  ds_read_b64_tr_b16 v[42:43], v214 offset:55296
  v_mfma_f32_16x16x32_bf16 v[156:159], v[52:55], v[108:111], v[156:159]
  ds_read_b64_tr_b16 v[44:45], v215 offset:53248
  v_mfma_f32_16x16x32_bf16 v[148:151], v[48:51], v[108:111], v[148:151]
  ds_read_b64_tr_b16 v[46:47], v215 offset:55296
  buffer_load_dwordx4 v[140:143], v221, s[20:23], s90 offen offset:2048 sc1
  s_waitcnt lgkmcnt(8)
  v_add_u32 v212, 65536, v212
  v_add_u32 v213, 65536, v213
  v_add_u32 v214, 65536, v214
  v_add_u32 v215, 65536, v215
  s_waitcnt vmcnt(7)
  v_mfma_f32_16x16x32_bf16 v[144:147], v[16:19], v[112:115], v[144:147]
  ds_read_b64_tr_b16 v[48:49], v212 offset:0
  v_mfma_f32_16x16x32_bf16 v[152:155], v[20:23], v[112:115], v[152:155]
  ds_read_b64_tr_b16 v[50:51], v212 offset:2048
  v_mfma_f32_16x16x32_bf16 v[160:163], v[24:27], v[112:115], v[160:163]
  ds_read_b64_tr_b16 v[52:53], v213 offset:0
  v_mfma_f32_16x16x32_bf16 v[168:171], v[28:31], v[112:115], v[168:171]
  ds_read_b64_tr_b16 v[54:55], v213 offset:2048
  buffer_load_dwordx4 v[80:83], v220, s[20:23], s91 offen offset:0 sc1
  s_waitcnt vmcnt(7)
  v_mfma_f32_16x16x32_bf16 v[172:175], v[28:31], v[116:119], v[172:175]
  ds_read_b64_tr_b16 v[56:57], v214 offset:0
  v_mfma_f32_16x16x32_bf16 v[164:167], v[24:27], v[116:119], v[164:167]
  ds_read_b64_tr_b16 v[58:59], v214 offset:2048
  v_mfma_f32_16x16x32_bf16 v[156:159], v[20:23], v[116:119], v[156:159]
  ds_read_b64_tr_b16 v[60:61], v215 offset:0
  v_mfma_f32_16x16x32_bf16 v[148:151], v[16:19], v[116:119], v[148:151]
  ds_read_b64_tr_b16 v[62:63], v215 offset:2048
  buffer_load_dwordx4 v[84:87], v221, s[20:23], s91 offen offset:0 sc1
  s_waitcnt lgkmcnt(8)
  s_waitcnt vmcnt(7)
  v_mfma_f32_16x16x32_bf16 v[144:147], v[32:35], v[120:123], v[144:147]
  ds_read_b64_tr_b16 v[16:17], v212 offset:4096
  v_mfma_f32_16x16x32_bf16 v[152:155], v[36:39], v[120:123], v[152:155]
  ds_read_b64_tr_b16 v[18:19], v212 offset:6144
  v_mfma_f32_16x16x32_bf16 v[160:163], v[40:43], v[120:123], v[160:163]
  ds_read_b64_tr_b16 v[20:21], v213 offset:4096
  v_mfma_f32_16x16x32_bf16 v[168:171], v[44:47], v[120:123], v[168:171]
  ds_read_b64_tr_b16 v[22:23], v213 offset:6144
  buffer_load_dwordx4 v[88:91], v220, s[20:23], s91 offen offset:2048 sc1
  s_waitcnt vmcnt(7)
  v_mfma_f32_16x16x32_bf16 v[172:175], v[44:47], v[124:127], v[172:175]
  ds_read_b64_tr_b16 v[24:25], v214 offset:4096
  v_mfma_f32_16x16x32_bf16 v[164:167], v[40:43], v[124:127], v[164:167]
  ds_read_b64_tr_b16 v[26:27], v214 offset:6144
  v_mfma_f32_16x16x32_bf16 v[156:159], v[36:39], v[124:127], v[156:159]
  ds_read_b64_tr_b16 v[28:29], v215 offset:4096
  v_mfma_f32_16x16x32_bf16 v[148:151], v[32:35], v[124:127], v[148:151]
  ds_read_b64_tr_b16 v[30:31], v215 offset:6144
  buffer_load_dwordx4 v[92:95], v221, s[20:23], s91 offen offset:2048 sc1
  s_waitcnt lgkmcnt(8)
  s_waitcnt vmcnt(7)
  v_mfma_f32_16x16x32_bf16 v[144:147], v[48:51], v[128:131], v[144:147]
  ds_read_b64_tr_b16 v[32:33], v212 offset:16384
  v_mfma_f32_16x16x32_bf16 v[152:155], v[52:55], v[128:131], v[152:155]
  ds_read_b64_tr_b16 v[34:35], v212 offset:18432
  v_mfma_f32_16x16x32_bf16 v[160:163], v[56:59], v[128:131], v[160:163]
  ds_read_b64_tr_b16 v[36:37], v213 offset:16384
  v_mfma_f32_16x16x32_bf16 v[168:171], v[60:63], v[128:131], v[168:171]
  ds_read_b64_tr_b16 v[38:39], v213 offset:18432
  buffer_load_dwordx4 v[96:99], v221, s[20:23], s92 offen offset:0 sc1
  s_waitcnt vmcnt(7)
  v_mfma_f32_16x16x32_bf16 v[172:175], v[60:63], v[132:135], v[172:175]
  ds_read_b64_tr_b16 v[40:41], v214 offset:16384
  v_mfma_f32_16x16x32_bf16 v[164:167], v[56:59], v[132:135], v[164:167]
  ds_read_b64_tr_b16 v[42:43], v214 offset:18432
  v_mfma_f32_16x16x32_bf16 v[156:159], v[52:55], v[132:135], v[156:159]
  ds_read_b64_tr_b16 v[44:45], v215 offset:16384
  v_mfma_f32_16x16x32_bf16 v[148:151], v[48:51], v[132:135], v[148:151]
  ds_read_b64_tr_b16 v[46:47], v215 offset:18432
  buffer_load_dwordx4 v[100:103], v221, s[20:23], s92 offen offset:2048 sc1
  s_waitcnt lgkmcnt(8)
  s_waitcnt vmcnt(7)
  v_mfma_f32_16x16x32_bf16 v[144:147], v[16:19], v[136:139], v[144:147]
  ds_read_b64_tr_b16 v[48:49], v212 offset:20480
  v_mfma_f32_16x16x32_bf16 v[152:155], v[20:23], v[136:139], v[152:155]
  ds_read_b64_tr_b16 v[50:51], v212 offset:22528
  v_mfma_f32_16x16x32_bf16 v[160:163], v[24:27], v[136:139], v[160:163]
  ds_read_b64_tr_b16 v[52:53], v213 offset:20480
  v_mfma_f32_16x16x32_bf16 v[168:171], v[28:31], v[136:139], v[168:171]
  ds_read_b64_tr_b16 v[54:55], v213 offset:22528
  buffer_load_dwordx4 v[104:107], v220, s[20:23], s92 offen offset:0 sc1
  s_waitcnt vmcnt(7)
  v_mfma_f32_16x16x32_bf16 v[172:175], v[28:31], v[140:143], v[172:175]
  ds_read_b64_tr_b16 v[56:57], v214 offset:20480
  v_mfma_f32_16x16x32_bf16 v[164:167], v[24:27], v[140:143], v[164:167]
  ds_read_b64_tr_b16 v[58:59], v214 offset:22528
  v_mfma_f32_16x16x32_bf16 v[156:159], v[20:23], v[140:143], v[156:159]
  ds_read_b64_tr_b16 v[60:61], v215 offset:20480
  v_mfma_f32_16x16x32_bf16 v[148:151], v[16:19], v[140:143], v[148:151]
  ds_read_b64_tr_b16 v[62:63], v215 offset:22528
  buffer_load_dwordx4 v[108:111], v220, s[20:23], s92 offen offset:2048 sc1
  s_waitcnt lgkmcnt(8)
  v_add_u32 v212, 4294852608, v212
  v_add_u32 v213, 4294852608, v213
  v_add_u32 v214, 4294852608, v214
  v_add_u32 v215, 4294852608, v215
  s_waitcnt vmcnt(7)
  v_mfma_f32_16x16x32_bf16 v[144:147], v[32:35], v[80:83], v[144:147]
  ds_read_b64_tr_b16 v[16:17], v212 offset:0
  v_mfma_f32_16x16x32_bf16 v[152:155], v[36:39], v[80:83], v[152:155]
  ds_read_b64_tr_b16 v[18:19], v212 offset:2048
  v_mfma_f32_16x16x32_bf16 v[160:163], v[40:43], v[80:83], v[160:163]
  ds_read_b64_tr_b16 v[20:21], v213 offset:0
  v_mfma_f32_16x16x32_bf16 v[168:171], v[44:47], v[80:83], v[168:171]
  ds_read_b64_tr_b16 v[22:23], v213 offset:2048
  s_waitcnt vmcnt(6)
  v_mfma_f32_16x16x32_bf16 v[172:175], v[44:47], v[84:87], v[172:175]
  ds_read_b64_tr_b16 v[24:25], v214 offset:0
  v_mfma_f32_16x16x32_bf16 v[164:167], v[40:43], v[84:87], v[164:167]
  ds_read_b64_tr_b16 v[26:27], v214 offset:2048
  v_mfma_f32_16x16x32_bf16 v[156:159], v[36:39], v[84:87], v[156:159]
  ds_read_b64_tr_b16 v[28:29], v215 offset:0
  v_mfma_f32_16x16x32_bf16 v[148:151], v[32:35], v[84:87], v[148:151]
  ds_read_b64_tr_b16 v[30:31], v215 offset:2048
  s_waitcnt lgkmcnt(8)
  ds_read_b32 v3, v1 offset:52236
  s_waitcnt vmcnt(5)
  v_mfma_f32_16x16x32_bf16 v[144:147], v[48:51], v[88:91], v[144:147]
  ds_read_b64_tr_b16 v[32:33], v212 offset:4096
  v_mfma_f32_16x16x32_bf16 v[152:155], v[52:55], v[88:91], v[152:155]
  ds_read_b64_tr_b16 v[34:35], v212 offset:6144
  v_mfma_f32_16x16x32_bf16 v[160:163], v[56:59], v[88:91], v[160:163]
  ds_read_b64_tr_b16 v[36:37], v213 offset:4096
  v_mfma_f32_16x16x32_bf16 v[168:171], v[60:63], v[88:91], v[168:171]
  ds_read_b64_tr_b16 v[38:39], v213 offset:6144
  s_waitcnt vmcnt(4)
  v_mfma_f32_16x16x32_bf16 v[172:175], v[60:63], v[92:95], v[172:175]
  ds_read_b64_tr_b16 v[40:41], v214 offset:4096
  v_mfma_f32_16x16x32_bf16 v[164:167], v[56:59], v[92:95], v[164:167]
  ds_read_b64_tr_b16 v[42:43], v214 offset:6144
  v_mfma_f32_16x16x32_bf16 v[156:159], v[52:55], v[92:95], v[156:159]
  ds_read_b64_tr_b16 v[44:45], v215 offset:4096
  v_mfma_f32_16x16x32_bf16 v[148:151], v[48:51], v[92:95], v[148:151]
  ds_read_b64_tr_b16 v[46:47], v215 offset:6144
  s_waitcnt lgkmcnt(8)
  v_cmp_ne_u32 vcc, s41, v3
  s_and_b32 s61, vcc_lo, 15
  s_cbranch_scc0 L_fe_ok
  s_mov_b32 s60, 400000
L_fe:
  s_sleep 1
  ds_read_b32 v3, v1 offset:52236
  s_waitcnt lgkmcnt(0)
  v_cmp_ne_u32 vcc, s41, v3
  s_and_b32 s61, vcc_lo, 15
  s_cbranch_scc0 L_fe_go
  s_sub_u32 s60, s60, 1
  s_cbranch_scc0 L_fe
L_fe_go:
L_fe_ok:
  s_waitcnt vmcnt(3)
  v_mfma_f32_16x16x32_bf16 v[172:175], v[28:31], v[96:99], v[172:175]
  v_mfma_f32_16x16x32_bf16 v[164:167], v[24:27], v[96:99], v[164:167]
  v_mfma_f32_16x16x32_bf16 v[156:159], v[20:23], v[96:99], v[156:159]
  v_mfma_f32_16x16x32_bf16 v[148:151], v[16:19], v[96:99], v[148:151]
  s_waitcnt lgkmcnt(0)
  s_waitcnt vmcnt(2)
  v_mfma_f32_16x16x32_bf16 v[172:175], v[44:47], v[100:103], v[172:175]
  v_mfma_f32_16x16x32_bf16 v[164:167], v[40:43], v[100:103], v[164:167]
  v_mfma_f32_16x16x32_bf16 v[156:159], v[36:39], v[100:103], v[156:159]
  v_mfma_f32_16x16x32_bf16 v[148:151], v[32:35], v[100:103], v[148:151]
  s_waitcnt vmcnt(1)
  v_mfma_f32_16x16x32_bf16 v[168:171], v[28:31], v[104:107], v[168:171]
  v_mfma_f32_16x16x32_bf16 v[160:163], v[24:27], v[104:107], v[160:163]
  v_mfma_f32_16x16x32_bf16 v[152:155], v[20:23], v[104:107], v[152:155]
  v_mfma_f32_16x16x32_bf16 v[144:147], v[16:19], v[104:107], v[144:147]
  s_waitcnt vmcnt(0)
  v_mfma_f32_16x16x32_bf16 v[168:171], v[44:47], v[108:111], v[168:171]
  ds_write_b128 v227, v[172:175] offset:35840
  v_mfma_f32_16x16x32_bf16 v[160:163], v[40:43], v[108:111], v[160:163]
  ds_write_b128 v227, v[164:167] offset:34816
  v_mfma_f32_16x16x32_bf16 v[152:155], v[36:39], v[108:111], v[152:155]
  ds_write_b128 v227, v[156:159] offset:52224
  v_mfma_f32_16x16x32_bf16 v[144:147], v[32:35], v[108:111], v[144:147]
  ds_write_b128 v227, v[148:151] offset:51200
  s_nop 1
  ds_write_b128 v226, v[168:171] offset:33792
  ds_write_b128 v226, v[160:163] offset:32768
  s_waitcnt lgkmcnt(0)
  s_barrier
  ds_read_b128 v[132:135], v226 offset:18432
  ds_read_b128 v[176:179], v226 offset:51200
  ds_read_b128 v[180:183], v226 offset:52224
  ds_read_b32 v72, v226 offset:19456
  ds_read_b128 v[112:115], v226 offset:16384
  ds_read_b128 v[116:119], v226 offset:17408
  v_add_u32 v226, 49152, v226
  s_waitcnt lgkmcnt(5)
  v_lshlrev_b32 v200, 16, v132
  v_and_b32 v201, 0xffff0000, v132
  v_lshlrev_b32 v202, 16, v133
  v_and_b32 v203, 0xffff0000, v133
  v_lshlrev_b32 v204, 16, v134
  v_and_b32 v205, 0xffff0000, v134
  v_lshlrev_b32 v206, 16, v135
  v_and_b32 v207, 0xffff0000, v135
  v_pk_add_f32 v[192:193], v[144:145], v[200:201]
  v_pk_add_f32 v[194:195], v[146:147], v[202:203]
  v_pk_add_f32 v[196:197], v[152:153], v[204:205]
  v_pk_add_f32 v[198:199], v[154:155], v[206:207]
  s_waitcnt lgkmcnt(2)
  v_pk_add_f32 v[192:193], v[192:193], v[176:177]
  v_pk_add_f32 v[194:195], v[194:195], v[178:179]
  v_pk_add_f32 v[196:197], v[196:197], v[180:181]
  v_pk_add_f32 v[198:199], v[198:199], v[182:183]
  s_branch L_fin
L_dft:
  s_add_u32 s37, s44, s43
  s_sub_u32 s45, 32, s37
  s_cmp_eq_u32 s37, 0
  s_cselect_b32 s45, 16, s45
  s_cmp_eq_u32 s39, 0
  s_cselect_b32 s42, s37, s45
  s_getpc_b64 s[4:5]
  s_add_u32 s4, s4, dft_tables@rel32@lo+4
  s_addc_u32 s5, s5, dft_tables@rel32@hi+12
  s_mov_b32 s6, 139264
  s_lshl_b32 s43, s36, 8
  s_add_u32 s43, s43, s42
  s_mul_i32 s43, s43, 896
  v_lshrrev_b32 v10, 3, v0
  v_and_b32 v11, 7, v0
  v_mul_u32_u24 v4, 28672, v10
  v_lshl_add_u32 v4, v11, 4, v4
  v_cmp_gt_u32 vcc, 4, v11
  v_mov_b32 v5, 0x40000000
  s_lshl_b32 s44, s36, 14
  v_cndmask_b32 v5, v5, v4, vcc
  s_mov_b64 s[46:47], vcc
  v_lshlrev_b32 v15, 7, v0
  s_waitcnt lgkmcnt(0)
  s_cmp_eq_u32 s36, 3
  s_cbranch_scc0 L_ntdt
  s_mov_b32 exec_lo, 0x1f
  s_mov_b32 exec_hi, 0
  s_mul_i32 s61, s2, 640
  buffer_load_dword v235, v15, s[4:7], s61 offen
  s_mov_b64 exec, -1
L_ntdt:
  buffer_load_dwordx4 v[16:19], v4, s[8:11], s43 offen offset:0
  buffer_load_dwordx4 v[32:35], v4, s[8:11], s43 offen offset:448
  buffer_load_dwordx4 v[20:23], v4, s[8:11], s43 offen offset:128
  buffer_load_dwordx4 v[36:39], v4, s[8:11], s43 offen offset:576
  buffer_load_dwordx4 v[24:27], v4, s[8:11], s43 offen offset:256
  buffer_load_dwordx4 v[40:43], v4, s[8:11], s43 offen offset:704
  buffer_load_dwordx4 v[28:31], v5, s[8:11], s43 offen offset:384
  buffer_load_dwordx4 v[44:47], v5, s[8:11], s43 offen offset:832
  s_lshl_b32 s45, s36, 10
  s_add_u32 m0, s45, 0
  s_add_u32 s45, s45, 131072
  buffer_load_dwordx4 v1, s[4:7], s45 offen lds
  s_lshl_b32 s45, s2, 3
  s_add_u32 s45, s45, s36
  s_lshl_b32 s45, s45, 7
  s_add_u32 s45, s45, 10747904
  s_load_dword s35, s[20:21], s45 glc
  s_add_u32 s45, s45, 65536
  s_load_dword s34, s[20:21], s45 glc
  s_lshl_b32 s45, s36, 3
  s_add_u32 s45, s45, 10682368
  s_load_dwordx2 s[30:31], s[20:21], s45
  s_and_b32 s45, s2, 7
  s_lshl_b32 s45, s45, 3
  s_add_u32 s45, s45, s36
  s_lshl_b32 s45, s45, 7
  s_add_u32 s45, s45, 10616832
  s_load_dword s33, s[20:21], s45 glc
  v_mov_b32 v13, 0x3f803f80
  v_mov_b32 v48, 0
  v_mov_b32 v49, 0
  v_mov_b32 v50, 0
  v_mov_b32 v51, 0
  s_waitcnt vmcnt(7)
  v_dot2_f32_bf16 v48, v16, v13, v48
  v_dot2_f32_bf16 v49, v16, v16, v49
  v_dot2_f32_bf16 v50, v32, v13, v50
  v_dot2_f32_bf16 v51, v32, v32, v51
  v_dot2_f32_bf16 v48, v17, v13, v48
  v_dot2_f32_bf16 v49, v17, v17, v49
  v_dot2_f32_bf16 v50, v33, v13, v50
  v_dot2_f32_bf16 v51, v33, v33, v51
  v_dot2_f32_bf16 v48, v18, v13, v48
  v_dot2_f32_bf16 v49, v18, v18, v49
  v_dot2_f32_bf16 v50, v34, v13, v50
  v_dot2_f32_bf16 v51, v34, v34, v51
  v_dot2_f32_bf16 v48, v19, v13, v48
  v_dot2_f32_bf16 v49, v19, v19, v49
  v_dot2_f32_bf16 v50, v35, v13, v50
  v_dot2_f32_bf16 v51, v35, v35, v51
  s_waitcnt vmcnt(5)
  v_dot2_f32_bf16 v48, v20, v13, v48
  v_dot2_f32_bf16 v49, v20, v20, v49
  v_dot2_f32_bf16 v50, v36, v13, v50
  v_dot2_f32_bf16 v51, v36, v36, v51
  v_dot2_f32_bf16 v48, v21, v13, v48
  v_dot2_f32_bf16 v49, v21, v21, v49
  v_dot2_f32_bf16 v50, v37, v13, v50
  v_dot2_f32_bf16 v51, v37, v37, v51
  v_dot2_f32_bf16 v48, v22, v13, v48
  v_dot2_f32_bf16 v49, v22, v22, v49
  v_dot2_f32_bf16 v50, v38, v13, v50
  v_dot2_f32_bf16 v51, v38, v38, v51
  v_dot2_f32_bf16 v48, v23, v13, v48
  v_dot2_f32_bf16 v49, v23, v23, v49
  v_dot2_f32_bf16 v50, v39, v13, v50
  v_dot2_f32_bf16 v51, v39, v39, v51
  s_waitcnt vmcnt(3)
  v_dot2_f32_bf16 v48, v24, v13, v48
  v_dot2_f32_bf16 v49, v24, v24, v49
  v_dot2_f32_bf16 v50, v40, v13, v50
  v_dot2_f32_bf16 v51, v40, v40, v51
  v_dot2_f32_bf16 v48, v25, v13, v48
  v_dot2_f32_bf16 v49, v25, v25, v49
  v_dot2_f32_bf16 v50, v41, v13, v50
  v_dot2_f32_bf16 v51, v41, v41, v51
  v_dot2_f32_bf16 v48, v26, v13, v48
  v_dot2_f32_bf16 v49, v26, v26, v49
  v_dot2_f32_bf16 v50, v42, v13, v50
  v_dot2_f32_bf16 v51, v42, v42, v51
  v_dot2_f32_bf16 v48, v27, v13, v48
  v_dot2_f32_bf16 v49, v27, v27, v49
  v_dot2_f32_bf16 v50, v43, v13, v50
  v_dot2_f32_bf16 v51, v43, v43, v51
  s_waitcnt vmcnt(1)
  v_dot2_f32_bf16 v48, v28, v13, v48
  v_dot2_f32_bf16 v49, v28, v28, v49
  v_dot2_f32_bf16 v50, v44, v13, v50
  v_dot2_f32_bf16 v51, v44, v44, v51
  v_dot2_f32_bf16 v48, v29, v13, v48
  v_dot2_f32_bf16 v49, v29, v29, v49
  v_dot2_f32_bf16 v50, v45, v13, v50
  v_dot2_f32_bf16 v51, v45, v45, v51
  v_dot2_f32_bf16 v48, v30, v13, v48
  v_dot2_f32_bf16 v49, v30, v30, v49
  v_dot2_f32_bf16 v50, v46, v13, v50
  v_dot2_f32_bf16 v51, v46, v46, v51
  v_dot2_f32_bf16 v48, v31, v13, v48
  v_dot2_f32_bf16 v49, v31, v31, v49
  v_dot2_f32_bf16 v50, v47, v13, v50
  v_dot2_f32_bf16 v51, v47, v47, v51
  s_lshl_b32 s49, s2, 3
  s_add_u32 s49, s49, s36
  s_mul_i32 s49, s49, 6272
  s_mov_b32 exec_hi, 0x1ffff
  buffer_load_dword v235, v15, s[16:19], s49 offen
  s_mov_b64 exec, -1
  s_lshl_b32 s45, s36, 3
  v_add_u32 v14, s45, v10
  v_mul_u32_u24 v6, 480, v14
  v_lshl_add_u32 v6, v11, 3, v6
  v_add_f32 v48, v48, v50
  v_add_f32 v49, v49, v51
  v_lshlrev_b32 v14, 2, v14
  s_nop 0
  v_add_f32_dpp v48, v48, v48 quad_perm:[1,0,3,2] row_mask:0xf bank_mask:0xf
  v_add_f32_dpp v49, v49, v49 quad_perm:[1,0,3,2] row_mask:0xf bank_mask:0xf
  s_nop 0
  v_add_f32_dpp v48, v48, v48 quad_perm:[2,3,0,1] row_mask:0xf bank_mask:0xf
  v_add_f32_dpp v49, v49, v49 quad_perm:[2,3,0,1] row_mask:0xf bank_mask:0xf
  s_nop 0
  v_add_f32_dpp v48, v48, v48 row_half_mirror row_mask:0xf bank_mask:0xf
  v_add_f32_dpp v49, v49, v49 row_half_mirror row_mask:0xf bank_mask:0xf
  v_mul_f32 v48, 0x3b124925, v48
  v_mul_f32 v49, 0x3b124925, v49
  v_fma_f32 v49, -v48, v48, v49
  v_max_f32 v49, 0, v49
  v_cvt_pk_bf16_f32 v48, v49, v48
  v_lshlrev_b32 v49, 16, v48
  v_and_b32 v48, 0xffff0000, v48
  v_add_f32 v49, 0x3727c5ac, v49
  v_cvt_pk_bf16_f32 v49, v49, v49
  v_lshlrev_b32 v49, 16, v49
  v_sqrt_f32 v49, v49
  s_nop 0
  v_cvt_pk_bf16_f32 v49, v49, v49
  v_lshlrev_b32 v49, 16, v49
  v_rcp_f32 v50, v49
  s_lshl_b32 s45, s42, 8
  s_add_u32 s45, s45, 10485760
  v_mul_f32 v52, v48, v50
  v_mul_f32 v52, -2.0, v52
  s_mov_b32 s48, 0xffff0000
  s_mov_b32 exec_lo, 0x01010101
  s_mov_b32 exec_hi, 0x01010101
  buffer_store_dword v50, v14, s[20:23], s45 offen sc1
  s_mov_b64 exec, -1
  v_lshlrev_b32 v54, 16, v16
  v_and_b32 v55, s48, v16
  v_lshlrev_b32 v56, 16, v32
  v_and_b32 v57, s48, v32
  v_pk_add_f32 v[96:97], v[54:55], v[56:57]
  v_pk_add_f32 v[98:99], v[54:55], v[56:57] neg_lo:[0,1] neg_hi:[0,1]
  v_pk_fma_f32 v[96:97], v[96:97], v[50:51], v[52:53] op_sel_hi:[1,0,0]
  v_pk_mul_f32 v[98:99], v[98:99], v[50:51] op_sel_hi:[1,0]
  v_lshlrev_b32 v54, 16, v17
  v_and_b32 v55, s48, v17
  v_lshlrev_b32 v56, 16, v33
  v_and_b32 v57, s48, v33
  v_pk_add_f32 v[100:101], v[54:55], v[56:57]
  v_pk_add_f32 v[102:103], v[54:55], v[56:57] neg_lo:[0,1] neg_hi:[0,1]
  v_pk_fma_f32 v[100:101], v[100:101], v[50:51], v[52:53] op_sel_hi:[1,0,0]
  v_pk_mul_f32 v[102:103], v[102:103], v[50:51] op_sel_hi:[1,0]
  v_cvt_pk_bf16_f32 v64, v96, v100
  v_cvt_pk_bf16_f32 v66, v97, v101
  v_cvt_pk_bf16_f32 v68, v98, v102
  v_cvt_pk_bf16_f32 v70, v99, v103
  buffer_load_dwordx4 v[128:131], v1, s[4:7], s44 offen offset:0
  v_lshlrev_b32 v54, 16, v18
  v_and_b32 v55, s48, v18
  v_lshlrev_b32 v56, 16, v34
  v_and_b32 v57, s48, v34
  v_pk_add_f32 v[96:97], v[54:55], v[56:57]
  v_pk_add_f32 v[98:99], v[54:55], v[56:57] neg_lo:[0,1] neg_hi:[0,1]
  v_pk_fma_f32 v[96:97], v[96:97], v[50:51], v[52:53] op_sel_hi:[1,0,0]
  v_pk_mul_f32 v[98:99], v[98:99], v[50:51] op_sel_hi:[1,0]
  v_lshlrev_b32 v54, 16, v19
  v_and_b32 v55, s48, v19
  v_lshlrev_b32 v56, 16, v35
  v_and_b32 v57, s48, v35
  v_pk_add_f32 v[100:101], v[54:55], v[56:57]
  v_pk_add_f32 v[102:103], v[54:55], v[56:57] neg_lo:[0,1] neg_hi:[0,1]
  v_pk_fma_f32 v[100:101], v[100:101], v[50:51], v[52:53] op_sel_hi:[1,0,0]
  v_pk_mul_f32 v[102:103], v[102:103], v[50:51] op_sel_hi:[1,0]
  v_cvt_pk_bf16_f32 v65, v96, v100
  v_cvt_pk_bf16_f32 v67, v97, v101
  v_cvt_pk_bf16_f32 v69, v98, v102
  v_cvt_pk_bf16_f32 v71, v99, v103
  buffer_load_dwordx4 v[132:135], v1, s[4:7], s44 offen offset:1024
  ds_write_b64 v6, v[66:67] offset:8416
  ds_write_b64 v6, v[70:71] offset:39136
  ds_write_b64 v6, v[64:65] offset:8192
  ds_write_b64 v6, v[68:69] offset:38912
  v_lshlrev_b32 v54, 16, v20
  v_and_b32 v55, s48, v20
  v_lshlrev_b32 v56, 16, v36
  v_and_b32 v57, s48, v36
  v_pk_add_f32 v[96:97], v[54:55], v[56:57]
  v_pk_add_f32 v[98:99], v[54:55], v[56:57] neg_lo:[0,1] neg_hi:[0,1]
  v_pk_fma_f32 v[96:97], v[96:97], v[50:51], v[52:53] op_sel_hi:[1,0,0]
  v_pk_mul_f32 v[98:99], v[98:99], v[50:51] op_sel_hi:[1,0]
  v_lshlrev_b32 v54, 16, v21
  v_and_b32 v55, s48, v21
  v_lshlrev_b32 v56, 16, v37
  v_and_b32 v57, s48, v37
  v_pk_add_f32 v[100:101], v[54:55], v[56:57]
  v_pk_add_f32 v[102:103], v[54:55], v[56:57] neg_lo:[0,1] neg_hi:[0,1]
  v_pk_fma_f32 v[100:101], v[100:101], v[50:51], v[52:53] op_sel_hi:[1,0,0]
  v_pk_mul_f32 v[102:103], v[102:103], v[50:51] op_sel_hi:[1,0]
  v_cvt_pk_bf16_f32 v72, v96, v100
  v_cvt_pk_bf16_f32 v74, v97, v101
  v_cvt_pk_bf16_f32 v76, v98, v102
  v_cvt_pk_bf16_f32 v78, v99, v103
  buffer_load_dwordx4 v[136:139], v1, s[4:7], s44 offen offset:2048
  v_lshlrev_b32 v54, 16, v22
  v_and_b32 v55, s48, v22
  v_lshlrev_b32 v56, 16, v38
  v_and_b32 v57, s48, v38
  v_pk_add_f32 v[96:97], v[54:55], v[56:57]
  v_pk_add_f32 v[98:99], v[54:55], v[56:57] neg_lo:[0,1] neg_hi:[0,1]
  v_pk_fma_f32 v[96:97], v[96:97], v[50:51], v[52:53] op_sel_hi:[1,0,0]
  v_pk_mul_f32 v[98:99], v[98:99], v[50:51] op_sel_hi:[1,0]
  v_lshlrev_b32 v54, 16, v23
  v_and_b32 v55, s48, v23
  v_lshlrev_b32 v56, 16, v39
  v_and_b32 v57, s48, v39
  v_pk_add_f32 v[100:101], v[54:55], v[56:57]
  v_pk_add_f32 v[102:103], v[54:55], v[56:57] neg_lo:[0,1] neg_hi:[0,1]
  v_pk_fma_f32 v[100:101], v[100:101], v[50:51], v[52:53] op_sel_hi:[1,0,0]
  v_pk_mul_f32 v[102:103], v[102:103], v[50:51] op_sel_hi:[1,0]
  v_cvt_pk_bf16_f32 v73, v96, v100
  v_cvt_pk_bf16_f32 v75, v97, v101
  v_cvt_pk_bf16_f32 v77, v98, v102
  v_cvt_pk_bf16_f32 v79, v99, v103
  buffer_load_dwordx4 v[140:143], v1, s[4:7], s44 offen offset:3072
  ds_write_b64 v6, v[74:75] offset:8480
  ds_write_b64 v6, v[78:79] offset:39200
  ds_write_b64 v6, v[72:73] offset:8256
  ds_write_b64 v6, v[76:77] offset:38976
  v_lshlrev_b32 v54, 16, v24
  v_and_b32 v55, s48, v24
  v_lshlrev_b32 v56, 16, v40
  v_and_b32 v57, s48, v40
  v_pk_add_f32 v[96:97], v[54:55], v[56:57]
  v_pk_add_f32 v[98:99], v[54:55], v[56:57] neg_lo:[0,1] neg_hi:[0,1]
  v_pk_fma_f32 v[96:97], v[96:97], v[50:51], v[52:53] op_sel_hi:[1,0,0]
  v_pk_mul_f32 v[98:99], v[98:99], v[50:51] op_sel_hi:[1,0]
  v_lshlrev_b32 v54, 16, v25
  v_and_b32 v55, s48, v25
  v_lshlrev_b32 v56, 16, v41
  v_and_b32 v57, s48, v41
  v_pk_add_f32 v[100:101], v[54:55], v[56:57]
  v_pk_add_f32 v[102:103], v[54:55], v[56:57] neg_lo:[0,1] neg_hi:[0,1]
  v_pk_fma_f32 v[100:101], v[100:101], v[50:51], v[52:53] op_sel_hi:[1,0,0]
  v_pk_mul_f32 v[102:103], v[102:103], v[50:51] op_sel_hi:[1,0]
  v_cvt_pk_bf16_f32 v80, v96, v100
  v_cvt_pk_bf16_f32 v82, v97, v101
  v_cvt_pk_bf16_f32 v84, v98, v102
  v_cvt_pk_bf16_f32 v86, v99, v103
  s_add_u32 s44, s44, 4096
  buffer_load_dwordx4 v[144:147], v1, s[4:7], s44 offen offset:0
  v_lshlrev_b32 v54, 16, v26
  v_and_b32 v55, s48, v26
  v_lshlrev_b32 v56, 16, v42
  v_and_b32 v57, s48, v42
  v_pk_add_f32 v[96:97], v[54:55], v[56:57]
  v_pk_add_f32 v[98:99], v[54:55], v[56:57] neg_lo:[0,1] neg_hi:[0,1]
  v_pk_fma_f32 v[96:97], v[96:97], v[50:51], v[52:53] op_sel_hi:[1,0,0]
  v_pk_mul_f32 v[98:99], v[98:99], v[50:51] op_sel_hi:[1,0]
  v_lshlrev_b32 v54, 16, v27
  v_and_b32 v55, s48, v27
  v_lshlrev_b32 v56, 16, v43
  v_and_b32 v57, s48, v43
  v_pk_add_f32 v[100:101], v[54:55], v[56:57]
  v_pk_add_f32 v[102:103], v[54:55], v[56:57] neg_lo:[0,1] neg_hi:[0,1]
  v_pk_fma_f32 v[100:101], v[100:101], v[50:51], v[52:53] op_sel_hi:[1,0,0]
  v_pk_mul_f32 v[102:103], v[102:103], v[50:51] op_sel_hi:[1,0]
  v_cvt_pk_bf16_f32 v81, v96, v100
  v_cvt_pk_bf16_f32 v83, v97, v101
  v_cvt_pk_bf16_f32 v85, v98, v102
  v_cvt_pk_bf16_f32 v87, v99, v103
  buffer_load_dwordx4 v[148:151], v1, s[4:7], s44 offen offset:1024
  ds_write_b64 v6, v[82:83] offset:8544
  ds_write_b64 v6, v[86:87] offset:39264
  ds_write_b64 v6, v[80:81] offset:8320
  ds_write_b64 v6, v[84:85] offset:39040
  v_lshlrev_b32 v54, 16, v28
  v_and_b32 v55, s48, v28
  v_lshlrev_b32 v56, 16, v44
  v_and_b32 v57, s48, v44
  v_pk_add_f32 v[96:97], v[54:55], v[56:57]
  v_pk_add_f32 v[98:99], v[54:55], v[56:57] neg_lo:[0,1] neg_hi:[0,1]
  v_pk_fma_f32 v[96:97], v[96:97], v[50:51], v[52:53] op_sel_hi:[1,0,0]
  v_pk_mul_f32 v[98:99], v[98:99], v[50:51] op_sel_hi:[1,0]
  v_lshlrev_b32 v54, 16, v29
  v_and_b32 v55, s48, v29
  v_lshlrev_b32 v56, 16, v45
  v_and_b32 v57, s48, v45
  v_pk_add_f32 v[100:101], v[54:55], v[56:57]
  v_pk_add_f32 v[102:103], v[54:55], v[56:57] neg_lo:[0,1] neg_hi:[0,1]
  v_pk_fma_f32 v[100:101], v[100:101], v[50:51], v[52:53] op_sel_hi:[1,0,0]
  v_pk_mul_f32 v[102:103], v[102:103], v[50:51] op_sel_hi:[1,0]
  v_cvt_pk_bf16_f32 v88, v96, v100
  v_cvt_pk_bf16_f32 v90, v97, v101
  v_cvt_pk_bf16_f32 v92, v98, v102
  v_cvt_pk_bf16_f32 v94, v99, v103
  buffer_load_dwordx4 v[152:155], v1, s[4:7], s44 offen offset:2048
  v_lshlrev_b32 v54, 16, v30
  v_and_b32 v55, s48, v30
  v_lshlrev_b32 v56, 16, v46
  v_and_b32 v57, s48, v46
  v_pk_add_f32 v[96:97], v[54:55], v[56:57]
  v_pk_add_f32 v[98:99], v[54:55], v[56:57] neg_lo:[0,1] neg_hi:[0,1]
  v_pk_fma_f32 v[96:97], v[96:97], v[50:51], v[52:53] op_sel_hi:[1,0,0]
  v_pk_mul_f32 v[98:99], v[98:99], v[50:51] op_sel_hi:[1,0]
  v_lshlrev_b32 v54, 16, v31
  v_and_b32 v55, s48, v31
  v_lshlrev_b32 v56, 16, v47
  v_and_b32 v57, s48, v47
  v_pk_add_f32 v[100:101], v[54:55], v[56:57]
  v_pk_add_f32 v[102:103], v[54:55], v[56:57] neg_lo:[0,1] neg_hi:[0,1]
  v_pk_fma_f32 v[100:101], v[100:101], v[50:51], v[52:53] op_sel_hi:[1,0,0]
  v_pk_mul_f32 v[102:103], v[102:103], v[50:51] op_sel_hi:[1,0]
  v_cvt_pk_bf16_f32 v89, v96, v100
  v_cvt_pk_bf16_f32 v91, v97, v101
  v_cvt_pk_bf16_f32 v93, v98, v102
  v_cvt_pk_bf16_f32 v95, v99, v103
  buffer_load_dwordx4 v[156:159], v1, s[4:7], s44 offen offset:3072
  ds_write_b64 v6, v[90:91] offset:8608
  ds_write_b64 v6, v[94:95] offset:39328
  s_mov_b64 exec, s[46:47]
  ds_write_b64 v6, v[88:89] offset:8384
  ds_write_b64 v6, v[92:93] offset:39104
  s_mov_b64 exec, -1
  s_add_u32 s44, s44, 4096
  buffer_load_dwordx4 v[160:163], v1, s[4:7], s44 offen offset:0
  buffer_load_dwordx4 v[164:167], v1, s[4:7], s44 offen offset:1024
  buffer_load_dwordx4 v[168:171], v1, s[4:7], s44 offen offset:2048
  buffer_load_dwordx4 v[172:175], v1, s[4:7], s44 offen offset:3072
  s_add_u32 s44, s44, 4096
  buffer_load_dwordx4 v[176:179], v1, s[4:7], s44 offen offset:0
  buffer_load_dwordx4 v[180:183], v1, s[4:7], s44 offen offset:1024
  buffer_load_dwordx4 v[184:187], v1, s[4:7], s44 offen offset:2048
  buffer_load_dwordx4 v[188:191], v1, s[4:7], s44 offen offset:3072
  v_and_b32 v10, 15, v0
  v_lshrrev_b32 v11, 4, v0
  v_mul_u32_u24 v6, 480, v10
  v_lshl_add_u32 v6, v11, 4, v6
  s_lshr_b32 s45, s36, 2
  s_mul_i32 s43, s45, 30720
  v_add_u32 v6, s43, v6
  s_lshl_b32 s43, s36, 13
  s_add_u32 s43, s43, 81920
  v_add_u32 v7, s43, v1
  v_xor_b32 v8, 8192, v7
  v_mov_b32 v2, 0
  ds_write_b32 v7, v2 offset:4096
  s_waitcnt vmcnt(16) lgkmcnt(0)
  s_barrier
  ds_read_b128 v[16:19], v6 offset:8192
  ds_read_b128 v[20:23], v6 offset:15872
  ds_read_b128 v[24:27], v6 offset:23552
  ds_read_b128 v[28:31], v6 offset:31232
  s_waitcnt vmcnt(14) lgkmcnt(0)
  v_mfma_f32_16x16x32_bf16 v[64:67], v[16:19], v[128:131], 0
  ds_read_b128 v[32:35], v6 offset:8416
  v_mfma_f32_16x16x32_bf16 v[68:71], v[16:19], v[132:135], 0
  ds_read_b128 v[36:39], v6 offset:16096
  v_mfma_f32_16x16x32_bf16 v[80:83], v[20:23], v[128:131], 0
  ds_read_b128 v[40:43], v6 offset:23776
  v_mfma_f32_16x16x32_bf16 v[84:87], v[20:23], v[132:135], 0
  ds_read_b128 v[44:47], v6 offset:31456
  v_mfma_f32_16x16x32_bf16 v[96:99], v[24:27], v[128:131], 0
  v_mfma_f32_16x16x32_bf16 v[100:103], v[24:27], v[132:135], 0
  v_mfma_f32_16x16x32_bf16 v[112:115], v[28:31], v[128:131], 0
  v_mfma_f32_16x16x32_bf16 v[116:119], v[28:31], v[132:135], 0
  s_waitcnt vmcnt(12) lgkmcnt(0)
  v_mfma_f32_16x16x32_bf16 v[72:75], v[32:35], v[136:139], 0
  ds_read_b128 v[16:19], v6 offset:8256
  v_mfma_f32_16x16x32_bf16 v[76:79], v[32:35], v[140:143], 0
  ds_read_b128 v[20:23], v6 offset:15936
  v_mfma_f32_16x16x32_bf16 v[88:91], v[36:39], v[136:139], 0
  ds_read_b128 v[24:27], v6 offset:23616
  v_mfma_f32_16x16x32_bf16 v[92:95], v[36:39], v[140:143], 0
  ds_read_b128 v[28:31], v6 offset:31296
  v_mfma_f32_16x16x32_bf16 v[104:107], v[40:43], v[136:139], 0
  v_mfma_f32_16x16x32_bf16 v[108:111], v[40:43], v[140:143], 0
  v_mfma_f32_16x16x32_bf16 v[120:123], v[44:47], v[136:139], 0
  v_mfma_f32_16x16x32_bf16 v[124:127], v[44:47], v[140:143], 0
  s_waitcnt vmcnt(10) lgkmcnt(0)
  v_mfma_f32_16x16x32_bf16 v[64:67], v[16:19], v[144:147], v[64:67]
  ds_read_b128 v[32:35], v6 offset:8480
  v_mfma_f32_16x16x32_bf16 v[68:71], v[16:19], v[148:151], v[68:71]
  ds_read_b128 v[36:39], v6 offset:16160
  v_mfma_f32_16x16x32_bf16 v[80:83], v[20:23], v[144:147], v[80:83]
  ds_read_b128 v[40:43], v6 offset:23840
  v_mfma_f32_16x16x32_bf16 v[84:87], v[20:23], v[148:151], v[84:87]
  ds_read_b128 v[44:47], v6 offset:31520
  v_mfma_f32_16x16x32_bf16 v[96:99], v[24:27], v[144:147], v[96:99]
  v_mfma_f32_16x16x32_bf16 v[100:103], v[24:27], v[148:151], v[100:103]
  v_mfma_f32_16x16x32_bf16 v[112:115], v[28:31], v[144:147], v[112:115]
  v_mfma_f32_16x16x32_bf16 v[116:119], v[28:31], v[148:151], v[116:119]
  s_waitcnt vmcnt(8) lgkmcnt(0)
  v_mfma_f32_16x16x32_bf16 v[72:75], v[32:35], v[152:155], v[72:75]
  ds_read_b128 v[16:19], v6 offset:8320
  v_mfma_f32_16x16x32_bf16 v[76:79], v[32:35], v[156:159], v[76:79]
  ds_read_b128 v[20:23], v6 offset:16000
  v_mfma_f32_16x16x32_bf16 v[88:91], v[36:39], v[152:155], v[88:91]
  ds_read_b128 v[24:27], v6 offset:23680
  v_mfma_f32_16x16x32_bf16 v[92:95], v[36:39], v[156:159], v[92:95]
  ds_read_b128 v[28:31], v6 offset:31360
  v_mfma_f32_16x16x32_bf16 v[104:107], v[40:43], v[152:155], v[104:107]
  v_mfma_f32_16x16x32_bf16 v[108:111], v[40:43], v[156:159], v[108:111]
  v_mfma_f32_16x16x32_bf16 v[120:123], v[44:47], v[152:155], v[120:123]
  v_mfma_f32_16x16x32_bf16 v[124:127], v[44:47], v[156:159], v[124:127]
  s_waitcnt vmcnt(6) lgkmcnt(0)
  v_mfma_f32_16x16x32_bf16 v[64:67], v[16:19], v[160:163], v[64:67]
  ds_read_b128 v[32:35], v6 offset:8544
  v_mfma_f32_16x16x32_bf16 v[68:71], v[16:19], v[164:167], v[68:71]
  ds_read_b128 v[36:39], v6 offset:16224
  v_mfma_f32_16x16x32_bf16 v[80:83], v[20:23], v[160:163], v[80:83]
  ds_read_b128 v[40:43], v6 offset:23904
  v_mfma_f32_16x16x32_bf16 v[84:87], v[20:23], v[164:167], v[84:87]
  ds_read_b128 v[44:47], v6 offset:31584
  v_mfma_f32_16x16x32_bf16 v[96:99], v[24:27], v[160:163], v[96:99]
  v_mfma_f32_16x16x32_bf16 v[100:103], v[24:27], v[164:167], v[100:103]
  v_mfma_f32_16x16x32_bf16 v[112:115], v[28:31], v[160:163], v[112:115]
  v_mfma_f32_16x16x32_bf16 v[116:119], v[28:31], v[164:167], v[116:119]
  s_waitcnt vmcnt(4) lgkmcnt(0)
  v_mfma_f32_16x16x32_bf16 v[72:75], v[32:35], v[168:171], v[72:75]
  ds_read_b128 v[16:19], v6 offset:8384
  v_mfma_f32_16x16x32_bf16 v[76:79], v[32:35], v[172:175], v[76:79]
  ds_read_b128 v[20:23], v6 offset:16064
  v_mfma_f32_16x16x32_bf16 v[88:91], v[36:39], v[168:171], v[88:91]
  ds_read_b128 v[24:27], v6 offset:23744
  v_mfma_f32_16x16x32_bf16 v[92:95], v[36:39], v[172:175], v[92:95]
  ds_read_b128 v[28:31], v6 offset:31424
  v_mfma_f32_16x16x32_bf16 v[104:107], v[40:43], v[168:171], v[104:107]
  v_mfma_f32_16x16x32_bf16 v[108:111], v[40:43], v[172:175], v[108:111]
  v_mfma_f32_16x16x32_bf16 v[120:123], v[44:47], v[168:171], v[120:123]
  v_mfma_f32_16x16x32_bf16 v[124:127], v[44:47], v[172:175], v[124:127]
  s_waitcnt vmcnt(2) lgkmcnt(0)
  v_mfma_f32_16x16x32_bf16 v[64:67], v[16:19], v[176:179], v[64:67]
  ds_read_b128 v[32:35], v6 offset:8608
  v_mfma_f32_16x16x32_bf16 v[68:71], v[16:19], v[180:183], v[68:71]
  ds_read_b128 v[36:39], v6 offset:16288
  v_mfma_f32_16x16x32_bf16 v[80:83], v[20:23], v[176:179], v[80:83]
  ds_read_b128 v[40:43], v6 offset:23968
  v_mfma_f32_16x16x32_bf16 v[84:87], v[20:23], v[180:183], v[84:87]
  ds_read_b128 v[44:47], v6 offset:31648
  v_mfma_f32_16x16x32_bf16 v[96:99], v[24:27], v[176:179], v[96:99]
  v_mfma_f32_16x16x32_bf16 v[100:103], v[24:27], v[180:183], v[100:103]
  v_mfma_f32_16x16x32_bf16 v[112:115], v[28:31], v[176:179], v[112:115]
  v_mfma_f32_16x16x32_bf16 v[116:119], v[28:31], v[180:183], v[116:119]
  s_waitcnt vmcnt(0) lgkmcnt(0)
  v_mfma_f32_16x16x32_bf16 v[72:75], v[32:35], v[184:187], v[72:75]
  v_mfma_f32_16x16x32_bf16 v[76:79], v[32:35], v[188:191], v[76:79]
  v_mfma_f32_16x16x32_bf16 v[88:91], v[36:39], v[184:187], v[88:91]
  v_mfma_f32_16x16x32_bf16 v[92:95], v[36:39], v[188:191], v[92:95]
  v_mfma_f32_16x16x32_bf16 v[104:107], v[40:43], v[184:187], v[104:107]
  v_mfma_f32_16x16x32_bf16 v[108:111], v[40:43], v[188:191], v[108:111]
  v_mfma_f32_16x16x32_bf16 v[120:123], v[44:47], v[184:187], v[120:123]
  v_mfma_f32_16x16x32_bf16 v[124:127], v[44:47], v[188:191], v[124:127]
  ds_read_b128 v[128:131], v1 offset:0
  ds_read_b128 v[132:135], v1 offset:1024
  ds_read_b128 v[136:139], v1 offset:2048
  ds_read_b128 v[140:143], v1 offset:3072
  ds_read_b128 v[144:147], v1 offset:4096
  ds_read_b128 v[148:151], v1 offset:5120
  ds_read_b128 v[152:155], v1 offset:6144
  ds_read_b128 v[156:159], v1 offset:7168
  v_lshlrev_b32 v4, 17, v11
  v_lshl_add_u32 v4, v10, 4, v4
  s_lshl_b32 s43, s42, 1
  s_add_u32 s43, s43, s45
  s_lshl_b32 s43, s43, 10
  s_and_b32 s44, s36, 1
  s_lshl_b32 s48, s44, 9
  s_add_u32 s43, s43, s48
  s_and_b32 s48, s36, 2
  s_lshl_b32 s48, s48, 7
  s_add_u32 s43, s43, s48
  s_add_u32 s43, s43, 8388608
  v_add_f32 v48, v64, v72
  v_add_f32 v49, v65, v73
  v_add_f32 v50, v66, v74
  v_add_f32 v51, v67, v75
  v_sub_f32 v72, v64, v72
  v_sub_f32 v73, v65, v73
  v_sub_f32 v74, v66, v74
  v_sub_f32 v75, v67, v75
  v_cvt_pk_bf16_f32 v16, v48, v49
  v_cvt_pk_bf16_f32 v17, v50, v51
  v_cvt_pk_bf16_f32 v32, v72, v73
  v_cvt_pk_bf16_f32 v33, v74, v75
  v_add_f32 v48, v68, v76
  v_add_f32 v49, v69, v77
  v_add_f32 v50, v70, v78
  v_add_f32 v51, v71, v79
  v_sub_f32 v76, v76, v68
  v_sub_f32 v77, v77, v69
  v_sub_f32 v78, v78, v70
  v_sub_f32 v79, v79, v71
  v_cvt_pk_bf16_f32 v24, v48, v49
  v_cvt_pk_bf16_f32 v25, v50, v51
  v_cvt_pk_bf16_f32 v40, v76, v77
  v_cvt_pk_bf16_f32 v41, v78, v79
  v_add_f32 v48, v80, v88
  v_add_f32 v49, v81, v89
  v_add_f32 v50, v82, v90
  v_add_f32 v51, v83, v91
  v_sub_f32 v88, v80, v88
  v_sub_f32 v89, v81, v89
  v_sub_f32 v90, v82, v90
  v_sub_f32 v91, v83, v91
  v_cvt_pk_bf16_f32 v18, v48, v49
  v_cvt_pk_bf16_f32 v19, v50, v51
  v_cvt_pk_bf16_f32 v34, v88, v89
  v_cvt_pk_bf16_f32 v35, v90, v91
  v_add_f32 v48, v84, v92
  v_add_f32 v49, v85, v93
  v_add_f32 v50, v86, v94
  v_add_f32 v51, v87, v95
  v_sub_f32 v92, v92, v84
  v_sub_f32 v93, v93, v85
  v_sub_f32 v94, v94, v86
  v_sub_f32 v95, v95, v87
  v_cvt_pk_bf16_f32 v26, v48, v49
  v_cvt_pk_bf16_f32 v27, v50, v51
  v_cvt_pk_bf16_f32 v42, v92, v93
  v_cvt_pk_bf16_f32 v43, v94, v95
  v_add_f32 v48, v96, v104
  v_add_f32 v49, v97, v105
  v_add_f32 v50, v98, v106
  v_add_f32 v51, v99, v107
  v_sub_f32 v104, v96, v104
  v_sub_f32 v105, v97, v105
  v_sub_f32 v106, v98, v106
  v_sub_f32 v107, v99, v107
  v_cvt_pk_bf16_f32 v20, v48, v49
  v_cvt_pk_bf16_f32 v21, v50, v51
  v_cvt_pk_bf16_f32 v36, v104, v105
  v_cvt_pk_bf16_f32 v37, v106, v107
  v_add_f32 v48, v100, v108
  v_add_f32 v49, v101, v109
  v_add_f32 v50, v102, v110
  v_add_f32 v51, v103, v111
  v_sub_f32 v108, v108, v100
  v_sub_f32 v109, v109, v101
  v_sub_f32 v110, v110, v102
  v_sub_f32 v111, v111, v103
  v_cvt_pk_bf16_f32 v28, v48, v49
  v_cvt_pk_bf16_f32 v29, v50, v51
  v_cvt_pk_bf16_f32 v44, v108, v109
  v_cvt_pk_bf16_f32 v45, v110, v111
  v_add_f32 v48, v112, v120
  v_add_f32 v49, v113, v121
  v_add_f32 v50, v114, v122
  v_add_f32 v51, v115, v123
  v_sub_f32 v120, v112, v120
  v_sub_f32 v121, v113, v121
  v_sub_f32 v122, v114, v122
  v_sub_f32 v123, v115, v123
  v_cvt_pk_bf16_f32 v22, v48, v49
  v_cvt_pk_bf16_f32 v23, v50, v51
  v_cvt_pk_bf16_f32 v38, v120, v121
  v_cvt_pk_bf16_f32 v39, v122, v123
  v_add_f32 v48, v116, v124
  v_add_f32 v49, v117, v125
  v_add_f32 v50, v118, v126
  v_add_f32 v51, v119, v127
  v_sub_f32 v124, v124, v116
  v_sub_f32 v125, v125, v117
  v_sub_f32 v126, v126, v118
  v_sub_f32 v127, v127, v119
  v_cvt_pk_bf16_f32 v30, v48, v49
  v_cvt_pk_bf16_f32 v31, v50, v51
  v_cvt_pk_bf16_f32 v46, v124, v125
  v_cvt_pk_bf16_f32 v47, v126, v127
  v_mov_b32 v2, 1
  s_cmp_eq_u32 s44, 0
  s_cbranch_scc1 L_dxe
  ds_write_b128 v8, v[16:19] offset:0
  ds_write_b128 v8, v[20:23] offset:1024
  ds_write_b128 v8, v[24:27] offset:2048
  ds_write_b128 v8, v[28:31] offset:3072
  ds_write_b32 v8, v2 offset:4096
  ds_read_b32 v3, v7 offset:4096
  s_mov_b32 s60, 400000
L_dx1:
  s_waitcnt lgkmcnt(0)
  v_readfirstlane_b32 s61, v3
  s_cmp_eq_u32 s61, 1
  s_cbranch_scc1 L_dx1_ok
  s_sleep 1
  ds_read_b32 v3, v7 offset:4096
  s_sub_u32 s60, s60, 1
  s_cbranch_scc0 L_dx1
L_dx1_ok:
  ds_read_b128 v[16:19], v7 offset:0
  ds_read_b128 v[20:23], v7 offset:1024
  ds_read_b128 v[24:27], v7 offset:2048
  ds_read_b128 v[28:31], v7 offset:3072
  s_branch L_dxd
L_dxe:
  ds_write_b128 v8, v[32:35] offset:0
  ds_write_b128 v8, v[36:39] offset:1024
  ds_write_b128 v8, v[40:43] offset:2048
  ds_write_b128 v8, v[44:47] offset:3072
  ds_write_b32 v8, v2 offset:4096
  ds_read_b32 v3, v7 offset:4096
  s_mov_b32 s60, 400000
L_dx0:
  s_waitcnt lgkmcnt(0)
  v_readfirstlane_b32 s61, v3
  s_cmp_eq_u32 s61, 1
  s_cbranch_scc1 L_dx0_ok
  s_sleep 1
  ds_read_b32 v3, v7 offset:4096
  s_sub_u32 s60, s60, 1
  s_cbranch_scc0 L_dx0
L_dx0_ok:
  ds_read_b128 v[32:35], v7 offset:0
  ds_read_b128 v[36:39], v7 offset:1024
  ds_read_b128 v[40:43], v7 offset:2048
  ds_read_b128 v[44:47], v7 offset:3072
L_dxd:
  s_waitcnt lgkmcnt(0)
  v_mfma_f32_16x16x32_bf16 v[160:163], v[128:131], v[16:19], 0
  v_mfma_f32_16x16x32_bf16 v[164:167], v[128:131], v[24:27], 0
  v_mfma_f32_16x16x32_bf16 v[168:171], v[128:131], v[32:35], 0
  v_mfma_f32_16x16x32_bf16 v[172:175], v[128:131], v[40:43], 0
  v_mfma_f32_16x16x32_bf16 v[160:163], v[132:135], v[20:23], v[160:163]
  v_mfma_f32_16x16x32_bf16 v[164:167], v[132:135], v[28:31], v[164:167]
  v_mfma_f32_16x16x32_bf16 v[168:171], v[132:135], v[36:39], v[168:171]
  v_mfma_f32_16x16x32_bf16 v[172:175], v[132:135], v[44:47], v[172:175]
  v_mfma_f32_16x16x32_bf16 v[176:179], v[136:139], v[16:19], 0
  v_mfma_f32_16x16x32_bf16 v[180:183], v[136:139], v[24:27], 0
  v_mfma_f32_16x16x32_bf16 v[184:187], v[136:139], v[32:35], 0
  v_mfma_f32_16x16x32_bf16 v[188:191], v[136:139], v[40:43], 0
  v_mfma_f32_16x16x32_bf16 v[176:179], v[140:143], v[20:23], v[176:179]
  v_mfma_f32_16x16x32_bf16 v[180:183], v[140:143], v[28:31], v[180:183]
  v_mfma_f32_16x16x32_bf16 v[184:187], v[140:143], v[36:39], v[184:187]
  v_mfma_f32_16x16x32_bf16 v[188:191], v[140:143], v[44:47], v[188:191]
  v_cvt_pk_bf16_f32 v192, v160, v161
  v_cvt_pk_bf16_f32 v193, v164, v165
  v_cvt_pk_bf16_f32 v194, v168, v169
  v_cvt_pk_bf16_f32 v195, v172, v173
  s_add_u32 s48, s43, 0
  buffer_store_dwordx4 v[192:195], v4, s[20:23], s48 offen sc1
  v_cvt_pk_bf16_f32 v196, v162, v163
  v_cvt_pk_bf16_f32 v197, v166, v167
  v_cvt_pk_bf16_f32 v198, v170, v171
  v_cvt_pk_bf16_f32 v199, v174, v175
  s_add_u32 s48, s43, 65536
  buffer_store_dwordx4 v[196:199], v4, s[20:23], s48 offen sc1
  v_mfma_f32_16x16x32_bf16 v[160:163], v[144:147], v[16:19], 0
  v_mfma_f32_16x16x32_bf16 v[164:167], v[144:147], v[24:27], 0
  v_mfma_f32_16x16x32_bf16 v[168:171], v[144:147], v[32:35], 0
  v_mfma_f32_16x16x32_bf16 v[172:175], v[144:147], v[40:43], 0
  v_mfma_f32_16x16x32_bf16 v[160:163], v[148:151], v[20:23], v[160:163]
  v_mfma_f32_16x16x32_bf16 v[164:167], v[148:151], v[28:31], v[164:167]
  v_mfma_f32_16x16x32_bf16 v[168:171], v[148:151], v[36:39], v[168:171]
  v_mfma_f32_16x16x32_bf16 v[172:175], v[148:151], v[44:47], v[172:175]
  v_cvt_pk_bf16_f32 v200, v176, v177
  v_cvt_pk_bf16_f32 v201, v180, v181
  v_cvt_pk_bf16_f32 v202, v184, v185
  v_cvt_pk_bf16_f32 v203, v188, v189
  s_add_u32 s48, s43, 524288
  buffer_store_dwordx4 v[200:203], v4, s[20:23], s48 offen sc1
  v_cvt_pk_bf16_f32 v204, v178, v179
  v_cvt_pk_bf16_f32 v205, v182, v183
  v_cvt_pk_bf16_f32 v206, v186, v187
  v_cvt_pk_bf16_f32 v207, v190, v191
  s_add_u32 s48, s43, 589824
  buffer_store_dwordx4 v[204:207], v4, s[20:23], s48 offen sc1
  v_mfma_f32_16x16x32_bf16 v[176:179], v[152:155], v[16:19], 0
  v_mfma_f32_16x16x32_bf16 v[180:183], v[152:155], v[24:27], 0
  v_mfma_f32_16x16x32_bf16 v[184:187], v[152:155], v[32:35], 0
  v_mfma_f32_16x16x32_bf16 v[188:191], v[152:155], v[40:43], 0
  v_mfma_f32_16x16x32_bf16 v[176:179], v[156:159], v[20:23], v[176:179]
  v_mfma_f32_16x16x32_bf16 v[180:183], v[156:159], v[28:31], v[180:183]
  v_mfma_f32_16x16x32_bf16 v[184:187], v[156:159], v[36:39], v[184:187]
  v_mfma_f32_16x16x32_bf16 v[188:191], v[156:159], v[44:47], v[188:191]
  v_cvt_pk_bf16_f32 v208, v160, v161
  v_cvt_pk_bf16_f32 v209, v164, v165
  v_cvt_pk_bf16_f32 v210, v168, v169
  v_cvt_pk_bf16_f32 v211, v172, v173
  s_add_u32 s48, s43, 1048576
  buffer_store_dwordx4 v[208:211], v4, s[20:23], s48 offen sc1
  v_cvt_pk_bf16_f32 v212, v162, v163
  v_cvt_pk_bf16_f32 v213, v166, v167
  v_cvt_pk_bf16_f32 v214, v170, v171
  v_cvt_pk_bf16_f32 v215, v174, v175
  s_add_u32 s48, s43, 1114112
  buffer_store_dwordx4 v[212:215], v4, s[20:23], s48 offen sc1
  v_cvt_pk_bf16_f32 v216, v176, v177
  v_cvt_pk_bf16_f32 v217, v180, v181
  v_cvt_pk_bf16_f32 v218, v184, v185
  v_cvt_pk_bf16_f32 v219, v188, v189
  s_add_u32 s48, s43, 1572864
  buffer_store_dwordx4 v[216:219], v4, s[20:23], s48 offen sc1
  v_cvt_pk_bf16_f32 v220, v178, v179
  v_cvt_pk_bf16_f32 v221, v182, v183
  v_cvt_pk_bf16_f32 v222, v186, v187
  v_cvt_pk_bf16_f32 v223, v190, v191
  s_add_u32 s48, s43, 1638400
  buffer_store_dwordx4 v[220:223], v4, s[20:23], s48 offen sc1
  s_mul_i32 s30, s30, 0x9E3779B1
  s_add_u32 s30, s30, 0x7F4A7C15
  s_mul_i32 s31, s31, 0x9E3779B1
  s_add_u32 s31, s31, 0x7F4A7C15
  s_lshl_b32 s48, s36, 10
  s_lshr_b32 s47, s42, 3
  s_mul_i32 s47, s47, 96
  s_add_u32 s48, s48, s47
  s_lshl_b32 s47, s42, 2
  s_add_u32 s48, s48, s47
  s_add_u32 s48, s48, 10616832
  s_add_u32 s47, s48, 512
  s_waitcnt vmcnt(0)
  s_barrier
  s_atomic_swap s30, s[20:21], s48
  s_atomic_swap s31, s[20:21], s47
  s_waitcnt lgkmcnt(0)
L_end:
  s_endpgm
.section .rodata,"a"
.p2align 6
.amdhsa_kernel recurrent_scan__spectral_fnet__dense_activation_relu__prompt_kernel
  .amdhsa_next_free_vgpr 256
  .amdhsa_next_free_sgpr 102
  .amdhsa_accum_offset 256
  .amdhsa_group_segment_fixed_size 0
  .amdhsa_kernarg_size 88
  .amdhsa_user_sgpr_count 2
  .amdhsa_user_sgpr_kernarg_segment_ptr 1
  .amdhsa_system_sgpr_workgroup_id_x 1
.end_amdhsa_kernel
.p2align 10
dft_tables:
.quad 0x3f803f803f803f80,0x3f803f803f803f80,0x3f723f7a3f7e3f80,0x3f353f483f593f67,0x3f483f673f7a3f80,0x3e643ede3f20,0x3f083f483f723f80,0xbf35bedebde53e64
.quad 0x3e643f203f673f80,0xbf80bf67bf20be64,0xbde53ede3f593f80,0xbf35bf7abf72bf20,0xbede3e643f483f80,0xbf20bf7abf67,0xbf3500003f353f80,0x3f350000bf35bf80
.quad 0xbf67be643f203f80,0x3f803f20be64bf67,0xbf7ebede3f083f80,0x3f353f7a3ea9bf20,0xbf7abf203ede3f80,0x3f673f48be64,0xbf59bf483ea93f80,0xbf353ede3f7e3e64
.quad 0xbf20bf673e643f80,0xbf80be643f673f20,0xbea9bf7a3de53f80,0xbf35bf483f083f67,0xbf8000003f80,0xbf8000003f80,0x3ea9bf7abde53f80,0x3f35bf48bf083f67
.quad 0x3f803f803f803f80,0x3f803f803f803f80,0x3ea93ede3f083f20,0xbde500003de53e64,0xbf48bf20bedebe64,0xbf7abf80bf7abf67,0xbf59bf7abf7ebf67,0x3ea90000bea9bf20
.quad 0x3e64be64bf20bf67,0x3f673f803f673f20,0x3f7e3f483ea9be64,0xbf0800003f083f67,0x3ede3f673f7a3f20,0xbf48bf80bf48be64,0xbf3500003f353f80,0x3f350000bf35bf80
.quad 0xbf67bf67be643f20,0x3f203f803f20be64,0x3de5bf48bf72be64,0xbf5900003f593f67,0x3f7a3e64bf48bf67,0xbedebf80bede3f20,0x3f083f7a3de5bf67,0x3f720000bf72bf20
.quad 0xbf203f203f67be64,0x3e643f803e64bf67,0xbf72bede3f593f20,0xbf7e00003f7e3e64,0xbf8000003f80,0xbf8000003f80,0x3f72bedebf593f20,0x3f7e0000bf7e3e64
.quad 0x3f803f803f803f80,0x3f803f803f803f80,0xbf08bedebea9be64,0xbf59bf48bf35bf20,0xbedebf20bf48bf67,0x3ede3e640000be64,0x3f7e3f7a3f593f20,0x3de53ede3f353f67
.quad 0xbf20be643e643f20,0xbf20bf67bf80bf67,0xbea9bf48bf7ebf67,0x3f723f7a3f353e64,0x3f7a3f673edebe64,0xbf7abf2000003f20,0xbf3500003f353f80,0x3f350000bf35bf80
.quad 0xbe64bf67bf67be64,0xbe643f203f803f20,0x3f723f48bde5bf67,0xbea9bf7abf353e64,0xbf483e643f7a3f20,0x3f483f670000bf67,0xbde5bf7abf083f20,0xbf7ebede3f353f67
.quad 0x3f673f20bf20bf67,0x3f67be64bf80be64,0xbf593ede3f72be64,0xbf083f483f35bf20,0xbf8000003f80,0xbf8000003f80,0x3f593edebf72be64,0x3f083f48bf35bf20
.quad 0x3f803f803f803f80,0x3f803f803f803f80,0xbf7ebf7abf72bf67,0xbf72bf7abf7ebf80,0x3f7a3f673f483f20,0x3f483f673f7a3f80,0xbf72bf48bf08be64,0xbf08bf48bf72bf80
.quad 0x3f673f203e64be64,0x3e643f203f673f80,0xbf59bede3de53f20,0x3de5bedebf59bf80,0x3f483e64bedebf67,0xbede3e643f483f80,0xbf3500003f353f80,0x3f350000bf35bf80
.quad 0x3f20be64bf67bf67,0xbf67be643f203f80,0xbf083ede3f7e3f20,0x3f7e3edebf08bf80,0x3edebf20bf7abe64,0xbf7abf203ede3f80,0xbea93f483f59be64,0x3f593f48bea9bf80
.quad 0x3e64bf67bf203f20,0xbf20bf673e643f80,0xbde53f7a3ea9bf67,0x3ea93f7abde5bf80,0xbf8000003f80,0xbf8000003f80,0x3de53f7abea9bf67,0xbea93f7a3de5bf80
.quad 0x0,0x0,0x3ea93e643de50000,0x3f353f203f083ede,0x3f203ede3e640000,0x3f803f7a3f673f48,0x3f593f203ea90000,0x3f353f673f7e3f7a
.quad 0x3f7a3f483ede0000,0x3ede3f483f7a,0x3f7e3f673f080000,0xbf35be643ea93f48,0x3f673f7a3f200000,0xbf80bf48be643ede,0x3f353f803f350000,0xbf35bf80bf350000
.quad 0x3ede3f7a3f480000,0xbf48bf7abede,0x3de53f673f590000,0x3f35be64bf72bf48,0xbe643f483f670000,0x3f803edebf20bf7a,0xbf083f203f720000,0x3f353f67bde5bf7a
.quad 0xbf483ede3f7a0000,0x3f7a3edebf48,0xbf723e643f7e0000,0xbf353f203f59bede,0xbf8000003f800000,0xbf8000003f800000,0xbf72be643f7e0000,0xbf35bf203f593ede
.quad 0x0,0x0,0x3f723f673f593f48,0x3f7e3f803f7e3f7a,0x3f203f483f673f7a,0xbe6400003e643ede,0xbf08be643de53ede,0xbf72bf80bf72bf48
.quad 0xbf7abf7abf48bede,0x3ede0000bedebf48,0xbde5bf20bf72bf7a,0x3f593f803f593ede,0x3f673edebe64bf48,0xbf2000003f203f7a,0x3f353f803f350000,0xbf35bf80bf350000
.quad 0xbede3ede3f7a3f48,0x3f480000bf48bf7a,0xbf7ebf203ea93f7a,0x3f083f803f08bede,0xbe64bf7abf203ede,0xbf6700003f673f48,0x3f59be64bf7ebede,0xbea9bf80bea93f48
.quad 0x3f483f48bedebf7a,0x3f7a0000bf7abede,0xbea93f673f08bf48,0x3de53f803de5bf7a,0xbf8000003f800000,0xbf8000003f800000,0xbea9bf673f083f48,0x3de5bf803de53f7a
.quad 0x0,0x0,0x3f593f673f723f7a,0x3f083f203f353f48,0xbf67bf48bf20bede,0xbf67bf7abf80bf7a,0x3de5be64bf08bf48,0x3f7e3f673f353ede
.quad 0x3f483f7a3f7a3f48,0xbf48bede00003ede,0xbf72bf20bde53ede,0x3ea9be64bf35bf7a,0x3e64bedebf67bf7a,0x3e643f483f803f48,0x3f353f803f350000,0xbf35bf80bf350000
.quad 0xbf7abede3ede3f7a,0x3f7a3f480000bf48,0x3ea9bf20bf7ebede,0xbf72be643f353f7a,0x3f203f7a3e64bf48,0x3f20bedebf80bede,0xbf7ebe643f593f48,0xbde53f673f35bede
.quad 0x3edebf48bf483ede,0xbedebf7a00003f7a,0x3f083f67bea9bf7a,0x3f593f20bf35bf48,0xbf8000003f800000,0xbf8000003f800000,0x3f08bf67bea93f7a,0x3f59bf20bf353f48
.quad 0x0,0x0,0x3de53e643ea93ede,0xbea9be64bde50000,0xbe64bedebf20bf48,0x3f203ede3e640000,0x3ea93f203f593f7a,0xbf59bf20bea90000
.quad 0xbedebf48bf7abf7a,0x3f7a3f483ede0000,0x3f083f673f7e3f48,0xbf7ebf67bf080000,0xbf20bf7abf67bede,0x3f673f7a3f200000,0x3f353f803f350000,0xbf35bf80bf350000
.quad 0xbf48bf7abede3ede,0x3ede3f7a3f480000,0x3f593f673de5bf48,0xbde5bf67bf590000,0xbf67bf483e643f7a,0xbe643f483f670000,0x3f723f20bf08bf7a,0x3f08bf20bf720000
.quad 0xbf7abede3f483f48,0xbf483ede3f7a0000,0x3f7e3e64bf72bede,0x3f72be64bf7e0000,0xbf8000003f800000,0xbf8000003f800000,0x3f7ebe64bf723ede,0x3f723e64bf7e0000
.quad 0x3f803f803f803f80,0x3f803f803f803f80,0x3f6d3f763f7c3f80,0x3f2b3f3f3f513f60,0x3f353f593f723f7e,0xbde53de53ea93f08,0x3ec43f2b3f603f7c,0xbf51bf14be8e3d66
.quad 0x3ede3f483f7a,0xbf7abf7abf48bede,0xbec43e2c3f2b3f76,0xbef8bf60bf80bf51,0xbf35bde53f083f72,0x3ea9bea9bf59bf7e,0xbf6dbec43ec43f6d,0x3f6d3ec4bec4bf6d
.quad 0xbf80bf203e643f67,0x3f673f673e64bf20,0xbf6dbf513d663f60,0x3e8e3f763f3fbe2c,0xbf35bf72bde53f59,0xbf083f083f7e3ea9,0xbec4bf80be8e3f51,0xbf7cbe2c3f603f3f
.quad 0xbf7abede3f48,0xbf48bf483ede3f7a,0x3ec4bf60bf143f3f,0xbd66bf80be2c3f76,0x3f35bf35bf353f35,0x3f35bf35bf353f35,0x3f6dbef8bf513f2b,0x3f80bd66bf7c3e8e
.quad 0x3f803f803f803f80,0x3f803f803f803f80,0x3e8e3ec43ef83f14,0xbe2cbd663d663e2c,0xbf59bf35bf08bea9,0xbf72bf7ebf7ebf72,0xbf3fbf6dbf80bf76,0x3ef83e2cbe2cbef8
.quad 0x3ede0000bedebf48,0x3f483f7a3f7a3f48,0x3f7c3f6d3f143d66,0xbf3fbe8e3e8e3f3f,0x3de53f353f7e3f59,0xbf08bf72bf72bf08,0xbf6dbec43ec43f6d,0x3f6d3ec4bec4bf6d
.quad 0xbf20bf80bf203e64,0x3e643f673f673e64,0x3f14bec4bf7cbf2b,0xbf80bef83ef83f80,0x3f723f35bea9bf7e,0x3de5bf59bf593de5,0xbd663f6d3f2bbef8,0x3f763f14bf14bf76
.quad 0xbf7a00003f7a3ede,0xbede3f483f48bede,0xbef8bf6d3e8e3f7c,0xbf51bf2b3f2b3f51,0x3f35bf35bf353f35,0x3f35bf35bf353f35,0x3f603ec4bf76be2c,0x3f143f3fbf3fbf14
.quad 0x3f803f803f803f80,0x3f803f803f803f80,0xbf14bef8bec4be8e,0xbf60bf51bf3fbf2b,0xbea9bf08bf35bf59,0x3f083ea93de5bde5,0x3f763f803f6d3f3f,0xbd663e8e3f143f51
.quad 0xbf48bede00003ede,0xbedebf48bf7abf7a,0xbd66bf14bf6dbf7c,0x3f513f803f603ef8,0x3f593f7e3f353de5,0xbf7ebf59bea93ea9,0xbf6dbec43ec43f6d,0x3f6d3ec4bec4bf6d
.quad 0x3e64bf20bf80bf20,0xbf203e643f673f67,0x3f2b3f7c3ec4bf14,0x3e2cbf3fbf76be8e,0xbf7ebea93f353f72,0x3ea93f7e3f08bf08,0x3ef8bf2bbf6d3d66,0xbf3fbf603e2c3f7c
.quad 0x3ede3f7a0000bf7a,0x3f7a3edebf48bf48,0xbf7cbe8e3f6d3ef8,0xbf763e2c3f803d66,0x3f35bf35bf353f35,0x3f35bf35bf353f35,0x3e2c3f76bec4bf60,0xbe8e3f7c3d66bf80
.quad 0x3f803f803f803f80,0x3f803f803f803f80,0xbf80bf7cbf76bf6d,0xbf6dbf76bf7cbf80,0x3f7e3f723f593f35,0x3f353f593f723f7e,0xbf7cbf60bf2bbec4,0xbec4bf2bbf60bf7c
.quad 0x3f7a3f483ede0000,0x3ede3f483f7a,0xbf76bf2bbe2c3ec4,0x3ec4be2cbf2bbf76,0x3f723f08bde5bf35,0xbf35bde53f083f72,0xbf6dbec43ec43f6d,0x3f6d3ec4bec4bf6d
.quad 0x3f673e64bf20bf80,0xbf80bf203e643f67,0xbf60bd663f513f6d,0x3f6d3f51bd66bf60,0x3f59bde5bf72bf35,0xbf35bf72bde53f59,0xbf513e8e3f803ec4,0x3ec43f803e8ebf51
.quad 0x3f48bedebf7a0000,0xbf7abede3f48,0xbf3f3f143f60bec4,0xbec43f603f14bf3f,0x3f35bf35bf353f35,0x3f35bf35bf353f35,0xbf2b3f513ef8bf6d,0xbf6d3ef83f51bf2b
.quad 0x0,0x0,0x3ec43e8e3e2c3d66,0x3f3f3f2b3f143ef8,0x3f353f083ea93de5,0x3f7e3f7e3f723f59,0x3f6d3f3f3ef83e2c,0x3f143f513f763f80
.quad 0x3f803f673f203e64,0xbe643e643f203f67,0x3f6d3f7c3f3f3e8e,0xbf60bef83d663f14,0x3f353f7e3f593ea9,0xbf72bf72bf083de5,0x3ec43f6d3f6d3ec4,0xbec4bf6dbf6dbec4
.quad 0x3f483f7a3ede,0x3edebedebf7abf48,0xbec43f143f803ef8,0x3f763e8ebf2bbf7c,0xbf353ea93f7e3f08,0x3f593f59bde5bf72,0xbf6d3d663f763f14,0x3e2c3f7c3ef8bf2b
.quad 0xbf80be643f673f20,0xbf203f203f67be64,0xbf6dbef83f513f2b,0xbf80bd663f7c3e8e,0xbf35bf353f353f35,0xbf35bf353f353f35,0xbec4bf603f143f3f,0x3d66bf803e2c3f76
.quad 0x0,0x0,0x3f763f6d3f603f51,0x3f7c3f803f803f7c,0x3f083f353f593f72,0xbea9bde53de53ea9,0xbf2bbec4bd663e8e,0xbf60bf7cbf7cbf60
.quad 0xbf67bf80bf67bf20,0x3f203e64be64bf20,0x3e2cbec4bf51bf80,0x3f2b3f763f763f2b,0x3f7e3f353de5bf08,0xbf59bea93ea93f59,0x3ec43f6d3f6d3ec4,0xbec4bf6dbf6dbec4
.quad 0xbf4800003f483f7a,0x3f7a3edebedebf7a,0xbf51bf6dbe2c3f3f,0x3d663f603f603d66,0x3ea9bf35bf72bde5,0xbf7ebf083f083f7e,0x3f803ec4bf3fbf60,0x3e8ebf51bf513e8e
.quad 0x3e643f803e64bf67,0x3f673f20bf20bf67,0xbf603ec43f76be2c,0xbf143f3f3f3fbf14,0xbf35bf353f353f35,0xbf35bf353f353f35,0x3ef8bf6dbe8e3f7c,0x3f51bf2bbf2b3f51
.quad 0x0,0x0,0x3f513f603f6d3f76,0x3ef83f143f2b3f3f,0xbf72bf59bf35bf08,0xbf59bf72bf7ebf7e,0x3e8ebd66bec4bf2b,0x3f803f763f513f14
.quad 0x3f203f673f803f67,0xbf67bf20be643e64,0xbf80bf51bec43e2c,0x3f143d66bef8bf60,0x3f08bde5bf35bf7e,0xbde53f083f723f72,0x3ec43f6d3f6d3ec4,0xbec4bf6dbf6dbec4
.quad 0xbf7abf4800003f48,0x3f483f7a3edebede,0x3f3fbe2cbf6dbf51,0xbf7cbf2b3e8e3f76,0x3de53f723f35bea9,0x3f723de5bf59bf59,0xbf60bf3f3ec43f80,0xbf2b3ef83f7c3e2c
.quad 0x3f67be64bf80be64,0x3e64bf67bf203f20,0xbe2c3f763ec4bf60,0x3e8e3f7cbd66bf80,0xbf35bf353f353f35,0xbf35bf353f353f35,0x3f7cbe8ebf6d3ef8,0x3f763e2cbf803d66
.quad 0x0,0x0,0x3d663e2c3e8e3ec4,0xbec4be8ebe2cbd66,0xbde5bea9bf08bf35,0x3f353f083ea93de5,0x3e2c3ef83f3f3f6d,0xbf6dbf3fbef8be2c
.quad 0xbe64bf20bf67bf80,0x3f803f673f203e64,0x3e8e3f3f3f7c3f6d,0xbf6dbf7cbf3fbe8e,0xbea9bf59bf7ebf35,0x3f353f7e3f593ea9,0x3ec43f6d3f6d3ec4,0xbec4bf6dbf6dbec4
.quad 0xbedebf7abf480000,0x3f483f7a3ede,0x3ef83f803f14bec4,0x3ec4bf14bf80bef8,0xbf08bf7ebea93f35,0xbf353ea93f7e3f08,0x3f143f763d66bf6d,0x3f6dbd66bf76bf14
.quad 0xbf20bf673e643f80,0xbf80be643f673f20,0x3f2b3f51bef8bf6d,0x3f6d3ef8bf51bf2b,0xbf35bf353f353f35,0xbf35bf353f353f35,0x3f3f3f14bf60bec4,0x3ec43f60bf14bf3f
.quad 0x3f803f803f803f80,0x3f803f803f803f80,0xbf35bf48bf59bf67,0xbea9bedebf08bf20,0x3e643ede3f20,0xbf48bf20bedebe64,0x3f353ede3de5be64,0x3f593f7a3f7e3f67
.quad 0xbf80bf67bf20be64,0x3e64be64bf20bf67,0x3f353f7a3f723f20,0xbf7ebf48bea93e64,0xbf20bf7abf67,0x3ede3f673f7a3f20,0xbf3500003f353f80,0x3f350000bf35bf80
.quad 0x3f803f20be64bf67,0xbf67bf67be643f20,0xbf35bf7abea93f20,0xbde53f483f723e64,0x3f673f48be64,0x3f7a3e64bf48bf67,0x3f35bedebf7ebe64,0xbf08bf7abde53f67
.quad 0xbf80be643f673f20,0xbf203f203f67be64,0x3f353f48bf08bf67,0x3f723edebf59bf20,0xbf8000003f80,0xbf8000003f80,0xbf353f483f08bf67,0xbf723ede3f59bf20
.quad 0x3f803f803f803f80,0x3f803f803f803f80,0x3de50000bde5be64,0x3f083ede3ea93e64,0xbf7abf80bf7abf67,0xbedebf20bf48bf67,0xbea900003ea93f20,0xbf7ebf7abf59bf20
.quad 0x3f673f803f673f20,0xbf20be643e643f20,0x3f080000bf08bf67,0x3ea93f483f7e3f67,0xbf48bf80bf48be64,0x3f7a3f673edebe64,0xbf3500003f353f80,0x3f350000bf35bf80
.quad 0x3f203f803f20be64,0xbe64bf67bf67be64,0x3f590000bf59bf67,0xbf72bf483de53f67,0xbedebf80bede3f20,0xbf483e643f7a3f20,0xbf7200003f723f20,0x3de53f7a3f08bf20
.quad 0x3e643f803e64bf67,0x3f673f20bf20bf67,0x3f7e0000bf7ebe64,0x3f59bedebf723e64,0xbf8000003f80,0xbf8000003f80,0xbf7e00003f7ebe64,0xbf59bede3f723e64
.quad 0x3f803f803f803f80,0x3f803f803f803f80,0x3f593f483f353f20,0x3f7e3f7a3f723f67,0x3ede3e640000be64,0x3f7a3f673f483f20,0xbde5bedebf35bf67,0x3f723f483f083e64
.quad 0xbf20bf67bf80bf67,0x3f673f203e64be64,0xbf72bf7abf35be64,0x3f593edebde5bf20,0xbf7abf2000003f20,0x3f483e64bedebf67,0xbf3500003f353f80,0x3f350000bf35bf80
.quad 0xbe643f203f803f20,0x3f20be64bf67bf67,0x3ea93f7a3f35be64,0x3f08bedebf7ebf20,0x3f483f670000bf67,0x3edebf20bf7abe64,0x3f7e3edebf35bf67,0x3ea9bf48bf593e64
.quad 0x3f67be64bf80be64,0x3e64bf67bf203f20,0x3f08bf48bf353f20,0x3de5bf7abea93f67,0xbf8000003f80,0xbf8000003f80,0xbf08bf483f353f20,0xbde5bf7a3ea93f67
.quad 0x3f803f803f803f80,0x3f803f803f803f80,0x3f723f7a3f7e3f80,0x3f353f483f593f67,0x3f483f673f7a3f80,0x3e643ede3f20,0x3f083f483f723f80,0xbf35bedebde53e64
.quad 0x3e643f203f673f80,0xbf80bf67bf20be64,0xbde53ede3f593f80,0xbf35bf7abf72bf20,0xbede3e643f483f80,0xbf20bf7abf67,0xbf3500003f353f80,0x3f350000bf35bf80
.quad 0xbf67be643f203f80,0x3f803f20be64bf67,0xbf7ebede3f083f80,0x3f353f7a3ea9bf20,0xbf7abf203ede3f80,0x3f673f48be64,0xbf59bf483ea93f80,0xbf353ede3f7e3e64
.quad 0xbf20bf673e643f80,0xbf80be643f673f20,0xbea9bf7a3de53f80,0xbf35bf483f083f67,0xbf8000003f80,0xbf8000003f80,0x3ea9bf7abde53f80,0x3f35bf48bf083f67
.quad 0x0,0x0,0xbf35bf20bf08bede,0xbf72bf67bf59bf48,0x3f803f7a3f673f48,0x3f203f483f673f7a,0xbf35bf67bf7ebf7a,0x3f083e64bde5bede
.quad 0x3ede3f483f7a,0xbf7abf7abf48bede,0x3f353e64bea9bf48,0x3de53f203f723f7a,0xbf80bf48be643ede,0x3f673edebe64bf48,0x3f353f803f350000,0xbf35bf80bf350000
.quad 0xbf48bf7abede,0xbede3ede3f7a3f48,0xbf353e643f723f48,0x3f7e3f20bea9bf7a,0x3f803edebf20bf7a,0xbe64bf7abf203ede,0xbf35bf673de53f7a,0xbf593e643f7e3ede
.quad 0x3f7a3edebf48,0x3f483f48bedebf7a,0x3f35bf20bf593ede,0x3ea9bf67bf083f48,0xbf8000003f800000,0xbf8000003f800000,0x3f353f20bf59bede,0x3ea93f67bf08bf48
.quad 0x0,0x0,0xbf7ebf80bf7ebf7a,0xbf59bf67bf72bf7a,0xbe6400003e643ede,0xbf67bf48bf20bede,0x3f723f803f723f48,0xbde53e643f083f48
.quad 0x3ede0000bedebf48,0x3f483f7a3f7a3f48,0xbf59bf80bf59bede,0x3f723f203de5bede,0xbf2000003f203f7a,0x3e64bedebf67bf7a,0x3f353f803f350000,0xbf35bf80bf350000
.quad 0x3f480000bf48bf7a,0xbf7abede3ede3f7a,0xbf08bf80bf083ede,0xbea93f203f7e3ede,0xbf6700003f673f48,0x3f203f7a3e64bf48,0x3ea93f803ea9bf48,0x3f7e3e64bf59bf48
.quad 0x3f7a0000bf7abede,0x3edebf48bf483ede,0xbde5bf80bde53f7a,0xbf08bf673ea93f7a,0xbf8000003f800000,0xbf8000003f800000,0xbde53f80bde5bf7a,0xbf083f673ea9bf7a
.quad 0x0,0x0,0xbf08bf20bf35bf48,0xbde5be64bea9bede,0xbf67bf7abf80bf7a,0xbe64bedebf20bf48,0xbf7ebf67bf35bede,0xbea9bf20bf59bf7a
.quad 0xbf48bede00003ede,0xbedebf48bf7abf7a,0xbea93e643f353f7a,0xbf08bf67bf7ebf48,0x3e643f483f803f48,0xbf20bf7abf67bede,0x3f353f803f350000,0xbf35bf80bf350000
.quad 0x3f7a3f480000bf48,0xbf48bf7abede3ede,0x3f723e64bf35bf7a,0xbf59bf67bde53f48,0x3f20bedebf80bede,0xbf67bf483e643f7a,0x3de5bf67bf353ede,0xbf72bf203f083f7a
.quad 0xbedebf7a00003f7a,0xbf7abede3f483f48,0xbf59bf203f353f48,0xbf7ebe643f723ede,0xbf8000003f800000,0xbf8000003f800000,0xbf593f203f35bf48,0xbf7e3e643f72bede
.quad 0x0,0x0,0x3ea93e643de50000,0x3f353f203f083ede,0x3f203ede3e640000,0x3f803f7a3f673f48,0x3f593f203ea90000,0x3f353f673f7e3f7a
.quad 0x3f7a3f483ede0000,0x3ede3f483f7a,0x3f7e3f673f080000,0xbf35be643ea93f48,0x3f673f7a3f200000,0xbf80bf48be643ede,0x3f353f803f350000,0xbf35bf80bf350000
.quad 0x3ede3f7a3f480000,0xbf48bf7abede,0x3de53f673f590000,0x3f35be64bf72bf48,0xbe643f483f670000,0x3f803edebf20bf7a,0xbf083f203f720000,0x3f353f67bde5bf7a
.quad 0xbf483ede3f7a0000,0x3f7a3edebf48,0xbf723e643f7e0000,0xbf353f203f59bede,0xbf8000003f800000,0xbf8000003f800000,0xbf72be643f7e0000,0xbf35bf203f593ede
.quad 0x3f803f803f803f80,0x3f803f803f803f80,0xbf2bbf3fbf51bf60,0xbe8ebec4bef8bf14,0xbde53de53ea93f08,0xbf59bf35bf08bea9,0x3f513f143e8ebd66,0x3f3f3f6d3f803f76
.quad 0xbf7abf7abf48bede,0x3ede0000bedebf48,0x3ef83f603f803f51,0xbf7cbf6dbf14bd66,0x3ea9bea9bf59bf7e,0x3de53f353f7e3f59,0xbf6dbec43ec43f6d,0x3f6d3ec4bec4bf6d
.quad 0x3f673f673e64bf20,0xbf20bf80bf203e64,0xbe8ebf76bf3f3e2c,0xbf143ec43f7c3f2b,0xbf083f083f7e3ea9,0x3f723f35bea9bf7e,0x3f7c3e2cbf60bf3f,0x3d66bf6dbf2b3ef8
.quad 0xbf48bf483ede3f7a,0xbf7a00003f7a3ede,0x3d663f803e2cbf76,0x3ef83f6dbe8ebf7c,0x3f35bf35bf353f35,0x3f35bf35bf353f35,0xbf803d663f7cbe8e,0xbf60bec43f763e2c
.quad 0x3f803f803f803f80,0x3f803f803f803f80,0x3e2c3d66bd66be2c,0x3f143ef83ec43e8e,0xbf72bf7ebf7ebf72,0xbea9bf08bf35bf59,0xbef8be2c3e2c3ef8,0xbf76bf80bf6dbf3f
.quad 0x3f483f7a3f7a3f48,0xbf48bede00003ede,0x3f3f3e8ebe8ebf3f,0x3d663f143f6d3f7c,0xbf08bf72bf72bf08,0x3f593f7e3f353de5,0xbf6dbec43ec43f6d,0x3f6d3ec4bec4bf6d
.quad 0x3e643f673f673e64,0x3e64bf20bf80bf20,0x3f803ef8bef8bf80,0xbf2bbf7cbec43f14,0x3de5bf59bf593de5,0xbf7ebea93f353f72,0xbf76bf143f143f76,0xbef83f2b3f6dbd66
.quad 0xbede3f483f48bede,0x3ede3f7a0000bf7a,0x3f513f2bbf2bbf51,0x3f7c3e8ebf6dbef8,0x3f35bf35bf353f35,0x3f35bf35bf353f35,0xbf14bf3f3f3f3f14,0xbe2cbf763ec43f60
.quad 0x3f803f803f803f80,0x3f803f803f803f80,0x3f603f513f3f3f2b,0x3f803f7c3f763f6d,0x3f083ea93de5bde5,0x3f7e3f723f593f35,0x3d66be8ebf14bf51,0x3f7c3f603f2b3ec4
.quad 0xbedebf48bf7abf7a,0x3f7a3f483ede0000,0xbf51bf80bf60bef8,0x3f763f2b3e2cbec4,0xbf7ebf59bea93ea9,0x3f723f08bde5bf35,0xbf6dbec43ec43f6d,0x3f6d3ec4bec4bf6d
.quad 0xbf203e643f673f67,0x3f673e64bf20bf80,0xbe2c3f3f3f763e8e,0x3f603d66bf51bf6d,0x3ea93f7e3f08bf08,0x3f59bde5bf72bf35,0x3f3f3f60be2cbf7c,0x3f51be8ebf80bec4
.quad 0x3f7a3edebf48bf48,0x3f48bedebf7a0000,0x3f76be2cbf80bd66,0x3f3fbf14bf603ec4,0x3f35bf35bf353f35,0x3f35bf35bf353f35,0x3e8ebf7cbd663f80,0x3f2bbf51bef83f6d
.quad 0x3f803f803f803f80,0x3f803f803f803f80,0x3f6d3f763f7c3f80,0x3f2b3f3f3f513f60,0x3f353f593f723f7e,0xbde53de53ea93f08,0x3ec43f2b3f603f7c,0xbf51bf14be8e3d66
.quad 0x3ede3f483f7a,0xbf7abf7abf48bede,0xbec43e2c3f2b3f76,0xbef8bf60bf80bf51,0xbf35bde53f083f72,0x3ea9bea9bf59bf7e,0xbf6dbec43ec43f6d,0x3f6d3ec4bec4bf6d
.quad 0xbf80bf203e643f67,0x3f673f673e64bf20,0xbf6dbf513d663f60,0x3e8e3f763f3fbe2c,0xbf35bf72bde53f59,0xbf083f083f7e3ea9,0xbec4bf80be8e3f51,0xbf7cbe2c3f603f3f
.quad 0xbf7abede3f48,0xbf48bf483ede3f7a,0x3ec4bf60bf143f3f,0xbd66bf80be2c3f76,0x3f35bf35bf353f35,0x3f35bf35bf353f35,0x3f6dbef8bf513f2b,0x3f80bd66bf7c3e8e
.quad 0x0,0x0,0xbf3fbf2bbf14bef8,0xbf76bf6dbf60bf51,0x3f7e3f7e3f723f59,0x3f083f353f593f72,0xbf14bf51bf76bf80,0x3f2b3ec43d66be8e
.quad 0xbe643e643f203f67,0xbf67bf80bf67bf20,0x3f603ef8bd66bf14,0xbe2c3ec43f513f80,0xbf72bf72bf083de5,0x3f7e3f353de5bf08,0x3ec43f6d3f6d3ec4,0xbec4bf6dbf6dbec4
.quad 0x3edebedebf7abf48,0xbf4800003f483f7a,0xbf76be8e3f2b3f7c,0x3f513f6d3e2cbf3f,0x3f593f59bde5bf72,0x3ea9bf35bf72bde5,0xbe2cbf7cbef83f2b,0xbf80bec43f3f3f60
.quad 0xbf203f203f67be64,0x3e643f803e64bf67,0x3f803d66bf7cbe8e,0x3f60bec4bf763e2c,0xbf35bf353f353f35,0xbf35bf353f353f35,0xbd663f80be2cbf76,0xbef83f6d3e8ebf7c
.quad 0x0,0x0,0xbf7cbf80bf80bf7c,0xbf51bf60bf6dbf76,0xbea9bde53de53ea9,0xbf72bf59bf35bf08,0x3f603f7c3f7c3f60,0xbe8e3d663ec43f2b
.quad 0x3f203e64be64bf20,0x3f203f673f803f67,0xbf2bbf76bf76bf2b,0x3f803f513ec4be2c,0xbf59bea93ea93f59,0x3f08bde5bf35bf7e,0x3ec43f6d3f6d3ec4,0xbec4bf6dbf6dbec4
.quad 0x3f7a3edebedebf7a,0xbf7abf4800003f48,0xbd66bf60bf60bd66,0xbf3f3e2c3f6d3f51,0xbf7ebf083f083f7e,0x3de53f723f35bea9,0xbe8e3f513f51be8e,0x3f603f3fbec4bf80
.quad 0x3f673f20bf20bf67,0x3f67be64bf80be64,0x3f14bf3fbf3f3f14,0x3e2cbf76bec43f60,0xbf35bf353f353f35,0xbf35bf353f353f35,0xbf513f2b3f2bbf51,0xbf7c3e8e3f6dbef8
.quad 0x0,0x0,0xbef8bf14bf2bbf3f,0xbd66be2cbe8ebec4,0xbf59bf72bf7ebf7e,0xbde5bea9bf08bf35,0xbf80bf76bf51bf14,0xbe2cbef8bf3fbf6d
.quad 0xbf67bf20be643e64,0xbe64bf20bf67bf80,0xbf14bd663ef83f60,0xbe8ebf3fbf7cbf6d,0xbde53f083f723f72,0xbea9bf59bf7ebf35,0x3ec43f6d3f6d3ec4,0xbec4bf6dbf6dbec4
.quad 0x3f483f7a3edebede,0xbedebf7abf480000,0x3f7c3f2bbe8ebf76,0xbef8bf80bf143ec4,0x3f723de5bf59bf59,0xbf08bf7ebea93f35,0x3f2bbef8bf7cbe2c,0xbf14bf76bd663f6d
.quad 0x3e64bf67bf203f20,0xbf20bf673e643f80,0xbe8ebf7c3d663f80,0xbf2bbf513ef83f6d,0xbf35bf353f353f35,0xbf35bf353f353f35,0xbf76be2c3f80bd66,0xbf3fbf143f603ec4
.quad 0x0,0x0,0x3ec43e8e3e2c3d66,0x3f3f3f2b3f143ef8,0x3f353f083ea93de5,0x3f7e3f7e3f723f59,0x3f6d3f3f3ef83e2c,0x3f143f513f763f80
.quad 0x3f803f673f203e64,0xbe643e643f203f67,0x3f6d3f7c3f3f3e8e,0xbf60bef83d663f14,0x3f353f7e3f593ea9,0xbf72bf72bf083de5,0x3ec43f6d3f6d3ec4,0xbec4bf6dbf6dbec4
.quad 0x3f483f7a3ede,0x3edebedebf7abf48,0xbec43f143f803ef8,0x3f763e8ebf2bbf7c,0xbf353ea93f7e3f08,0x3f593f59bde5bf72,0xbf6d3d663f763f14,0x3e2c3f7c3ef8bf2b
.quad 0xbf80be643f673f20,0xbf203f203f67be64,0xbf6dbef83f513f2b,0xbf80bd663f7c3e8e,0xbf35bf353f353f35,0xbf35bf353f353f35,0xbec4bf603f143f3f,0x3d66bf803e2c3f76
.quad 0x3f803f803f803f80,0x3f803f803f803f80,0x3ea93ede3f083f20,0xbde500003de53e64,0xbf48bf20bedebe64,0xbf7abf80bf7abf67,0xbf59bf7abf7ebf67,0x3ea90000bea9bf20
.quad 0x3e64be64bf20bf67,0x3f673f803f673f20,0x3f7e3f483ea9be64,0xbf0800003f083f67,0x3ede3f673f7a3f20,0xbf48bf80bf48be64,0xbf3500003f353f80,0x3f350000bf35bf80
.quad 0xbf67bf67be643f20,0x3f203f803f20be64,0x3de5bf48bf72be64,0xbf5900003f593f67,0x3f7a3e64bf48bf67,0xbedebf80bede3f20,0x3f083f7a3de5bf67,0x3f720000bf72bf20
.quad 0xbf203f203f67be64,0x3e643f803e64bf67,0xbf72bede3f593f20,0xbf7e00003f7e3e64,0xbf8000003f80,0xbf8000003f80,0x3f72bedebf593f20,0x3f7e0000bf7e3e64
.quad 0x3f803f803f803f80,0x3f803f803f803f80,0xbf08bedebea9be64,0xbf59bf48bf35bf20,0xbedebf20bf48bf67,0x3ede3e640000be64,0x3f7e3f7a3f593f20,0x3de53ede3f353f67
.quad 0xbf20be643e643f20,0xbf20bf67bf80bf67,0xbea9bf48bf7ebf67,0x3f723f7a3f353e64,0x3f7a3f673edebe64,0xbf7abf2000003f20,0xbf3500003f353f80,0x3f350000bf35bf80
.quad 0xbe64bf67bf67be64,0xbe643f203f803f20,0x3f723f48bde5bf67,0xbea9bf7abf353e64,0xbf483e643f7a3f20,0x3f483f670000bf67,0xbde5bf7abf083f20,0xbf7ebede3f353f67
.quad 0x3f673f20bf20bf67,0x3f67be64bf80be64,0xbf593ede3f72be64,0xbf083f483f35bf20,0xbf8000003f80,0xbf8000003f80,0x3f593edebf72be64,0x3f083f48bf35bf20
.quad 0x3f803f803f803f80,0x3f803f803f803f80,0xbf7ebf7abf72bf67,0xbf72bf7abf7ebf80,0x3f7a3f673f483f20,0x3f483f673f7a3f80,0xbf72bf48bf08be64,0xbf08bf48bf72bf80
.quad 0x3f673f203e64be64,0x3e643f203f673f80,0xbf59bede3de53f20,0x3de5bedebf59bf80,0x3f483e64bedebf67,0xbede3e643f483f80,0xbf3500003f353f80,0x3f350000bf35bf80
.quad 0x3f20be64bf67bf67,0xbf67be643f203f80,0xbf083ede3f7e3f20,0x3f7e3edebf08bf80,0x3edebf20bf7abe64,0xbf7abf203ede3f80,0xbea93f483f59be64,0x3f593f48bea9bf80
.quad 0x3e64bf67bf203f20,0xbf20bf673e643f80,0xbde53f7a3ea9bf67,0x3ea93f7abde5bf80,0xbf8000003f80,0xbf8000003f80,0x3de53f7abea9bf67,0xbea93f7a3de5bf80
.quad 0x3f803f803f803f80,0x3f803f803f803f80,0xbf35bf48bf59bf67,0xbea9bedebf08bf20,0x3e643ede3f20,0xbf48bf20bedebe64,0x3f353ede3de5be64,0x3f593f7a3f7e3f67
.quad 0xbf80bf67bf20be64,0x3e64be64bf20bf67,0x3f353f7a3f723f20,0xbf7ebf48bea93e64,0xbf20bf7abf67,0x3ede3f673f7a3f20,0xbf3500003f353f80,0x3f350000bf35bf80
.quad 0x3f803f20be64bf67,0xbf67bf67be643f20,0xbf35bf7abea93f20,0xbde53f483f723e64,0x3f673f48be64,0x3f7a3e64bf48bf67,0x3f35bedebf7ebe64,0xbf08bf7abde53f67
.quad 0xbf80be643f673f20,0xbf203f203f67be64,0x3f353f48bf08bf67,0x3f723edebf59bf20,0xbf8000003f80,0xbf8000003f80,0xbf353f483f08bf67,0xbf723ede3f59bf20
.quad 0x0,0x0,0x3f723f673f593f48,0x3f7e3f803f7e3f7a,0x3f203f483f673f7a,0xbe6400003e643ede,0xbf08be643de53ede,0xbf72bf80bf72bf48
.quad 0xbf7abf7abf48bede,0x3ede0000bedebf48,0xbde5bf20bf72bf7a,0x3f593f803f593ede,0x3f673edebe64bf48,0xbf2000003f203f7a,0x3f353f803f350000,0xbf35bf80bf350000
.quad 0xbede3ede3f7a3f48,0x3f480000bf48bf7a,0xbf7ebf203ea93f7a,0x3f083f803f08bede,0xbe64bf7abf203ede,0xbf6700003f673f48,0x3f59be64bf7ebede,0xbea9bf80bea93f48
.quad 0x3f483f48bedebf7a,0x3f7a0000bf7abede,0xbea93f673f08bf48,0x3de53f803de5bf7a,0xbf8000003f800000,0xbf8000003f800000,0xbea9bf673f083f48,0x3de5bf803de53f7a
.quad 0x0,0x0,0x3f593f673f723f7a,0x3f083f203f353f48,0xbf67bf48bf20bede,0xbf67bf7abf80bf7a,0x3de5be64bf08bf48,0x3f7e3f673f353ede
.quad 0x3f483f7a3f7a3f48,0xbf48bede00003ede,0xbf72bf20bde53ede,0x3ea9be64bf35bf7a,0x3e64bedebf67bf7a,0x3e643f483f803f48,0x3f353f803f350000,0xbf35bf80bf350000
.quad 0xbf7abede3ede3f7a,0x3f7a3f480000bf48,0x3ea9bf20bf7ebede,0xbf72be643f353f7a,0x3f203f7a3e64bf48,0x3f20bedebf80bede,0xbf7ebe643f593f48,0xbde53f673f35bede
.quad 0x3edebf48bf483ede,0xbedebf7a00003f7a,0x3f083f67bea9bf7a,0x3f593f20bf35bf48,0xbf8000003f800000,0xbf8000003f800000,0x3f08bf67bea93f7a,0x3f59bf20bf353f48
.quad 0x0,0x0,0x3de53e643ea93ede,0xbea9be64bde50000,0xbe64bedebf20bf48,0x3f203ede3e640000,0x3ea93f203f593f7a,0xbf59bf20bea90000
.quad 0xbedebf48bf7abf7a,0x3f7a3f483ede0000,0x3f083f673f7e3f48,0xbf7ebf67bf080000,0xbf20bf7abf67bede,0x3f673f7a3f200000,0x3f353f803f350000,0xbf35bf80bf350000
.quad 0xbf48bf7abede3ede,0x3ede3f7a3f480000,0x3f593f673de5bf48,0xbde5bf67bf590000,0xbf67bf483e643f7a,0xbe643f483f670000,0x3f723f20bf08bf7a,0x3f08bf20bf720000
.quad 0xbf7abede3f483f48,0xbf483ede3f7a0000,0x3f7e3e64bf72bede,0x3f72be64bf7e0000,0xbf8000003f800000,0xbf8000003f800000,0x3f7ebe64bf723ede,0x3f723e64bf7e0000
.quad 0x0,0x0,0xbf35bf20bf08bede,0xbf72bf67bf59bf48,0x3f803f7a3f673f48,0x3f203f483f673f7a,0xbf35bf67bf7ebf7a,0x3f083e64bde5bede
.quad 0x3ede3f483f7a,0xbf7abf7abf48bede,0x3f353e64bea9bf48,0x3de53f203f723f7a,0xbf80bf48be643ede,0x3f673edebe64bf48,0x3f353f803f350000,0xbf35bf80bf350000
.quad 0xbf48bf7abede,0xbede3ede3f7a3f48,0xbf353e643f723f48,0x3f7e3f20bea9bf7a,0x3f803edebf20bf7a,0xbe64bf7abf203ede,0xbf35bf673de53f7a,0xbf593e643f7e3ede
.quad 0x3f7a3edebf48,0x3f483f48bedebf7a,0x3f35bf20bf593ede,0x3ea9bf67bf083f48,0xbf8000003f800000,0xbf8000003f800000,0x3f353f20bf59bede,0x3ea93f67bf08bf48
.quad 0x3f803f803f803f80,0x3f803f803f803f80,0x3e8e3ec43ef83f14,0xbe2cbd663d663e2c,0xbf59bf35bf08bea9,0xbf72bf7ebf7ebf72,0xbf3fbf6dbf80bf76,0x3ef83e2cbe2cbef8
.quad 0x3ede0000bedebf48,0x3f483f7a3f7a3f48,0x3f7c3f6d3f143d66,0xbf3fbe8e3e8e3f3f,0x3de53f353f7e3f59,0xbf08bf72bf72bf08,0xbf6dbec43ec43f6d,0x3f6d3ec4bec4bf6d
.quad 0xbf20bf80bf203e64,0x3e643f673f673e64,0x3f14bec4bf7cbf2b,0xbf80bef83ef83f80,0x3f723f35bea9bf7e,0x3de5bf59bf593de5,0xbd663f6d3f2bbef8,0x3f763f14bf14bf76
.quad 0xbf7a00003f7a3ede,0xbede3f483f48bede,0xbef8bf6d3e8e3f7c,0xbf51bf2b3f2b3f51,0x3f35bf35bf353f35,0x3f35bf35bf353f35,0x3f603ec4bf76be2c,0x3f143f3fbf3fbf14
.quad 0x3f803f803f803f80,0x3f803f803f803f80,0xbf14bef8bec4be8e,0xbf60bf51bf3fbf2b,0xbea9bf08bf35bf59,0x3f083ea93de5bde5,0x3f763f803f6d3f3f,0xbd663e8e3f143f51
.quad 0xbf48bede00003ede,0xbedebf48bf7abf7a,0xbd66bf14bf6dbf7c,0x3f513f803f603ef8,0x3f593f7e3f353de5,0xbf7ebf59bea93ea9,0xbf6dbec43ec43f6d,0x3f6d3ec4bec4bf6d
.quad 0x3e64bf20bf80bf20,0xbf203e643f673f67,0x3f2b3f7c3ec4bf14,0x3e2cbf3fbf76be8e,0xbf7ebea93f353f72,0x3ea93f7e3f08bf08,0x3ef8bf2bbf6d3d66,0xbf3fbf603e2c3f7c
.quad 0x3ede3f7a0000bf7a,0x3f7a3edebf48bf48,0xbf7cbe8e3f6d3ef8,0xbf763e2c3f803d66,0x3f35bf35bf353f35,0x3f35bf35bf353f35,0x3e2c3f76bec4bf60,0xbe8e3f7c3d66bf80
.quad 0x3f803f803f803f80,0x3f803f803f803f80,0xbf80bf7cbf76bf6d,0xbf6dbf76bf7cbf80,0x3f7e3f723f593f35,0x3f353f593f723f7e,0xbf7cbf60bf2bbec4,0xbec4bf2bbf60bf7c
.quad 0x3f7a3f483ede0000,0x3ede3f483f7a,0xbf76bf2bbe2c3ec4,0x3ec4be2cbf2bbf76,0x3f723f08bde5bf35,0xbf35bde53f083f72,0xbf6dbec43ec43f6d,0x3f6d3ec4bec4bf6d
.quad 0x3f673e64bf20bf80,0xbf80bf203e643f67,0xbf60bd663f513f6d,0x3f6d3f51bd66bf60,0x3f59bde5bf72bf35,0xbf35bf72bde53f59,0xbf513e8e3f803ec4,0x3ec43f803e8ebf51
.quad 0x3f48bedebf7a0000,0xbf7abede3f48,0xbf3f3f143f60bec4,0xbec43f603f14bf3f,0x3f35bf35bf353f35,0x3f35bf35bf353f35,0xbf2b3f513ef8bf6d,0xbf6d3ef83f51bf2b
.quad 0x3f803f803f803f80,0x3f803f803f803f80,0xbf2bbf3fbf51bf60,0xbe8ebec4bef8bf14,0xbde53de53ea93f08,0xbf59bf35bf08bea9,0x3f513f143e8ebd66,0x3f3f3f6d3f803f76
.quad 0xbf7abf7abf48bede,0x3ede0000bedebf48,0x3ef83f603f803f51,0xbf7cbf6dbf14bd66,0x3ea9bea9bf59bf7e,0x3de53f353f7e3f59,0xbf6dbec43ec43f6d,0x3f6d3ec4bec4bf6d
.quad 0x3f673f673e64bf20,0xbf20bf80bf203e64,0xbe8ebf76bf3f3e2c,0xbf143ec43f7c3f2b,0xbf083f083f7e3ea9,0x3f723f35bea9bf7e,0x3f7c3e2cbf60bf3f,0x3d66bf6dbf2b3ef8
.quad 0xbf48bf483ede3f7a,0xbf7a00003f7a3ede,0x3d663f803e2cbf76,0x3ef83f6dbe8ebf7c,0x3f35bf35bf353f35,0x3f35bf35bf353f35,0xbf803d663f7cbe8e,0xbf60bec43f763e2c
.quad 0x0,0x0,0x3f763f6d3f603f51,0x3f7c3f803f803f7c,0x3f083f353f593f72,0xbea9bde53de53ea9,0xbf2bbec4bd663e8e,0xbf60bf7cbf7cbf60
.quad 0xbf67bf80bf67bf20,0x3f203e64be64bf20,0x3e2cbec4bf51bf80,0x3f2b3f763f763f2b,0x3f7e3f353de5bf08,0xbf59bea93ea93f59,0x3ec43f6d3f6d3ec4,0xbec4bf6dbf6dbec4
.quad 0xbf4800003f483f7a,0x3f7a3edebedebf7a,0xbf51bf6dbe2c3f3f,0x3d663f603f603d66,0x3ea9bf35bf72bde5,0xbf7ebf083f083f7e,0x3f803ec4bf3fbf60,0x3e8ebf51bf513e8e
.quad 0x3e643f803e64bf67,0x3f673f20bf20bf67,0xbf603ec43f76be2c,0xbf143f3f3f3fbf14,0xbf35bf353f353f35,0xbf35bf353f353f35,0x3ef8bf6dbe8e3f7c,0x3f51bf2bbf2b3f51
.quad 0x0,0x0,0x3f513f603f6d3f76,0x3ef83f143f2b3f3f,0xbf72bf59bf35bf08,0xbf59bf72bf7ebf7e,0x3e8ebd66bec4bf2b,0x3f803f763f513f14
.quad 0x3f203f673f803f67,0xbf67bf20be643e64,0xbf80bf51bec43e2c,0x3f143d66bef8bf60,0x3f08bde5bf35bf7e,0xbde53f083f723f72,0x3ec43f6d3f6d3ec4,0xbec4bf6dbf6dbec4
.quad 0xbf7abf4800003f48,0x3f483f7a3edebede,0x3f3fbe2cbf6dbf51,0xbf7cbf2b3e8e3f76,0x3de53f723f35bea9,0x3f723de5bf59bf59,0xbf60bf3f3ec43f80,0xbf2b3ef83f7c3e2c
.quad 0x3f67be64bf80be64,0x3e64bf67bf203f20,0xbe2c3f763ec4bf60,0x3e8e3f7cbd66bf80,0xbf35bf353f353f35,0xbf35bf353f353f35,0x3f7cbe8ebf6d3ef8,0x3f763e2cbf803d66
.quad 0x0,0x0,0x3d663e2c3e8e3ec4,0xbec4be8ebe2cbd66,0xbde5bea9bf08bf35,0x3f353f083ea93de5,0x3e2c3ef83f3f3f6d,0xbf6dbf3fbef8be2c
.quad 0xbe64bf20bf67bf80,0x3f803f673f203e64,0x3e8e3f3f3f7c3f6d,0xbf6dbf7cbf3fbe8e,0xbea9bf59bf7ebf35,0x3f353f7e3f593ea9,0x3ec43f6d3f6d3ec4,0xbec4bf6dbf6dbec4
.quad 0xbedebf7abf480000,0x3f483f7a3ede,0x3ef83f803f14bec4,0x3ec4bf14bf80bef8,0xbf08bf7ebea93f35,0xbf353ea93f7e3f08,0x3f143f763d66bf6d,0x3f6dbd66bf76bf14
.quad 0xbf20bf673e643f80,0xbf80be643f673f20,0x3f2b3f51bef8bf6d,0x3f6d3ef8bf51bf2b,0xbf35bf353f353f35,0xbf35bf353f353f35,0x3f3f3f14bf60bec4,0x3ec43f60bf14bf3f
.quad 0x0,0x0,0xbf3fbf2bbf14bef8,0xbf76bf6dbf60bf51,0x3f7e3f7e3f723f59,0x3f083f353f593f72,0xbf14bf51bf76bf80,0x3f2b3ec43d66be8e
.quad 0xbe643e643f203f67,0xbf67bf80bf67bf20,0x3f603ef8bd66bf14,0xbe2c3ec43f513f80,0xbf72bf72bf083de5,0x3f7e3f353de5bf08,0x3ec43f6d3f6d3ec4,0xbec4bf6dbf6dbec4
.quad 0x3edebedebf7abf48,0xbf4800003f483f7a,0xbf76be8e3f2b3f7c,0x3f513f6d3e2cbf3f,0x3f593f59bde5bf72,0x3ea9bf35bf72bde5,0xbe2cbf7cbef83f2b,0xbf80bec43f3f3f60
.quad 0xbf203f203f67be64,0x3e643f803e64bf67,0x3f803d66bf7cbe8e,0x3f60bec4bf763e2c,0xbf35bf353f353f35,0xbf35bf353f353f35,0xbd663f80be2cbf76,0xbef83f6d3e8ebf7c
.quad 0x3f803f803f803f80,0x3f803f803f803f80,0x3de50000bde5be64,0x3f083ede3ea93e64,0xbf7abf80bf7abf67,0xbedebf20bf48bf67,0xbea900003ea93f20,0xbf7ebf7abf59bf20
.quad 0x3f673f803f673f20,0xbf20be643e643f20,0x3f080000bf08bf67,0x3ea93f483f7e3f67,0xbf48bf80bf48be64,0x3f7a3f673edebe64,0xbf3500003f353f80,0x3f350000bf35bf80
.quad 0x3f203f803f20be64,0xbe64bf67bf67be64,0x3f590000bf59bf67,0xbf72bf483de53f67,0xbedebf80bede3f20,0xbf483e643f7a3f20,0xbf7200003f723f20,0x3de53f7a3f08bf20
.quad 0x3e643f803e64bf67,0x3f673f20bf20bf67,0x3f7e0000bf7ebe64,0x3f59bedebf723e64,0xbf8000003f80,0xbf8000003f80,0xbf7e00003f7ebe64,0xbf59bede3f723e64
.quad 0x3f803f803f803f80,0x3f803f803f803f80,0x3f593f483f353f20,0x3f7e3f7a3f723f67,0x3ede3e640000be64,0x3f7a3f673f483f20,0xbde5bedebf35bf67,0x3f723f483f083e64
.quad 0xbf20bf67bf80bf67,0x3f673f203e64be64,0xbf72bf7abf35be64,0x3f593edebde5bf20,0xbf7abf2000003f20,0x3f483e64bedebf67,0xbf3500003f353f80,0x3f350000bf35bf80
.quad 0xbe643f203f803f20,0x3f20be64bf67bf67,0x3ea93f7a3f35be64,0x3f08bedebf7ebf20,0x3f483f670000bf67,0x3edebf20bf7abe64,0x3f7e3edebf35bf67,0x3ea9bf48bf593e64
.quad 0x3f67be64bf80be64,0x3e64bf67bf203f20,0x3f08bf48bf353f20,0x3de5bf7abea93f67,0xbf8000003f80,0xbf8000003f80,0xbf08bf483f353f20,0xbde5bf7a3ea93f67
.quad 0x0,0x0,0x0,0x0,0x0,0x0,0x0,0x0
.quad 0x0,0x0,0x0,0x0,0x0,0x0,0x0,0x0
.quad 0x0,0x0,0x0,0x0,0x0,0x0,0x0,0x0
.quad 0x0,0x0,0x0,0x0,0x0,0x0,0x0,0x0
.quad 0x0,0x0,0x0,0x0,0x0,0x0,0x0,0x0
.quad 0x0,0x0,0x0,0x0,0x0,0x0,0x0,0x0
.quad 0x0,0x0,0x0,0x0,0x0,0x0,0x0,0x0
.quad 0x0,0x0,0x0,0x0,0x0,0x0,0x0,0x0
.quad 0x0,0x0,0xbf7ebf80bf7ebf7a,0xbf59bf67bf72bf7a,0xbe6400003e643ede,0xbf67bf48bf20bede,0x3f723f803f723f48,0xbde53e643f083f48
.quad 0x3ede0000bedebf48,0x3f483f7a3f7a3f48,0xbf59bf80bf59bede,0x3f723f203de5bede,0xbf2000003f203f7a,0x3e64bedebf67bf7a,0x3f353f803f350000,0xbf35bf80bf350000
.quad 0x3f480000bf48bf7a,0xbf7abede3ede3f7a,0xbf08bf80bf083ede,0xbea93f203f7e3ede,0xbf6700003f673f48,0x3f203f7a3e64bf48,0x3ea93f803ea9bf48,0x3f7e3e64bf59bf48
.quad 0x3f7a0000bf7abede,0x3edebf48bf483ede,0xbde5bf80bde53f7a,0xbf08bf673ea93f7a,0xbf8000003f800000,0xbf8000003f800000,0xbde53f80bde5bf7a,0xbf083f673ea9bf7a
.quad 0x0,0x0,0xbf08bf20bf35bf48,0xbde5be64bea9bede,0xbf67bf7abf80bf7a,0xbe64bedebf20bf48,0xbf7ebf67bf35bede,0xbea9bf20bf59bf7a
.quad 0xbf48bede00003ede,0xbedebf48bf7abf7a,0xbea93e643f353f7a,0xbf08bf67bf7ebf48,0x3e643f483f803f48,0xbf20bf7abf67bede,0x3f353f803f350000,0xbf35bf80bf350000
.quad 0x3f7a3f480000bf48,0xbf48bf7abede3ede,0x3f723e64bf35bf7a,0xbf59bf67bde53f48,0x3f20bedebf80bede,0xbf67bf483e643f7a,0x3de5bf67bf353ede,0xbf72bf203f083f7a
.quad 0xbedebf7a00003f7a,0xbf7abede3f483f48,0xbf59bf203f353f48,0xbf7ebe643f723ede,0xbf8000003f800000,0xbf8000003f800000,0xbf593f203f35bf48,0xbf7e3e643f72bede
.quad 0x0,0x0,0x0,0x0,0x0,0x0,0x0,0x0
.quad 0x0,0x0,0x0,0x0,0x0,0x0,0x0,0x0
.quad 0x0,0x0,0x0,0x0,0x0,0x0,0x0,0x0
.quad 0x0,0x0,0x0,0x0,0x0,0x0,0x0,0x0
.quad 0x0,0x0,0x0,0x0,0x0,0x0,0x0,0x0
.quad 0x0,0x0,0x0,0x0,0x0,0x0,0x0,0x0
.quad 0x0,0x0,0x0,0x0,0x0,0x0,0x0,0x0
.quad 0x0,0x0,0x0,0x0,0x0,0x0,0x0,0x0
.quad 0x3f803f803f803f80,0x3f803f803f803f80,0x3e2c3d66bd66be2c,0x3f143ef83ec43e8e,0xbf72bf7ebf7ebf72,0xbea9bf08bf35bf59,0xbef8be2c3e2c3ef8,0xbf76bf80bf6dbf3f
.quad 0x3f483f7a3f7a3f48,0xbf48bede00003ede,0x3f3f3e8ebe8ebf3f,0x3d663f143f6d3f7c,0xbf08bf72bf72bf08,0x3f593f7e3f353de5,0xbf6dbec43ec43f6d,0x3f6d3ec4bec4bf6d
.quad 0x3e643f673f673e64,0x3e64bf20bf80bf20,0x3f803ef8bef8bf80,0xbf2bbf7cbec43f14,0x3de5bf59bf593de5,0xbf7ebea93f353f72,0xbf76bf143f143f76,0xbef83f2b3f6dbd66
.quad 0xbede3f483f48bede,0x3ede3f7a0000bf7a,0x3f513f2bbf2bbf51,0x3f7c3e8ebf6dbef8,0x3f35bf35bf353f35,0x3f35bf35bf353f35,0xbf14bf3f3f3f3f14,0xbe2cbf763ec43f60
.quad 0x3f803f803f803f80,0x3f803f803f803f80,0x3f603f513f3f3f2b,0x3f803f7c3f763f6d,0x3f083ea93de5bde5,0x3f7e3f723f593f35,0x3d66be8ebf14bf51,0x3f7c3f603f2b3ec4
.quad 0xbedebf48bf7abf7a,0x3f7a3f483ede0000,0xbf51bf80bf60bef8,0x3f763f2b3e2cbec4,0xbf7ebf59bea93ea9,0x3f723f08bde5bf35,0xbf6dbec43ec43f6d,0x3f6d3ec4bec4bf6d
.quad 0xbf203e643f673f67,0x3f673e64bf20bf80,0xbe2c3f3f3f763e8e,0x3f603d66bf51bf6d,0x3ea93f7e3f08bf08,0x3f59bde5bf72bf35,0x3f3f3f60be2cbf7c,0x3f51be8ebf80bec4
.quad 0x3f7a3edebf48bf48,0x3f48bedebf7a0000,0x3f76be2cbf80bd66,0x3f3fbf14bf603ec4,0x3f35bf35bf353f35,0x3f35bf35bf353f35,0x3e8ebf7cbd663f80,0x3f2bbf51bef83f6d
.quad 0x0,0x0,0x0,0x0,0x0,0x0,0x0,0x0
.quad 0x0,0x0,0x0,0x0,0x0,0x0,0x0,0x0
.quad 0x0,0x0,0x0,0x0,0x0,0x0,0x0,0x0
.quad 0x0,0x0,0x0,0x0,0x0,0x0,0x0,0x0
.quad 0x0,0x0,0x0,0x0,0x0,0x0,0x0,0x0
.quad 0x0,0x0,0x0,0x0,0x0,0x0,0x0,0x0
.quad 0x0,0x0,0x0,0x0,0x0,0x0,0x0,0x0
.quad 0x0,0x0,0x0,0x0,0x0,0x0,0x0,0x0
.quad 0x0,0x0,0xbf7cbf80bf80bf7c,0xbf51bf60bf6dbf76,0xbea9bde53de53ea9,0xbf72bf59bf35bf08,0x3f603f7c3f7c3f60,0xbe8e3d663ec43f2b
.quad 0x3f203e64be64bf20,0x3f203f673f803f67,0xbf2bbf76bf76bf2b,0x3f803f513ec4be2c,0xbf59bea93ea93f59,0x3f08bde5bf35bf7e,0x3ec43f6d3f6d3ec4,0xbec4bf6dbf6dbec4
.quad 0x3f7a3edebedebf7a,0xbf7abf4800003f48,0xbd66bf60bf60bd66,0xbf3f3e2c3f6d3f51,0xbf7ebf083f083f7e,0x3de53f723f35bea9,0xbe8e3f513f51be8e,0x3f603f3fbec4bf80
.quad 0x3f673f20bf20bf67,0x3f67be64bf80be64,0x3f14bf3fbf3f3f14,0x3e2cbf76bec43f60,0xbf35bf353f353f35,0xbf35bf353f353f35,0xbf513f2b3f2bbf51,0xbf7c3e8e3f6dbef8
.quad 0x0,0x0,0xbef8bf14bf2bbf3f,0xbd66be2cbe8ebec4,0xbf59bf72bf7ebf7e,0xbde5bea9bf08bf35,0xbf80bf76bf51bf14,0xbe2cbef8bf3fbf6d
.quad 0xbf67bf20be643e64,0xbe64bf20bf67bf80,0xbf14bd663ef83f60,0xbe8ebf3fbf7cbf6d,0xbde53f083f723f72,0xbea9bf59bf7ebf35,0x3ec43f6d3f6d3ec4,0xbec4bf6dbf6dbec4
.quad 0x3f483f7a3edebede,0xbedebf7abf480000,0x3f7c3f2bbe8ebf76,0xbef8bf80bf143ec4,0x3f723de5bf59bf59,0xbf08bf7ebea93f35,0x3f2bbef8bf7cbe2c,0xbf14bf76bd663f6d
.quad 0x3e64bf67bf203f20,0xbf20bf673e643f80,0xbe8ebf7c3d663f80,0xbf2bbf513ef83f6d,0xbf35bf353f353f35,0xbf35bf353f353f35,0xbf76be2c3f80bd66,0xbf3fbf143f603ec4
.quad 0x0,0x0,0x0,0x0,0x0,0x0,0x0,0x0
.quad 0x0,0x0,0x0,0x0,0x0,0x0,0x0,0x0
.quad 0x0,0x0,0x0,0x0,0x0,0x0,0x0,0x0
.quad 0x0,0x0,0x0,0x0,0x0,0x0,0x0,0x0
.quad 0x0,0x0,0x0,0x0,0x0,0x0,0x0,0x0
.quad 0x0,0x0,0x0,0x0,0x0,0x0,0x0,0x0
.quad 0x0,0x0,0x0,0x0,0x0,0x0,0x0,0x0
.quad 0x0,0x0,0x0,0x0,0x0,0x0,0x0,0x0
.quad 0x3f7c3f7e3f803f80,0x3f6d3f723f763f7a,0x3f603f723f7c3f80,0x3ec43f083f2b3f48,0x3f2b3f593f763f80,0xbec4bde53e2c3ede,0x3ec43f353f6d3f80,0xbf6dbf35bec40000
.quad 0x3d663f083f603f80,0xbf6dbf7ebf51bede,0xbe8e3ea93f513f80,0xbec4bf59bf80bf48,0xbf143de53f3f3f80,0x3ec4bea9bf60bf7a,0xbf51bde53f2b3f80,0x3f6d3ea9bef8bf7a
.quad 0xbf76bea93f143f80,0x3f6d3f593d66bf48,0xbf80bf083ef83f80,0x3ec43f7e3f14bede,0xbf6dbf353ec43f80,0xbec43f353f6d0000,0xbf3fbf593e8e3f80,0xbf6d3de53f7c3ede
.quad 0xbef8bf723e2c3f80,0xbf6dbf083f3f3f48,0xbe2cbf7e3d663f80,0xbec4bf723e8e3f7a,0x3e2cbf7ebd663f80,0x3ec4bf72be8e3f7a,0x3ef8bf72be2c3f80,0x3f6dbf08bf3f3f48
.quad 0x3f513f593f603f67,0x3f2b3f353f3f3f48,0xbe8ebde53d663e64,0xbf51bf35bf14bede,0xbf80bf72bf51bf20,0xbef8bf35bf60bf7a,0xbec4bf35bf6dbf80,0x3f6d3f353ec40000
.quad 0x3f3f3ea9be2cbf20,0x3e8e3f353f763f7a,0x3f603f7e3f3f3e64,0xbf7cbf35be2c3ede,0xbe2c3f083f763f67,0xbd66bf35bf80bf48,0xbf7cbf083e8e3f67,0x3f803f35bd66bf48
.quad 0xbef8bf7ebf2b3e64,0xbe2c3f353f7c3ede,0x3f2bbea9bf7cbf20,0xbf76bf353e8e3f7a,0x3f6d3f35bec4bf80,0x3ec4bf35bf6d0000,0xbd663f723f14bf20,0x3f603f35bef8bf7a
.quad 0xbf763de53f803e64,0xbf143f353f51bede,0xbf14bf593ef83f67,0xbf3fbf353f2b3f48,0x3f14bf59bef83f67,0x3f3fbf35bf2b3f48,0x3f763de5bf803e64,0x3f143f35bf51bede
.quad 0x3ef83f083f143f20,0x3e8e3ea93ec43ede,0xbf80bf7ebf76bf67,0xbf3fbf59bf6dbf7a,0x3f143ea93d66be64,0x3f7c3f7e3f6d3f48,0x3ec43f353f6d3f80,0xbf6dbf35bec40000
.quad 0xbf7cbf72bf2bbe64,0x3f143de5bec4bf48,0x3f2b3de5bef8bf67,0xbd663f083f6d3f7a,0x3e8e3f593f7c3f20,0xbef8bf72bf6dbede,0xbf76bf59be2c3f20,0x3f603f723ec4bede
.quad 0x3f3fbde5bf60bf67,0xbf80bf083ec43f7a,0x3e2c3f723f3fbe64,0x3f51bde5bf6dbf48,0xbf6dbf353ec43f80,0xbec43f353f6d0000,0x3f51bea9bf80be64,0xbe2cbf7ebec43f48
.quad 0x3d663f7e3e8ebf67,0x3f2b3f59bec4bf7a,0xbf60bf083f513f20,0xbf76bea93f6d3ede,0x3f60bf08bf513f20,0x3f76bea9bf6d3ede,0xbd663f7ebe8ebf67,0xbf2b3f593ec4bf7a
.quad 0x3d663de53e2c3e64,0xbe2cbde5bd660000,0xbe2cbea9bef8bf20,0x3ef83ea93e2c0000,0x3e8e3f083f3f3f67,0xbf3fbf08be8e0000,0xbec4bf35bf6dbf80,0x3f6d3f353ec40000
.quad 0x3ef83f593f803f67,0xbf80bf59bef80000,0xbf14bf72bf76bf20,0x3f763f723f140000,0x3f2b3f7e3f513e64,0xbf51bf7ebf2b0000,0xbf3fbf7ebf143e64,0x3f143f7e3f3f0000
.quad 0x3f513f723e8ebf20,0xbe8ebf72bf510000,0xbf60bf593d663f67,0xbd663f593f600000,0x3f6d3f35bec4bf80,0x3ec4bf35bf6d0000,0xbf76bf083f2b3f67,0xbf2b3f083f760000
.quad 0x3f7c3ea9bf60bf20,0x3f60bea9bf7c0000,0xbf80bde53f7c3e64,0xbf7c3de53f800000,0x3f80bde5bf7c3e64,0x3f7c3de5bf800000,0xbf7c3ea93f60bf20,0xbf60bea93f7c0000
.quad 0x3e2c3de53d660000,0x3ec43ea93e8e3e64,0x3ef83ea93e2c0000,0x3f6d3f593f3f3f20,0x3f3f3f083e8e0000,0x3f6d3f7e3f7c3f67,0x3f6d3f353ec40000,0x3ec43f353f6d3f80
.quad 0x3f803f593ef80000,0xbec43de53f143f67,0x3f763f723f140000,0xbf6dbf083d663f20,0x3f513f7e3f2b0000,0xbf6dbf72bef83e64,0x3f143f7e3f3f0000,0xbec4bf72bf60be64
.quad 0x3e8e3f723f510000,0x3ec4bf08bf80bf20,0xbd663f593f600000,0x3f6d3de5bf51bf67,0xbec43f353f6d0000,0x3f6d3f35bec4bf80,0xbf2b3f083f760000,0x3ec43f7e3e2cbf67
.quad 0xbf603ea93f7c0000,0xbec43f593f2bbf20,0xbf7c3de53f800000,0xbf6d3ea93f76be64,0xbf7cbde53f800000,0xbf6dbea93f763e64,0xbf60bea93f7c0000,0xbec4bf593f2b3f20
.quad 0x3f143f083ef83ede,0x3f3f3f353f2b3f20,0x3f763f7e3f803f7a,0x3f143f353f513f67,0x3d663ea93f143f48,0xbf60bf35bef8be64,0xbf6dbf35bec40000,0xbec4bf35bf6dbf80
.quad 0xbf2bbf72bf7cbf48,0x3f763f353e8ebe64,0x3ef8bde5bf2bbf7a,0x3e2c3f353f7c3f67,0x3f7c3f593e8ebede,0xbf80bf35bd663f20,0x3e2c3f593f763ede,0x3d66bf35bf80bf20
.quad 0xbf60bde53f3f3f7a,0x3f7c3f35be2cbf67,0xbf3fbf72be2c3f48,0xbe8e3f353f763e64,0x3ec4bf35bf6d0000,0xbf6dbf353ec43f80,0x3f803ea9bf51bf48,0x3ef8bf35bf603e64
.quad 0x3e8e3f7e3d66bf7a,0x3f513f35bf14bf67,0xbf513f083f60bede,0xbf2b3f353f3fbf20,0xbf51bf083f603ede,0xbf2bbf353f3f3f20,0x3e8ebf7e3d663f7a,0x3f51bf35bf143f67
.quad 0x3f603f593f513f48,0x3f763f723f6d3f67,0xbd663de53e8e3ede,0xbf2bbf08bec4be64,0xbf51bf72bf80bf7a,0x3e2cbde5bec4bf20,0x3f6d3f353ec40000,0x3ec43f353f6d3f80
.quad 0xbe2c3ea93f3f3f7a,0xbf51bf7ebf6dbf20,0xbf3fbf7ebf60bede,0x3f803f593ec4be64,0x3f763f08be2cbf48,0xbf60bea93ec43f67,0xbe8e3f083f7c3f48,0x3ef8bea9bf6dbf67
.quad 0xbf2bbf7ebef83ede,0x3d663f593f6d3e64,0x3f7c3ea9bf2bbf7a,0xbf14bf7ebec43f20,0xbec43f353f6d0000,0x3f6d3f35bec4bf80,0xbf14bf723d663f7a,0xbf7cbde53f6d3f20
.quad 0x3f803de5bf76bede,0x3f3fbf08bf6d3e64,0xbef83f593f14bf48,0xbe8e3f723ec4bf67,0xbef8bf593f143f48,0xbe8ebf723ec43f67,0x3f80bde5bf763ede,0x3f3f3f08bf6dbe64
.quad 0x3f803f7e3f7c3f7a,0x3f7c3f7e3f803f80,0xbf7cbf72bf60bf48,0xbf60bf72bf7cbf80,0x3f763f593f2b3ede,0x3f2b3f593f763f80,0xbf6dbf35bec40000,0xbec4bf35bf6dbf80
.quad 0x3f603f083d66bede,0x3d663f083f603f80,0xbf51bea93e8e3f48,0x3e8ebea9bf51bf80,0x3f3f3de5bf14bf7a,0xbf143de53f3f3f80,0xbf2b3de53f513f7a,0x3f513de5bf2bbf80
.quad 0x3f14bea9bf76bf48,0xbf76bea93f143f80,0xbef83f083f803ede,0x3f803f08bef8bf80,0x3ec4bf35bf6d0000,0xbf6dbf353ec43f80,0xbe8e3f593f3fbede,0x3f3f3f59be8ebf80
.quad 0x3e2cbf72bef83f48,0xbef8bf723e2c3f80,0xbd663f7e3e2cbf7a,0x3e2c3f7ebd66bf80,0xbd66bf7e3e2c3f7a,0x3e2cbf7ebd663f80,0x3e2c3f72bef8bf48,0xbef83f723e2cbf80
.quad 0x3f7b3f7d3f7f3f80,0x3f6a3f6f3f743f78,0x3f553f6a3f783f7f,0x3e9b3eeb3f1a3f3a,0x3f0e3f443f6a3f7d,0xbf02be803ce63e9b,0x3e483f0e3f553f7b,0xbf7bbf55bf0ebe48
.quad 0xbe483e9b3f3a3f78,0xbf4dbf7dbf6fbf25,0xbf0e3ce63f1a3f74,0xbdacbf25bf78bf6f,0xbf55be803eeb3f6f,0x3f303ce6bf25bf7d,0xbf7bbf023e9b3f6a,0x3f803f30bdacbf4d
.quad 0xbf7bbf3a3e0f3f63,0x3f253f7f3f02bed1,0xbf55bf63bce63f5c,0xbe0f3f4d3f6a3dac,0xbf0ebf7bbe483f55,0xbf553e483f7b3f0e,0xbe48bf7fbeb73f4d,0xbf78bf023f303f63
.quad 0x3e48bf6fbf023f44,0xbeebbf743e0f3f80,0x3f0ebf4dbf253f3a,0x3eb7bf6abeeb3f5c,0x3f55bf1abf443f30,0x3f6fbed1bf633f02,0x3f7bbeb7bf5c3f25,0x3f633e9bbf7d3ce6
.quad 0x3f4d3f553f5c3f63,0x3f253f303f3a3f44,0xbeb7be48bce63e0f,0xbf5cbf44bf25bf02,0xbf7fbf7bbf63bf3a,0xbeb7bf1abf4dbf6f,0xbe48bf0ebf55bf7b,0x3f7b3f553f0e3e48
.quad 0x3f633f0e3dacbed1,0x3ce63f023f5c3f80,0x3f303f7b3f6a3f02,0xbf7dbf63beeb3e0f,0xbf023e483f4d3f7f,0x3e9bbed1bf6abf74,0xbf78bf55be0f3f25,0x3f633f6f3eb7beeb
.quad 0xbce6bf55bf6fbe80,0xbf1a3e9b3f743f4d,0x3f743e48bf44bf6f,0xbf30bf78be803f3a,0x3f0e3f7b3e48bf55,0x3f55be48bf7bbf0e,0xbf253f0e3f74bce6,0x3ed13f7d3e0fbf6a
.quad 0xbf6abf0e3f3a3f4d,0xbf783dac3f7f3e80,0x3e0fbf7bbe803f74,0xbdacbf80bce63f7f,0x3f7dbe48bf783e9b,0x3f7f3ce6bf803dac,0x3ed13f55bf30bf1a,0xbe803f7fbdacbf78
.quad 0x3eeb3f023f0e3f1a,0x3e803e9b3eb73ed1,0xbf7dbf80bf7bbf6f,0xbf30bf4dbf63bf74,0x3f303eeb3e48bdac,0x3f743f803f783f5c,0x3e483f0e3f553f7b,0xbf7bbf55bf0ebe48
.quad 0xbf6abf7fbf55beeb,0x3f443eb7be0fbf1a,0x3f5c3ed1be48bf3a,0xbeb73e803f443f7f,0xbdac3f1a3f7b3f5c,0xbe0fbf44bf80bf3a,0xbf44bf7dbf0e3e80,0x3f1a3f7f3f3abce6
.quad 0x3f783eb7bf0ebf80,0xbf6abf5cbdac3f44,0xbeb73f253f7b3e9b,0x3f7f3ed1bf1abf7d,0xbf0ebf7bbe483f55,0xbf553e483f7b3f0e,0x3f803e9bbf55bf44,0x3eebbf3abf5c3e80
.quad 0xbf1a3f303f55bed1,0x3ce63f7d3e9bbf63,0xbe9bbf783e483f7d,0xbf02bf633ed13f6f,0x3f743e80bf7bbe0f,0x3f5c3eebbf6abeb7,0xbf4d3f3a3f0ebf6a,0xbf803e0f3f74beeb
.quad 0x3ce63dac3e0f3e48,0xbe48be0fbdacbce6,0xbdacbe80bed1bf0e,0x3f0e3ed13e803dac,0x3e0f3ed13f253f55,0xbf55bf25bed1be0f,0xbe48bf0ebf55bf7b,0x3f7b3f553f0e3e48
.quad 0x3e803f303f743f7b,0xbf7bbf74bf30be80,0xbe9bbf4dbf80bf55,0x3f553f803f4d3e9b,0x3eb73f633f783f0e,0xbf0ebf78bf63beb7,0xbed1bf74bf5cbe48,0x3e483f5c3f743ed1
.quad 0x3eeb3f7d3f30be48,0x3e48bf30bf7dbeeb,0xbf02bf80beeb3f0e,0xbf0e3eeb3f803f02,0x3f0e3f7b3e48bf55,0x3f55be48bf7bbf0e,0xbf1abf6f3dac3f7b,0xbf7bbdac3f6f3f1a
.quad 0x3f253f5cbeb7bf7b,0x3f7b3eb7bf5cbf25,0xbf30bf443f1a3f55,0xbf55bf1a3f443f30,0x3f3a3f25bf4dbf0e,0x3f0e3f4dbf25bf3a,0xbf44bf023f6f3e48,0xbe48bf6f3f023f44
.quad 0x3e483e0f3dac3ce6,0x3ed13eb73e9b3e80,0x3f0e3ed13e803dac,0x3f743f633f4d3f30,0x3f553f253ed13e0f,0x3f5c3f783f803f74,0x3f7b3f553f0e3e48,0x3e483f0e3f553f7b
.quad 0x3f7b3f743f303e80,0xbf1abe0f3eb73f44,0x3f553f803f4d3e9b,0xbf7fbf44be803eb7,0x3f0e3f783f633eb7,0xbf3abf80bf44be0f,0x3e483f5c3f743ed1,0x3ce6bf3abf7fbf1a
.quad 0xbe483f303f7d3eeb,0x3f44bdacbf5cbf6a,0xbf0e3eeb3f803f02,0x3f7d3f1abed1bf7f,0xbf553e483f7b3f0e,0x3f0e3f7b3e48bf55,0xbf7bbdac3f6f3f1a,0xbe803f5c3f3abeeb
.quad 0xbf7bbeb73f5c3f25,0xbf633e9b3f7d3ce6,0xbf55bf1a3f443f30,0xbf6fbed13f633f02,0xbf0ebf4d3f253f3a,0xbeb7bf6a3eeb3f5c,0xbe48bf6f3f023f44,0x3eebbf74be0f3f80
.quad 0x3f1a3f0e3f023eeb,0x3f443f3a3f303f25,0x3f6f3f7b3f803f7d,0x3f023f253f443f5c,0xbdac3e483eeb3f30,0xbf6fbf4dbf1abeb7,0xbf7bbf55bf0ebe48,0xbe48bf0ebf55bf7b
.quad 0xbeebbf55bf7fbf6a,0x3f803f5c3f023ce6,0x3f3a3e48bed1bf5c,0xbe0f3eeb3f633f7d,0x3f5c3f7b3f1abdac,0xbf74bf6abed13e9b,0xbe803f0e3f7d3f44,0x3eebbeb7bf6fbf63
.quad 0xbf80bf0e3eb73f78,0x3f4d3f743e9bbf1a,0xbe9bbf7bbf253eb7,0xbf3a3e803f783f30,0x3f55be48bf7bbf0e,0xbf0ebf7bbe483f55,0x3f443f55be9bbf80,0x3f6abe0fbf7dbed1
.quad 0xbed13f553f30bf1a,0x3e803f7f3dacbf78,0xbf7dbe483f783e9b,0xbf7f3ce63f803dac,0xbe0fbf7b3e803f74,0x3dacbf803ce63f7f,0x3f6abf0ebf3a3f4d,0x3f783dacbf7f3e80
.quad 0x3f633f5c3f553f4d,0x3f783f743f6f3f6a,0xbe0f3ce63e483eb7,0xbf3abf1abeebbe9b,0xbf3abf63bf7bbf7f,0x3e9b3ce6be80bf02,0x3f7b3f553f0e3e48,0x3e483f0e3f553f7b
.quad 0xbed13dac3f0e3f63,0xbf25bf6fbf7dbf4d,0xbf02bf6abf7bbf30,0x3f6f3f783f253dac,0x3f7f3f4d3e48bf02,0xbf7dbf253ce63f30,0xbf253e0f3f553f78,0x3f4d3dacbf30bf80
.quad 0xbe80bf6fbf55bce6,0xbed13f023f7f3f25,0x3f6f3f44be48bf74,0xbdacbf6abf4d3e0f,0xbf553e483f7b3f0e,0x3f0e3f7b3e48bf55,0x3ce6bf74bf0e3f25,0xbf63bf303f023f78
.quad 0x3f4d3f3abf0ebf6a,0x3f803e0fbf74beeb,0xbf743e803f7bbe0f,0xbf5c3eeb3f6abeb7,0x3e9bbf78be483f7d,0x3f02bf63bed13f6f,0x3f1a3f30bf55bed1,0xbce63f7dbe9bbf63
.quad 0x3f803f7f3f7d3f7b,0x3f7b3f7d3f7f3f80,0xbf7fbf78bf6abf55,0xbf55bf6abf78bf7f,0x3f7d3f6a3f443f0e,0x3f0e3f443f6a3f7d,0xbf7bbf55bf0ebe48,0xbe48bf0ebf55bf7b
.quad 0x3f783f3a3e9bbe48,0xbe483e9b3f3a3f78,0xbf74bf1abce63f0e,0x3f0ebce6bf1abf74,0x3f6f3eebbe80bf55,0xbf55be803eeb3f6f,0xbf6abe9b3f023f7b,0x3f7b3f02be9bbf6a
.quad 0x3f633e0fbf3abf7b,0xbf7bbf3a3e0f3f63,0xbf5c3ce63f633f55,0x3f553f633ce6bf5c,0x3f55be48bf7bbf0e,0xbf0ebf7bbe483f55,0xbf4d3eb73f7f3e48,0x3e483f7f3eb7bf4d
.quad 0x3f44bf02bf6f3e48,0x3e48bf6fbf023f44,0xbf3a3f253f4dbf0e,0xbf0e3f4d3f25bf3a,0x3f30bf44bf1a3f55,0x3f55bf1abf443f30,0xbf253f5c3eb7bf7b,0xbf7b3eb73f5cbf25
.quad 0xbec4bea9be8ebe64,0xbf14bf08bef8bede,0x3f6d3f593f3f3f20,0x3f763f7e3f803f7a,0xbf6dbf7ebf7cbf67,0xbd66bea9bf14bf48,0x3ec43f353f6d3f80,0xbf6dbf35bec40000
.quad 0x3ec4bde5bf14bf67,0x3f2b3f723f7c3f48,0xbf6dbf083d663f20,0x3ef8bde5bf2bbf7a,0x3f6d3f723ef8be64,0xbf7cbf59be8e3ede,0xbec4bf72bf60be64,0x3e2c3f593f763ede
.quad 0xbec43f083f803f20,0x3f603de5bf3fbf7a,0x3f6d3de5bf51bf67,0xbf3fbf72be2c3f48,0xbf6dbf353ec43f80,0xbec43f353f6d0000,0x3ec43f7e3e2cbf67,0x3f803ea9bf51bf48
.quad 0x3ec4bf59bf2b3f20,0xbe8ebf7ebd663f7a,0xbf6d3ea93f76be64,0xbf513f083f60bede,0x3f6d3ea9bf76be64,0x3f513f08bf60bede,0xbec4bf593f2b3f20,0x3e8ebf7e3d663f7a
.quad 0xbf3fbf35bf2bbf20,0xbf60bf59bf51bf48,0x3f143f353f513f67,0xbd663de53e8e3ede,0x3f603f353ef83e64,0x3f513f723f803f7a,0xbec4bf35bf6dbf80,0x3f6d3f353ec40000
.quad 0xbf76bf35be8e3e64,0x3e2cbea9bf3fbf7a,0x3e2c3f353f7c3f67,0xbf3fbf7ebf60bede,0x3f803f353d66bf20,0xbf76bf083e2c3f48,0x3d66bf35bf80bf20,0xbe8e3f083f7c3f48
.quad 0xbf7cbf353e2c3f67,0x3f2b3f7e3ef8bede,0xbe8e3f353f763e64,0x3f7c3ea9bf2bbf7a,0x3f6d3f35bec4bf80,0x3ec4bf35bf6d0000,0x3ef8bf35bf603e64,0xbf14bf723d663f7a
.quad 0xbf51bf353f143f67,0xbf80bde53f763ede,0xbf2b3f353f3fbf20,0xbef83f593f14bf48,0x3f2b3f35bf3fbf20,0x3ef83f59bf14bf48,0x3f51bf35bf143f67,0x3f80bde5bf763ede
.quad 0xbf76bf72bf6dbf67,0xbf80bf7ebf7cbf7a,0xbf2bbf08bec4be64,0xbf7cbf72bf60bf48,0xbe2c3de53ec43f20,0xbf76bf59bf2bbede,0x3ec43f353f6d3f80,0xbf6dbf35bec40000
.quad 0x3f513f7e3f6d3f20,0xbf60bf08bd663ede,0x3f803f593ec4be64,0xbf51bea93e8e3f48,0x3f603ea9bec4bf67,0xbf3fbde53f143f7a,0x3ef8bea9bf6dbf67,0xbf2b3de53f513f7a
.quad 0xbd66bf59bf6dbe64,0xbf143ea93f763f48,0xbf14bf7ebec43f20,0xbef83f083f803ede,0xbf6dbf353ec43f80,0xbec43f353f6d0000,0xbf7cbde53f6d3f20,0xbe8e3f593f3fbede
.quad 0xbf3f3f083f6dbe64,0xbe2c3f723ef8bf48,0xbe8e3f723ec4bf67,0xbd663f7e3e2cbf7a,0x3e8e3f72bec4bf67,0x3d663f7ebe2cbf7a,0x3f3f3f08bf6dbe64,0x3e2c3f72bef8bf48
.quad 0xbf7cbf7ebf80bf80,0xbf6dbf72bf76bf7a,0xbf60bf72bf7cbf80,0xbec4bf08bf2bbf48,0xbf2bbf59bf76bf80,0x3ec43de5be2cbede,0xbec4bf35bf6dbf80,0x3f6d3f353ec40000
.quad 0xbd66bf08bf60bf80,0x3f6d3f7e3f513ede,0x3e8ebea9bf51bf80,0x3ec43f593f803f48,0x3f14bde5bf3fbf80,0xbec43ea93f603f7a,0x3f513de5bf2bbf80,0xbf6dbea93ef83f7a
.quad 0x3f763ea9bf14bf80,0xbf6dbf59bd663f48,0x3f803f08bef8bf80,0xbec4bf7ebf143ede,0x3f6d3f35bec4bf80,0x3ec4bf35bf6d0000,0x3f3f3f59be8ebf80,0x3f6dbde5bf7cbede
.quad 0x3ef83f72be2cbf80,0x3f6d3f08bf3fbf48,0x3e2c3f7ebd66bf80,0x3ec43f72be8ebf7a,0xbe2c3f7e3d66bf80,0xbec43f723e8ebf7a,0xbef83f723e2cbf80,0xbf6d3f083f3fbf48
.quad 0x3f6d3f723f763f7a,0x3f513f593f603f67,0xbec4bf08bf2bbf48,0x3e8e3de5bd66be64,0xbec4bde53e2c3ede,0xbf80bf72bf51bf20,0x3f6d3f353ec40000,0x3ec43f353f6d3f80
.quad 0xbf6dbf7ebf51bede,0x3f3f3ea9be2cbf20,0x3ec43f593f803f48,0xbf60bf7ebf3fbe64,0x3ec4bea9bf60bf7a,0xbe2c3f083f763f67,0xbf6dbea93ef83f7a,0x3f7c3f08be8ebf67
.quad 0x3f6d3f593d66bf48,0xbef8bf7ebf2b3e64,0xbec4bf7ebf143ede,0xbf2b3ea93f7c3f20,0xbec43f353f6d0000,0x3f6d3f35bec4bf80,0x3f6dbde5bf7cbede,0x3d66bf72bf143f20
.quad 0xbf6dbf083f3f3f48,0xbf763de53f803e64,0x3ec43f72be8ebf7a,0x3f143f59bef8bf67,0x3ec4bf72be8e3f7a,0x3f14bf59bef83f67,0xbf6d3f083f3fbf48,0xbf76bde53f80be64
.quad 0x3f2b3f353f3f3f48,0x3ef83f083f143f20,0x3f513f353f143ede,0x3f803f7e3f763f67,0xbef8bf35bf60bf7a,0x3f143ea93d66be64,0xbf6dbf35bec40000,0xbec4bf35bf6dbf80
.quad 0x3e8e3f353f763f7a,0xbf7cbf72bf2bbe64,0x3f7c3f353e2cbede,0xbf2bbde53ef83f67,0xbd66bf35bf80bf48,0x3e8e3f593f7c3f20,0xbf80bf353d663f48,0x3f763f593e2cbf20
.quad 0xbe2c3f353f7c3ede,0x3f3fbde5bf60bf67,0x3f763f35be8ebf7a,0xbe2cbf72bf3f3e64,0x3ec4bf35bf6d0000,0xbf6dbf353ec43f80,0xbf60bf353ef83f7a,0xbf513ea93f803e64
.quad 0xbf143f353f51bede,0x3d663f7e3e8ebf67,0x3f3f3f35bf2bbf48,0x3f603f08bf51bf20,0x3f3fbf35bf2b3f48,0x3f60bf08bf513f20,0xbf14bf353f513ede,0x3d66bf7e3e8e3f67
.quad 0x3e8e3ea93ec43ede,0x3d663de53e2c3e64,0x3f3f3f593f6d3f7a,0x3e2c3ea93ef83f20,0x3f7c3f7e3f6d3f48,0x3e8e3f083f3f3f67,0x3f6d3f353ec40000,0x3ec43f353f6d3f80
.quad 0x3f143de5bec4bf48,0x3ef83f593f803f67,0x3d66bf08bf6dbf7a,0x3f143f723f763f20,0xbef8bf72bf6dbede,0x3f2b3f7e3f513e64,0xbf60bf72bec43ede,0x3f3f3f7e3f14be64
.quad 0xbf80bf083ec43f7a,0x3f513f723e8ebf20,0xbf513de53f6d3f48,0x3f603f59bd66bf67,0xbec43f353f6d0000,0x3f6d3f35bec4bf80,0x3e2c3f7e3ec4bf48,0x3f763f08bf2bbf67
.quad 0x3f2b3f59bec4bf7a,0x3f7c3ea9bf60bf20,0x3f763ea9bf6dbede,0x3f803de5bf7cbe64,0x3f76bea9bf6d3ede,0x3f80bde5bf7c3e64,0x3f2bbf59bec43f7a,0x3f7cbea9bf603f20
.quad 0xbe2cbde5bd660000,0xbec4bea9be8ebe64,0xbef8bea9be2c0000,0xbf6dbf59bf3fbf20,0xbf3fbf08be8e0000,0xbf6dbf7ebf7cbf67,0xbf6dbf35bec40000,0xbec4bf35bf6dbf80
.quad 0xbf80bf59bef80000,0x3ec4bde5bf14bf67,0xbf76bf72bf140000,0x3f6d3f08bd66bf20,0xbf51bf7ebf2b0000,0x3f6d3f723ef8be64,0xbf14bf7ebf3f0000,0x3ec43f723f603e64
.quad 0xbe8ebf72bf510000,0xbec43f083f803f20,0x3d66bf59bf600000,0xbf6dbde53f513f67,0x3ec4bf35bf6d0000,0xbf6dbf353ec43f80,0x3f2bbf08bf760000,0xbec4bf7ebe2c3f67
.quad 0x3f60bea9bf7c0000,0x3ec4bf59bf2b3f20,0x3f7cbde5bf800000,0x3f6dbea9bf763e64,0x3f7c3de5bf800000,0x3f6d3ea9bf76be64,0x3f603ea9bf7c0000,0x3ec43f59bf2bbf20
.quad 0xbed1beb7be9bbe80,0xbf1abf0ebf02beeb,0x3f743f633f4d3f30,0x3f6f3f7b3f803f7d,0xbf5cbf78bf80bf74,0x3dacbe48beebbf30,0x3e483f0e3f553f7b,0xbf7bbf55bf0ebe48
.quad 0x3f1a3e0fbeb7bf44,0x3eeb3f553f7f3f6a,0xbf7fbf44be803eb7,0x3f3a3e48bed1bf5c,0x3f3a3f803f443e0f,0xbf5cbf7bbf1a3dac,0x3ce6bf3abf7fbf1a,0xbe803f0e3f7d3f44
.quad 0xbf443dac3f5c3f6a,0x3f803f0ebeb7bf78,0x3f7d3f1abed1bf7f,0xbe9bbf7bbf253eb7,0xbf0ebf7bbe483f55,0xbf553e483f7b3f0e,0xbe803f5c3f3abeeb,0x3f443f55be9bbf80
.quad 0x3f63be9bbf7dbce6,0x3ed1bf55bf303f1a,0xbf6fbed13f633f02,0xbf7dbe483f783e9b,0x3eb73f6abeebbf5c,0x3e0f3f7bbe80bf74,0x3eebbf74be0f3f80,0x3f6abf0ebf3a3f4d
.quad 0xbf44bf3abf30bf25,0xbf63bf5cbf55bf4d,0x3f023f253f443f5c,0xbe0f3ce63e483eb7,0x3f6f3f4d3f1a3eb7,0x3f3a3f633f7b3f7f,0xbe48bf0ebf55bf7b,0x3f7b3f553f0e3e48
.quad 0xbf80bf5cbf02bce6,0x3ed1bdacbf0ebf63,0xbe0f3eeb3f633f7d,0xbf02bf6abf7bbf30,0x3f743f6a3ed1be9b,0xbf7fbf4dbe483f02,0x3eebbeb7bf6fbf63,0xbf253e0f3f553f78
.quad 0xbf4dbf74be9b3f1a,0x3e803f6f3f553ce6,0xbf3a3e803f783f30,0x3f6f3f44be48bf74,0x3f0e3f7b3e48bf55,0x3f55be48bf7bbf0e,0x3f6abe0fbf7dbed1,0x3ce6bf74bf0e3f25
.quad 0xbe80bf7fbdac3f78,0xbf4dbf3a3f0e3f6a,0xbf7f3ce63f803dac,0xbf743e803f7bbe0f,0xbdac3f80bce6bf7f,0xbe9b3f783e48bf7d,0x3f783dacbf7f3e80,0x3f1a3f30bf55bed1
.quad 0xbf78bf74bf6fbf6a,0xbf80bf7fbf7dbf7b,0xbf3abf1abeebbe9b,0xbf7fbf78bf6abf55,0xbe9bbce63e803f02,0xbf7dbf6abf44bf0e,0x3e483f0e3f553f7b,0xbf7bbf55bf0ebe48
.quad 0x3f253f6f3f7d3f4d,0xbf78bf3abe9b3e48,0x3f6f3f783f253dac,0xbf74bf1abce63f0e,0x3f7d3f25bce6bf30,0xbf6fbeeb3e803f55,0x3f4d3dacbf30bf80,0xbf6abe9b3f023f7b
.quad 0x3ed1bf02bf7fbf25,0xbf63be0f3f3a3f7b,0xbdacbf6abf4d3e0f,0xbf5c3ce63f633f55,0xbf0ebf7bbe483f55,0xbf553e483f7b3f0e,0xbf63bf303f023f78,0xbf4d3eb73f7f3e48
.quad 0xbf80be0f3f743eeb,0xbf443f023f6fbe48,0xbf5c3eeb3f6abeb7,0xbf3a3f253f4dbf0e,0xbf023f633ed1bf6f,0xbf303f443f1abf55,0xbce63f7dbe9bbf63,0xbf253f5c3eb7bf7b
.quad 0xbf7bbf7dbf7fbf80,0xbf6abf6fbf74bf78,0xbf55bf6abf78bf7f,0xbe9bbeebbf1abf3a,0xbf0ebf44bf6abf7d,0x3f023e80bce6be9b,0xbe48bf0ebf55bf7b,0x3f7b3f553f0e3e48
.quad 0x3e48be9bbf3abf78,0x3f4d3f7d3f6f3f25,0x3f0ebce6bf1abf74,0x3dac3f253f783f6f,0x3f553e80beebbf6f,0xbf30bce63f253f7d,0x3f7b3f02be9bbf6a,0xbf80bf303dac3f4d
.quad 0x3f7b3f3abe0fbf63,0xbf25bf7fbf023ed1,0x3f553f633ce6bf5c,0x3e0fbf4dbf6abdac,0x3f0e3f7b3e48bf55,0x3f55be48bf7bbf0e,0x3e483f7f3eb7bf4d,0x3f783f02bf30bf63
.quad 0xbe483f6f3f02bf44,0x3eeb3f74be0fbf80,0xbf0e3f4d3f25bf3a,0xbeb73f6a3eebbf5c,0xbf553f1a3f44bf30,0xbf6f3ed13f63bf02,0xbf7b3eb73f5cbf25,0xbf63be9b3f7dbce6
.quad 0x3f6a3f6f3f743f78,0x3f4d3f553f5c3f63,0xbe9bbeebbf1abf3a,0x3eb73e483ce6be0f,0xbf02be803ce63e9b,0xbf7fbf7bbf63bf3a,0x3f7b3f553f0e3e48,0x3e483f0e3f553f7b
.quad 0xbf4dbf7dbf6fbf25,0x3f633f0e3dacbed1,0x3dac3f253f783f6f,0xbf30bf7bbf6abf02,0x3f303ce6bf25bf7d,0xbf023e483f4d3f7f,0xbf80bf303dac3f4d,0x3f783f553e0fbf25
.quad 0x3f253f7f3f02bed1,0xbce6bf55bf6fbe80,0x3e0fbf4dbf6abdac,0xbf74be483f443f6f,0xbf553e483f7b3f0e,0x3f0e3f7b3e48bf55,0x3f783f02bf30bf63,0x3f25bf0ebf743ce6
.quad 0xbeebbf743e0f3f80,0xbf6abf0e3f3a3f4d,0xbeb73f6a3eebbf5c,0xbe0f3f7b3e80bf74,0x3f6fbed1bf633f02,0x3f7dbe48bf783e9b,0xbf63be9b3f7dbce6,0xbed1bf553f303f1a
.quad 0x3f253f303f3a3f44,0x3eeb3f023f0e3f1a,0x3f5c3f443f253f02,0x3f7d3f803f7b3f6f,0xbeb7bf1abf4dbf6f,0x3f303eeb3e48bdac,0xbf7bbf55bf0ebe48,0xbe48bf0ebf55bf7b
.quad 0x3ce63f023f5c3f80,0xbf6abf7fbf55beeb,0x3f7d3f633eebbe0f,0xbf5cbed13e483f3a,0x3e9bbed1bf6abf74,0xbdac3f1a3f7b3f5c,0xbf63bf6fbeb73eeb,0x3f443f7d3f0ebe80
.quad 0xbf1a3e9b3f743f4d,0x3f783eb7bf0ebf80,0x3f303f783e80bf3a,0x3eb7bf25bf7bbe9b,0x3f55be48bf7bbf0e,0xbf0ebf7bbe483f55,0xbed1bf7dbe0f3f6a,0xbf80be9b3f553f44
.quad 0xbf783dac3f7f3e80,0xbf1a3f303f55bed1,0x3dac3f803ce6bf7f,0x3e9b3f78be48bf7d,0x3f7f3ce6bf803dac,0x3f743e80bf7bbe0f,0x3e80bf7f3dac3f78,0x3f4dbf3abf0e3f6a
.quad 0x3e803e9b3eb73ed1,0x3ce63dac3e0f3e48,0x3f303f4d3f633f74,0x3dac3e803ed13f0e,0x3f743f803f783f5c,0x3e0f3ed13f253f55,0x3f7b3f553f0e3e48,0x3e483f0e3f553f7b
.quad 0x3f443eb7be0fbf1a,0x3e803f303f743f7b,0x3eb7be80bf44bf7f,0x3e9b3f4d3f803f55,0xbe0fbf44bf80bf3a,0x3eb73f633f783f0e,0xbf1abf7fbf3a3ce6,0x3ed13f743f5c3e48
.quad 0xbf6abf5cbdac3f44,0x3eeb3f7d3f30be48,0xbf7fbed13f1a3f7d,0x3f023f803eebbf0e,0xbf553e483f7b3f0e,0x3f0e3f7b3e48bf55,0xbeeb3f3a3f5cbe80,0x3f1a3f6fbdacbf7b
.quad 0x3ce63f7d3e9bbf63,0x3f253f5cbeb7bf7b,0x3f023f63bed1bf6f,0x3f303f44bf1abf55,0x3f5c3eebbf6abeb7,0x3f3a3f25bf4dbf0e,0x3f80be0fbf743eeb,0x3f443f02bf6fbe48
.quad 0xbe48be0fbdacbce6,0xbed1beb7be9bbe80,0xbf0ebed1be80bdac,0xbf74bf63bf4dbf30,0xbf55bf25bed1be0f,0xbf5cbf78bf80bf74,0xbf7bbf55bf0ebe48,0xbe48bf0ebf55bf7b
.quad 0xbf7bbf74bf30be80,0x3f1a3e0fbeb7bf44,0xbf55bf80bf4dbe9b,0x3f7f3f443e80beb7,0xbf0ebf78bf63beb7,0x3f3a3f803f443e0f,0xbe48bf5cbf74bed1,0xbce63f3a3f7f3f1a
.quad 0x3e48bf30bf7dbeeb,0xbf443dac3f5c3f6a,0x3f0ebeebbf80bf02,0xbf7dbf1a3ed13f7f,0x3f55be48bf7bbf0e,0xbf0ebf7bbe483f55,0x3f7b3dacbf6fbf1a,0x3e80bf5cbf3a3eeb
.quad 0x3f7b3eb7bf5cbf25,0x3f63be9bbf7dbce6,0x3f553f1abf44bf30,0x3f6f3ed1bf63bf02,0x3f0e3f4dbf25bf3a,0x3eb73f6abeebbf5c,0x3e483f6fbf02bf44,0xbeeb3f743e0fbf80
.quad 0xbf51bf59bf60bf67,0xbf2bbf35bf3fbf48,0x3e8e3de5bd66be64,0x3f513f353f143ede,0x3f803f723f513f20,0x3ef83f353f603f7a,0x3ec43f353f6d3f80,0xbf6dbf35bec40000
.quad 0xbf3fbea93e2c3f20,0xbe8ebf35bf76bf7a,0xbf60bf7ebf3fbe64,0x3f7c3f353e2cbede,0x3e2cbf08bf76bf67,0x3d663f353f803f48,0x3f7c3f08be8ebf67,0xbf80bf353d663f48
.quad 0x3ef83f7e3f2bbe64,0x3e2cbf35bf7cbede,0xbf2b3ea93f7c3f20,0x3f763f35be8ebf7a,0xbf6dbf353ec43f80,0xbec43f353f6d0000,0x3d66bf72bf143f20,0xbf60bf353ef83f7a
.quad 0x3f76bde5bf80be64,0x3f14bf35bf513ede,0x3f143f59bef8bf67,0x3f3f3f35bf2bbf48,0xbf143f593ef8bf67,0xbf3f3f353f2bbf48,0xbf76bde53f80be64,0xbf14bf353f513ede
.quad 0xbef8bf08bf14bf20,0xbe8ebea9bec4bede,0x3f803f7e3f763f67,0x3f3f3f593f6d3f7a,0xbf14bea9bd663e64,0xbf7cbf7ebf6dbf48,0xbec4bf35bf6dbf80,0x3f6d3f353ec40000
.quad 0x3f7c3f723f2b3e64,0xbf14bde53ec43f48,0xbf2bbde53ef83f67,0x3d66bf08bf6dbf7a,0xbe8ebf59bf7cbf20,0x3ef83f723f6d3ede,0x3f763f593e2cbf20,0xbf60bf72bec43ede
.quad 0xbf3f3de53f603f67,0x3f803f08bec4bf7a,0xbe2cbf72bf3f3e64,0xbf513de53f6d3f48,0x3f6d3f35bec4bf80,0x3ec4bf35bf6d0000,0xbf513ea93f803e64,0x3e2c3f7e3ec4bf48
.quad 0xbd66bf7ebe8e3f67,0xbf2bbf593ec43f7a,0x3f603f08bf51bf20,0x3f763ea9bf6dbede,0xbf603f083f51bf20,0xbf763ea93f6dbede,0x3d66bf7e3e8e3f67,0x3f2bbf59bec43f7a
.quad 0xbd66bde5be2cbe64,0x3e2c3de53d660000,0x3e2c3ea93ef83f20,0xbef8bea9be2c0000,0xbe8ebf08bf3fbf67,0x3f3f3f083e8e0000,0x3ec43f353f6d3f80,0xbf6dbf35bec40000
.quad 0xbef8bf59bf80bf67,0x3f803f593ef80000,0x3f143f723f763f20,0xbf76bf72bf140000,0xbf2bbf7ebf51be64,0x3f513f7e3f2b0000,0x3f3f3f7e3f14be64,0xbf14bf7ebf3f0000
.quad 0xbf51bf72be8e3f20,0x3e8e3f723f510000,0x3f603f59bd66bf67,0x3d66bf59bf600000,0xbf6dbf353ec43f80,0xbec43f353f6d0000,0x3f763f08bf2bbf67,0x3f2bbf08bf760000
.quad 0xbf7cbea93f603f20,0xbf603ea93f7c0000,0x3f803de5bf7cbe64,0x3f7cbde5bf800000,0xbf803de53f7cbe64,0xbf7cbde53f800000,0x3f7cbea9bf603f20,0x3f603ea9bf7c0000
.quad 0x3ec43ea93e8e3e64,0x3f143f083ef83ede,0xbf6dbf59bf3fbf20,0xbf76bf7ebf80bf7a,0x3f6d3f7e3f7c3f67,0x3d663ea93f143f48,0xbec4bf35bf6dbf80,0x3f6d3f353ec40000
.quad 0xbec43de53f143f67,0xbf2bbf72bf7cbf48,0x3f6d3f08bd66bf20,0xbef83de53f2b3f7a,0xbf6dbf72bef83e64,0x3f7c3f593e8ebede,0x3ec43f723f603e64,0xbe2cbf59bf76bede
.quad 0x3ec4bf08bf80bf20,0xbf60bde53f3f3f7a,0xbf6dbde53f513f67,0x3f3f3f723e2cbf48,0x3f6d3f35bec4bf80,0x3ec4bf35bf6d0000,0xbec4bf7ebe2c3f67,0xbf80bea93f513f48
.quad 0xbec43f593f2bbf20,0x3e8e3f7e3d66bf7a,0x3f6dbea9bf763e64,0x3f51bf08bf603ede,0xbf6dbea93f763e64,0xbf51bf083f603ede,0x3ec43f59bf2bbf20,0xbe8e3f7ebd66bf7a
.quad 0xbf14bf08bef8bede,0xbf3fbf35bf2bbf20,0xbf76bf7ebf80bf7a,0xbf14bf35bf51bf67,0xbd66bea9bf14bf48,0x3f603f353ef83e64,0x3f6d3f353ec40000,0x3ec43f353f6d3f80
.quad 0x3f2b3f723f7c3f48,0xbf76bf35be8e3e64,0xbef83de53f2b3f7a,0xbe2cbf35bf7cbf67,0xbf7cbf59be8e3ede,0x3f803f353d66bf20,0xbe2cbf59bf76bede,0xbd663f353f803f20
.quad 0x3f603de5bf3fbf7a,0xbf7cbf353e2c3f67,0x3f3f3f723e2cbf48,0x3e8ebf35bf76be64,0xbec43f353f6d0000,0x3f6d3f35bec4bf80,0xbf80bea93f513f48,0xbef83f353f60be64
.quad 0xbe8ebf7ebd663f7a,0xbf51bf353f143f67,0x3f51bf08bf603ede,0x3f2bbf35bf3f3f20,0x3f513f08bf60bede,0x3f2b3f35bf3fbf20,0xbe8e3f7ebd66bf7a,0xbf513f353f14bf67
.quad 0xbf60bf59bf51bf48,0xbf76bf72bf6dbf67,0x3d66bde5be8ebede,0x3f2b3f083ec43e64,0x3f513f723f803f7a,0xbe2c3de53ec43f20,0xbf6dbf35bec40000,0xbec4bf35bf6dbf80
.quad 0x3e2cbea9bf3fbf7a,0x3f513f7e3f6d3f20,0x3f3f3f7e3f603ede,0xbf80bf59bec43e64,0xbf76bf083e2c3f48,0x3f603ea9bec4bf67,0x3e8ebf08bf7cbf48,0xbef83ea93f6d3f67
.quad 0x3f2b3f7e3ef8bede,0xbd66bf59bf6dbe64,0xbf7cbea93f2b3f7a,0x3f143f7e3ec4bf20,0x3ec4bf35bf6d0000,0xbf6dbf353ec43f80,0x3f143f72bd66bf7a,0x3f7c3de5bf6dbf20
.quad 0xbf80bde53f763ede,0xbf3f3f083f6dbe64,0x3ef8bf59bf143f48,0x3e8ebf72bec43f67,0x3ef83f59bf14bf48,0x3e8e3f72bec4bf67,0xbf803de53f76bede,0xbf3fbf083f6d3e64
.quad 0xbf80bf7ebf7cbf7a,0xbf7cbf7ebf80bf80,0x3f7c3f723f603f48,0x3f603f723f7c3f80,0xbf76bf59bf2bbede,0xbf2bbf59bf76bf80,0x3f6d3f353ec40000,0x3ec43f353f6d3f80
.quad 0xbf60bf08bd663ede,0xbd66bf08bf60bf80,0x3f513ea9be8ebf48,0xbe8e3ea93f513f80,0xbf3fbde53f143f7a,0x3f14bde5bf3fbf80,0x3f2bbde5bf51bf7a,0xbf51bde53f2b3f80
.quad 0xbf143ea93f763f48,0x3f763ea9bf14bf80,0x3ef8bf08bf80bede,0xbf80bf083ef83f80,0xbec43f353f6d0000,0x3f6d3f35bec4bf80,0x3e8ebf59bf3f3ede,0xbf3fbf593e8e3f80
.quad 0xbe2c3f723ef8bf48,0x3ef83f72be2cbf80,0x3d66bf7ebe2c3f7a,0xbe2cbf7e3d663f80,0x3d663f7ebe2cbf7a,0xbe2c3f7e3d66bf80,0xbe2cbf723ef83f48,0x3ef8bf72be2c3f80
.quad 0xbf6dbf72bf76bf7a,0xbf51bf59bf60bf67,0x3ec43f083f2b3f48,0xbe8ebde53d663e64,0x3ec43de5be2cbede,0x3f803f723f513f20,0xbf6dbf35bec40000,0xbec4bf35bf6dbf80
.quad 0x3f6d3f7e3f513ede,0xbf3fbea93e2c3f20,0xbec4bf59bf80bf48,0x3f603f7e3f3f3e64,0xbec43ea93f603f7a,0x3e2cbf08bf76bf67,0x3f6d3ea9bef8bf7a,0xbf7cbf083e8e3f67
.quad 0xbf6dbf59bd663f48,0x3ef83f7e3f2bbe64,0x3ec43f7e3f14bede,0x3f2bbea9bf7cbf20,0x3ec4bf35bf6d0000,0xbf6dbf353ec43f80,0xbf6d3de53f7c3ede,0xbd663f723f14bf20
.quad 0x3f6d3f08bf3fbf48,0x3f76bde5bf80be64,0xbec4bf723e8e3f7a,0xbf14bf593ef83f67,0xbec43f723e8ebf7a,0xbf143f593ef8bf67,0x3f6dbf08bf3f3f48,0x3f763de5bf803e64
.quad 0xbf4dbf55bf5cbf63,0xbf25bf30bf3abf44,0x3eb73e483ce6be0f,0x3f5c3f443f253f02,0x3f7f3f7b3f633f3a,0x3eb73f1a3f4d3f6f,0x3e483f0e3f553f7b,0xbf7bbf55bf0ebe48
.quad 0xbf63bf0ebdac3ed1,0xbce6bf02bf5cbf80,0xbf30bf7bbf6abf02,0x3f7d3f633eebbe0f,0x3f02be48bf4dbf7f,0xbe9b3ed13f6a3f74,0x3f783f553e0fbf25,0xbf63bf6fbeb73eeb
.quad 0x3ce63f553f6f3e80,0x3f1abe9bbf74bf4d,0xbf74be483f443f6f,0x3f303f783e80bf3a,0xbf0ebf7bbe483f55,0xbf553e483f7b3f0e,0x3f25bf0ebf743ce6,0xbed1bf7dbe0f3f6a
.quad 0x3f6a3f0ebf3abf4d,0x3f78bdacbf7fbe80,0xbe0f3f7b3e80bf74,0x3dac3f803ce6bf7f,0xbf7d3e483f78be9b,0xbf7fbce63f80bdac,0xbed1bf553f303f1a,0x3e80bf7f3dac3f78
.quad 0xbeebbf02bf0ebf1a,0xbe80be9bbeb7bed1,0x3f7d3f803f7b3f6f,0x3f303f4d3f633f74,0xbf30beebbe483dac,0xbf74bf80bf78bf5c,0xbe48bf0ebf55bf7b,0x3f7b3f553f0e3e48
.quad 0x3f6a3f7f3f553eeb,0xbf44beb73e0f3f1a,0xbf5cbed13e483f3a,0x3eb7be80bf44bf7f,0x3dacbf1abf7bbf5c,0x3e0f3f443f803f3a,0x3f443f7d3f0ebe80,0xbf1abf7fbf3a3ce6
.quad 0xbf78beb73f0e3f80,0x3f6a3f5c3dacbf44,0x3eb7bf25bf7bbe9b,0xbf7fbed13f1a3f7d,0x3f0e3f7b3e48bf55,0x3f55be48bf7bbf0e,0xbf80be9b3f553f44,0xbeeb3f3a3f5cbe80
.quad 0x3f1abf30bf553ed1,0xbce6bf7dbe9b3f63,0x3e9b3f78be48bf7d,0x3f023f63bed1bf6f,0xbf74be803f7b3e0f,0xbf5cbeeb3f6a3eb7,0x3f4dbf3abf0e3f6a,0x3f80be0fbf743eeb
.quad 0xbce6bdacbe0fbe48,0x3e483e0f3dac3ce6,0x3dac3e803ed13f0e,0xbf0ebed1be80bdac,0xbe0fbed1bf25bf55,0x3f553f253ed13e0f,0x3e483f0e3f553f7b,0xbf7bbf55bf0ebe48
.quad 0xbe80bf30bf74bf7b,0x3f7b3f743f303e80,0x3e9b3f4d3f803f55,0xbf55bf80bf4dbe9b,0xbeb7bf63bf78bf0e,0x3f0e3f783f633eb7,0x3ed13f743f5c3e48,0xbe48bf5cbf74bed1
.quad 0xbeebbf7dbf303e48,0xbe483f303f7d3eeb,0x3f023f803eebbf0e,0x3f0ebeebbf80bf02,0xbf0ebf7bbe483f55,0xbf553e483f7b3f0e,0x3f1a3f6fbdacbf7b,0x3f7b3dacbf6fbf1a
.quad 0xbf25bf5c3eb73f7b,0xbf7bbeb73f5c3f25,0x3f303f44bf1abf55,0x3f553f1abf44bf30,0xbf3abf253f4d3f0e,0xbf0ebf4d3f253f3a,0x3f443f02bf6fbe48,0x3e483f6fbf02bf44
.quad 0x3ed13eb73e9b3e80,0x3f1a3f0e3f023eeb,0xbf74bf63bf4dbf30,0xbf6fbf7bbf80bf7d,0x3f5c3f783f803f74,0xbdac3e483eeb3f30,0xbe48bf0ebf55bf7b,0x3f7b3f553f0e3e48
.quad 0xbf1abe0f3eb73f44,0xbeebbf55bf7fbf6a,0x3f7f3f443e80beb7,0xbf3abe483ed13f5c,0xbf3abf80bf44be0f,0x3f5c3f7b3f1abdac,0xbce63f3a3f7f3f1a,0x3e80bf0ebf7dbf44
.quad 0x3f44bdacbf5cbf6a,0xbf80bf0e3eb73f78,0xbf7dbf1a3ed13f7f,0x3e9b3f7b3f25beb7,0x3f0e3f7b3e48bf55,0x3f55be48bf7bbf0e,0x3e80bf5cbf3a3eeb,0xbf44bf553e9b3f80
.quad 0xbf633e9b3f7d3ce6,0xbed13f553f30bf1a,0x3f6f3ed1bf63bf02,0x3f7d3e48bf78be9b,0xbeb7bf6a3eeb3f5c,0xbe0fbf7b3e803f74,0xbeeb3f743e0fbf80,0xbf6a3f0e3f3abf4d
.quad 0xbf1abf0ebf02beeb,0xbf44bf3abf30bf25,0xbf6fbf7bbf80bf7d,0xbf02bf25bf44bf5c,0x3dacbe48beebbf30,0x3f6f3f4d3f1a3eb7,0x3f7b3f553f0e3e48,0x3e483f0e3f553f7b
.quad 0x3eeb3f553f7f3f6a,0xbf80bf5cbf02bce6,0xbf3abe483ed13f5c,0x3e0fbeebbf63bf7d,0xbf5cbf7bbf1a3dac,0x3f743f6a3ed1be9b,0x3e80bf0ebf7dbf44,0xbeeb3eb73f6f3f63
.quad 0x3f803f0ebeb7bf78,0xbf4dbf74be9b3f1a,0x3e9b3f7b3f25beb7,0x3f3abe80bf78bf30,0xbf553e483f7b3f0e,0x3f0e3f7b3e48bf55,0xbf44bf553e9b3f80,0xbf6a3e0f3f7d3ed1
.quad 0x3ed1bf55bf303f1a,0xbe80bf7fbdac3f78,0x3f7d3e48bf78be9b,0x3f7fbce6bf80bdac,0x3e0f3f7bbe80bf74,0xbdac3f80bce6bf7f,0xbf6a3f0e3f3abf4d,0xbf78bdac3f7fbe80
.quad 0xbf63bf5cbf55bf4d,0xbf78bf74bf6fbf6a,0x3e0fbce6be48beb7,0x3f3a3f1a3eeb3e9b,0x3f3a3f633f7b3f7f,0xbe9bbce63e803f02,0xbf7bbf55bf0ebe48,0xbe48bf0ebf55bf7b
.quad 0x3ed1bdacbf0ebf63,0x3f253f6f3f7d3f4d,0x3f023f6a3f7b3f30,0xbf6fbf78bf25bdac,0xbf7fbf4dbe483f02,0x3f7d3f25bce6bf30,0x3f25be0fbf55bf78,0xbf4dbdac3f303f80
.quad 0x3e803f6f3f553ce6,0x3ed1bf02bf7fbf25,0xbf6fbf443e483f74,0x3dac3f6a3f4dbe0f,0x3f55be48bf7bbf0e,0xbf0ebf7bbe483f55,0xbce63f743f0ebf25,0x3f633f30bf02bf78
.quad 0xbf4dbf3a3f0e3f6a,0xbf80be0f3f743eeb,0x3f74be80bf7b3e0f,0x3f5cbeebbf6a3eb7,0xbe9b3f783e48bf7d,0xbf023f633ed1bf6f,0xbf1abf303f553ed1,0x3ce6bf7d3e9b3f63
.quad 0xbf80bf7fbf7dbf7b,0xbf7bbf7dbf7fbf80,0x3f7f3f783f6a3f55,0x3f553f6a3f783f7f,0xbf7dbf6abf44bf0e,0xbf0ebf44bf6abf7d,0x3f7b3f553f0e3e48,0x3e483f0e3f553f7b
.quad 0xbf78bf3abe9b3e48,0x3e48be9bbf3abf78,0x3f743f1a3ce6bf0e,0xbf0e3ce63f1a3f74,0xbf6fbeeb3e803f55,0x3f553e80beebbf6f,0x3f6a3e9bbf02bf7b,0xbf7bbf023e9b3f6a
.quad 0xbf63be0f3f3a3f7b,0x3f7b3f3abe0fbf63,0x3f5cbce6bf63bf55,0xbf55bf63bce63f5c,0xbf553e483f7b3f0e,0x3f0e3f7b3e48bf55,0x3f4dbeb7bf7fbe48,0xbe48bf7fbeb73f4d
.quad 0xbf443f023f6fbe48,0xbe483f6f3f02bf44,0x3f3abf25bf4d3f0e,0x3f0ebf4dbf253f3a,0xbf303f443f1abf55,0xbf553f1a3f44bf30,0x3f25bf5cbeb73f7b,0x3f7bbeb7bf5c3f25
.quad 0xbf6abf6fbf74bf78,0xbf4dbf55bf5cbf63,0x3e9b3eeb3f1a3f3a,0xbeb7be48bce63e0f,0x3f023e80bce6be9b,0x3f7f3f7b3f633f3a,0xbf7bbf55bf0ebe48,0xbe48bf0ebf55bf7b
.quad 0x3f4d3f7d3f6f3f25,0xbf63bf0ebdac3ed1,0xbdacbf25bf78bf6f,0x3f303f7b3f6a3f02,0xbf30bce63f253f7d,0x3f02be48bf4dbf7f,0x3f803f30bdacbf4d,0xbf78bf55be0f3f25
.quad 0xbf25bf7fbf023ed1,0x3ce63f553f6f3e80,0xbe0f3f4d3f6a3dac,0x3f743e48bf44bf6f,0x3f55be48bf7bbf0e,0xbf0ebf7bbe483f55,0xbf78bf023f303f63,0xbf253f0e3f74bce6
.quad 0x3eeb3f74be0fbf80,0x3f6a3f0ebf3abf4d,0x3eb7bf6abeeb3f5c,0x3e0fbf7bbe803f74,0xbf6f3ed13f63bf02,0xbf7d3e483f78be9b,0x3f633e9bbf7d3ce6,0x3ed13f55bf30bf1a
.quad 0x3f3f3f353f2b3f20,0x3f603f593f513f48,0xbf14bf35bf51bf67,0x3d66bde5be8ebede,0xbf60bf35bef8be64,0xbf51bf72bf80bf7a,0x3ec43f353f6d3f80,0xbf6dbf35bec40000
.quad 0x3f763f353e8ebe64,0xbe2c3ea93f3f3f7a,0xbe2cbf35bf7cbf67,0x3f3f3f7e3f603ede,0xbf80bf35bd663f20,0x3f763f08be2cbf48,0xbd663f353f803f20,0x3e8ebf08bf7cbf48
.quad 0x3f7c3f35be2cbf67,0xbf2bbf7ebef83ede,0x3e8ebf35bf76be64,0xbf7cbea93f2b3f7a,0xbf6dbf353ec43f80,0xbec43f353f6d0000,0xbef83f353f60be64,0x3f143f72bd66bf7a
.quad 0x3f513f35bf14bf67,0x3f803de5bf76bede,0x3f2bbf35bf3f3f20,0x3ef8bf59bf143f48,0xbf2bbf353f3f3f20,0xbef8bf593f143f48,0xbf513f353f14bf67,0xbf803de53f76bede
.quad 0x3f763f723f6d3f67,0x3f803f7e3f7c3f7a,0x3f2b3f083ec43e64,0x3f7c3f723f603f48,0x3e2cbde5bec4bf20,0x3f763f593f2b3ede,0xbec4bf35bf6dbf80,0x3f6d3f353ec40000
.quad 0xbf51bf7ebf6dbf20,0x3f603f083d66bede,0xbf80bf59bec43e64,0x3f513ea9be8ebf48,0xbf60bea93ec43f67,0x3f3f3de5bf14bf7a,0xbef83ea93f6d3f67,0x3f2bbde5bf51bf7a
.quad 0x3d663f593f6d3e64,0x3f14bea9bf76bf48,0x3f143f7e3ec4bf20,0x3ef8bf08bf80bede,0x3f6d3f35bec4bf80,0x3ec4bf35bf6d0000,0x3f7c3de5bf6dbf20,0x3e8ebf59bf3f3ede
.quad 0x3f3fbf08bf6d3e64,0x3e2cbf72bef83f48,0x3e8ebf72bec43f67,0x3d66bf7ebe2c3f7a,0xbe8ebf723ec43f67,0xbd66bf7e3e2c3f7a,0xbf3fbf083f6d3e64,0xbe2cbf723ef83f48
.quad 0x0,0x0,0x0,0x0,0x0,0x0,0x0,0x0
.quad 0x0,0x0,0x0,0x0,0x0,0x0,0x0,0x0
.quad 0x0,0x0,0x0,0x0,0x0,0x0,0x0,0x0
.quad 0x0,0x0,0x0,0x0,0x0,0x0,0x0,0x0
.quad 0x0,0x0,0x0,0x0,0x0,0x0,0x0,0x0
.quad 0x0,0x0,0x0,0x0,0x0,0x0,0x0,0x0
.quad 0x0,0x0,0x0,0x0,0x0,0x0,0x0,0x0
.quad 0x0,0x0,0x0,0x0,0x0,0x0,0x0,0x0
.quad 0xbf2bbf35bf3fbf48,0xbef8bf08bf14bf20,0xbf51bf35bf14bede,0xbf80bf7ebf76bf67,0x3ef83f353f603f7a,0xbf14bea9bd663e64,0x3f6d3f353ec40000,0x3ec43f353f6d3f80
.quad 0xbe8ebf35bf76bf7a,0x3f7c3f723f2b3e64,0xbf7cbf35be2c3ede,0x3f2b3de5bef8bf67,0x3d663f353f803f48,0xbe8ebf59bf7cbf20,0x3f803f35bd66bf48,0xbf76bf59be2c3f20
.quad 0x3e2cbf35bf7cbede,0xbf3f3de53f603f67,0xbf76bf353e8e3f7a,0x3e2c3f723f3fbe64,0xbec43f353f6d0000,0x3f6d3f35bec4bf80,0x3f603f35bef8bf7a,0x3f51bea9bf80be64
.quad 0x3f14bf35bf513ede,0xbd66bf7ebe8e3f67,0xbf3fbf353f2b3f48,0xbf60bf083f513f20,0xbf3f3f353f2bbf48,0xbf603f083f51bf20,0x3f143f35bf51bede,0xbd663f7ebe8ebf67
.quad 0xbe8ebea9bec4bede,0xbd66bde5be2cbe64,0xbf3fbf59bf6dbf7a,0xbe2cbea9bef8bf20,0xbf7cbf7ebf6dbf48,0xbe8ebf08bf3fbf67,0xbf6dbf35bec40000,0xbec4bf35bf6dbf80
.quad 0xbf14bde53ec43f48,0xbef8bf59bf80bf67,0xbd663f083f6d3f7a,0xbf14bf72bf76bf20,0x3ef83f723f6d3ede,0xbf2bbf7ebf51be64,0x3f603f723ec4bede,0xbf3fbf7ebf143e64
.quad 0x3f803f08bec4bf7a,0xbf51bf72be8e3f20,0x3f51bde5bf6dbf48,0xbf60bf593d663f67,0x3ec4bf35bf6d0000,0xbf6dbf353ec43f80,0xbe2cbf7ebec43f48,0xbf76bf083f2b3f67
.quad 0xbf2bbf593ec43f7a,0xbf7cbea93f603f20,0xbf76bea93f6d3ede,0xbf80bde53f7c3e64,0xbf763ea93f6dbede,0xbf803de53f7cbe64,0xbf2b3f593ec4bf7a,0xbf7c3ea93f60bf20
.quad 0x0,0x0,0x0,0x0,0x0,0x0,0x0,0x0
.quad 0x0,0x0,0x0,0x0,0x0,0x0,0x0,0x0
.quad 0x0,0x0,0x0,0x0,0x0,0x0,0x0,0x0
.quad 0x0,0x0,0x0,0x0,0x0,0x0,0x0,0x0
.quad 0x0,0x0,0x0,0x0,0x0,0x0,0x0,0x0
.quad 0x0,0x0,0x0,0x0,0x0,0x0,0x0,0x0
.quad 0x0,0x0,0x0,0x0,0x0,0x0,0x0,0x0
.quad 0x0,0x0,0x0,0x0,0x0,0x0,0x0,0x0
.quad 0x3f443f3a3f303f25,0x3f633f5c3f553f4d,0xbf02bf25bf44bf5c,0x3e0fbce6be48beb7,0xbf6fbf4dbf1abeb7,0xbf3abf63bf7bbf7f,0x3e483f0e3f553f7b,0xbf7bbf55bf0ebe48
.quad 0x3f803f5c3f023ce6,0xbed13dac3f0e3f63,0x3e0fbeebbf63bf7d,0x3f023f6a3f7b3f30,0xbf74bf6abed13e9b,0x3f7f3f4d3e48bf02,0xbeeb3eb73f6f3f63,0x3f25be0fbf55bf78
.quad 0x3f4d3f743e9bbf1a,0xbe80bf6fbf55bce6,0x3f3abe80bf78bf30,0xbf6fbf443e483f74,0xbf0ebf7bbe483f55,0xbf553e483f7b3f0e,0xbf6a3e0f3f7d3ed1,0xbce63f743f0ebf25
.quad 0x3e803f7f3dacbf78,0x3f4d3f3abf0ebf6a,0x3f7fbce6bf80bdac,0x3f74be80bf7b3e0f,0x3dacbf803ce63f7f,0x3e9bbf78be483f7d,0xbf78bdac3f7fbe80,0xbf1abf303f553ed1
.quad 0x3f783f743f6f3f6a,0x3f803f7f3f7d3f7b,0x3f3a3f1a3eeb3e9b,0x3f7f3f783f6a3f55,0x3e9b3ce6be80bf02,0x3f7d3f6a3f443f0e,0xbe48bf0ebf55bf7b,0x3f7b3f553f0e3e48
.quad 0xbf25bf6fbf7dbf4d,0x3f783f3a3e9bbe48,0xbf6fbf78bf25bdac,0x3f743f1a3ce6bf0e,0xbf7dbf253ce63f30,0x3f6f3eebbe80bf55,0xbf4dbdac3f303f80,0x3f6a3e9bbf02bf7b
.quad 0xbed13f023f7f3f25,0x3f633e0fbf3abf7b,0x3dac3f6a3f4dbe0f,0x3f5cbce6bf63bf55,0x3f0e3f7b3e48bf55,0x3f55be48bf7bbf0e,0x3f633f30bf02bf78,0x3f4dbeb7bf7fbe48
.quad 0x3f803e0fbf74beeb,0x3f44bf02bf6f3e48,0x3f5cbeebbf6a3eb7,0x3f3abf25bf4d3f0e,0x3f02bf63bed13f6f,0x3f30bf44bf1a3f55,0x3ce6bf7d3e9b3f63,0x3f25bf5cbeb73f7b
.quad 0x0,0x0,0x0,0x0,0x0,0x0,0x0,0x0
.quad 0x0,0x0,0x0,0x0,0x0,0x0,0x0,0x0
.quad 0x0,0x0,0x0,0x0,0x0,0x0,0x0,0x0
.quad 0x0,0x0,0x0,0x0,0x0,0x0,0x0,0x0
.quad 0x0,0x0,0x0,0x0,0x0,0x0,0x0,0x0
.quad 0x0,0x0,0x0,0x0,0x0,0x0,0x0,0x0
.quad 0x0,0x0,0x0,0x0,0x0,0x0,0x0,0x0
.quad 0x0,0x0,0x0,0x0,0x0,0x0,0x0,0x0
.quad 0xbf25bf30bf3abf44,0xbeebbf02bf0ebf1a,0xbf5cbf44bf25bf02,0xbf7dbf80bf7bbf6f,0x3eb73f1a3f4d3f6f,0xbf30beebbe483dac,0x3f7b3f553f0e3e48,0x3e483f0e3f553f7b
.quad 0xbce6bf02bf5cbf80,0x3f6a3f7f3f553eeb,0xbf7dbf63beeb3e0f,0x3f5c3ed1be48bf3a,0xbe9b3ed13f6a3f74,0x3dacbf1abf7bbf5c,0x3f633f6f3eb7beeb,0xbf44bf7dbf0e3e80
.quad 0x3f1abe9bbf74bf4d,0xbf78beb73f0e3f80,0xbf30bf78be803f3a,0xbeb73f253f7b3e9b,0xbf553e483f7b3f0e,0x3f0e3f7b3e48bf55,0x3ed13f7d3e0fbf6a,0x3f803e9bbf55bf44
.quad 0x3f78bdacbf7fbe80,0x3f1abf30bf553ed1,0xbdacbf80bce63f7f,0xbe9bbf783e483f7d,0xbf7fbce63f80bdac,0xbf74be803f7b3e0f,0xbe803f7fbdacbf78,0xbf4d3f3a3f0ebf6a
.quad 0xbe80be9bbeb7bed1,0xbce6bdacbe0fbe48,0xbf30bf4dbf63bf74,0xbdacbe80bed1bf0e,0xbf74bf80bf78bf5c,0xbe0fbed1bf25bf55,0xbf7bbf55bf0ebe48,0xbe48bf0ebf55bf7b
.quad 0xbf44beb73e0f3f1a,0xbe80bf30bf74bf7b,0xbeb73e803f443f7f,0xbe9bbf4dbf80bf55,0x3e0f3f443f803f3a,0xbeb7bf63bf78bf0e,0x3f1a3f7f3f3abce6,0xbed1bf74bf5cbe48
.quad 0x3f6a3f5c3dacbf44,0xbeebbf7dbf303e48,0x3f7f3ed1bf1abf7d,0xbf02bf80beeb3f0e,0x3f55be48bf7bbf0e,0xbf0ebf7bbe483f55,0x3eebbf3abf5c3e80,0xbf1abf6f3dac3f7b
.quad 0xbce6bf7dbe9b3f63,0xbf25bf5c3eb73f7b,0xbf02bf633ed13f6f,0xbf30bf443f1a3f55,0xbf5cbeeb3f6a3eb7,0xbf3abf253f4d3f0e,0xbf803e0f3f74beeb,0xbf44bf023f6f3e48
.quad 0x0,0x0,0x0,0x0,0x0,0x0,0x0,0x0
.quad 0x0,0x0,0x0,0x0,0x0,0x0,0x0,0x0
.quad 0x0,0x0,0x0,0x0,0x0,0x0,0x0,0x0
.quad 0x0,0x0,0x0,0x0,0x0,0x0,0x0,0x0
.quad 0x0,0x0,0x0,0x0,0x0,0x0,0x0,0x0
.quad 0x0,0x0,0x0,0x0,0x0,0x0,0x0,0x0
.quad 0x0,0x0,0x0,0x0,0x0,0x0,0x0,0x0
.quad 0x0,0x0,0x0,0x0,0x0,0x0,0x0,0x0
.quad 0x3f20bf67be643f80,0x3f80be64bf673f20,0x3f59bf48bea93f80,0x3f353edebf7e3e64,0x3f7abf20bede3f80,0x3f67bf48be64,0x3f7ebedebf083f80,0xbf353f7abea9bf20
.quad 0x3f67be64bf203f80,0xbf803f203e64bf67,0x3f350000bf353f80,0xbf3500003f35bf80,0x3ede3e64bf483f80,0xbf203f7abf67,0x3de53edebf593f80,0x3f35bf7a3f72bf20
.quad 0xbe643f20bf673f80,0x3f80bf673f20be64,0xbf083f48bf723f80,0x3f35bede3de53e64,0xbf483f67bf7a3f80,0x3e64bede3f20,0xbf723f7abf7e3f80,0xbf353f48bf593f67
.quad 0xbf803f80bf803f80,0xbf803f80bf803f80,0xbf723f7abf7e3f80,0xbf353f48bf593f67,0xbf483f67bf7a3f80,0x3e64bede3f20,0xbf083f48bf723f80,0x3f35bede3de53e64
.quad 0x3f203f20bf67be64,0xbe643f80be64bf67,0xbf083f7abde5bf67,0xbf7200003f72bf20,0xbf7a3e643f48bf67,0x3edebf803ede3f20,0xbde5bf483f72be64,0x3f590000bf593f67
.quad 0x3f67bf673e643f20,0xbf203f80bf20be64,0x3f350000bf353f80,0xbf3500003f35bf80,0xbede3f67bf7a3f20,0x3f48bf803f48be64,0xbf7e3f48bea9be64,0x3f080000bf083f67
.quad 0xbe64be643f20bf67,0xbf673f80bf673f20,0x3f59bf7a3f7ebf67,0xbea900003ea9bf20,0x3f48bf203edebe64,0x3f7abf803f7abf67,0xbea93edebf083f20,0x3de50000bde53e64
.quad 0xbf803f80bf803f80,0xbf803f80bf803f80,0xbea93edebf083f20,0x3de50000bde53e64,0x3f48bf203edebe64,0x3f7abf803f7abf67,0x3f59bf7a3f7ebf67,0xbea900003ea9bf20
.quad 0xbf673f203f20bf67,0xbf67be643f80be64,0x3de5bf7a3f083f20,0x3f7ebedebf353f67,0x3f483e64bf7a3f20,0xbf483f670000bf67,0xbf723f483de5bf67,0x3ea9bf7a3f353e64
.quad 0x3e64bf673f67be64,0x3e643f20bf803f20,0x3f350000bf353f80,0xbf3500003f35bf80,0xbf7a3f67bedebe64,0x3f7abf2000003f20,0x3ea9bf483f7ebf67,0xbf723f7abf353e64
.quad 0x3f20be64be643f20,0x3f20bf673f80bf67,0xbf7e3f7abf593f20,0xbde53edebf353f67,0x3edebf203f48bf67,0xbede3e640000be64,0x3f08bede3ea9be64,0x3f59bf483f35bf20
.quad 0xbf803f80bf803f80,0xbf803f80bf803f80,0x3f08bede3ea9be64,0x3f59bf483f35bf20,0x3edebf203f48bf67,0xbede3e640000be64,0xbf7e3f7abf593f20,0xbde53edebf353f67
.quad 0xbe64bf673f203f20,0x3f20bf67be643f80,0x3ea93f48bf59be64,0xbf593f483ea9bf80,0xbedebf203f7abe64,0x3f7abf20bede3f80,0x3f083edebf7e3f20,0xbf7e3ede3f08bf80
.quad 0xbf20be643f67bf67,0x3f67be64bf203f80,0x3f350000bf353f80,0xbf3500003f35bf80,0xbf483e643edebf67,0x3ede3e64bf483f80,0x3f59bedebde53f20,0xbde5bede3f59bf80
.quad 0xbf673f20be64be64,0xbe643f20bf673f80,0x3f72bf483f08be64,0x3f08bf483f72bf80,0xbf7a3f67bf483f20,0xbf483f67bf7a3f80,0x3f7ebf7a3f72bf67,0x3f72bf7a3f7ebf80
.quad 0xbf803f80bf803f80,0xbf803f80bf803f80,0x3f7ebf7a3f72bf67,0x3f72bf7a3f7ebf80,0xbf7a3f67bf483f20,0xbf483f67bf7a3f80,0x3f72bf483f08be64,0x3f08bf483f72bf80
.quad 0xbf48bede3f7a0000,0xbf7a3ede3f48,0xbf08bf203f720000,0x3f35bf67bde53f7a,0xbe64bf483f670000,0x3f80bedebf203f7a,0x3de5bf673f590000,0x3f353e64bf723f48
.quad 0x3edebf7a3f480000,0x3f48bf7a3ede,0x3f35bf803f350000,0xbf353f80bf350000,0x3f67bf7a3f200000,0xbf803f48be64bede,0x3f7ebf673f080000,0xbf353e643ea9bf48
.quad 0x3f7abf483ede0000,0xbede3f48bf7a,0x3f59bf203ea90000,0x3f35bf673f7ebf7a,0x3f20bede3e640000,0x3f80bf7a3f67bf48,0x3ea9be643de50000,0x3f35bf203f08bede
.quad 0x0,0x0,0xbea93e64bde50000,0xbf353f20bf083ede,0xbf203edebe640000,0xbf803f7abf673f48,0xbf593f20bea90000,0xbf353f67bf7e3f7a
.quad 0x3f48bf48bede3f7a,0x3f7a0000bf7a3ede,0x3f593e64bf7e3ede,0xbea93f80bea9bf48,0xbe643f7abf20bede,0xbf6700003f67bf48,0xbf7e3f203ea9bf7a,0x3f08bf803f083ede
.quad 0xbedebede3f7abf48,0x3f480000bf483f7a,0x3f35bf803f350000,0xbf353f80bf350000,0x3f67bedebe643f48,0xbf2000003f20bf7a,0xbde53f20bf723f7a,0x3f59bf803f59bede
.quad 0xbf7a3f7abf483ede,0x3ede0000bede3f48,0xbf083e643de5bede,0xbf723f80bf723f48,0x3f20bf483f67bf7a,0xbe6400003e64bede,0x3f72bf673f59bf48,0x3f7ebf803f7ebf7a
.quad 0x0,0x0,0xbf723f67bf593f48,0xbf7e3f80bf7e3f7a,0xbf203f48bf673f7a,0x3e640000be643ede,0x3f08be64bde53ede,0x3f72bf803f72bf48
.quad 0x3ede3f48bf48bede,0xbede3f7a0000bf7a,0xbf7e3e643f59bf48,0xbde5bf673f353ede,0x3f20bf7a3e643f48,0x3f203edebf803ede,0x3ea93f20bf7e3ede,0xbf723e643f35bf7a
.quad 0xbf7a3ede3edebf7a,0x3f7abf4800003f48,0x3f35bf803f350000,0xbf353f80bf350000,0x3e643edebf673f7a,0x3e64bf483f80bf48,0xbf723f20bde5bede,0x3ea93e64bf353f7a
.quad 0x3f48bf7a3f7abf48,0xbf483ede0000bede,0x3de53e64bf083f48,0x3f7ebf673f35bede,0xbf673f48bf203ede,0xbf673f7abf803f7a,0x3f59bf673f72bf7a,0x3f08bf203f35bf48
.quad 0x0,0x0,0xbf593f67bf723f7a,0xbf083f20bf353f48,0x3f67bf483f20bede,0x3f67bf7a3f80bf7a,0xbde5be643f08bf48,0xbf7e3f67bf353ede
.quad 0xbf7a3ede3f48bf48,0xbf48bede3f7a0000,0x3f72bf20bf083f7a,0x3f083f20bf720000,0xbf673f483e64bf7a,0xbe64bf483f670000,0x3f59bf673de53f48,0xbde53f67bf590000
.quad 0xbf483f7abedebede,0x3edebf7a3f480000,0x3f35bf803f350000,0xbf353f80bf350000,0xbf203f7abf673ede,0x3f67bf7a3f200000,0x3f08bf673f7ebf48,0xbf7e3f67bf080000
.quad 0xbede3f48bf7a3f7a,0x3f7abf483ede0000,0x3ea9bf203f59bf7a,0xbf593f20bea90000,0xbe643edebf203f48,0x3f20bede3e640000,0x3de5be643ea9bede,0xbea93e64bde50000
.quad 0x0,0x0,0xbde53e64bea93ede,0x3ea9be643de50000,0x3e64bede3f20bf48,0xbf203edebe640000,0xbea93f20bf593f7a,0x3f59bf203ea90000
.quad 0x3f80be64bf673f20,0x3f203f20bf67be64,0x3f6d3d66bf763f14,0xbe2c3f7cbef8bf2b,0x3f353ea9bf7e3f08,0xbf593f593de5bf72,0x3ec43f14bf803ef8,0xbf763e8e3f2bbf7c
.quad 0x3f48bf7a3ede,0xbedebede3f7abf48,0xbec43f6dbf6d3ec4,0x3ec4bf6d3f6dbec4,0xbf353f7ebf593ea9,0x3f72bf723f083de5,0xbf6d3f7cbf3f3e8e,0x3f60bef8bd663f14
.quad 0xbf803f67bf203e64,0x3e643e64bf203f67,0xbf6d3f3fbef83e2c,0xbf143f51bf763f80,0xbf353f08bea93de5,0xbf7e3f7ebf723f59,0xbec43e8ebe2c3d66,0xbf3f3f2bbf143ef8
.quad 0x0,0x0,0x3ec4be8e3e2cbd66,0x3f3fbf2b3f14bef8,0x3f35bf083ea9bde5,0x3f7ebf7e3f72bf59,0x3f6dbf3f3ef8be2c,0x3f14bf513f76bf80
.quad 0xbe643f80be64bf67,0xbf673f203f20bf67,0xbf803ec43f3fbf60,0xbe8ebf513f513e8e,0xbea9bf353f72bde5,0x3f7ebf08bf083f7e,0x3f51bf6d3e2c3f3f,0xbd663f60bf603d66
.quad 0x3f480000bf483f7a,0xbf7a3ede3edebf7a,0xbec43f6dbf6d3ec4,0x3ec4bf6d3f6dbec4,0xbf7e3f35bde5bf08,0x3f59bea9bea93f59,0xbe2cbec43f51bf80,0xbf2b3f76bf763f2b
.quad 0x3f67bf803f67bf20,0xbf203e643e64bf20,0x3f2bbec43d663e8e,0x3f60bf7c3f7cbf60,0xbf083f35bf593f72,0x3ea9bde5bde53ea9,0xbf763f6dbf603f51,0xbf7c3f80bf803f7c
.quad 0x0,0x0,0x3f76bf6d3f60bf51,0x3f7cbf803f80bf7c,0x3f08bf353f59bf72,0xbea93de53de5bea9,0xbf2b3ec4bd66be8e,0xbf603f7cbf7c3f60
.quad 0xbf67be643f80be64,0xbe64bf673f203f20,0x3f60bf3fbec43f80,0x3f2b3ef8bf7c3e2c,0xbde53f72bf35bea9,0xbf723de53f59bf59,0xbf3fbe2c3f6dbf51,0x3f7cbf2bbe8e3f76
.quad 0x3f7abf4800003f48,0xbf483f7abedebede,0xbec43f6dbf6d3ec4,0x3ec4bf6d3f6dbec4,0xbf08bde53f35bf7e,0x3de53f08bf723f72,0x3f80bf513ec43e2c,0xbf143d663ef8bf60
.quad 0xbf203f67bf803f67,0x3f67bf203e643e64,0xbe8ebd663ec4bf2b,0xbf803f76bf513f14,0x3f72bf593f35bf08,0x3f59bf723f7ebf7e,0xbf513f60bf6d3f76,0xbef83f14bf2b3f3f
.quad 0x0,0x0,0x3f51bf603f6dbf76,0x3ef8bf143f2bbf3f,0xbf723f59bf353f08,0xbf593f72bf7e3f7e,0x3e8e3d66bec43f2b,0x3f80bf763f51bf14
.quad 0x3f20bf67be643f80,0x3f80be64bf673f20,0xbf143f76bd66bf6d,0xbf6dbd663f76bf14,0x3f08bf7e3ea93f35,0x3f353ea9bf7e3f08,0xbef83f80bf14bec4,0xbec4bf143f80bef8
.quad 0x3edebf7a3f480000,0x3f48bf7a3ede,0xbec43f6dbf6d3ec4,0x3ec4bf6d3f6dbec4,0x3ea9bf593f7ebf35,0xbf353f7ebf593ea9,0xbe8e3f3fbf7c3f6d,0x3f6dbf7c3f3fbe8e
.quad 0x3e64bf203f67bf80,0xbf803f67bf203e64,0xbe2c3ef8bf3f3f6d,0x3f6dbf3f3ef8be2c,0x3de5bea93f08bf35,0xbf353f08bea93de5,0xbd663e2cbe8e3ec4,0x3ec4be8e3e2cbd66
.quad 0x0,0x0,0x3d66be2c3e8ebec4,0xbec43e8ebe2c3d66,0xbde53ea9bf083f35,0x3f35bf083ea9bde5,0x3e2cbef83f3fbf6d,0xbf6d3f3fbef83e2c
.quad 0xbf7a3ede3f48,0x3f48bf48bede3f7a,0x3ec4bf803e8e3f51,0x3f7cbe2cbf603f3f,0x3f35bf723de53f59,0x3f083f08bf7e3ea9,0x3f6dbf51bd663f60,0xbe8e3f76bf3fbe2c
.quad 0x3f80bf20be643f67,0xbf673f67be64bf20,0x3f6dbec4bec43f6d,0xbf6d3ec43ec4bf6d,0x3f35bde5bf083f72,0xbea9bea93f59bf7e,0x3ec43e2cbf2b3f76,0x3ef8bf603f80bf51
.quad 0x3edebf483f7a,0x3f7abf7a3f48bede,0xbec43f2bbf603f7c,0x3f51bf143e8e3d66,0xbf353f59bf723f7e,0x3de53de5bea93f08,0xbf6d3f76bf7c3f80,0xbf2b3f3fbf513f60
.quad 0xbf803f80bf803f80,0xbf803f80bf803f80,0xbf6d3f76bf7c3f80,0xbf2b3f3fbf513f60,0xbf353f59bf723f7e,0x3de53de5bea93f08,0xbec43f2bbf603f7c,0x3f51bf143e8e3d66
.quad 0x3f7a0000bf7a3ede,0x3ede3f48bf48bede,0x3d663f6dbf2bbef8,0xbf763f143f14bf76,0xbf723f353ea9bf7e,0xbde5bf593f593de5,0xbf14bec43f7cbf2b,0x3f80bef8bef83f80
.quad 0x3f20bf803f203e64,0xbe643f67bf673e64,0x3f6dbec4bec43f6d,0xbf6d3ec43ec4bf6d,0xbde53f35bf7e3f59,0x3f08bf723f72bf08,0xbf7c3f6dbf143d66,0x3f3fbe8ebe8e3f3f
.quad 0xbede00003edebf48,0xbf483f7abf7a3f48,0x3f3fbf6d3f80bf76,0xbef83e2c3e2cbef8,0x3f59bf353f08bea9,0x3f72bf7e3f7ebf72,0xbe8e3ec4bef83f14,0x3e2cbd66bd663e2c
.quad 0xbf803f80bf803f80,0xbf803f80bf803f80,0xbe8e3ec4bef83f14,0x3e2cbd66bd663e2c,0x3f59bf353f08bea9,0x3f72bf7e3f7ebf72,0x3f3fbf6d3f80bf76,0xbef83e2c3e2cbef8
.quad 0xbede3f7a0000bf7a,0xbf7a3ede3f48bf48,0xbef8bf2b3f6d3d66,0x3f3fbf60be2c3f7c,0x3f7ebea9bf353f72,0xbea93f7ebf08bf08,0xbf2b3f7cbec4bf14,0xbe2cbf3f3f76be8e
.quad 0xbe64bf203f80bf20,0x3f203e64bf673f67,0x3f6dbec4bec43f6d,0xbf6d3ec43ec4bf6d,0xbf593f7ebf353de5,0x3f7ebf593ea93ea9,0x3d66bf143f6dbf7c,0xbf513f80bf603ef8
.quad 0x3f48bede00003ede,0x3edebf483f7abf7a,0xbf763f80bf6d3f3f,0x3d663e8ebf143f51,0x3ea9bf083f35bf59,0xbf083ea9bde5bde5,0x3f14bef83ec4be8e,0x3f60bf513f3fbf2b
.quad 0xbf803f80bf803f80,0xbf803f80bf803f80,0x3f14bef83ec4be8e,0x3f60bf513f3fbf2b,0x3ea9bf083f35bf59,0xbf083ea9bde5bde5,0xbf763f80bf6d3f3f,0x3d663e8ebf143f51
.quad 0xbf48bede3f7a0000,0xbf7a3ede3f48,0x3f513e8ebf803ec4,0xbec43f80be8ebf51,0xbf59bde53f72bf35,0x3f35bf723de53f59,0x3f60bd66bf513f6d,0xbf6d3f513d66bf60
.quad 0xbf673e643f20bf80,0x3f80bf20be643f67,0x3f6dbec4bec43f6d,0xbf6d3ec43ec4bf6d,0xbf723f083de5bf35,0x3f35bde5bf083f72,0x3f76bf2b3e2c3ec4,0xbec4be2c3f2bbf76
.quad 0xbf7a3f48bede0000,0x3edebf483f7a,0x3f7cbf603f2bbec4,0x3ec4bf2b3f60bf7c,0xbf7e3f72bf593f35,0xbf353f59bf723f7e,0x3f80bf7c3f76bf6d,0x3f6dbf763f7cbf80
.quad 0xbf803f80bf803f80,0xbf803f80bf803f80,0x3f80bf7c3f76bf6d,0x3f6dbf763f7cbf80,0xbf7e3f72bf593f35,0xbf353f59bf723f7e,0x3f7cbf603f2bbec4,0x3ec4bf2b3f60bf7c
.quad 0x3f80be64bf673f20,0x3f203f20bf67be64,0xbf35bede3f7ebe64,0x3f08bf7a3de53f67,0x3f67bf48be64,0xbf7a3e643f48bf67,0x3f35bf7a3ea93f20,0x3de53f48bf723e64
.quad 0xbf803f203e64bf67,0x3f67bf673e643f20,0x3f350000bf353f80,0xbf3500003f35bf80,0xbf203f7abf67,0xbede3f67bf7a3f20,0xbf353f7abf723f20,0x3f7ebf483ea93e64
.quad 0x3f80bf673f20be64,0xbe64be643f20bf67,0xbf353edebde5be64,0xbf593f7abf7e3f67,0x3e64bede3f20,0x3f48bf203edebe64,0x3f35bf483f59bf67,0x3ea9bede3f08bf20
.quad 0xbf803f80bf803f80,0xbf803f80bf803f80,0x3f35bf483f59bf67,0x3ea9bede3f08bf20,0x3e64bede3f20,0x3f48bf203edebe64,0xbf353edebde5be64,0xbf593f7abf7e3f67
.quad 0xbe643f80be64bf67,0xbf673f203f20bf67,0x3f720000bf723f20,0xbde53f7abf08bf20,0x3edebf803ede3f20,0x3f483e64bf7a3f20,0xbf5900003f59bf67,0x3f72bf48bde53f67
.quad 0xbf203f80bf20be64,0x3e64bf673f67be64,0x3f350000bf353f80,0xbf3500003f35bf80,0x3f48bf803f48be64,0xbf7a3f67bedebe64,0xbf0800003f08bf67,0xbea93f48bf7e3f67
.quad 0xbf673f80bf673f20,0x3f20be64be643f20,0x3ea90000bea93f20,0x3f7ebf7a3f59bf20,0x3f7abf803f7abf67,0x3edebf203f48bf67,0xbde500003de5be64,0xbf083edebea93e64
.quad 0xbf803f80bf803f80,0xbf803f80bf803f80,0xbde500003de5be64,0xbf083edebea93e64,0x3f7abf803f7abf67,0x3edebf203f48bf67,0x3ea90000bea93f20,0x3f7ebf7a3f59bf20
.quad 0xbf67be643f80be64,0xbe64bf673f203f20,0xbf7e3ede3f35bf67,0xbea9bf483f593e64,0xbf483f670000bf67,0xbedebf203f7abe64,0xbea93f7abf35be64,0xbf08bede3f7ebf20
.quad 0x3e643f20bf803f20,0xbf20be643f67bf67,0x3f350000bf353f80,0xbf3500003f35bf80,0x3f7abf2000003f20,0xbf483e643edebf67,0x3f72bf7a3f35be64,0xbf593ede3de5bf20
.quad 0x3f20bf673f80bf67,0xbf673f20be64be64,0x3de5bede3f35bf67,0xbf723f48bf083e64,0xbede3e640000be64,0xbf7a3f67bf483f20,0xbf593f48bf353f20,0xbf7e3f7abf723f67
.quad 0xbf803f80bf803f80,0xbf803f80bf803f80,0xbf593f48bf353f20,0xbf7e3f7abf723f67,0xbede3e640000be64,0xbf7a3f67bf483f20,0x3de5bede3f35bf67,0xbf723f48bf083e64
.quad 0x3f20bf67be643f80,0x3f80be64bf673f20,0x3f59bf48bea93f80,0x3f353edebf7e3e64,0x3f7abf20bede3f80,0x3f67bf48be64,0x3f7ebedebf083f80,0xbf353f7abea9bf20
.quad 0x3f67be64bf203f80,0xbf803f203e64bf67,0x3f350000bf353f80,0xbf3500003f35bf80,0x3ede3e64bf483f80,0xbf203f7abf67,0x3de53edebf593f80,0x3f35bf7a3f72bf20
.quad 0xbe643f20bf673f80,0x3f80bf673f20be64,0xbf083f48bf723f80,0x3f35bede3de53e64,0xbf483f67bf7a3f80,0x3e64bede3f20,0xbf723f7abf7e3f80,0xbf353f48bf593f67
.quad 0xbf803f80bf803f80,0xbf803f80bf803f80,0xbf723f7abf7e3f80,0xbf353f48bf593f67,0xbf483f67bf7a3f80,0x3e64bede3f20,0xbf083f48bf723f80,0x3f35bede3de53e64
.quad 0xbf7a3ede3f48,0x3f48bf48bede3f7a,0xbf353f673de5bf7a,0xbf59be643f7ebede,0x3f80bedebf203f7a,0xbe643f7abf20bede,0xbf35be643f72bf48,0x3f7ebf20bea93f7a
.quad 0x3f48bf7a3ede,0xbedebede3f7abf48,0x3f35bf803f350000,0xbf353f80bf350000,0xbf803f48be64bede,0x3f67bedebe643f48,0x3f35be64bea93f48,0x3de5bf203f72bf7a
.quad 0xbede3f48bf7a,0xbf7a3f7abf483ede,0xbf353f67bf7e3f7a,0x3f08be64bde53ede,0x3f80bf7a3f67bf48,0x3f20bf483f67bf7a,0xbf353f20bf083ede,0xbf723f67bf593f48
.quad 0x0,0x0,0x3f35bf203f08bede,0x3f72bf673f59bf48,0xbf803f7abf673f48,0xbf203f48bf673f7a,0x3f35bf673f7ebf7a,0xbf083e643de5bede
.quad 0x3f7a0000bf7a3ede,0x3ede3f48bf48bede,0x3ea9bf803ea93f48,0x3f7ebe64bf593f48,0xbf6700003f67bf48,0x3f20bf7a3e643f48,0xbf083f80bf08bede,0xbea9bf203f7ebede
.quad 0x3f480000bf483f7a,0xbf7a3ede3edebf7a,0x3f35bf803f350000,0xbf353f80bf350000,0xbf2000003f20bf7a,0x3e643edebf673f7a,0xbf593f80bf593ede,0x3f72bf203de53ede
.quad 0x3ede0000bede3f48,0x3f48bf7a3f7abf48,0x3f72bf803f72bf48,0xbde5be643f08bf48,0xbe6400003e64bede,0xbf673f48bf203ede,0xbf7e3f80bf7e3f7a,0xbf593f67bf723f7a
.quad 0x0,0x0,0x3f7ebf803f7ebf7a,0x3f59bf673f72bf7a,0x3e640000be643ede,0x3f67bf483f20bede,0xbf723f80bf723f48,0x3de53e64bf083f48
.quad 0xbede3f7a0000bf7a,0xbf7a3ede3f48bf48,0x3de53f67bf35bede,0xbf723f203f08bf7a,0x3f203edebf803ede,0xbf673f483e64bf7a,0x3f72be64bf353f7a,0xbf593f67bde5bf48
.quad 0x3f7abf4800003f48,0xbf483f7abedebede,0x3f35bf803f350000,0xbf353f80bf350000,0x3e64bf483f80bf48,0xbf203f7abf673ede,0xbea9be643f35bf7a,0xbf083f67bf7e3f48
.quad 0xbf483ede0000bede,0xbede3f48bf7a3f7a,0xbf7e3f67bf353ede,0xbea93f20bf593f7a,0xbf673f7abf803f7a,0xbe643edebf203f48,0xbf083f20bf353f48,0xbde53e64bea93ede
.quad 0x0,0x0,0x3f08bf203f35bf48,0x3de5be643ea9bede,0x3f67bf7a3f80bf7a,0x3e64bede3f20bf48,0x3f7ebf673f35bede,0x3ea9bf203f59bf7a
.quad 0xbf48bede3f7a0000,0xbf7a3ede3f48,0xbf08bf203f720000,0x3f35bf67bde53f7a,0xbe64bf483f670000,0x3f80bedebf203f7a,0x3de5bf673f590000,0x3f353e64bf723f48
.quad 0x3edebf7a3f480000,0x3f48bf7a3ede,0x3f35bf803f350000,0xbf353f80bf350000,0x3f67bf7a3f200000,0xbf803f48be64bede,0x3f7ebf673f080000,0xbf353e643ea9bf48
.quad 0x3f7abf483ede0000,0xbede3f48bf7a,0x3f59bf203ea90000,0x3f35bf673f7ebf7a,0x3f20bede3e640000,0x3f80bf7a3f67bf48,0x3ea9be643de50000,0x3f35bf203f08bede
.quad 0x0,0x0,0xbea93e64bde50000,0xbf353f20bf083ede,0xbf203edebe640000,0xbf803f7abf673f48,0xbf593f20bea90000,0xbf353f67bf7e3f7a
.quad 0x3f203f20bf67be64,0xbe643f80be64bf67,0x3e2cbf7c3ef83f2b,0x3f80bec4bf3f3f60,0xbf593f593de5bf72,0xbea9bf353f72bde5,0x3f76be8ebf2b3f7c,0xbf513f6dbe2cbf3f
.quad 0xbedebede3f7abf48,0x3f480000bf483f7a,0xbec43f6dbf6d3ec4,0x3ec4bf6d3f6dbec4,0x3f72bf723f083de5,0xbf7e3f35bde5bf08,0xbf603ef83d66bf14,0x3e2c3ec4bf513f80
.quad 0x3e643e64bf203f67,0x3f67bf803f67bf20,0x3f14bf513f76bf80,0xbf2b3ec4bd66be8e,0xbf7e3f7ebf723f59,0xbf083f35bf593f72,0x3f3fbf2b3f14bef8,0x3f76bf6d3f60bf51
.quad 0x0,0x0,0xbf3f3f2bbf143ef8,0xbf763f6dbf603f51,0x3f7ebf7e3f72bf59,0x3f08bf353f59bf72,0xbf143f51bf763f80,0x3f2bbec43d663e8e
.quad 0xbf673f203f20bf67,0xbf67be643f80be64,0x3e8e3f51bf51be8e,0xbf603f3f3ec4bf80,0x3f7ebf08bf083f7e,0xbde53f72bf35bea9,0x3d66bf603f60bd66,0x3f3f3e2cbf6d3f51
.quad 0xbf7a3ede3edebf7a,0x3f7abf4800003f48,0xbec43f6dbf6d3ec4,0x3ec4bf6d3f6dbec4,0x3f59bea9bea93f59,0xbf08bde53f35bf7e,0x3f2bbf763f76bf2b,0xbf803f51bec4be2c
.quad 0xbf203e643e64bf20,0xbf203f67bf803f67,0xbf603f7cbf7c3f60,0x3e8e3d66bec43f2b,0x3ea9bde5bde53ea9,0x3f72bf593f35bf08,0x3f7cbf803f80bf7c,0x3f51bf603f6dbf76
.quad 0x0,0x0,0xbf7c3f80bf803f7c,0xbf513f60bf6d3f76,0xbea93de53de5bea9,0xbf723f59bf353f08,0x3f60bf7c3f7cbf60,0xbe8ebd663ec4bf2b
.quad 0xbe64bf673f203f20,0x3f20bf67be643f80,0xbf2bbef83f7cbe2c,0x3f14bf763d663f6d,0xbf723de53f59bf59,0x3f08bf7e3ea93f35,0xbf7c3f2b3e8ebf76,0x3ef8bf803f143ec4
.quad 0xbf483f7abedebede,0x3edebf7a3f480000,0xbec43f6dbf6d3ec4,0x3ec4bf6d3f6dbec4,0x3de53f08bf723f72,0x3ea9bf593f7ebf35,0x3f14bd66bef83f60,0x3e8ebf3f3f7cbf6d
.quad 0x3f67bf203e643e64,0x3e64bf203f67bf80,0x3f80bf763f51bf14,0x3e2cbef83f3fbf6d,0x3f59bf723f7ebf7e,0x3de5bea93f08bf35,0x3ef8bf143f2bbf3f,0x3d66be2c3e8ebec4
.quad 0x0,0x0,0xbef83f14bf2b3f3f,0xbd663e2cbe8e3ec4,0xbf593f72bf7e3f7e,0xbde53ea9bf083f35,0xbf803f76bf513f14,0xbe2c3ef8bf3f3f6d
.quad 0x3f80be64bf673f20,0x3f203f20bf67be64,0x3f6d3d66bf763f14,0xbe2c3f7cbef8bf2b,0x3f353ea9bf7e3f08,0xbf593f593de5bf72,0x3ec43f14bf803ef8,0xbf763e8e3f2bbf7c
.quad 0x3f48bf7a3ede,0xbedebede3f7abf48,0xbec43f6dbf6d3ec4,0x3ec4bf6d3f6dbec4,0xbf353f7ebf593ea9,0x3f72bf723f083de5,0xbf6d3f7cbf3f3e8e,0x3f60bef8bd663f14
.quad 0xbf803f67bf203e64,0x3e643e64bf203f67,0xbf6d3f3fbef83e2c,0xbf143f51bf763f80,0xbf353f08bea93de5,0xbf7e3f7ebf723f59,0xbec43e8ebe2c3d66,0xbf3f3f2bbf143ef8
.quad 0x0,0x0,0x3ec4be8e3e2cbd66,0x3f3fbf2b3f14bef8,0x3f35bf083ea9bde5,0x3f7ebf7e3f72bf59,0x3f6dbf3f3ef8be2c,0x3f14bf513f76bf80
.quad 0x3f48bf48bede3f7a,0x3f7a0000bf7a3ede,0xbf7c3e2c3f60bf3f,0xbd66bf6d3f2b3ef8,0x3f083f08bf7e3ea9,0xbf723f353ea9bf7e,0x3e8ebf763f3f3e2c,0x3f143ec4bf7c3f2b
.quad 0xbf673f67be64bf20,0x3f20bf803f203e64,0x3f6dbec4bec43f6d,0xbf6d3ec43ec4bf6d,0xbea9bea93f59bf7e,0xbde53f35bf7e3f59,0xbef83f60bf803f51,0x3f7cbf6d3f14bd66
.quad 0x3f7abf7a3f48bede,0xbede00003edebf48,0xbf513f14be8ebd66,0xbf3f3f6dbf803f76,0x3de53de5bea93f08,0x3f59bf353f08bea9,0x3f2bbf3f3f51bf60,0x3e8ebec43ef8bf14
.quad 0xbf803f80bf803f80,0xbf803f80bf803f80,0x3f2bbf3f3f51bf60,0x3e8ebec43ef8bf14,0x3de53de5bea93f08,0x3f59bf353f08bea9,0xbf513f14be8ebd66,0xbf3f3f6dbf803f76
.quad 0x3ede3f48bf48bede,0xbede3f7a0000bf7a,0x3f76bf14bf143f76,0x3ef83f2bbf6dbd66,0xbde5bf593f593de5,0x3f7ebea9bf353f72,0xbf803ef83ef8bf80,0x3f2bbf7c3ec43f14
.quad 0xbe643f67bf673e64,0xbe64bf203f80bf20,0x3f6dbec4bec43f6d,0xbf6d3ec43ec4bf6d,0x3f08bf723f72bf08,0xbf593f7ebf353de5,0xbf3f3e8e3e8ebf3f,0xbd663f14bf6d3f7c
.quad 0xbf483f7abf7a3f48,0x3f48bede00003ede,0x3ef8be2cbe2c3ef8,0x3f76bf803f6dbf3f,0x3f72bf7e3f7ebf72,0x3ea9bf083f35bf59,0xbe2c3d663d66be2c,0xbf143ef8bec43e8e
.quad 0xbf803f80bf803f80,0xbf803f80bf803f80,0xbe2c3d663d66be2c,0xbf143ef8bec43e8e,0x3f72bf7e3f7ebf72,0x3ea9bf083f35bf59,0x3ef8be2cbe2c3ef8,0x3f76bf803f6dbf3f
.quad 0xbf7a3ede3f48bf48,0xbf48bede3f7a0000,0xbf3f3f603e2cbf7c,0xbf51be8e3f80bec4,0xbea93f7ebf08bf08,0xbf59bde53f72bf35,0x3e2c3f3fbf763e8e,0xbf603d663f51bf6d
.quad 0x3f203e64bf673f67,0xbf673e643f20bf80,0x3f6dbec4bec43f6d,0xbf6d3ec43ec4bf6d,0x3f7ebf593ea93ea9,0xbf723f083de5bf35,0x3f51bf803f60bef8,0xbf763f2bbe2cbec4
.quad 0x3edebf483f7abf7a,0xbf7a3f48bede0000,0xbd66be8e3f14bf51,0xbf7c3f60bf2b3ec4,0xbf083ea9bde5bde5,0xbf7e3f72bf593f35,0xbf603f51bf3f3f2b,0xbf803f7cbf763f6d
.quad 0xbf803f80bf803f80,0xbf803f80bf803f80,0xbf603f51bf3f3f2b,0xbf803f7cbf763f6d,0xbf083ea9bde5bde5,0xbf7e3f72bf593f35,0xbd66be8e3f14bf51,0xbf7c3f60bf2b3ec4
.quad 0xbf7a3ede3f48,0x3f48bf48bede3f7a,0x3ec4bf803e8e3f51,0x3f7cbe2cbf603f3f,0x3f35bf723de53f59,0x3f083f08bf7e3ea9,0x3f6dbf51bd663f60,0xbe8e3f76bf3fbe2c
.quad 0x3f80bf20be643f67,0xbf673f67be64bf20,0x3f6dbec4bec43f6d,0xbf6d3ec43ec4bf6d,0x3f35bde5bf083f72,0xbea9bea93f59bf7e,0x3ec43e2cbf2b3f76,0x3ef8bf603f80bf51
.quad 0x3edebf483f7a,0x3f7abf7a3f48bede,0xbec43f2bbf603f7c,0x3f51bf143e8e3d66,0xbf353f59bf723f7e,0x3de53de5bea93f08,0xbf6d3f76bf7c3f80,0xbf2b3f3fbf513f60
.quad 0xbf803f80bf803f80,0xbf803f80bf803f80,0xbf6d3f76bf7c3f80,0xbf2b3f3fbf513f60,0xbf353f59bf723f7e,0x3de53de5bea93f08,0xbec43f2bbf603f7c,0x3f51bf143e8e3d66
.quad 0x3f203f20bf67be64,0xbe643f80be64bf67,0xbf083f7abde5bf67,0xbf7200003f72bf20,0xbf7a3e643f48bf67,0x3edebf803ede3f20,0xbde5bf483f72be64,0x3f590000bf593f67
.quad 0x3f67bf673e643f20,0xbf203f80bf20be64,0x3f350000bf353f80,0xbf3500003f35bf80,0xbede3f67bf7a3f20,0x3f48bf803f48be64,0xbf7e3f48bea9be64,0x3f080000bf083f67
.quad 0xbe64be643f20bf67,0xbf673f80bf673f20,0x3f59bf7a3f7ebf67,0xbea900003ea9bf20,0x3f48bf203edebe64,0x3f7abf803f7abf67,0xbea93edebf083f20,0x3de50000bde53e64
.quad 0xbf803f80bf803f80,0xbf803f80bf803f80,0xbea93edebf083f20,0x3de50000bde53e64,0x3f48bf203edebe64,0x3f7abf803f7abf67,0x3f59bf7a3f7ebf67,0xbea900003ea9bf20
.quad 0xbf673f203f20bf67,0xbf67be643f80be64,0x3de5bf7a3f083f20,0x3f7ebedebf353f67,0x3f483e64bf7a3f20,0xbf483f670000bf67,0xbf723f483de5bf67,0x3ea9bf7a3f353e64
.quad 0x3e64bf673f67be64,0x3e643f20bf803f20,0x3f350000bf353f80,0xbf3500003f35bf80,0xbf7a3f67bedebe64,0x3f7abf2000003f20,0x3ea9bf483f7ebf67,0xbf723f7abf353e64
.quad 0x3f20be64be643f20,0x3f20bf673f80bf67,0xbf7e3f7abf593f20,0xbde53edebf353f67,0x3edebf203f48bf67,0xbede3e640000be64,0x3f08bede3ea9be64,0x3f59bf483f35bf20
.quad 0xbf803f80bf803f80,0xbf803f80bf803f80,0x3f08bede3ea9be64,0x3f59bf483f35bf20,0x3edebf203f48bf67,0xbede3e640000be64,0xbf7e3f7abf593f20,0xbde53edebf353f67
.quad 0xbe64bf673f203f20,0x3f20bf67be643f80,0x3ea93f48bf59be64,0xbf593f483ea9bf80,0xbedebf203f7abe64,0x3f7abf20bede3f80,0x3f083edebf7e3f20,0xbf7e3ede3f08bf80
.quad 0xbf20be643f67bf67,0x3f67be64bf203f80,0x3f350000bf353f80,0xbf3500003f35bf80,0xbf483e643edebf67,0x3ede3e64bf483f80,0x3f59bedebde53f20,0xbde5bede3f59bf80
.quad 0xbf673f20be64be64,0xbe643f20bf673f80,0x3f72bf483f08be64,0x3f08bf483f72bf80,0xbf7a3f67bf483f20,0xbf483f67bf7a3f80,0x3f7ebf7a3f72bf67,0x3f72bf7a3f7ebf80
.quad 0xbf803f80bf803f80,0xbf803f80bf803f80,0x3f7ebf7a3f72bf67,0x3f72bf7a3f7ebf80,0xbf7a3f67bf483f20,0xbf483f67bf7a3f80,0x3f72bf483f08be64,0x3f08bf483f72bf80
.quad 0x3f80be64bf673f20,0x3f203f20bf67be64,0xbf35bede3f7ebe64,0x3f08bf7a3de53f67,0x3f67bf48be64,0xbf7a3e643f48bf67,0x3f35bf7a3ea93f20,0x3de53f48bf723e64
.quad 0xbf803f203e64bf67,0x3f67bf673e643f20,0x3f350000bf353f80,0xbf3500003f35bf80,0xbf203f7abf67,0xbede3f67bf7a3f20,0xbf353f7abf723f20,0x3f7ebf483ea93e64
.quad 0x3f80bf673f20be64,0xbe64be643f20bf67,0xbf353edebde5be64,0xbf593f7abf7e3f67,0x3e64bede3f20,0x3f48bf203edebe64,0x3f35bf483f59bf67,0x3ea9bede3f08bf20
.quad 0xbf803f80bf803f80,0xbf803f80bf803f80,0x3f35bf483f59bf67,0x3ea9bede3f08bf20,0x3e64bede3f20,0x3f48bf203edebe64,0xbf353edebde5be64,0xbf593f7abf7e3f67
.quad 0x3f48bf48bede3f7a,0x3f7a0000bf7a3ede,0x3f593e64bf7e3ede,0xbea93f80bea9bf48,0xbe643f7abf20bede,0xbf6700003f67bf48,0xbf7e3f203ea9bf7a,0x3f08bf803f083ede
.quad 0xbedebede3f7abf48,0x3f480000bf483f7a,0x3f35bf803f350000,0xbf353f80bf350000,0x3f67bedebe643f48,0xbf2000003f20bf7a,0xbde53f20bf723f7a,0x3f59bf803f59bede
.quad 0xbf7a3f7abf483ede,0x3ede0000bede3f48,0xbf083e643de5bede,0xbf723f80bf723f48,0x3f20bf483f67bf7a,0xbe6400003e64bede,0x3f72bf673f59bf48,0x3f7ebf803f7ebf7a
.quad 0x0,0x0,0xbf723f67bf593f48,0xbf7e3f80bf7e3f7a,0xbf203f48bf673f7a,0x3e640000be643ede,0x3f08be64bde53ede,0x3f72bf803f72bf48
.quad 0x3ede3f48bf48bede,0xbede3f7a0000bf7a,0xbf7e3e643f59bf48,0xbde5bf673f353ede,0x3f20bf7a3e643f48,0x3f203edebf803ede,0x3ea93f20bf7e3ede,0xbf723e643f35bf7a
.quad 0xbf7a3ede3edebf7a,0x3f7abf4800003f48,0x3f35bf803f350000,0xbf353f80bf350000,0x3e643edebf673f7a,0x3e64bf483f80bf48,0xbf723f20bde5bede,0x3ea93e64bf353f7a
.quad 0x3f48bf7a3f7abf48,0xbf483ede0000bede,0x3de53e64bf083f48,0x3f7ebf673f35bede,0xbf673f48bf203ede,0xbf673f7abf803f7a,0x3f59bf673f72bf7a,0x3f08bf203f35bf48
.quad 0x0,0x0,0xbf593f67bf723f7a,0xbf083f20bf353f48,0x3f67bf483f20bede,0x3f67bf7a3f80bf7a,0xbde5be643f08bf48,0xbf7e3f67bf353ede
.quad 0xbf7a3ede3f48bf48,0xbf48bede3f7a0000,0x3f72bf20bf083f7a,0x3f083f20bf720000,0xbf673f483e64bf7a,0xbe64bf483f670000,0x3f59bf673de53f48,0xbde53f67bf590000
.quad 0xbf483f7abedebede,0x3edebf7a3f480000,0x3f35bf803f350000,0xbf353f80bf350000,0xbf203f7abf673ede,0x3f67bf7a3f200000,0x3f08bf673f7ebf48,0xbf7e3f67bf080000
.quad 0xbede3f48bf7a3f7a,0x3f7abf483ede0000,0x3ea9bf203f59bf7a,0xbf593f20bea90000,0xbe643edebf203f48,0x3f20bede3e640000,0x3de5be643ea9bede,0xbea93e64bde50000
.quad 0x0,0x0,0xbde53e64bea93ede,0x3ea9be643de50000,0x3e64bede3f20bf48,0xbf203edebe640000,0xbea93f20bf593f7a,0x3f59bf203ea90000
.quad 0xbf7a3ede3f48,0x3f48bf48bede3f7a,0xbf353f673de5bf7a,0xbf59be643f7ebede,0x3f80bedebf203f7a,0xbe643f7abf20bede,0xbf35be643f72bf48,0x3f7ebf20bea93f7a
.quad 0x3f48bf7a3ede,0xbedebede3f7abf48,0x3f35bf803f350000,0xbf353f80bf350000,0xbf803f48be64bede,0x3f67bedebe643f48,0x3f35be64bea93f48,0x3de5bf203f72bf7a
.quad 0xbede3f48bf7a,0xbf7a3f7abf483ede,0xbf353f67bf7e3f7a,0x3f08be64bde53ede,0x3f80bf7a3f67bf48,0x3f20bf483f67bf7a,0xbf353f20bf083ede,0xbf723f67bf593f48
.quad 0x0,0x0,0x3f35bf203f08bede,0x3f72bf673f59bf48,0xbf803f7abf673f48,0xbf203f48bf673f7a,0x3f35bf673f7ebf7a,0xbf083e643de5bede
.quad 0xbe643f80be64bf67,0xbf673f203f20bf67,0xbf803ec43f3fbf60,0xbe8ebf513f513e8e,0xbea9bf353f72bde5,0x3f7ebf08bf083f7e,0x3f51bf6d3e2c3f3f,0xbd663f60bf603d66
.quad 0x3f480000bf483f7a,0xbf7a3ede3edebf7a,0xbec43f6dbf6d3ec4,0x3ec4bf6d3f6dbec4,0xbf7e3f35bde5bf08,0x3f59bea9bea93f59,0xbe2cbec43f51bf80,0xbf2b3f76bf763f2b
.quad 0x3f67bf803f67bf20,0xbf203e643e64bf20,0x3f2bbec43d663e8e,0x3f60bf7c3f7cbf60,0xbf083f35bf593f72,0x3ea9bde5bde53ea9,0xbf763f6dbf603f51,0xbf7c3f80bf803f7c
.quad 0x0,0x0,0x3f76bf6d3f60bf51,0x3f7cbf803f80bf7c,0x3f08bf353f59bf72,0xbea93de53de5bea9,0xbf2b3ec4bd66be8e,0xbf603f7cbf7c3f60
.quad 0xbf67be643f80be64,0xbe64bf673f203f20,0x3f60bf3fbec43f80,0x3f2b3ef8bf7c3e2c,0xbde53f72bf35bea9,0xbf723de53f59bf59,0xbf3fbe2c3f6dbf51,0x3f7cbf2bbe8e3f76
.quad 0x3f7abf4800003f48,0xbf483f7abedebede,0xbec43f6dbf6d3ec4,0x3ec4bf6d3f6dbec4,0xbf08bde53f35bf7e,0x3de53f08bf723f72,0x3f80bf513ec43e2c,0xbf143d663ef8bf60
.quad 0xbf203f67bf803f67,0x3f67bf203e643e64,0xbe8ebd663ec4bf2b,0xbf803f76bf513f14,0x3f72bf593f35bf08,0x3f59bf723f7ebf7e,0xbf513f60bf6d3f76,0xbef83f14bf2b3f3f
.quad 0x0,0x0,0x3f51bf603f6dbf76,0x3ef8bf143f2bbf3f,0xbf723f59bf353f08,0xbf593f72bf7e3f7e,0x3e8e3d66bec43f2b,0x3f80bf763f51bf14
.quad 0x3f20bf67be643f80,0x3f80be64bf673f20,0xbf143f76bd66bf6d,0xbf6dbd663f76bf14,0x3f08bf7e3ea93f35,0x3f353ea9bf7e3f08,0xbef83f80bf14bec4,0xbec4bf143f80bef8
.quad 0x3edebf7a3f480000,0x3f48bf7a3ede,0xbec43f6dbf6d3ec4,0x3ec4bf6d3f6dbec4,0x3ea9bf593f7ebf35,0xbf353f7ebf593ea9,0xbe8e3f3fbf7c3f6d,0x3f6dbf7c3f3fbe8e
.quad 0x3e64bf203f67bf80,0xbf803f67bf203e64,0xbe2c3ef8bf3f3f6d,0x3f6dbf3f3ef8be2c,0x3de5bea93f08bf35,0xbf353f08bea93de5,0xbd663e2cbe8e3ec4,0x3ec4be8e3e2cbd66
.quad 0x0,0x0,0x3d66be2c3e8ebec4,0xbec43e8ebe2c3d66,0xbde53ea9bf083f35,0x3f35bf083ea9bde5,0x3e2cbef83f3fbf6d,0xbf6d3f3fbef83e2c
.quad 0x3f203f20bf67be64,0xbe643f80be64bf67,0x3e2cbf7c3ef83f2b,0x3f80bec4bf3f3f60,0xbf593f593de5bf72,0xbea9bf353f72bde5,0x3f76be8ebf2b3f7c,0xbf513f6dbe2cbf3f
.quad 0xbedebede3f7abf48,0x3f480000bf483f7a,0xbec43f6dbf6d3ec4,0x3ec4bf6d3f6dbec4,0x3f72bf723f083de5,0xbf7e3f35bde5bf08,0xbf603ef83d66bf14,0x3e2c3ec4bf513f80
.quad 0x3e643e64bf203f67,0x3f67bf803f67bf20,0x3f14bf513f76bf80,0xbf2b3ec4bd66be8e,0xbf7e3f7ebf723f59,0xbf083f35bf593f72,0x3f3fbf2b3f14bef8,0x3f76bf6d3f60bf51
.quad 0x0,0x0,0xbf3f3f2bbf143ef8,0xbf763f6dbf603f51,0x3f7ebf7e3f72bf59,0x3f08bf353f59bf72,0xbf143f51bf763f80,0x3f2bbec43d663e8e
.quad 0x3f7a0000bf7a3ede,0x3ede3f48bf48bede,0x3d663f6dbf2bbef8,0xbf763f143f14bf76,0xbf723f353ea9bf7e,0xbde5bf593f593de5,0xbf14bec43f7cbf2b,0x3f80bef8bef83f80
.quad 0x3f20bf803f203e64,0xbe643f67bf673e64,0x3f6dbec4bec43f6d,0xbf6d3ec43ec4bf6d,0xbde53f35bf7e3f59,0x3f08bf723f72bf08,0xbf7c3f6dbf143d66,0x3f3fbe8ebe8e3f3f
.quad 0xbede00003edebf48,0xbf483f7abf7a3f48,0x3f3fbf6d3f80bf76,0xbef83e2c3e2cbef8,0x3f59bf353f08bea9,0x3f72bf7e3f7ebf72,0xbe8e3ec4bef83f14,0x3e2cbd66bd663e2c
.quad 0xbf803f80bf803f80,0xbf803f80bf803f80,0xbe8e3ec4bef83f14,0x3e2cbd66bd663e2c,0x3f59bf353f08bea9,0x3f72bf7e3f7ebf72,0x3f3fbf6d3f80bf76,0xbef83e2c3e2cbef8
.quad 0xbede3f7a0000bf7a,0xbf7a3ede3f48bf48,0xbef8bf2b3f6d3d66,0x3f3fbf60be2c3f7c,0x3f7ebea9bf353f72,0xbea93f7ebf08bf08,0xbf2b3f7cbec4bf14,0xbe2cbf3f3f76be8e
.quad 0xbe64bf203f80bf20,0x3f203e64bf673f67,0x3f6dbec4bec43f6d,0xbf6d3ec43ec4bf6d,0xbf593f7ebf353de5,0x3f7ebf593ea93ea9,0x3d66bf143f6dbf7c,0xbf513f80bf603ef8
.quad 0x3f48bede00003ede,0x3edebf483f7abf7a,0xbf763f80bf6d3f3f,0x3d663e8ebf143f51,0x3ea9bf083f35bf59,0xbf083ea9bde5bde5,0x3f14bef83ec4be8e,0x3f60bf513f3fbf2b
.quad 0xbf803f80bf803f80,0xbf803f80bf803f80,0x3f14bef83ec4be8e,0x3f60bf513f3fbf2b,0x3ea9bf083f35bf59,0xbf083ea9bde5bde5,0xbf763f80bf6d3f3f,0x3d663e8ebf143f51
.quad 0xbf48bede3f7a0000,0xbf7a3ede3f48,0x3f513e8ebf803ec4,0xbec43f80be8ebf51,0xbf59bde53f72bf35,0x3f35bf723de53f59,0x3f60bd66bf513f6d,0xbf6d3f513d66bf60
.quad 0xbf673e643f20bf80,0x3f80bf20be643f67,0x3f6dbec4bec43f6d,0xbf6d3ec43ec4bf6d,0xbf723f083de5bf35,0x3f35bde5bf083f72,0x3f76bf2b3e2c3ec4,0xbec4be2c3f2bbf76
.quad 0xbf7a3f48bede0000,0x3edebf483f7a,0x3f7cbf603f2bbec4,0x3ec4bf2b3f60bf7c,0xbf7e3f72bf593f35,0xbf353f59bf723f7e,0x3f80bf7c3f76bf6d,0x3f6dbf763f7cbf80
.quad 0xbf803f80bf803f80,0xbf803f80bf803f80,0x3f80bf7c3f76bf6d,0x3f6dbf763f7cbf80,0xbf7e3f72bf593f35,0xbf353f59bf723f7e,0x3f7cbf603f2bbec4,0x3ec4bf2b3f60bf7c
.quad 0x3f48bf48bede3f7a,0x3f7a0000bf7a3ede,0xbf7c3e2c3f60bf3f,0xbd66bf6d3f2b3ef8,0x3f083f08bf7e3ea9,0xbf723f353ea9bf7e,0x3e8ebf763f3f3e2c,0x3f143ec4bf7c3f2b
.quad 0xbf673f67be64bf20,0x3f20bf803f203e64,0x3f6dbec4bec43f6d,0xbf6d3ec43ec4bf6d,0xbea9bea93f59bf7e,0xbde53f35bf7e3f59,0xbef83f60bf803f51,0x3f7cbf6d3f14bd66
.quad 0x3f7abf7a3f48bede,0xbede00003edebf48,0xbf513f14be8ebd66,0xbf3f3f6dbf803f76,0x3de53de5bea93f08,0x3f59bf353f08bea9,0x3f2bbf3f3f51bf60,0x3e8ebec43ef8bf14
.quad 0xbf803f80bf803f80,0xbf803f80bf803f80,0x3f2bbf3f3f51bf60,0x3e8ebec43ef8bf14,0x3de53de5bea93f08,0x3f59bf353f08bea9,0xbf513f14be8ebd66,0xbf3f3f6dbf803f76
.quad 0xbe643f80be64bf67,0xbf673f203f20bf67,0x3f720000bf723f20,0xbde53f7abf08bf20,0x3edebf803ede3f20,0x3f483e64bf7a3f20,0xbf5900003f59bf67,0x3f72bf48bde53f67
.quad 0xbf203f80bf20be64,0x3e64bf673f67be64,0x3f350000bf353f80,0xbf3500003f35bf80,0x3f48bf803f48be64,0xbf7a3f67bedebe64,0xbf0800003f08bf67,0xbea93f48bf7e3f67
.quad 0xbf673f80bf673f20,0x3f20be64be643f20,0x3ea90000bea93f20,0x3f7ebf7a3f59bf20,0x3f7abf803f7abf67,0x3edebf203f48bf67,0xbde500003de5be64,0xbf083edebea93e64
.quad 0xbf803f80bf803f80,0xbf803f80bf803f80,0xbde500003de5be64,0xbf083edebea93e64,0x3f7abf803f7abf67,0x3edebf203f48bf67,0x3ea90000bea93f20,0x3f7ebf7a3f59bf20
.quad 0xbf67be643f80be64,0xbe64bf673f203f20,0xbf7e3ede3f35bf67,0xbea9bf483f593e64,0xbf483f670000bf67,0xbedebf203f7abe64,0xbea93f7abf35be64,0xbf08bede3f7ebf20
.quad 0x3e643f20bf803f20,0xbf20be643f67bf67,0x3f350000bf353f80,0xbf3500003f35bf80,0x3f7abf2000003f20,0xbf483e643edebf67,0x3f72bf7a3f35be64,0xbf593ede3de5bf20
.quad 0x3f20bf673f80bf67,0xbf673f20be64be64,0x3de5bede3f35bf67,0xbf723f48bf083e64,0xbede3e640000be64,0xbf7a3f67bf483f20,0xbf593f48bf353f20,0xbf7e3f7abf723f67
.quad 0xbf803f80bf803f80,0xbf803f80bf803f80,0xbf593f48bf353f20,0xbf7e3f7abf723f67,0xbede3e640000be64,0xbf7a3f67bf483f20,0x3de5bede3f35bf67,0xbf723f48bf083e64
.quad 0x0,0x0,0x0,0x0,0x0,0x0,0x0,0x0
.quad 0x0,0x0,0x0,0x0,0x0,0x0,0x0,0x0
.quad 0x0,0x0,0x0,0x0,0x0,0x0,0x0,0x0
.quad 0x0,0x0,0x0,0x0,0x0,0x0,0x0,0x0
.quad 0x0,0x0,0x0,0x0,0x0,0x0,0x0,0x0
.quad 0x0,0x0,0x0,0x0,0x0,0x0,0x0,0x0
.quad 0x0,0x0,0x0,0x0,0x0,0x0,0x0,0x0
.quad 0x0,0x0,0x0,0x0,0x0,0x0,0x0,0x0
.quad 0x3f7a0000bf7a3ede,0x3ede3f48bf48bede,0x3ea9bf803ea93f48,0x3f7ebe64bf593f48,0xbf6700003f67bf48,0x3f20bf7a3e643f48,0xbf083f80bf08bede,0xbea9bf203f7ebede
.quad 0x3f480000bf483f7a,0xbf7a3ede3edebf7a,0x3f35bf803f350000,0xbf353f80bf350000,0xbf2000003f20bf7a,0x3e643edebf673f7a,0xbf593f80bf593ede,0x3f72bf203de53ede
.quad 0x3ede0000bede3f48,0x3f48bf7a3f7abf48,0x3f72bf803f72bf48,0xbde5be643f08bf48,0xbe6400003e64bede,0xbf673f48bf203ede,0xbf7e3f80bf7e3f7a,0xbf593f67bf723f7a
.quad 0x0,0x0,0x3f7ebf803f7ebf7a,0x3f59bf673f72bf7a,0x3e640000be643ede,0x3f67bf483f20bede,0xbf723f80bf723f48,0x3de53e64bf083f48
.quad 0xbede3f7a0000bf7a,0xbf7a3ede3f48bf48,0x3de53f67bf35bede,0xbf723f203f08bf7a,0x3f203edebf803ede,0xbf673f483e64bf7a,0x3f72be64bf353f7a,0xbf593f67bde5bf48
.quad 0x3f7abf4800003f48,0xbf483f7abedebede,0x3f35bf803f350000,0xbf353f80bf350000,0x3e64bf483f80bf48,0xbf203f7abf673ede,0xbea9be643f35bf7a,0xbf083f67bf7e3f48
.quad 0xbf483ede0000bede,0xbede3f48bf7a3f7a,0xbf7e3f67bf353ede,0xbea93f20bf593f7a,0xbf673f7abf803f7a,0xbe643edebf203f48,0xbf083f20bf353f48,0xbde53e64bea93ede
.quad 0x0,0x0,0x3f08bf203f35bf48,0x3de5be643ea9bede,0x3f67bf7a3f80bf7a,0x3e64bede3f20bf48,0x3f7ebf673f35bede,0x3ea9bf203f59bf7a
.quad 0x0,0x0,0x0,0x0,0x0,0x0,0x0,0x0
.quad 0x0,0x0,0x0,0x0,0x0,0x0,0x0,0x0
.quad 0x0,0x0,0x0,0x0,0x0,0x0,0x0,0x0
.quad 0x0,0x0,0x0,0x0,0x0,0x0,0x0,0x0
.quad 0x0,0x0,0x0,0x0,0x0,0x0,0x0,0x0
.quad 0x0,0x0,0x0,0x0,0x0,0x0,0x0,0x0
.quad 0x0,0x0,0x0,0x0,0x0,0x0,0x0,0x0
.quad 0x0,0x0,0x0,0x0,0x0,0x0,0x0,0x0
.quad 0xbf673f203f20bf67,0xbf67be643f80be64,0x3e8e3f51bf51be8e,0xbf603f3f3ec4bf80,0x3f7ebf08bf083f7e,0xbde53f72bf35bea9,0x3d66bf603f60bd66,0x3f3f3e2cbf6d3f51
.quad 0xbf7a3ede3edebf7a,0x3f7abf4800003f48,0xbec43f6dbf6d3ec4,0x3ec4bf6d3f6dbec4,0x3f59bea9bea93f59,0xbf08bde53f35bf7e,0x3f2bbf763f76bf2b,0xbf803f51bec4be2c
.quad 0xbf203e643e64bf20,0xbf203f67bf803f67,0xbf603f7cbf7c3f60,0x3e8e3d66bec43f2b,0x3ea9bde5bde53ea9,0x3f72bf593f35bf08,0x3f7cbf803f80bf7c,0x3f51bf603f6dbf76
.quad 0x0,0x0,0xbf7c3f80bf803f7c,0xbf513f60bf6d3f76,0xbea93de53de5bea9,0xbf723f59bf353f08,0x3f60bf7c3f7cbf60,0xbe8ebd663ec4bf2b
.quad 0xbe64bf673f203f20,0x3f20bf67be643f80,0xbf2bbef83f7cbe2c,0x3f14bf763d663f6d,0xbf723de53f59bf59,0x3f08bf7e3ea93f35,0xbf7c3f2b3e8ebf76,0x3ef8bf803f143ec4
.quad 0xbf483f7abedebede,0x3edebf7a3f480000,0xbec43f6dbf6d3ec4,0x3ec4bf6d3f6dbec4,0x3de53f08bf723f72,0x3ea9bf593f7ebf35,0x3f14bd66bef83f60,0x3e8ebf3f3f7cbf6d
.quad 0x3f67bf203e643e64,0x3e64bf203f67bf80,0x3f80bf763f51bf14,0x3e2cbef83f3fbf6d,0x3f59bf723f7ebf7e,0x3de5bea93f08bf35,0x3ef8bf143f2bbf3f,0x3d66be2c3e8ebec4
.quad 0x0,0x0,0xbef83f14bf2b3f3f,0xbd663e2cbe8e3ec4,0xbf593f72bf7e3f7e,0xbde53ea9bf083f35,0xbf803f76bf513f14,0xbe2c3ef8bf3f3f6d
.quad 0x0,0x0,0x0,0x0,0x0,0x0,0x0,0x0
.quad 0x0,0x0,0x0,0x0,0x0,0x0,0x0,0x0
.quad 0x0,0x0,0x0,0x0,0x0,0x0,0x0,0x0
.quad 0x0,0x0,0x0,0x0,0x0,0x0,0x0,0x0
.quad 0x0,0x0,0x0,0x0,0x0,0x0,0x0,0x0
.quad 0x0,0x0,0x0,0x0,0x0,0x0,0x0,0x0
.quad 0x0,0x0,0x0,0x0,0x0,0x0,0x0,0x0
.quad 0x0,0x0,0x0,0x0,0x0,0x0,0x0,0x0
.quad 0x3ede3f48bf48bede,0xbede3f7a0000bf7a,0x3f76bf14bf143f76,0x3ef83f2bbf6dbd66,0xbde5bf593f593de5,0x3f7ebea9bf353f72,0xbf803ef83ef8bf80,0x3f2bbf7c3ec43f14
.quad 0xbe643f67bf673e64,0xbe64bf203f80bf20,0x3f6dbec4bec43f6d,0xbf6d3ec43ec4bf6d,0x3f08bf723f72bf08,0xbf593f7ebf353de5,0xbf3f3e8e3e8ebf3f,0xbd663f14bf6d3f7c
.quad 0xbf483f7abf7a3f48,0x3f48bede00003ede,0x3ef8be2cbe2c3ef8,0x3f76bf803f6dbf3f,0x3f72bf7e3f7ebf72,0x3ea9bf083f35bf59,0xbe2c3d663d66be2c,0xbf143ef8bec43e8e
.quad 0xbf803f80bf803f80,0xbf803f80bf803f80,0xbe2c3d663d66be2c,0xbf143ef8bec43e8e,0x3f72bf7e3f7ebf72,0x3ea9bf083f35bf59,0x3ef8be2cbe2c3ef8,0x3f76bf803f6dbf3f
.quad 0xbf7a3ede3f48bf48,0xbf48bede3f7a0000,0xbf3f3f603e2cbf7c,0xbf51be8e3f80bec4,0xbea93f7ebf08bf08,0xbf59bde53f72bf35,0x3e2c3f3fbf763e8e,0xbf603d663f51bf6d
.quad 0x3f203e64bf673f67,0xbf673e643f20bf80,0x3f6dbec4bec43f6d,0xbf6d3ec43ec4bf6d,0x3f7ebf593ea93ea9,0xbf723f083de5bf35,0x3f51bf803f60bef8,0xbf763f2bbe2cbec4
.quad 0x3edebf483f7abf7a,0xbf7a3f48bede0000,0xbd66be8e3f14bf51,0xbf7c3f60bf2b3ec4,0xbf083ea9bde5bde5,0xbf7e3f72bf593f35,0xbf603f51bf3f3f2b,0xbf803f7cbf763f6d
.quad 0xbf803f80bf803f80,0xbf803f80bf803f80,0xbf603f51bf3f3f2b,0xbf803f7cbf763f6d,0xbf083ea9bde5bde5,0xbf7e3f72bf593f35,0xbd66be8e3f14bf51,0xbf7c3f60bf2b3ec4
.quad 0x0,0x0,0x0,0x0,0x0,0x0,0x0,0x0
.quad 0x0,0x0,0x0,0x0,0x0,0x0,0x0,0x0
.quad 0x0,0x0,0x0,0x0,0x0,0x0,0x0,0x0
.quad 0x0,0x0,0x0,0x0,0x0,0x0,0x0,0x0
.quad 0x0,0x0,0x0,0x0,0x0,0x0,0x0,0x0
.quad 0x0,0x0,0x0,0x0,0x0,0x0,0x0,0x0
.quad 0x0,0x0,0x0,0x0,0x0,0x0,0x0,0x0
.quad 0x0,0x0,0x0,0x0,0x0,0x0,0x0,0x0
.quad 0x3f3fbf59be8e3f80,0x3f6d3de5bf7c3ede,0x3f6dbf35bec43f80,0x3ec43f35bf6d0000,0x3f80bf08bef83f80,0xbec43f7ebf14bede,0x3f76bea9bf143f80,0xbf6d3f59bd66bf48
.quad 0x3f51bde5bf2b3f80,0xbf6d3ea93ef8bf7a,0x3f143de5bf3f3f80,0xbec4bea93f60bf7a,0x3e8e3ea9bf513f80,0x3ec4bf593f80bf48,0xbd663f08bf603f80,0x3f6dbf7e3f51bede
.quad 0xbec43f35bf6d3f80,0x3f6dbf353ec40000,0xbf2b3f59bf763f80,0x3ec4bde5be2c3ede,0xbf603f72bf7c3f80,0xbec43f08bf2b3f48,0xbf7c3f7ebf803f80,0xbf6d3f72bf763f7a
.quad 0xbf7c3f7ebf803f80,0xbf6d3f72bf763f7a,0xbf603f72bf7c3f80,0xbec43f08bf2b3f48,0xbf2b3f59bf763f80,0x3ec4bde5be2c3ede,0xbec43f35bf6d3f80,0x3f6dbf353ec40000
.quad 0x3d663f72bf14bf20,0xbf603f353ef8bf7a,0xbf6d3f353ec4bf80,0xbec4bf353f6d0000,0xbf2bbea93f7cbf20,0x3f76bf35be8e3f7a,0x3ef8bf7e3f2b3e64,0x3e2c3f35bf7c3ede
.quad 0x3f7cbf08be8e3f67,0xbf803f353d66bf48,0x3e2c3f08bf763f67,0x3d66bf353f80bf48,0xbf603f7ebf3f3e64,0x3f7cbf353e2c3ede,0xbf3f3ea93e2cbf20,0xbe8e3f35bf763f7a
.quad 0x3ec4bf353f6dbf80,0xbf6d3f35bec40000,0x3f80bf723f51bf20,0x3ef8bf353f60bf7a,0x3e8ebde5bd663e64,0x3f51bf353f14bede,0xbf513f59bf603f67,0xbf2b3f35bf3f3f48
.quad 0xbf513f59bf603f67,0xbf2b3f35bf3f3f48,0x3e8ebde5bd663e64,0x3f51bf353f14bede,0x3f80bf723f51bf20,0x3ef8bf353f60bf7a,0x3ec4bf353f6dbf80,0xbf6d3f35bec40000
.quad 0xbf51bea93f80be64,0x3e2cbf7e3ec43f48,0x3f6dbf35bec43f80,0x3ec43f35bf6d0000,0xbe2c3f72bf3fbe64,0xbf51bde53f6dbf48,0xbf3fbde53f60bf67,0x3f80bf08bec43f7a
.quad 0x3f76bf593e2c3f20,0xbf603f72bec4bede,0xbe8e3f59bf7c3f20,0x3ef8bf723f6dbede,0xbf2b3de53ef8bf67,0x3d663f08bf6d3f7a,0x3f7cbf723f2bbe64,0xbf143de53ec4bf48
.quad 0xbec43f35bf6d3f80,0x3f6dbf353ec40000,0xbf143ea9bd66be64,0xbf7c3f7ebf6d3f48,0x3f80bf7e3f76bf67,0x3f3fbf593f6dbf7a,0xbef83f08bf143f20,0xbe8e3ea9bec43ede
.quad 0xbef83f08bf143f20,0xbe8e3ea9bec43ede,0x3f80bf7e3f76bf67,0x3f3fbf593f6dbf7a,0xbf143ea9bd66be64,0xbf7c3f7ebf6d3f48,0xbec43f35bf6d3f80,0x3f6dbf353ec40000
.quad 0x3f76bf08bf2b3f67,0x3f2b3f08bf760000,0xbf6d3f353ec4bf80,0xbec4bf353f6d0000,0x3f60bf59bd663f67,0x3d663f59bf600000,0xbf513f72be8ebf20,0x3e8ebf723f510000
.quad 0x3f3fbf7e3f143e64,0xbf143f7ebf3f0000,0xbf2b3f7ebf513e64,0x3f51bf7e3f2b0000,0x3f14bf723f76bf20,0xbf763f72bf140000,0xbef83f59bf803f67,0x3f80bf593ef80000
.quad 0x3ec4bf353f6dbf80,0xbf6d3f35bec40000,0xbe8e3f08bf3f3f67,0x3f3fbf083e8e0000,0x3e2cbea93ef8bf20,0xbef83ea9be2c0000,0xbd663de5be2c3e64,0x3e2cbde53d660000
.quad 0xbd663de5be2c3e64,0x3e2cbde53d660000,0x3e2cbea93ef8bf20,0xbef83ea9be2c0000,0xbe8e3f08bf3f3f67,0x3f3fbf083e8e0000,0x3ec4bf353f6dbf80,0xbf6d3f35bec40000
.quad 0xbf2bbf083f760000,0x3ec4bf7e3e2c3f67,0xbec4bf353f6d0000,0x3f6dbf35bec43f80,0xbd66bf593f600000,0x3f6dbde5bf513f67,0x3e8ebf723f510000,0x3ec43f08bf803f20
.quad 0x3f14bf7e3f3f0000,0xbec43f72bf603e64,0x3f51bf7e3f2b0000,0xbf6d3f72bef8be64,0x3f76bf723f140000,0xbf6d3f083d66bf20,0x3f80bf593ef80000,0xbec4bde53f14bf67
.quad 0x3f6dbf353ec40000,0x3ec4bf353f6dbf80,0x3f3fbf083e8e0000,0x3f6dbf7e3f7cbf67,0x3ef8bea93e2c0000,0x3f6dbf593f3fbf20,0x3e2cbde53d660000,0x3ec4bea93e8ebe64
.quad 0xbe2c3de5bd660000,0xbec43ea9be8e3e64,0xbef83ea9be2c0000,0xbf6d3f59bf3f3f20,0xbf3f3f08be8e0000,0xbf6d3f7ebf7c3f67,0xbf6d3f35bec40000,0xbec43f35bf6d3f80
.quad 0x3f80bea9bf513f48,0x3ef83f35bf60be64,0x3ec43f35bf6d0000,0xbf6d3f353ec4bf80,0xbf3f3f72be2cbf48,0xbe8ebf353f76be64,0xbf603de53f3fbf7a,0x3f7cbf35be2c3f67
.quad 0x3e2cbf593f76bede,0x3d663f35bf803f20,0x3f7cbf593e8e3ede,0xbf803f35bd66bf20,0x3ef83de5bf2b3f7a,0x3e2cbf353f7cbf67,0xbf2b3f72bf7c3f48,0x3f76bf353e8e3e64
.quad 0xbf6d3f35bec40000,0xbec43f35bf6d3f80,0x3d66bea93f14bf48,0xbf603f35bef83e64,0x3f76bf7e3f80bf7a,0x3f14bf353f51bf67,0x3f14bf083ef8bede,0x3f3fbf353f2bbf20
.quad 0xbf143f08bef83ede,0xbf3f3f35bf2b3f20,0xbf763f7ebf803f7a,0xbf143f35bf513f67,0xbd663ea9bf143f48,0x3f60bf353ef8be64,0x3f6dbf353ec40000,0x3ec4bf353f6dbf80
.quad 0xbf143f723d66bf7a,0xbf7c3de53f6dbf20,0xbec4bf353f6d0000,0x3f6dbf35bec43f80,0x3f7cbea9bf2b3f7a,0xbf143f7ebec4bf20,0xbf2b3f7ebef8bede,0x3d66bf593f6dbe64
.quad 0xbe8ebf083f7cbf48,0x3ef83ea9bf6d3f67,0x3f76bf08be2c3f48,0xbf603ea93ec4bf67,0xbf3f3f7ebf603ede,0x3f80bf593ec43e64,0xbe2cbea93f3fbf7a,0xbf513f7ebf6d3f20
.quad 0x3f6dbf353ec40000,0x3ec4bf353f6dbf80,0xbf513f72bf803f7a,0x3e2c3de5bec43f20,0xbd66bde53e8ebede,0xbf2b3f08bec43e64,0x3f60bf593f51bf48,0x3f76bf723f6dbf67
.quad 0xbf603f59bf513f48,0xbf763f72bf6d3f67,0x3d663de5be8e3ede,0x3f2bbf083ec4be64,0x3f51bf723f80bf7a,0xbe2cbde53ec4bf20,0xbf6d3f35bec40000,0xbec43f35bf6d3f80
.quad 0xbe8ebf593f3f3ede,0x3f3fbf59be8e3f80,0x3ec43f35bf6d0000,0xbf6d3f353ec4bf80,0xbef8bf083f80bede,0x3f80bf08bef83f80,0x3f143ea9bf763f48,0xbf763ea93f14bf80
.quad 0xbf2bbde53f51bf7a,0x3f51bde5bf2b3f80,0x3f3fbde5bf143f7a,0xbf14bde53f3fbf80,0xbf513ea93e8ebf48,0x3e8e3ea9bf513f80,0x3f60bf083d663ede,0x3d66bf083f60bf80
.quad 0xbf6d3f35bec40000,0xbec43f35bf6d3f80,0x3f76bf593f2bbede,0x3f2bbf593f76bf80,0xbf7c3f72bf603f48,0xbf603f72bf7c3f80,0x3f80bf7e3f7cbf7a,0x3f7cbf7e3f80bf80
.quad 0xbf803f7ebf7c3f7a,0xbf7c3f7ebf803f80,0x3f7cbf723f60bf48,0x3f60bf723f7cbf80,0xbf763f59bf2b3ede,0xbf2b3f59bf763f80,0x3f6dbf353ec40000,0x3ec4bf353f6dbf80
.quad 0x3f7bbdacbf6f3f1a,0x3e803f5cbf3abeeb,0x3f553e48bf7b3f0e,0xbf0e3f7bbe48bf55,0x3f0e3eebbf803f02,0xbf7d3f1a3ed1bf7f,0x3e483f30bf7d3eeb,0xbf44bdac3f5cbf6a
.quad 0xbe483f5cbf743ed1,0xbce6bf3a3f7fbf1a,0xbf0e3f78bf633eb7,0x3f3abf803f44be0f,0xbf553f80bf4d3e9b,0x3f7fbf443e803eb7,0xbf7b3f74bf303e80,0x3f1abe0fbeb73f44
.quad 0xbf7b3f55bf0e3e48,0xbe483f0ebf553f7b,0xbf553f25bed13e0f,0xbf5c3f78bf803f74,0xbf0e3ed1be803dac,0xbf743f63bf4d3f30,0xbe483e0fbdac3ce6,0xbed13eb7be9b3e80
.quad 0x3e48be0f3dacbce6,0x3ed1beb73e9bbe80,0x3f0ebed13e80bdac,0x3f74bf633f4dbf30,0x3f55bf253ed1be0f,0x3f5cbf783f80bf74,0x3f7bbf553f0ebe48,0x3e48bf0e3f55bf7b
.quad 0xbf443f553e9bbf80,0xbf6abe0f3f7dbed1,0xbf55be483f7bbf0e,0x3f0ebf7b3e483f55,0x3e9bbf7b3f253eb7,0x3f3a3e80bf783f30,0x3f80bf0ebeb73f78,0xbf4d3f74be9bbf1a
.quad 0x3e803f0ebf7d3f44,0xbeebbeb73f6fbf63,0xbf5c3f7bbf1abdac,0x3f74bf6a3ed13e9b,0xbf3a3e483ed1bf5c,0x3e0f3eebbf633f7d,0x3eebbf553f7fbf6a,0xbf803f5cbf023ce6
.quad 0x3f7bbf553f0ebe48,0x3e48bf0e3f55bf7b,0x3dac3e48beeb3f30,0x3f6fbf4d3f1abeb7,0xbf6f3f7bbf803f7d,0xbf023f25bf443f5c,0xbf1a3f0ebf023eeb,0xbf443f3abf303f25
.quad 0x3f1abf0e3f02beeb,0x3f44bf3a3f30bf25,0x3f6fbf7b3f80bf7d,0x3f02bf253f44bf5c,0xbdacbe483eebbf30,0xbf6f3f4dbf1a3eb7,0xbf7b3f55bf0e3e48,0xbe483f0ebf553f7b
.quad 0xbce6bf743f0e3f25,0x3f63bf30bf023f78,0x3f553e48bf7b3f0e,0xbf0e3f7bbe48bf55,0xbf6f3f443e48bf74,0x3dacbf6a3f4d3e0f,0x3e80bf6f3f55bce6,0x3ed13f02bf7f3f25
.quad 0x3f253e0fbf553f78,0xbf4d3dac3f30bf80,0xbf7f3f4dbe48bf02,0x3f7dbf25bce63f30,0x3f02bf6a3f7bbf30,0xbf6f3f78bf253dac,0x3ed13dacbf0e3f63,0x3f25bf6f3f7dbf4d
.quad 0xbf7b3f55bf0e3e48,0xbe483f0ebf553f7b,0x3f3abf633f7bbf7f,0xbe9b3ce63e80bf02,0x3e0f3ce6be483eb7,0x3f3abf1a3eebbe9b,0xbf633f5cbf553f4d,0xbf783f74bf6f3f6a
.quad 0x3f63bf5c3f55bf4d,0x3f78bf743f6fbf6a,0xbe0fbce63e48beb7,0xbf3a3f1abeeb3e9b,0xbf3a3f63bf7b3f7f,0x3e9bbce6be803f02,0x3f7bbf553f0ebe48,0x3e48bf0e3f55bf7b
.quad 0x3f4d3eb7bf7f3e48,0xbe483f7fbeb7bf4d,0xbf55be483f7bbf0e,0x3f0ebf7b3e483f55,0x3f5c3ce6bf633f55,0xbf553f63bce6bf5c,0xbf633e0f3f3abf7b,0x3f7bbf3abe0f3f63
.quad 0x3f6abe9bbf023f7b,0xbf7b3f023e9bbf6a,0xbf6f3eeb3e80bf55,0x3f55be80beeb3f6f,0x3f74bf1a3ce63f0e,0xbf0ebce63f1abf74,0xbf783f3abe9bbe48,0x3e483e9bbf3a3f78
.quad 0x3f7bbf553f0ebe48,0x3e48bf0e3f55bf7b,0xbf7d3f6abf443f0e,0xbf0e3f44bf6a3f7d,0x3f7fbf783f6abf55,0x3f55bf6a3f78bf7f,0xbf803f7fbf7d3f7b,0xbf7b3f7dbf7f3f80
.quad 0x3f80bf7f3f7dbf7b,0x3f7bbf7d3f7fbf80,0xbf7f3f78bf6a3f55,0xbf553f6abf783f7f,0x3f7dbf6a3f44bf0e,0x3f0ebf443f6abf7d,0xbf7b3f55bf0e3e48,0xbe483f0ebf553f7b
.quad 0x3e48bf7f3eb73f4d,0x3f78bf02bf303f63,0x3f0ebf7b3e483f55,0x3f553e48bf7b3f0e,0x3f55bf633ce63f5c,0x3e0f3f4dbf6a3dac,0x3f7bbf3abe0f3f63,0xbf253f7fbf02bed1
.quad 0x3f7bbf02be9b3f6a,0xbf803f303dacbf4d,0x3f55be80beeb3f6f,0xbf303ce63f25bf7d,0x3f0e3ce6bf1a3f74,0x3dacbf253f78bf6f,0x3e483e9bbf3a3f78,0x3f4dbf7d3f6fbf25
.quad 0xbe483f0ebf553f7b,0x3f7bbf553f0ebe48,0xbf0e3f44bf6a3f7d,0x3f02be80bce63e9b,0xbf553f6abf783f7f,0xbe9b3eebbf1a3f3a,0xbf7b3f7dbf7f3f80,0xbf6a3f6fbf743f78
.quad 0xbf7b3f7dbf7f3f80,0xbf6a3f6fbf743f78,0xbf553f6abf783f7f,0xbe9b3eebbf1a3f3a,0xbf0e3f44bf6a3f7d,0x3f02be80bce63e9b,0xbe483f0ebf553f7b,0x3f7bbf553f0ebe48
.quad 0x3f253f0ebf74bce6,0xbed13f7dbe0fbf6a,0xbf0e3f7bbe48bf55,0xbf55be483f7bbf0e,0xbf743e483f44bf6f,0x3f30bf783e803f3a,0x3ce6bf553f6fbe80,0x3f1a3e9bbf743f4d
.quad 0x3f78bf553e0f3f25,0xbf633f6fbeb7beeb,0x3f023e48bf4d3f7f,0xbe9bbed13f6abf74,0xbf303f7bbf6a3f02,0x3f7dbf633eeb3e0f,0xbf633f0ebdacbed1,0xbce63f02bf5c3f80
.quad 0x3e48bf0e3f55bf7b,0xbf7b3f55bf0e3e48,0x3f7fbf7b3f63bf3a,0x3eb7bf1a3f4dbf6f,0x3eb7be483ce63e0f,0x3f5cbf443f25bf02,0xbf4d3f55bf5c3f63,0xbf253f30bf3a3f44
.quad 0xbf4d3f55bf5c3f63,0xbf253f30bf3a3f44,0x3eb7be483ce63e0f,0x3f5cbf443f25bf02,0x3f7fbf7b3f63bf3a,0x3eb7bf1a3f4dbf6f,0x3e48bf0e3f55bf7b,0xbf7b3f55bf0e3e48
.quad 0xbf803e9b3f55bf44,0xbeebbf3a3f5c3e80,0x3f0ebf7b3e483f55,0x3f553e48bf7b3f0e,0x3eb73f25bf7b3e9b,0xbf7f3ed13f1abf7d,0xbf783eb73f0ebf80,0x3f6abf5c3dac3f44
.quad 0x3f44bf7d3f0e3e80,0xbf1a3f7fbf3abce6,0x3dac3f1abf7b3f5c,0x3e0fbf443f80bf3a,0xbf5c3ed13e48bf3a,0x3eb73e80bf443f7f,0x3f6abf7f3f55beeb,0xbf443eb73e0fbf1a
.quad 0xbe483f0ebf553f7b,0x3f7bbf553f0ebe48,0xbf303eebbe48bdac,0xbf743f80bf783f5c,0x3f7dbf803f7bbf6f,0x3f30bf4d3f63bf74,0xbeeb3f02bf0e3f1a,0xbe803e9bbeb73ed1
.quad 0xbeeb3f02bf0e3f1a,0xbe803e9bbeb73ed1,0x3f7dbf803f7bbf6f,0x3f30bf4d3f63bf74,0xbf303eebbe48bdac,0xbf743f80bf783f5c,0xbe483f0ebf553f7b,0x3f7bbf553f0ebe48
.quad 0x3f1abf6fbdac3f7b,0x3f7bbdacbf6f3f1a,0xbf0e3f7bbe48bf55,0xbf55be483f7bbf0e,0x3f02bf803eeb3f0e,0x3f0e3eebbf803f02,0xbeeb3f7dbf30be48,0xbe48bf303f7dbeeb
.quad 0x3ed1bf743f5cbe48,0xbe483f5cbf743ed1,0xbeb73f63bf783f0e,0x3f0ebf783f63beb7,0x3e9bbf4d3f80bf55,0xbf553f80bf4d3e9b,0xbe803f30bf743f7b,0x3f7bbf743f30be80
.quad 0x3e48bf0e3f55bf7b,0xbf7b3f55bf0e3e48,0xbe0f3ed1bf253f55,0x3f55bf253ed1be0f,0x3dacbe803ed1bf0e,0xbf0e3ed1be803dac,0xbce63dacbe0f3e48,0x3e48be0f3dacbce6
.quad 0xbce63dacbe0f3e48,0x3e48be0f3dacbce6,0x3dacbe803ed1bf0e,0xbf0e3ed1be803dac,0xbe0f3ed1bf253f55,0x3f55bf253ed1be0f,0x3e48bf0e3f55bf7b,0xbf7b3f55bf0e3e48
.quad 0xbec43f7ebe2cbf67,0xbf803ea93f51bf48,0x3f6dbf35bec43f80,0x3ec43f35bf6d0000,0xbf6d3de53f51bf67,0x3f3fbf723e2c3f48,0x3ec43f08bf803f20,0xbf603de53f3fbf7a
.quad 0x3ec4bf723f60be64,0xbe2c3f59bf763ede,0xbf6d3f72bef8be64,0x3f7cbf593e8e3ede,0x3f6dbf08bd663f20,0xbef8bde53f2bbf7a,0xbec4bde53f14bf67,0xbf2b3f72bf7c3f48
.quad 0xbec43f35bf6d3f80,0x3f6dbf353ec40000,0x3f6dbf7e3f7cbf67,0x3d66bea93f14bf48,0xbf6d3f59bf3f3f20,0xbf763f7ebf803f7a,0x3ec4bea93e8ebe64,0x3f14bf083ef8bede
.quad 0x3ec4bea93e8ebe64,0x3f14bf083ef8bede,0xbf6d3f59bf3f3f20,0xbf763f7ebf803f7a,0x3f6dbf7e3f7cbf67,0x3d66bea93f14bf48,0xbec43f35bf6d3f80,0x3f6dbf353ec40000
.quad 0xbef8bf353f603e64,0x3f14bf72bd663f7a,0xbf6d3f353ec4bf80,0xbec4bf353f6d0000,0x3e8e3f35bf763e64,0xbf7c3ea93f2bbf7a,0x3f7cbf35be2c3f67,0xbf2b3f7ebef8bede
.quad 0xbd66bf353f80bf20,0x3e8e3f08bf7c3f48,0xbf803f35bd66bf20,0x3f76bf08be2c3f48,0xbe2c3f35bf7c3f67,0x3f3fbf7e3f60bede,0x3f76bf353e8e3e64,0xbe2cbea93f3fbf7a
.quad 0x3ec4bf353f6dbf80,0xbf6d3f35bec40000,0xbf603f35bef83e64,0xbf513f72bf803f7a,0xbf143f35bf513f67,0x3d663de5be8e3ede,0x3f3fbf353f2bbf20,0x3f60bf593f51bf48
.quad 0x3f3fbf353f2bbf20,0x3f60bf593f51bf48,0xbf143f35bf513f67,0x3d663de5be8e3ede,0xbf603f35bef83e64,0xbf513f72bf803f7a,0x3ec4bf353f6dbf80,0xbf6d3f35bec40000
.quad 0x3f7cbde5bf6d3f20,0x3e8e3f59bf3fbede,0x3f6dbf35bec43f80,0x3ec43f35bf6d0000,0x3f14bf7e3ec43f20,0x3ef83f08bf803ede,0x3d66bf593f6dbe64,0x3f143ea9bf763f48
.quad 0xbef8bea93f6dbf67,0x3f2b3de5bf513f7a,0xbf603ea93ec4bf67,0x3f3fbde5bf143f7a,0xbf803f59bec4be64,0x3f51bea9be8e3f48,0xbf513f7ebf6d3f20,0x3f60bf083d663ede
.quad 0xbec43f35bf6d3f80,0x3f6dbf353ec40000,0x3e2c3de5bec43f20,0x3f76bf593f2bbede,0x3f2bbf083ec4be64,0x3f7cbf723f60bf48,0x3f76bf723f6dbf67,0x3f80bf7e3f7cbf7a
.quad 0x3f76bf723f6dbf67,0x3f80bf7e3f7cbf7a,0x3f2bbf083ec4be64,0x3f7cbf723f60bf48,0x3e2c3de5bec43f20,0x3f76bf593f2bbede,0xbec43f35bf6d3f80,0x3f6dbf353ec40000
.quad 0xbf3f3f593e8ebf80,0xbf6dbde53f7cbede,0xbf6d3f353ec4bf80,0xbec4bf353f6d0000,0xbf803f083ef8bf80,0x3ec4bf7e3f143ede,0xbf763ea93f14bf80,0x3f6dbf593d663f48
.quad 0xbf513de53f2bbf80,0x3f6dbea9bef83f7a,0xbf14bde53f3fbf80,0x3ec43ea9bf603f7a,0xbe8ebea93f51bf80,0xbec43f59bf803f48,0x3d66bf083f60bf80,0xbf6d3f7ebf513ede
.quad 0x3ec4bf353f6dbf80,0xbf6d3f35bec40000,0x3f2bbf593f76bf80,0xbec43de53e2cbede,0x3f60bf723f7cbf80,0x3ec4bf083f2bbf48,0x3f7cbf7e3f80bf80,0x3f6dbf723f76bf7a
.quad 0x3f7cbf7e3f80bf80,0x3f6dbf723f76bf7a,0x3f60bf723f7cbf80,0x3ec4bf083f2bbf48,0x3f2bbf593f76bf80,0xbec43de53e2cbede,0x3ec4bf353f6dbf80,0xbf6d3f35bec40000
.quad 0x3f6d3de5bf7c3ede,0x3d663f72bf14bf20,0xbec4bf353f6d0000,0x3f6dbf35bec43f80,0xbec43f7ebf14bede,0xbf2bbea93f7cbf20,0x3f6dbf593d663f48,0xbef83f7ebf2bbe64
.quad 0xbf6d3ea93ef8bf7a,0x3f7cbf08be8e3f67,0x3ec43ea9bf603f7a,0xbe2cbf083f76bf67,0x3ec4bf593f80bf48,0xbf603f7ebf3f3e64,0xbf6d3f7ebf513ede,0x3f3fbea9be2c3f20
.quad 0x3f6dbf353ec40000,0x3ec4bf353f6dbf80,0xbec43de53e2cbede,0xbf803f72bf513f20,0xbec43f08bf2b3f48,0x3e8ebde5bd663e64,0x3f6dbf723f76bf7a,0x3f51bf593f60bf67
.quad 0xbf6d3f72bf763f7a,0xbf513f59bf603f67,0x3ec4bf083f2bbf48,0xbe8e3de53d66be64,0x3ec4bde5be2c3ede,0x3f80bf723f51bf20,0xbf6d3f35bec40000,0xbec43f35bf6d3f80
.quad 0xbf603f353ef8bf7a,0xbf51bea93f80be64,0x3ec43f35bf6d0000,0xbf6d3f353ec4bf80,0x3f76bf35be8e3f7a,0xbe2c3f72bf3fbe64,0xbe2cbf353f7cbede,0x3f3f3de5bf603f67
.quad 0xbf803f353d66bf48,0x3f76bf593e2c3f20,0xbd663f35bf803f48,0x3e8ebf593f7cbf20,0x3f7cbf353e2c3ede,0xbf2b3de53ef8bf67,0x3e8ebf353f76bf7a,0xbf7c3f72bf2b3e64
.quad 0xbf6d3f35bec40000,0xbec43f35bf6d3f80,0xbef83f35bf603f7a,0x3f14bea93d663e64,0x3f51bf353f14bede,0x3f80bf7e3f76bf67,0x3f2bbf353f3fbf48,0x3ef8bf083f14bf20
.quad 0xbf2b3f35bf3f3f48,0xbef83f08bf143f20,0xbf513f35bf143ede,0xbf803f7ebf763f67,0x3ef8bf353f60bf7a,0xbf143ea9bd66be64,0x3f6dbf353ec40000,0x3ec4bf353f6dbf80
.quad 0x3e2cbf7e3ec43f48,0x3f76bf08bf2b3f67,0xbec4bf353f6d0000,0x3f6dbf35bec43f80,0xbf51bde53f6dbf48,0x3f60bf59bd663f67,0xbf803f083ec4bf7a,0x3f51bf723e8e3f20
.quad 0xbf603f72bec4bede,0x3f3fbf7e3f143e64,0xbef83f72bf6d3ede,0x3f2bbf7e3f51be64,0x3d663f08bf6d3f7a,0x3f14bf723f76bf20,0x3f14bde5bec43f48,0x3ef8bf593f80bf67
.quad 0x3f6dbf353ec40000,0x3ec4bf353f6dbf80,0x3f7cbf7e3f6dbf48,0x3e8ebf083f3fbf67,0x3f3fbf593f6dbf7a,0x3e2cbea93ef8bf20,0x3e8ebea93ec4bede,0x3d66bde53e2cbe64
.quad 0xbe8e3ea9bec43ede,0xbd663de5be2c3e64,0xbf3f3f59bf6d3f7a,0xbe2c3ea9bef83f20,0xbf7c3f7ebf6d3f48,0xbe8e3f08bf3f3f67,0xbf6d3f35bec40000,0xbec43f35bf6d3f80
.quad 0x3f2b3f08bf760000,0xbec43f7ebe2cbf67,0x3ec43f35bf6d0000,0xbf6d3f353ec4bf80,0x3d663f59bf600000,0xbf6d3de53f51bf67,0xbe8e3f72bf510000,0xbec4bf083f80bf20
.quad 0xbf143f7ebf3f0000,0x3ec4bf723f60be64,0xbf513f7ebf2b0000,0x3f6dbf723ef83e64,0xbf763f72bf140000,0x3f6dbf08bd663f20,0xbf803f59bef80000,0x3ec43de5bf143f67
.quad 0xbf6d3f35bec40000,0xbec43f35bf6d3f80,0xbf3f3f08be8e0000,0xbf6d3f7ebf7c3f67,0xbef83ea9be2c0000,0xbf6d3f59bf3f3f20,0xbe2c3de5bd660000,0xbec43ea9be8e3e64
.quad 0x3e2cbde53d660000,0x3ec4bea93e8ebe64,0x3ef8bea93e2c0000,0x3f6dbf593f3fbf20,0x3f3fbf083e8e0000,0x3f6dbf7e3f7cbf67,0x3f6dbf353ec40000,0x3ec4bf353f6dbf80
.quad 0xbf783f023f30bf63,0xbf25bf0e3f743ce6,0x3f553e48bf7b3f0e,0xbf0e3f7bbe48bf55,0xbe0fbf4d3f6abdac,0x3f74be48bf443f6f,0xbf253f7fbf02bed1,0x3ce6bf553f6fbe80
.quad 0x3f80bf30bdac3f4d,0xbf783f55be0fbf25,0xbf303ce63f25bf7d,0x3f023e48bf4d3f7f,0xbdac3f25bf783f6f,0x3f30bf7b3f6abf02,0x3f4dbf7d3f6fbf25,0xbf633f0ebdacbed1
.quad 0xbf7b3f55bf0e3e48,0xbe483f0ebf553f7b,0x3f02be80bce63e9b,0x3f7fbf7b3f63bf3a,0x3e9bbeeb3f1abf3a,0xbeb73e48bce6be0f,0xbf6a3f6fbf743f78,0xbf4d3f55bf5c3f63
.quad 0x3f6abf6f3f74bf78,0x3f4dbf553f5cbf63,0xbe9b3eebbf1a3f3a,0x3eb7be483ce63e0f,0xbf023e803ce6be9b,0xbf7f3f7bbf633f3a,0x3f7bbf553f0ebe48,0x3e48bf0e3f55bf7b
.quad 0x3ed1bf7d3e0f3f6a,0x3f80be9bbf553f44,0xbf55be483f7bbf0e,0x3f0ebf7b3e483f55,0xbf303f78be80bf3a,0xbeb7bf253f7bbe9b,0x3f1a3e9bbf743f4d,0xbf783eb73f0ebf80
.quad 0x3f63bf6f3eb73eeb,0xbf443f7dbf0ebe80,0xbe9bbed13f6abf74,0x3dac3f1abf7b3f5c,0xbf7d3f63beebbe0f,0x3f5cbed1be483f3a,0xbce63f02bf5c3f80,0x3f6abf7f3f55beeb
.quad 0x3f7bbf553f0ebe48,0x3e48bf0e3f55bf7b,0x3eb7bf1a3f4dbf6f,0xbf303eebbe48bdac,0xbf5c3f44bf253f02,0xbf7d3f80bf7b3f6f,0xbf253f30bf3a3f44,0xbeeb3f02bf0e3f1a
.quad 0x3f25bf303f3abf44,0x3eebbf023f0ebf1a,0x3f5cbf443f25bf02,0x3f7dbf803f7bbf6f,0xbeb73f1abf4d3f6f,0x3f30beeb3e483dac,0xbf7b3f55bf0e3e48,0xbe483f0ebf553f7b
.quad 0x3eeb3f3abf5cbe80,0xbf1a3f6f3dacbf7b,0x3f553e48bf7b3f0e,0xbf0e3f7bbe48bf55,0x3f7fbed1bf1a3f7d,0xbf023f80beebbf0e,0x3f6abf5c3dac3f44,0xbeeb3f7dbf30be48
.quad 0x3f1abf7f3f3a3ce6,0xbed13f74bf5c3e48,0x3e0fbf443f80bf3a,0xbeb73f63bf783f0e,0xbeb7be803f44bf7f,0xbe9b3f4dbf803f55,0xbf443eb73e0fbf1a,0xbe803f30bf743f7b
.quad 0xbf7b3f55bf0e3e48,0xbe483f0ebf553f7b,0xbf743f80bf783f5c,0xbe0f3ed1bf253f55,0xbf303f4dbf633f74,0xbdac3e80bed13f0e,0xbe803e9bbeb73ed1,0xbce63dacbe0f3e48
.quad 0x3e80be9b3eb7bed1,0x3ce6bdac3e0fbe48,0x3f30bf4d3f63bf74,0x3dacbe803ed1bf0e,0x3f74bf803f78bf5c,0x3e0fbed13f25bf55,0x3f7bbf553f0ebe48,0x3e48bf0e3f55bf7b
.quad 0xbf7b3dac3f6fbf1a,0xbe80bf5c3f3a3eeb,0xbf55be483f7bbf0e,0x3f0ebf7b3e483f55,0xbf0ebeeb3f80bf02,0x3f7dbf1abed13f7f,0xbe48bf303f7dbeeb,0x3f443dacbf5c3f6a
.quad 0x3e48bf5c3f74bed1,0x3ce63f3abf7f3f1a,0x3f0ebf783f63beb7,0xbf3a3f80bf443e0f,0x3f55bf803f4dbe9b,0xbf7f3f44be80beb7,0x3f7bbf743f30be80,0xbf1a3e0f3eb7bf44
.quad 0x3f7bbf553f0ebe48,0x3e48bf0e3f55bf7b,0x3f55bf253ed1be0f,0x3f5cbf783f80bf74,0x3f0ebed13e80bdac,0x3f74bf633f4dbf30,0x3e48be0f3dacbce6,0x3ed1beb73e9bbe80
.quad 0xbe483e0fbdac3ce6,0xbed13eb7be9b3e80,0xbf0e3ed1be803dac,0xbf743f63bf4d3f30,0xbf553f25bed13e0f,0xbf5c3f78bf803f74,0xbf7b3f55bf0e3e48,0xbe483f0ebf553f7b
.quad 0x3e803f5cbf3abeeb,0xbf443f553e9bbf80,0x3f0ebf7b3e483f55,0x3f553e48bf7b3f0e,0xbf7d3f1a3ed1bf7f,0x3e9bbf7b3f253eb7,0x3f443dacbf5c3f6a,0xbf803f0e3eb7bf78
.quad 0xbce6bf3a3f7fbf1a,0x3e803f0ebf7d3f44,0xbf3a3f80bf443e0f,0x3f5cbf7b3f1a3dac,0x3f7fbf443e803eb7,0xbf3a3e483ed1bf5c,0xbf1a3e0f3eb7bf44,0xbeeb3f55bf7f3f6a
.quad 0xbe483f0ebf553f7b,0x3f7bbf553f0ebe48,0x3f5cbf783f80bf74,0xbdacbe483eebbf30,0xbf743f63bf4d3f30,0xbf6f3f7bbf803f7d,0x3ed1beb73e9bbe80,0x3f1abf0e3f02beeb
.quad 0x3ed1beb73e9bbe80,0x3f1abf0e3f02beeb,0xbf743f63bf4d3f30,0xbf6f3f7bbf803f7d,0x3f5cbf783f80bf74,0xbdacbe483eebbf30,0xbe483f0ebf553f7b,0x3f7bbf553f0ebe48
.quad 0xbf6abe0f3f7dbed1,0xbce6bf743f0e3f25,0xbf0e3f7bbe48bf55,0xbf55be483f7bbf0e,0x3f3a3e80bf783f30,0xbf6f3f443e48bf74,0x3f4dbf743e9b3f1a,0xbe803f6fbf553ce6
.quad 0xbeebbeb73f6fbf63,0x3f253e0fbf553f78,0xbf743f6abed1be9b,0x3f7fbf4d3e483f02,0x3e0f3eebbf633f7d,0x3f02bf6a3f7bbf30,0x3f80bf5c3f02bce6,0xbed1bdac3f0ebf63
.quad 0x3e48bf0e3f55bf7b,0xbf7b3f55bf0e3e48,0xbf6f3f4dbf1a3eb7,0xbf3a3f63bf7b3f7f,0xbf023f25bf443f5c,0x3e0f3ce6be483eb7,0x3f44bf3a3f30bf25,0x3f63bf5c3f55bf4d
.quad 0x3f44bf3a3f30bf25,0x3f63bf5c3f55bf4d,0xbf023f25bf443f5c,0x3e0f3ce6be483eb7,0xbf6f3f4dbf1a3eb7,0xbf3a3f63bf7b3f7f,0x3e48bf0e3f55bf7b,0xbf7b3f55bf0e3e48
.quad 0x3f63bf30bf023f78,0x3f4d3eb7bf7f3e48,0x3f0ebf7b3e483f55,0x3f553e48bf7b3f0e,0x3dacbf6a3f4d3e0f,0x3f5c3ce6bf633f55,0xbed1bf023f7fbf25,0x3f63be0fbf3a3f7b
.quad 0xbf4d3dac3f30bf80,0x3f6abe9bbf023f7b,0xbf7d3f253ce6bf30,0x3f6fbeebbe803f55,0xbf6f3f78bf253dac,0x3f74bf1a3ce63f0e,0xbf253f6fbf7d3f4d,0x3f78bf3a3e9b3e48
.quad 0xbe483f0ebf553f7b,0x3f7bbf553f0ebe48,0x3e9bbce6be803f02,0x3f7dbf6a3f44bf0e,0x3f3abf1a3eebbe9b,0x3f7fbf783f6abf55,0x3f78bf743f6fbf6a,0x3f80bf7f3f7dbf7b
.quad 0x3f78bf743f6fbf6a,0x3f80bf7f3f7dbf7b,0x3f3abf1a3eebbe9b,0x3f7fbf783f6abf55,0x3e9bbce6be803f02,0x3f7dbf6a3f44bf0e,0xbe483f0ebf553f7b,0x3f7bbf553f0ebe48
.quad 0xbe483f7fbeb7bf4d,0xbf783f023f30bf63,0xbf0e3f7bbe48bf55,0xbf55be483f7bbf0e,0xbf553f63bce6bf5c,0xbe0fbf4d3f6abdac,0xbf7b3f3a3e0fbf63,0x3f25bf7f3f023ed1
.quad 0xbf7b3f023e9bbf6a,0x3f80bf30bdac3f4d,0xbf553e803eebbf6f,0x3f30bce6bf253f7d,0xbf0ebce63f1abf74,0xbdac3f25bf783f6f,0xbe48be9b3f3abf78,0xbf4d3f7dbf6f3f25
.quad 0x3e48bf0e3f55bf7b,0xbf7b3f55bf0e3e48,0x3f0ebf443f6abf7d,0xbf023e803ce6be9b,0x3f55bf6a3f78bf7f,0x3e9bbeeb3f1abf3a,0x3f7bbf7d3f7fbf80,0x3f6abf6f3f74bf78
.quad 0x3f7bbf7d3f7fbf80,0x3f6abf6f3f74bf78,0x3f55bf6a3f78bf7f,0x3e9bbeeb3f1abf3a,0x3f0ebf443f6abf7d,0xbf023e803ce6be9b,0x3e48bf0e3f55bf7b,0xbf7b3f55bf0e3e48
.quad 0xbd66bf723f143f20,0x3f60bf35bef83f7a,0x3f6dbf35bec43f80,0x3ec43f35bf6d0000,0x3f2b3ea9bf7c3f20,0xbf763f353e8ebf7a,0xbef83f7ebf2bbe64,0xbe2cbf353f7cbede
.quad 0xbf7c3f083e8ebf67,0x3f80bf35bd663f48,0xbe2cbf083f76bf67,0xbd663f35bf803f48,0x3f60bf7e3f3fbe64,0xbf7c3f35be2cbede,0x3f3fbea9be2c3f20,0x3e8ebf353f76bf7a
.quad 0xbec43f35bf6d3f80,0x3f6dbf353ec40000,0xbf803f72bf513f20,0xbef83f35bf603f7a,0xbe8e3de53d66be64,0xbf513f35bf143ede,0x3f51bf593f60bf67,0x3f2bbf353f3fbf48
.quad 0x3f51bf593f60bf67,0x3f2bbf353f3fbf48,0xbe8e3de53d66be64,0xbf513f35bf143ede,0xbf803f72bf513f20,0xbef83f35bf603f7a,0xbec43f35bf6d3f80,0x3f6dbf353ec40000
.quad 0x3f513ea9bf803e64,0xbe2c3f7ebec4bf48,0xbf6d3f353ec4bf80,0xbec4bf353f6d0000,0x3e2cbf723f3f3e64,0x3f513de5bf6d3f48,0x3f3f3de5bf603f67,0xbf803f083ec4bf7a
.quad 0xbf763f59be2cbf20,0x3f60bf723ec43ede,0x3e8ebf593f7cbf20,0xbef83f72bf6d3ede,0x3f2bbde5bef83f67,0xbd66bf083f6dbf7a,0xbf7c3f72bf2b3e64,0x3f14bde5bec43f48
.quad 0x3ec4bf353f6dbf80,0xbf6d3f35bec40000,0x3f14bea93d663e64,0x3f7cbf7e3f6dbf48,0xbf803f7ebf763f67,0xbf3f3f59bf6d3f7a,0x3ef8bf083f14bf20,0x3e8ebea93ec4bede
.quad 0x3ef8bf083f14bf20,0x3e8ebea93ec4bede,0xbf803f7ebf763f67,0xbf3f3f59bf6d3f7a,0x3f14bea93d663e64,0x3f7cbf7e3f6dbf48,0x3ec4bf353f6dbf80,0xbf6d3f35bec40000
.quad 0xbf763f083f2bbf67,0xbf2bbf083f760000,0x3f6dbf35bec43f80,0x3ec43f35bf6d0000,0xbf603f593d66bf67,0xbd66bf593f600000,0x3f51bf723e8e3f20,0xbe8e3f72bf510000
.quad 0xbf3f3f7ebf14be64,0x3f14bf7e3f3f0000,0x3f2bbf7e3f51be64,0xbf513f7ebf2b0000,0xbf143f72bf763f20,0x3f76bf723f140000,0x3ef8bf593f80bf67,0xbf803f59bef80000
.quad 0xbec43f35bf6d3f80,0x3f6dbf353ec40000,0x3e8ebf083f3fbf67,0xbf3f3f08be8e0000,0xbe2c3ea9bef83f20,0x3ef8bea93e2c0000,0x3d66bde53e2cbe64,0xbe2c3de5bd660000
.quad 0x3d66bde53e2cbe64,0xbe2c3de5bd660000,0xbe2c3ea9bef83f20,0x3ef8bea93e2c0000,0x3e8ebf083f3fbf67,0xbf3f3f08be8e0000,0xbec43f35bf6d3f80,0x3f6dbf353ec40000
.quad 0x3ec4bf7e3e2c3f67,0x3f80bea9bf513f48,0xbf6d3f353ec4bf80,0xbec4bf353f6d0000,0x3f6dbde5bf513f67,0xbf3f3f72be2cbf48,0xbec4bf083f80bf20,0x3f60bde5bf3f3f7a
.quad 0xbec43f72bf603e64,0x3e2cbf593f76bede,0x3f6dbf723ef83e64,0xbf7c3f59be8ebede,0xbf6d3f083d66bf20,0x3ef83de5bf2b3f7a,0x3ec43de5bf143f67,0x3f2bbf723f7cbf48
.quad 0x3ec4bf353f6dbf80,0xbf6d3f35bec40000,0xbf6d3f7ebf7c3f67,0xbd663ea9bf143f48,0x3f6dbf593f3fbf20,0x3f76bf7e3f80bf7a,0xbec43ea9be8e3e64,0xbf143f08bef83ede
.quad 0xbec43ea9be8e3e64,0xbf143f08bef83ede,0x3f6dbf593f3fbf20,0x3f76bf7e3f80bf7a,0xbf6d3f7ebf7c3f67,0xbd663ea9bf143f48,0x3ec4bf353f6dbf80,0xbf6d3f35bec40000
.quad 0xbf803ea93f51bf48,0xbef8bf353f603e64,0xbec4bf353f6d0000,0x3f6dbf35bec43f80,0x3f3fbf723e2c3f48,0x3e8e3f35bf763e64,0x3f60bde5bf3f3f7a,0xbf7c3f353e2cbf67
.quad 0xbe2c3f59bf763ede,0xbd66bf353f80bf20,0xbf7c3f59be8ebede,0x3f80bf353d663f20,0xbef8bde53f2bbf7a,0xbe2c3f35bf7c3f67,0x3f2bbf723f7cbf48,0xbf763f35be8ebe64
.quad 0x3f6dbf353ec40000,0x3ec4bf353f6dbf80,0xbd663ea9bf143f48,0x3f60bf353ef8be64,0xbf763f7ebf803f7a,0xbf143f35bf513f67,0xbf143f08bef83ede,0xbf3f3f35bf2b3f20
.quad 0x3f14bf083ef8bede,0x3f3fbf353f2bbf20,0x3f76bf7e3f80bf7a,0x3f14bf353f51bf67,0x3d66bea93f14bf48,0xbf603f35bef83e64,0xbf6d3f35bec40000,0xbec43f35bf6d3f80
.quad 0x3f14bf72bd663f7a,0x3f7cbde5bf6d3f20,0x3ec43f35bf6d0000,0xbf6d3f353ec4bf80,0xbf7c3ea93f2bbf7a,0x3f14bf7e3ec43f20,0x3f2bbf7e3ef83ede,0xbd663f59bf6d3e64
.quad 0x3e8e3f08bf7c3f48,0xbef8bea93f6dbf67,0xbf763f083e2cbf48,0x3f60bea9bec43f67,0x3f3fbf7e3f60bede,0xbf803f59bec4be64,0x3e2c3ea9bf3f3f7a,0x3f51bf7e3f6dbf20
.quad 0xbf6d3f35bec40000,0xbec43f35bf6d3f80,0x3f51bf723f80bf7a,0xbe2cbde53ec4bf20,0x3d663de5be8e3ede,0x3f2bbf083ec4be64,0xbf603f59bf513f48,0xbf763f72bf6d3f67
.quad 0x3f60bf593f51bf48,0x3f76bf723f6dbf67,0xbd66bde53e8ebede,0xbf2b3f08bec43e64,0xbf513f72bf803f7a,0x3e2c3de5bec43f20,0x3f6dbf353ec40000,0x3ec4bf353f6dbf80
.quad 0x3e8e3f59bf3fbede,0xbf3f3f593e8ebf80,0xbec4bf353f6d0000,0x3f6dbf35bec43f80,0x3ef83f08bf803ede,0xbf803f083ef8bf80,0xbf14bea93f76bf48,0x3f76bea9bf143f80
.quad 0x3f2b3de5bf513f7a,0xbf513de53f2bbf80,0xbf3f3de53f14bf7a,0x3f143de5bf3f3f80,0x3f51bea9be8e3f48,0xbe8ebea93f51bf80,0xbf603f08bd66bede,0xbd663f08bf603f80
.quad 0x3f6dbf353ec40000,0x3ec4bf353f6dbf80,0xbf763f59bf2b3ede,0xbf2b3f59bf763f80,0x3f7cbf723f60bf48,0x3f60bf723f7cbf80,0xbf803f7ebf7c3f7a,0xbf7c3f7ebf803f80
.quad 0x3f80bf7e3f7cbf7a,0x3f7cbf7e3f80bf80,0xbf7c3f72bf603f48,0xbf603f72bf7c3f80,0x3f76bf593f2bbede,0x3f2bbf593f76bf80,0xbf6d3f35bec40000,0xbec43f35bf6d3f80
.quad 0xbf6dbde53f7cbede,0xbd66bf723f143f20,0x3ec43f35bf6d0000,0xbf6d3f353ec4bf80,0x3ec4bf7e3f143ede,0x3f2b3ea9bf7c3f20,0xbf6d3f59bd66bf48,0x3ef8bf7e3f2b3e64
.quad 0x3f6dbea9bef83f7a,0xbf7c3f083e8ebf67,0xbec4bea93f60bf7a,0x3e2c3f08bf763f67,0xbec43f59bf803f48,0x3f60bf7e3f3fbe64,0x3f6dbf7e3f51bede,0xbf3f3ea93e2cbf20
.quad 0xbf6d3f35bec40000,0xbec43f35bf6d3f80,0x3ec4bde5be2c3ede,0x3f80bf723f51bf20,0x3ec4bf083f2bbf48,0xbe8e3de53d66be64,0xbf6d3f72bf763f7a,0xbf513f59bf603f67
.quad 0x3f6dbf723f76bf7a,0x3f51bf593f60bf67,0xbec43f08bf2b3f48,0x3e8ebde5bd663e64,0xbec43de53e2cbede,0xbf803f72bf513f20,0x3f6dbf353ec40000,0x3ec4bf353f6dbf80
.quad 0x3f44bf55be9b3f80,0x3f6a3e0fbf7d3ed1,0x3f553e48bf7b3f0e,0xbf0e3f7bbe48bf55,0xbe9b3f7bbf25beb7,0xbf3abe803f78bf30,0xbf803f0e3eb7bf78,0x3f4dbf743e9b3f1a
.quad 0xbe80bf0e3f7dbf44,0x3eeb3eb7bf6f3f63,0x3f5cbf7b3f1a3dac,0xbf743f6abed1be9b,0x3f3abe48bed13f5c,0xbe0fbeeb3f63bf7d,0xbeeb3f55bf7f3f6a,0x3f80bf5c3f02bce6
.quad 0xbf7b3f55bf0e3e48,0xbe483f0ebf553f7b,0xbdacbe483eebbf30,0xbf6f3f4dbf1a3eb7,0x3f6fbf7b3f80bf7d,0x3f02bf253f44bf5c,0x3f1abf0e3f02beeb,0x3f44bf3a3f30bf25
.quad 0xbf1a3f0ebf023eeb,0xbf443f3abf303f25,0xbf6f3f7bbf803f7d,0xbf023f25bf443f5c,0x3dac3e48beeb3f30,0x3f6fbf4d3f1abeb7,0x3f7bbf553f0ebe48,0x3e48bf0e3f55bf7b
.quad 0x3ce63f74bf0ebf25,0xbf633f303f02bf78,0xbf55be483f7bbf0e,0x3f0ebf7b3e483f55,0x3f6fbf44be483f74,0xbdac3f6abf4dbe0f,0xbe803f6fbf553ce6,0xbed1bf023f7fbf25
.quad 0xbf25be0f3f55bf78,0x3f4dbdacbf303f80,0x3f7fbf4d3e483f02,0xbf7d3f253ce6bf30,0xbf023f6abf7b3f30,0x3f6fbf783f25bdac,0xbed1bdac3f0ebf63,0xbf253f6fbf7d3f4d
.quad 0x3f7bbf553f0ebe48,0x3e48bf0e3f55bf7b,0xbf3a3f63bf7b3f7f,0x3e9bbce6be803f02,0xbe0fbce63e48beb7,0xbf3a3f1abeeb3e9b,0x3f63bf5c3f55bf4d,0x3f78bf743f6fbf6a
.quad 0xbf633f5cbf553f4d,0xbf783f74bf6f3f6a,0x3e0f3ce6be483eb7,0x3f3abf1a3eebbe9b,0x3f3abf633f7bbf7f,0xbe9b3ce63e80bf02,0xbf7b3f55bf0e3e48,0xbe483f0ebf553f7b
.quad 0xbf4dbeb73f7fbe48,0x3e48bf7f3eb73f4d,0x3f553e48bf7b3f0e,0xbf0e3f7bbe48bf55,0xbf5cbce63f63bf55,0x3f55bf633ce63f5c,0x3f63be0fbf3a3f7b,0xbf7b3f3a3e0fbf63
.quad 0xbf6a3e9b3f02bf7b,0x3f7bbf02be9b3f6a,0x3f6fbeebbe803f55,0xbf553e803eebbf6f,0xbf743f1abce6bf0e,0x3f0e3ce6bf1a3f74,0x3f78bf3a3e9b3e48,0xbe48be9b3f3abf78
.quad 0xbf7b3f55bf0e3e48,0xbe483f0ebf553f7b,0x3f7dbf6a3f44bf0e,0x3f0ebf443f6abf7d,0xbf7f3f78bf6a3f55,0xbf553f6abf783f7f,0x3f80bf7f3f7dbf7b,0x3f7bbf7d3f7fbf80
.quad 0xbf803f7fbf7d3f7b,0xbf7b3f7dbf7f3f80,0x3f7fbf783f6abf55,0x3f55bf6a3f78bf7f,0xbf7d3f6abf443f0e,0xbf0e3f44bf6a3f7d,0x3f7bbf553f0ebe48,0x3e48bf0e3f55bf7b
.quad 0x3f78bf02bf303f63,0x3f253f0ebf74bce6,0xbf55be483f7bbf0e,0x3f0ebf7b3e483f55,0x3e0f3f4dbf6a3dac,0xbf743e483f44bf6f,0x3f25bf7f3f023ed1,0xbce63f55bf6f3e80
.quad 0xbf803f303dacbf4d,0x3f78bf553e0f3f25,0x3f30bce6bf253f7d,0xbf02be483f4dbf7f,0x3dacbf253f78bf6f,0xbf303f7bbf6a3f02,0xbf4d3f7dbf6f3f25,0x3f63bf0e3dac3ed1
.quad 0x3f7bbf553f0ebe48,0x3e48bf0e3f55bf7b,0xbf023e803ce6be9b,0xbf7f3f7bbf633f3a,0xbe9b3eebbf1a3f3a,0x3eb7be483ce63e0f,0x3f6abf6f3f74bf78,0x3f4dbf553f5cbf63
.quad 0xbf6a3f6fbf743f78,0xbf4d3f55bf5c3f63,0x3e9bbeeb3f1abf3a,0xbeb73e48bce6be0f,0x3f02be80bce63e9b,0x3f7fbf7b3f63bf3a,0xbf7b3f55bf0e3e48,0xbe483f0ebf553f7b
.quad 0xbf25bf0e3f743ce6,0x3ed1bf7d3e0f3f6a,0x3f0ebf7b3e483f55,0x3f553e48bf7b3f0e,0x3f74be48bf443f6f,0xbf303f78be80bf3a,0xbce63f55bf6f3e80,0xbf1abe9b3f74bf4d
.quad 0xbf783f55be0fbf25,0x3f63bf6f3eb73eeb,0xbf02be483f4dbf7f,0x3e9b3ed1bf6a3f74,0x3f30bf7b3f6abf02,0xbf7d3f63beebbe0f,0x3f63bf0e3dac3ed1,0x3ce6bf023f5cbf80
.quad 0xbe483f0ebf553f7b,0x3f7bbf553f0ebe48,0xbf7f3f7bbf633f3a,0xbeb73f1abf4d3f6f,0xbeb73e48bce6be0f,0xbf5c3f44bf253f02,0x3f4dbf553f5cbf63,0x3f25bf303f3abf44
.quad 0x3f4dbf553f5cbf63,0x3f25bf303f3abf44,0xbeb73e48bce6be0f,0xbf5c3f44bf253f02,0xbf7f3f7bbf633f3a,0xbeb73f1abf4d3f6f,0xbe483f0ebf553f7b,0x3f7bbf553f0ebe48
.quad 0x3f80be9bbf553f44,0x3eeb3f3abf5cbe80,0xbf0e3f7bbe48bf55,0xbf55be483f7bbf0e,0xbeb7bf253f7bbe9b,0x3f7fbed1bf1a3f7d,0x3f78beb7bf0e3f80,0xbf6a3f5cbdacbf44
.quad 0xbf443f7dbf0ebe80,0x3f1abf7f3f3a3ce6,0xbdacbf1a3f7bbf5c,0xbe0f3f44bf803f3a,0x3f5cbed1be483f3a,0xbeb7be803f44bf7f,0xbf6a3f7fbf553eeb,0x3f44beb7be0f3f1a
.quad 0x3e48bf0e3f55bf7b,0xbf7b3f55bf0e3e48,0x3f30beeb3e483dac,0x3f74bf803f78bf5c,0xbf7d3f80bf7b3f6f,0xbf303f4dbf633f74,0x3eebbf023f0ebf1a,0x3e80be9b3eb7bed1
.quad 0x3eebbf023f0ebf1a,0x3e80be9b3eb7bed1,0xbf7d3f80bf7b3f6f,0xbf303f4dbf633f74,0x3f30beeb3e483dac,0x3f74bf803f78bf5c,0x3e48bf0e3f55bf7b,0xbf7b3f55bf0e3e48
.quad 0xbf1a3f6f3dacbf7b,0xbf7b3dac3f6fbf1a,0x3f0ebf7b3e483f55,0x3f553e48bf7b3f0e,0xbf023f80beebbf0e,0xbf0ebeeb3f80bf02,0x3eebbf7d3f303e48,0x3e483f30bf7d3eeb
.quad 0xbed13f74bf5c3e48,0x3e48bf5c3f74bed1,0x3eb7bf633f78bf0e,0xbf0e3f78bf633eb7,0xbe9b3f4dbf803f55,0x3f55bf803f4dbe9b,0x3e80bf303f74bf7b,0xbf7b3f74bf303e80
.quad 0xbe483f0ebf553f7b,0x3f7bbf553f0ebe48,0x3e0fbed13f25bf55,0xbf553f25bed13e0f,0xbdac3e80bed13f0e,0x3f0ebed13e80bdac,0x3ce6bdac3e0fbe48,0xbe483e0fbdac3ce6
.quad 0x3ce6bdac3e0fbe48,0xbe483e0fbdac3ce6,0xbdac3e80bed13f0e,0x3f0ebed13e80bdac,0x3e0fbed13f25bf55,0xbf553f25bed13e0f,0xbe483f0ebf553f7b,0x3f7bbf553f0ebe48
.quad 0xbe80bf5c3f3a3eeb,0x3f44bf55be9b3f80,0xbf0e3f7bbe48bf55,0xbf55be483f7bbf0e,0x3f7dbf1abed13f7f,0xbe9b3f7bbf25beb7,0xbf44bdac3f5cbf6a,0x3f80bf0ebeb73f78
.quad 0x3ce63f3abf7f3f1a,0xbe80bf0e3f7dbf44,0x3f3abf803f44be0f,0xbf5c3f7bbf1abdac,0xbf7f3f44be80beb7,0x3f3abe48bed13f5c,0x3f1abe0fbeb73f44,0x3eebbf553f7fbf6a
.quad 0x3e48bf0e3f55bf7b,0xbf7b3f55bf0e3e48,0xbf5c3f78bf803f74,0x3dac3e48beeb3f30,0x3f74bf633f4dbf30,0x3f6fbf7b3f80bf7d,0xbed13eb7be9b3e80,0xbf1a3f0ebf023eeb
.quad 0xbed13eb7be9b3e80,0xbf1a3f0ebf023eeb,0x3f74bf633f4dbf30,0x3f6fbf7b3f80bf7d,0xbf5c3f78bf803f74,0x3dac3e48beeb3f30,0x3e48bf0e3f55bf7b,0xbf7b3f55bf0e3e48
.quad 0x3ef83f35bf60be64,0xbf143f723d66bf7a,0x3f6dbf35bec43f80,0x3ec43f35bf6d0000,0xbe8ebf353f76be64,0x3f7cbea9bf2b3f7a,0xbf7c3f353e2cbf67,0x3f2bbf7e3ef83ede
.quad 0x3d663f35bf803f20,0xbe8ebf083f7cbf48,0x3f80bf353d663f20,0xbf763f083e2cbf48,0x3e2cbf353f7cbf67,0xbf3f3f7ebf603ede,0xbf763f35be8ebe64,0x3e2c3ea9bf3f3f7a
.quad 0xbec43f35bf6d3f80,0x3f6dbf353ec40000,0x3f60bf353ef8be64,0x3f51bf723f80bf7a,0x3f14bf353f51bf67,0xbd66bde53e8ebede,0xbf3f3f35bf2b3f20,0xbf603f59bf513f48
.quad 0xbf3f3f35bf2b3f20,0xbf603f59bf513f48,0x3f14bf353f51bf67,0xbd66bde53e8ebede,0x3f60bf353ef8be64,0x3f51bf723f80bf7a,0xbec43f35bf6d3f80,0x3f6dbf353ec40000
.quad 0xbf7c3de53f6dbf20,0xbe8ebf593f3f3ede,0xbf6d3f353ec4bf80,0xbec4bf353f6d0000,0xbf143f7ebec4bf20,0xbef8bf083f80bede,0xbd663f59bf6d3e64,0xbf14bea93f76bf48
.quad 0x3ef83ea9bf6d3f67,0xbf2bbde53f51bf7a,0x3f60bea9bec43f67,0xbf3f3de53f14bf7a,0x3f80bf593ec43e64,0xbf513ea93e8ebf48,0x3f51bf7e3f6dbf20,0xbf603f08bd66bede
.quad 0x3ec4bf353f6dbf80,0xbf6d3f35bec40000,0xbe2cbde53ec4bf20,0xbf763f59bf2b3ede,0xbf2b3f08bec43e64,0xbf7c3f72bf603f48,0xbf763f72bf6d3f67,0xbf803f7ebf7c3f7a
.quad 0xbf763f72bf6d3f67,0xbf803f7ebf7c3f7a,0xbf2b3f08bec43e64,0xbf7c3f72bf603f48,0xbe2cbde53ec4bf20,0xbf763f59bf2b3ede,0x3ec4bf353f6dbf80,0xbf6d3f35bec40000
.quad 0x0,0x0,0x0,0x0,0x0,0x0,0x0,0x0
.quad 0x0,0x0,0x0,0x0,0x0,0x0,0x0,0x0
.quad 0x0,0x0,0x0,0x0,0x0,0x0,0x0,0x0
.quad 0x0,0x0,0x0,0x0,0x0,0x0,0x0,0x0
.quad 0x0,0x0,0x0,0x0,0x0,0x0,0x0,0x0
.quad 0x0,0x0,0x0,0x0,0x0,0x0,0x0,0x0
.quad 0x0,0x0,0x0,0x0,0x0,0x0,0x0,0x0
.quad 0x0,0x0,0x0,0x0,0x0,0x0,0x0,0x0
.quad 0x3f60bf35bef83f7a,0x3f513ea9bf803e64,0xbec4bf353f6d0000,0x3f6dbf35bec43f80,0xbf763f353e8ebf7a,0x3e2cbf723f3f3e64,0x3e2c3f35bf7c3ede,0xbf3fbde53f60bf67
.quad 0x3f80bf35bd663f48,0xbf763f59be2cbf20,0x3d66bf353f80bf48,0xbe8e3f59bf7c3f20,0xbf7c3f35be2cbede,0x3f2bbde5bef83f67,0xbe8e3f35bf763f7a,0x3f7cbf723f2bbe64
.quad 0x3f6dbf353ec40000,0x3ec4bf353f6dbf80,0x3ef8bf353f60bf7a,0xbf143ea9bd66be64,0xbf513f35bf143ede,0xbf803f7ebf763f67,0xbf2b3f35bf3f3f48,0xbef83f08bf143f20
.quad 0x3f2bbf353f3fbf48,0x3ef8bf083f14bf20,0x3f51bf353f14bede,0x3f80bf7e3f76bf67,0xbef83f35bf603f7a,0x3f14bea93d663e64,0xbf6d3f35bec40000,0xbec43f35bf6d3f80
.quad 0xbe2c3f7ebec4bf48,0xbf763f083f2bbf67,0x3ec43f35bf6d0000,0xbf6d3f353ec4bf80,0x3f513de5bf6d3f48,0xbf603f593d66bf67,0x3f80bf08bec43f7a,0xbf513f72be8ebf20
.quad 0x3f60bf723ec43ede,0xbf3f3f7ebf14be64,0x3ef8bf723f6dbede,0xbf2b3f7ebf513e64,0xbd66bf083f6dbf7a,0xbf143f72bf763f20,0xbf143de53ec4bf48,0xbef83f59bf803f67
.quad 0xbf6d3f35bec40000,0xbec43f35bf6d3f80,0xbf7c3f7ebf6d3f48,0xbe8e3f08bf3f3f67,0xbf3f3f59bf6d3f7a,0xbe2c3ea9bef83f20,0xbe8e3ea9bec43ede,0xbd663de5be2c3e64
.quad 0x3e8ebea93ec4bede,0x3d66bde53e2cbe64,0x3f3fbf593f6dbf7a,0x3e2cbea93ef8bf20,0x3f7cbf7e3f6dbf48,0x3e8ebf083f3fbf67,0x3f6dbf353ec40000,0x3ec4bf353f6dbf80
.quad 0x0,0x0,0x0,0x0,0x0,0x0,0x0,0x0
.quad 0x0,0x0,0x0,0x0,0x0,0x0,0x0,0x0
.quad 0x0,0x0,0x0,0x0,0x0,0x0,0x0,0x0
.quad 0x0,0x0,0x0,0x0,0x0,0x0,0x0,0x0
.quad 0x0,0x0,0x0,0x0,0x0,0x0,0x0,0x0
.quad 0x0,0x0,0x0,0x0,0x0,0x0,0x0,0x0
.quad 0x0,0x0,0x0,0x0,0x0,0x0,0x0,0x0
.quad 0x0,0x0,0x0,0x0,0x0,0x0,0x0,0x0
.quad 0xbed13f7dbe0fbf6a,0xbf803e9b3f55bf44,0x3f553e48bf7b3f0e,0xbf0e3f7bbe48bf55,0x3f30bf783e803f3a,0x3eb73f25bf7b3e9b,0xbf1abe9b3f74bf4d,0x3f78beb7bf0e3f80
.quad 0xbf633f6fbeb7beeb,0x3f44bf7d3f0e3e80,0x3e9b3ed1bf6a3f74,0xbdacbf1a3f7bbf5c,0x3f7dbf633eeb3e0f,0xbf5c3ed13e48bf3a,0x3ce6bf023f5cbf80,0xbf6a3f7fbf553eeb
.quad 0xbf7b3f55bf0e3e48,0xbe483f0ebf553f7b,0xbeb73f1abf4d3f6f,0x3f30beeb3e483dac,0x3f5cbf443f25bf02,0x3f7dbf803f7bbf6f,0x3f25bf303f3abf44,0x3eebbf023f0ebf1a
.quad 0xbf253f30bf3a3f44,0xbeeb3f02bf0e3f1a,0xbf5c3f44bf253f02,0xbf7d3f80bf7b3f6f,0x3eb7bf1a3f4dbf6f,0xbf303eebbe48bdac,0x3f7bbf553f0ebe48,0x3e48bf0e3f55bf7b
.quad 0xbeebbf3a3f5c3e80,0x3f1abf6fbdac3f7b,0xbf55be483f7bbf0e,0x3f0ebf7b3e483f55,0xbf7f3ed13f1abf7d,0x3f02bf803eeb3f0e,0xbf6a3f5cbdacbf44,0x3eebbf7d3f303e48
.quad 0xbf1a3f7fbf3abce6,0x3ed1bf743f5cbe48,0xbe0f3f44bf803f3a,0x3eb7bf633f78bf0e,0x3eb73e80bf443f7f,0x3e9bbf4d3f80bf55,0x3f44beb7be0f3f1a,0x3e80bf303f74bf7b
.quad 0x3f7bbf553f0ebe48,0x3e48bf0e3f55bf7b,0x3f74bf803f78bf5c,0x3e0fbed13f25bf55,0x3f30bf4d3f63bf74,0x3dacbe803ed1bf0e,0x3e80be9b3eb7bed1,0x3ce6bdac3e0fbe48
.quad 0xbe803e9bbeb73ed1,0xbce63dacbe0f3e48,0xbf303f4dbf633f74,0xbdac3e80bed13f0e,0xbf743f80bf783f5c,0xbe0f3ed1bf253f55,0xbf7b3f55bf0e3e48,0xbe483f0ebf553f7b
.quad 0x0,0x0,0x0,0x0,0x0,0x0,0x0,0x0
.quad 0x0,0x0,0x0,0x0,0x0,0x0,0x0,0x0
.quad 0x0,0x0,0x0,0x0,0x0,0x0,0x0,0x0
.quad 0x0,0x0,0x0,0x0,0x0,0x0,0x0,0x0
.quad 0x0,0x0,0x0,0x0,0x0,0x0,0x0,0x0
.quad 0x0,0x0,0x0,0x0,0x0,0x0,0x0,0x0
.quad 0x0,0x0,0x0,0x0,0x0,0x0,0x0,0x0
.quad 0x0,0x0,0x0,0x0,0x0,0x0,0x0,0x0
.quad 0x3f6a3e0fbf7d3ed1,0x3ce63f74bf0ebf25,0x3f0ebf7b3e483f55,0x3f553e48bf7b3f0e,0xbf3abe803f78bf30,0x3f6fbf44be483f74,0xbf4d3f74be9bbf1a,0x3e80bf6f3f55bce6
.quad 0x3eeb3eb7bf6f3f63,0xbf25be0f3f55bf78,0x3f74bf6a3ed13e9b,0xbf7f3f4dbe48bf02,0xbe0fbeeb3f63bf7d,0xbf023f6abf7b3f30,0xbf803f5cbf023ce6,0x3ed13dacbf0e3f63
.quad 0xbe483f0ebf553f7b,0x3f7bbf553f0ebe48,0x3f6fbf4d3f1abeb7,0x3f3abf633f7bbf7f,0x3f02bf253f44bf5c,0xbe0fbce63e48beb7,0xbf443f3abf303f25,0xbf633f5cbf553f4d
.quad 0xbf443f3abf303f25,0xbf633f5cbf553f4d,0x3f02bf253f44bf5c,0xbe0fbce63e48beb7,0x3f6fbf4d3f1abeb7,0x3f3abf633f7bbf7f,0xbe483f0ebf553f7b,0x3f7bbf553f0ebe48
.quad 0xbf633f303f02bf78,0xbf4dbeb73f7fbe48,0xbf0e3f7bbe48bf55,0xbf55be483f7bbf0e,0xbdac3f6abf4dbe0f,0xbf5cbce63f63bf55,0x3ed13f02bf7f3f25,0xbf633e0f3f3abf7b
.quad 0x3f4dbdacbf303f80,0xbf6a3e9b3f02bf7b,0x3f7dbf25bce63f30,0xbf6f3eeb3e80bf55,0x3f6fbf783f25bdac,0xbf743f1abce6bf0e,0x3f25bf6f3f7dbf4d,0xbf783f3abe9bbe48
.quad 0x3e48bf0e3f55bf7b,0xbf7b3f55bf0e3e48,0xbe9b3ce63e80bf02,0xbf7d3f6abf443f0e,0xbf3a3f1abeeb3e9b,0xbf7f3f78bf6a3f55,0xbf783f74bf6f3f6a,0xbf803f7fbf7d3f7b
.quad 0xbf783f74bf6f3f6a,0xbf803f7fbf7d3f7b,0xbf3a3f1abeeb3e9b,0xbf7f3f78bf6a3f55,0xbe9b3ce63e80bf02,0xbf7d3f6abf443f0e,0x3e48bf0e3f55bf7b,0xbf7b3f55bf0e3e48
.quad 0x0,0x0,0x0,0x0,0x0,0x0,0x0,0x0
.quad 0x0,0x0,0x0,0x0,0x0,0x0,0x0,0x0
.quad 0x0,0x0,0x0,0x0,0x0,0x0,0x0,0x0
.quad 0x0,0x0,0x0,0x0,0x0,0x0,0x0,0x0
.quad 0x0,0x0,0x0,0x0,0x0,0x0,0x0,0x0
.quad 0x0,0x0,0x0,0x0,0x0,0x0,0x0,0x0
.quad 0x0,0x0,0x0,0x0,0x0,0x0,0x0,0x0
.quad 0x0,0x0,0x0,0x0,0x0,0x0,0x0,0x0
.quad 0x3f7f3f803f803f80,0x3f7b3f7c3f7d3f7e,0x3f6a3f763f7d3f80,0x3f0e3f2b3f443f59,0x3f3a3f603f783f80,0xbe483d663e9b3f08,0x3eeb3f3f3f6f3f80,0xbf55bf14be803de5
.quad 0x3e0f3f143f633f80,0xbf7bbf76bf3abea9,0xbe483ec43f553f80,0xbf0ebf6dbf7bbf35,0xbf023e2c3f443f80,0x3e48bef8bf6fbf72,0xbf44bd663f303f80,0x3f553e2cbf1abf7e
.quad 0xbf6fbe8e3f1a3f80,0x3f7b3f3fbdacbf59,0xbf80bef83f023f80,0x3f0e3f803eebbf08,0xbf74bf2b3ed13f80,0xbe483f513f5cbde5,0xbf4dbf513e9b3f80,0xbf553e8e3f803ea9
.quad 0xbf0ebf6d3e483f80,0xbf7bbec43f553f35,0xbe80bf7c3dac3f80,0xbf0ebf603ed13f72,0x3dacbf80bce63f80,0x3e48bf7cbe0f3f7e,0x3ed1bf76be0f3f80,0x3f55bf2bbf253f59
.quad 0x3f743f763f783f7a,0x3f6a3f6d3f6f3f72,0x3ce63e2c3e9b3ede,0xbf02bec4be80bde5,0xbf6fbf51bf25bede,0xbf4dbf6dbf7dbf7e,0xbf25bf60bf7dbf7a,0x3f303ec43ce6bea9
.quad 0x3f023d66bed1bf48,0x3f253f6d3f7f3f59,0x3f7b3f6d3f0e0000,0xbf55bec43e483f35,0x3e0f3f3f3f803f48,0xbeebbf6dbf74bf08,0xbf63be8e3f023f7a,0x3f6f3ec4bed1bf72
.quad 0xbf3abf7cbeeb3ede,0x3e803f6d3f5c3de5,0x3ed1bf14bf7fbede,0xbf7dbec43f1a3f7e,0x3f7f3ef8bf1abf7a,0xbce6bf6dbf3a3ea9,0x3e803f803eb7bf48,0x3f7f3ec4bf44bf59
.quad 0xbf553ec43f7b0000,0xbe483f6d3f0ebf35,0xbf4dbf2b3f303f48,0xbf74bec43f633f08,0x3e9bbf76be803f7a,0x3ed1bf6dbeb73f72,0x3f80be2cbf743ede,0x3f5c3ec4bf78bde5
.quad 0x3f5c3f603f633f67,0x3f4d3f513f553f59,0xbf63bf51bf3abf20,0xbf7fbf80bf7bbf72,0x3dacbe2cbed1bf20,0x3f633f3f3f0e3ea9,0x3f4d3f763f7f3f67,0xbf02be2c3e483f08
.quad 0xbf6fbf2bbe803e64,0xbce6bef8bf55bf7e,0x3e48bec4bf55bf80,0x3f0e3f6d3f7b3f35,0x3f3a3f803f4d3e64,0xbf6abf76bf0e3de5,0xbf78bef83e9b3f67,0x3f7d3f14be48bf59
.quad 0x3e9bbf14bf80bf20,0xbf443d663f553f72,0x3f253f7c3eb7bf20,0x3e9bbf2bbf7bbea9,0xbf7dbe8e3f443f67,0x3e803f7c3f0ebf08,0x3ed1bf3fbf5c3e64,0xbf3abf603e483f7e
.quad 0x3f0e3f6dbe48bf80,0x3f7b3ec4bf55bf35,0xbf80bd663f7d3e64,0xbf6f3e8e3f7bbde5,0x3f02bf60beeb3f67,0x3f1abf51bf0e3f59,0x3eeb3f51bf30bf20,0xbdac3f80be48bf72
.quad 0x3f3a3f3f3f443f48,0x3f253f2b3f303f35,0xbf4dbf60bf6fbf7a,0xbeb7bef8bf1abf35,0x3f5c3f763f803f7a,0x3ce63e8e3f023f35,0xbf6abf80bf74bf48,0x3e9bbd66bed1bf35
.quad 0x3f743f7c3f4d3ede,0xbf1abe2c3e9b3f35,0xbf7bbf6dbf0e0000,0x3f553ec4be48bf35,0x3f7f3f513e80bede,0xbf78bf143dac3f35,0xbf80bf2b3dac3f48,0x3f7f3f3f3ce6bf35
.quad 0x3f7d3ef8bed1bf7a,0xbf6abf60be0f3f35,0xbf78be8e3f303f7a,0x3f3a3f763e80bf35,0x3f6f3d66bf63bf48,0xbeebbf80beb73f35,0xbf633e2c3f7d3ede,0x3e0f3f7c3eebbf35
.quad 0x3f55bec4bf7b0000,0x3e48bf6dbf0e3f35,0xbf443f143f5cbede,0xbf023f513f25bf35,0x3f30bf3fbf253f48,0x3f44bf2bbf3a3f35,0xbf1a3f603eb7bf7a,0xbf6f3ef83f4dbf35
.quad 0x3dac3d663ce60000,0x3e483e2c3e0f3de5,0x3ed13e8e3e0f0000,0x3f553f3f3f253f08,0x3f303ef83e800000,0x3f7b3f803f743f59,0x3f633f2b3eb70000,0x3f0e3f513f783f7e
.quad 0x3f7d3f513eeb0000,0xbe483e8e3f303f72,0x3f7b3f6d3f0e0000,0xbf55bec43e483f35,0x3f5c3f7c3f250000,0xbf7bbf60beb73ea9,0x3f253f803f3a0000,0xbf0ebf7cbf4dbde5
.quad 0x3eb73f763f4d0000,0x3e48bf2bbf7fbf08,0x3ce63f603f5c0000,0x3f55bd66bf63bf59,0xbe9b3f3f3f6a0000,0x3f7b3f14bf02bf7e,0xbf1a3f143f740000,0x3f0e3f763ce6bf72
.quad 0xbf553ec43f7b0000,0xbe483f6d3f0ebf35,0xbf783e2c3f7f0000,0xbf553ef83f6abea9,0xbf7fbd663f800000,0xbf7bbe2c3f7d3de5,0xbf6abe8e3f7d0000,0xbf0ebf3f3f443f08
.quad 0x3e9b3e8e3e803e64,0x3ed13ec43eb73ea9,0x3f803f7c3f743f67,0x3f5c3f6d3f783f7e,0x3eb73f143f443f67,0xbf1abec4be0f3de5,0xbf44bef8be0f3e64,0xbf3abf6dbf80bf72
.quad 0xbf5cbf80bf6abf20,0x3f443ec4bdacbf08,0x3e48bec4bf55bf80,0x3f0e3f6d3f7b3f35,0x3f7d3f2b3ce6bf20,0xbf63bec43e9b3f59,0x3eeb3f763f5c3e64,0xbeb7bf6dbf6abea9
.quad 0xbf303e2c3f633f67,0x3f783ec4bf02bf7e,0xbf6abf513dac3f67,0x3e0f3f6d3f4dbde5,0x3dacbf60bf4d3e64,0xbf80bec43f303f72,0x3f783d66bf6fbf20,0x3dacbf6dbf253f08
.quad 0x3f0e3f6dbe48bf80,0x3f7b3ec4bf55bf35,0xbf1a3f3f3f3abf20,0xbe9b3f6d3eebbf59,0xbf74be8e3f783e64,0xbf6abec43f6f3ea9,0xbce6bf7c3e9b3f67,0x3f02bf6dbe803f7e
.quad 0x3f023ef83eeb3ede,0x3f1a3f143f0e3f08,0x3eeb3f143f303f48,0xbdac3d663e483ea9,0xbf7fbf7cbf6abf48,0xbeebbf2bbf55bf72,0x3f1a3e8ebdacbede,0x3f5c3f7c3f7b3f59
.quad 0x3eb73f3f3f783f7a,0xbf80bf60bf0ebde5,0xbf7bbf6dbf0e0000,0x3f553ec4be48bf35,0x3f303d66bf1abf7a,0xbed13e8e3f553f7e,0x3e803f603f743ede,0xbe0fbf51bf7bbf08
.quad 0xbf74bf51bce63f48,0x3f253f803f0ebea9,0x3f44be2cbf6fbf48,0xbf74bf3f3e483f72,0x3e0f3f763f25bede,0x3f783e2cbf55bf59,0xbf6abf2b3f023f7a,0xbf303ef83f7b3de5
.quad 0x3f55bec4bf7b0000,0x3e48bf6dbf0e3f35,0x3ce63f803e0fbf7a,0x3eb73f76be48bf7e,0xbf5cbef83f633ede,0xbf4dbf143f553f08,0x3f63bf14bf3a3f48,0x3f7fbd66bf7b3ea9
.quad 0x3f303f2b3f253f20,0x3f443f3f3f3a3f35,0xbf1abef8beb7be64,0xbf6fbf60bf4dbf35,0x3f023e8e3ce6be64,0x3f803f763f5c3f35,0xbed1bd663e9b3f20,0xbf74bf80bf6abf35
.quad 0x3e9bbe2cbf1abf67,0x3f4d3f7c3f743f35,0xbe483ec43f553f80,0xbf0ebf6dbf7bbf35,0x3dacbf14bf78bf67,0x3e803f513f7f3f35,0x3ce63f3f3f7f3f20,0x3dacbf2bbf80bf35
.quad 0xbe0fbf60bf6abe64,0xbed13ef83f7d3f35,0x3e803f763f3abe64,0x3f30be8ebf78bf35,0xbeb7bf80beeb3f20,0xbf633d663f6f3f35,0x3eeb3f7c3e0fbf67,0x3f7d3e2cbf63bf35
.quad 0xbf0ebf6d3e483f80,0xbf7bbec43f553f35,0x3f253f51bf02bf67,0x3f5c3f14bf44bf35,0xbf3abf2b3f443f20,0xbf25bf3f3f303f35,0x3f4d3ef8bf6fbe64,0x3eb73f60bf1abf35
.quad 0x3f7f3f7f3f803f80,0x3f7a3f7c3f7d3f7e,0x3f623f703f7a3f7f,0x3efe3f1d3f383f4f,0x3f223f4f3f6e3f7e,0xbea2bd8f3e3a3ed8,0x3e953f1d3f5b3f7c,0xbf6bbf38bed8bd8f
.quad 0xbdc93ebd3f413f79,0xbf68bf80bf5ebf0b,0xbef13dc93f223f75,0xbe95bf46bf7fbf62,0xbf46be3a3efe3f70,0x3f05be1dbf41bf80,0xbf75bee53eb03f6b,0x3f7c3f0bbe72bf5e
.quad 0xbf7fbf2d3e3a3f65,0x3f4a3f773ebdbf05,0xbf62bf5b3c663f5e,0x3d8f3f653f57bd2c,0xbf22bf77be1d3f57,0xbf323ebd3f803ee5,0xbe95bf80bea23f4f,0xbf80beb03f4a3f53
.quad 0x3dc9bf75bef13f46,0xbf22bf623e953f7f,0x3ef1bf57bf1d3f3c,0x3e1dbf79bea23f6b,0x3f46bf28bf3c3f32,0x3f57bf11bf4f3f1d,0x3f75bed8bf573f28,0x3f773e01bf803e1d
.quad 0x3f733f753f773f79,0x3f683f6b3f6e3f70,0xbd2c3dc93e723ebd,0xbf11bee5bea2be3a,0xbf79bf62bf3cbf0b,0xbf38bf5ebf77bf80,0xbefebf46bf73bf80,0x3f4f3f0b3e56be1d
.quad 0x3f323e95be3abf1d,0x3ee53f4f3f7d3f73,0x3f623f7f3f463e95,0xbf75bf22bdc93ef1,0xbe563ef13f6e3f73,0xbe01bf3cbf80bf4a,0xbf7fbf223e013f4f,0x3f803f38bc66bf3c
.quad 0xbeb0bf75bf4fbc66,0xbe563f283f7f3f0b,0x3f4fbdc9bf68bf53,0xbf6ebf4a3e013f6b,0x3f4a3f62bd8fbf70,0x3f05bf11bf7cbe72,0xbebd3f463f57be87,0x3f413f5bbe72bf7f
.quad 0xbf7fbe953f623f22,0xbf463ef13f75bdc9,0xbe3abf7f3c663f7f,0xbefebf683eb03f77,0x3f65bef1bf5e3f05,0x3f70bebdbf6b3ed8,0x3f2d3f22bf5bbecb,0x3e3a3f73bee5bf53
.quad 0x3f5b3f5e3f623f65,0x3f4a3f4f3f533f57,0xbf6bbf5bbf46bf2d,0xbf7dbf80bf7ebf77,0x3e56bd2cbe95bf05,0x3f703f533f283ee5,0x3f2d3f653f7f3f77,0xbf28beb03c663ebd
.quad 0xbf7ebf53bef1bc66,0x3e56be87bf2dbf70,0x3ef1bdc9bf22bf75,0x3e953f463f7f3f62,0x3ee53f6b3f753f0b,0xbf38bf7fbf4fbe72,0xbf7dbf4abdc93f28,0x3f773f5b3e56bf11
.quad 0x3f32be1dbf62bf68,0xbf79becb3efe3f7e,0x3e3a3f703f46be1d,0x3f3cbe56bf73bf41,0xbf68bf413e953f7e,0xbea23f3c3f6b3c66,0x3f5ebe56bf7fbecb,0xbe3abf7ebed83f3c
.quad 0xbdc93f753ef1bf46,0x3f223f62be95bf7f,0xbf41bf383f223f53,0xbf6ebee53f5b3f17,0x3f79be87bf753ea2,0x3f7ebe1dbf7c3e56,0xbebd3f793dc9bf80,0xbf4f3f323f1dbf5e
.quad 0x3f383f3c3f413f46,0x3f223f283f2d3f32,0xbf41bf57bf68bf75,0xbe95bed8bf0bbf28,0x3f4a3f6b3f7d3f7f,0xbdc93e1d3ecb3f1d,0xbf53bf79bf7ebf62,0x3ef13e01be72bf11
.quad 0x3f5b3f7f3f6b3f22,0xbf46becb3d8f3f05,0xbf62bf7fbf46be95,0x3f753f223dc9bef1,0x3f683f773f11bdc9,0xbf7fbf53be873ed8,0xbf6ebf68bea23ef1,0x3f623f733ed8bebd
.quad 0x3f733f533d2cbf46,0xbf22bf80bf113ea2,0xbf77bf383e723f75,0x3e953f793f32be87,0x3f7a3f17befebf7f,0x3dc9bf5ebf4f3e56,0xbf7dbee53f383f62,0xbef13f323f65be1d
.quad 0x3f7f3e95bf62bf22,0x3f46bef1bf753dc9,0xbf80be013f7a3e95,0xbf753e563f7ebd2c,0x3f80bd2cbf7f3dc9,0x3f7f3d8fbf80bc66,0xbf7f3e563f70bef1,0xbf62beb03f7a3d8f
.quad 0x3dc93d8f3d2c3c66,0x3e563e3a3e1d3e01,0x3ef13eb03e563d8f,0x3f5e3f4a3f323f17,0x3f463f173ebd3e01,0x3f733f7f3f7c3f68,0x3f753f4a3f053e3a,0x3ecb3f323f683f7f
.quad 0x3f7f3f6e3f283e72,0xbed83d2c3efe3f57,0x3f623f7f3f463e95,0xbf75bf22bdc93ef1,0x3f223f7c3f5e3eb0,0xbf5bbf7dbf28bc66,0x3e953f653f703ecb,0xbe3abf57bf79befe
.quad 0xbdc93f3c3f7c3ee5,0x3f1dbe87bf6ebf5b,0xbef13f053f803efe,0x3f7f3ee5bf0bbf80,0xbf463e873f7d3f0b,0x3f383f6e3d2cbf65,0xbf75bc663f733f17,0xbd2c3f703f1dbf11
.quad 0xbf7fbe953f623f22,0xbf463ef13f75bdc9,0xbf62bf0b3f4a3f2d,0xbf7dbe723f733ecb,0xbf22bf413f2d3f38,0xbf0bbf533f173f4a,0xbe95bf683f0b3f41,0x3e87bf7e3c663f7d
.quad 0x3ea23e953e873e72,0x3ed83ecb3ebd3eb0,0x3f803f7f3f793f6e,0x3f533f653f733f7c,0x3e723ef13f2d3f57,0xbf32befebe87bc66,0xbf5ebf22bea23d2c,0xbf17bf57bf7abf7d
.quad 0xbf38bf75bf7cbf4a,0x3f653f173e1dbea2,0x3ef1bdc9bf22bf75,0x3e953f463f7f3f62,0x3f7a3f623ebdbea2,0xbf7ebf2dbd2c3f1d,0x3d8f3f463f7e3f17,0x3d2cbf32bf80bf2d
.quad 0xbf70be953f173f80,0x3f7a3f41bd8fbf57,0xbf17bf7fbed83f11,0xbebd3f1d3f7e3ecb,0x3f1dbef1bf7fbeb0,0xbf5bbf533e3a3f79,0x3f6e3f22bf0bbf77,0x3f28bf05bf79bd8f
.quad 0xbdc93f753ef1bf46,0x3f223f62be95bf7f,0xbf7c3dc93f803d8f,0xbf5e3ed83f70be87,0xbee5bf623efe3f5b,0xbeb0bf6e3ecb3f68,0x3f3cbf46bf053f6b,0x3f7cbea2bf653f11
.quad 0x3f053efe3ef13ee5,0x3f1d3f173f113f0b,0x3ecb3f053f223f3c,0xbe1dbc663e013e87,0xbf7abf80bf75bf5b,0xbeb0bf11bf41bf65,0x3f3c3ee53dc9be87,0x3f413f703f803f6e
.quad 0x3e013f113f623f80,0xbf7abf77bf3cbeb0,0xbf62bf7fbf46be95,0x3f753f223dc9bef1,0x3f653ecbbe95bf57,0xbf32bd8f3f173f79,0xbe1d3f1d3f7f3f41,0x3e87bf05bf7abf53
.quad 0xbf38bf7dbef13ed8,0x3e723f6b3f5e3e01,0x3f7c3eb0bf22bf7d,0xbf2dbf7abea23f28,0xbed83f283f753e01,0x3f733f2dbecbbf80,0xbefebf7abdc93f6b,0xbf7cbe013f683f2d
.quad 0x3f7f3e95bf62bf22,0x3f46bef1bf753dc9,0xbf283f323f46bf11,0xbebd3f653f05bf4f,0xbe72bf773e953f73,0xbe01bf7d3e3a3f7a,0x3f6e3e72bf7f3d2c,0x3f173f38bf4abefe
.quad 0x3f323f2d3f283f22,0x3f463f413f3c3f38,0xbf28bf0bbed8be95,0xbf75bf68bf57bf41,0x3f1d3ecb3e1dbdc9,0x3f7f3f7d3f6b3f4a,0xbf11be723e013ef1,0xbf62bf7ebf79bf53
.quad 0x3f053d8fbecbbf46,0x3f223f6b3f7f3f5b,0xbef13dc93f223f75,0xbe95bf46bf7fbf62,0x3ed8be87bf53bf7f,0xbdc93f113f773f68,0xbebd3ed83f733f62,0x3ef1bea2bf68bf6e
.quad 0x3ea2bf11bf80bf22,0xbf463d2c3f533f73,0xbe873f323f793e95,0x3f753e72bf38bf77,0x3e56bf4fbf5e3dc9,0xbf7fbefe3f173f7a,0xbe1d3f653f32bef1,0x3f623f38bee5bf7d
.quad 0x3dc9bf75bef13f46,0xbf22bf623e953f7f,0xbd2c3f7e3e56bf75,0x3e953f7abe01bf80,0xbc66bf803d8f3f7f,0x3dc9bf7fbd2c3f80,0x3d8f3f7abeb0bf62,0xbef13f703e56bf7f
.quad 0x3f0e3f143f1a3f20,0x3eeb3ef83f023f08,0x3e483d66bdacbe64,0x3f303f143eeb3ea9,0xbf55bf2bbeebbe64,0xbf6abf7cbf7fbf72,0x3f7b3f7c3f5c3f20,0xbdac3e8e3f1a3f59
.quad 0xbf0ebf60bf80bf67,0x3f783f3f3eb7bde5,0xbe483ec43f553f80,0xbf0ebf6dbf7bbf35,0x3f553e8ebed1bf67,0xbf1a3d663f303f7e,0xbf7bbf51be0f3f20,0x3f743f603e80bf08
.quad 0x3f0e3f803f25be64,0xbce6bf51bf74bea9,0x3e48bf3fbf74be64,0xbf6fbe2c3f443f72,0xbf553e2c3f783f20,0x3f253f763e0fbf59,0x3f7b3ef8bf30bf67,0x3f02bf2bbf6a3de5
.quad 0xbf0ebf6d3e483f80,0xbf7bbec43f553f35,0xbe483f763eb7bf67,0x3e0f3f803ce6bf7e,0x3f55bf14bf4d3f20,0x3f63bef8bf5c3f08,0xbf7bbd663f7fbe64,0xbf3abf143f633ea9
.quad 0x3eb73ec43ed13ede,0x3e803e8e3e9b3ea9,0x3f783f6d3f5c3f48,0x3f743f7c3f803f7e,0xbe0fbec4bf1abf48,0x3f443f143eb73de5,0xbf80bf6dbf3abede,0xbe0fbef8bf44bf72
.quad 0xbdac3ec43f443f7a,0xbf6abf80bf5cbf08,0x3f7b3f6d3f0e0000,0xbf55bec43e483f35,0x3e9bbec4bf63bf7a,0x3ce63f2b3f7d3f59,0xbf6abf6dbeb73ede,0x3f5c3f763eebbea9
.quad 0xbf023ec43f783f48,0x3f633e2cbf30bf7e,0x3f4d3f6d3e0fbf48,0x3dacbf51bf6abde5,0x3f30bec4bf80bede,0xbf4dbf603dac3f72,0xbf25bf6d3dac3f7a,0xbf6f3d663f783f08
.quad 0xbf553ec43f7b0000,0xbe483f6d3f0ebf35,0x3eeb3f6dbe9bbf7a,0x3f3a3f3fbf1abf59,0x3f6fbec4bf6a3ede,0x3f78be8ebf743ea9,0xbe80bf6d3f023f48,0x3e9bbf7cbce63f7e
.quad 0x3e0f3e2c3e483e64,0x3ce63d663dac3de5,0x3f253f3f3f553f67,0x3e0f3e8e3ed13f08,0x3f743f803f7b3f67,0x3e803ef83f303f59,0x3f783f513f0e3e64,0x3eb73f2b3f633f7e
.quad 0x3f303e8ebe48bf20,0x3eeb3f513f7d3f72,0x3e48bec4bf55bf80,0x3f0e3f6d3f7b3f35,0xbeb7bf60bf7bbf20,0x3f253f7c3f5c3ea9,0xbf4dbf7cbf0e3e64,0x3f3a3f803f25bde5
.quad 0xbf7fbf2b3e483f67,0x3f4d3f763eb7bf08,0xbf63bd663f553f67,0x3f5c3f603ce6bf59,0xbf023f143f7b3e64,0x3f6a3f3fbe9bbf7e,0x3ce63f763f0ebf20,0x3f743f14bf1abf72
.quad 0x3f0e3f6dbe48bf80,0x3f7b3ec4bf55bf35,0x3f6a3ef8bf55bf20,0x3f7f3e2cbf78bea9,0x3f7dbe2cbf7b3e64,0x3f80bd66bf7f3de5,0x3f44bf3fbf0e3f67,0x3f7dbe8ebf6a3f08
.quad 0xbdacbd66bce60000,0xbe48be2cbe0fbde5,0xbed1be8ebe0f0000,0xbf55bf3fbf25bf08,0xbf30bef8be800000,0xbf7bbf80bf74bf59,0xbf63bf2bbeb70000,0xbf0ebf51bf78bf7e
.quad 0xbf7dbf51beeb0000,0x3e48be8ebf30bf72,0xbf7bbf6dbf0e0000,0x3f553ec4be48bf35,0xbf5cbf7cbf250000,0x3f7b3f603eb7bea9,0xbf25bf80bf3a0000,0x3f0e3f7c3f4d3de5
.quad 0xbeb7bf76bf4d0000,0xbe483f2b3f7f3f08,0xbce6bf60bf5c0000,0xbf553d663f633f59,0x3e9bbf3fbf6a0000,0xbf7bbf143f023f7e,0x3f1abf14bf740000,0xbf0ebf76bce63f72
.quad 0x3f55bec4bf7b0000,0x3e48bf6dbf0e3f35,0x3f78be2cbf7f0000,0x3f55bef8bf6a3ea9,0x3f7f3d66bf800000,0x3f7b3e2cbf7dbde5,0x3f6a3e8ebf7d0000,0x3f0e3f3fbf44bf08
.quad 0x3f553f513f4d3f48,0x3f633f603f5c3f59,0xbf7bbf80bf7fbf7a,0xbf3abf51bf63bf72,0x3f0e3f3f3f633f7a,0xbed1be2c3dac3ea9,0x3e48be2cbf02bf48,0x3f7f3f763f4d3f08
.quad 0xbf55bef8bce63ede,0xbe80bf2bbf6fbf7e,0x3f7b3f6d3f0e0000,0xbf55bec43e483f35,0xbf0ebf76bf6abede,0x3f4d3f803f3a3de5,0xbe483f143f7d3f48,0x3e9bbef8bf78bf59
.quad 0x3f553d66bf44bf7a,0xbf80bf143e9b3f72,0xbf7bbf2b3e9b3f7a,0x3eb73f7c3f25bea9,0x3f0e3f7c3e80bf48,0x3f44be8ebf7dbf08,0x3e48bf60bf3a3ede,0xbf5cbf3f3ed13f7e
.quad 0xbf553ec43f7b0000,0xbe483f6d3f0ebf35,0x3f7b3e8ebf6fbede,0x3f7dbd66bf80bde5,0xbf0ebf513f1a3f48,0xbeebbf603f023f59,0xbe483f80bdacbf7a,0xbf303f513eebbf72
.quad 0x3f6f3f6d3f6a3f67,0x3f783f763f743f72,0xbe80bec4bf02bf20,0x3e9b3e2c3ce6bde5,0xbf7dbf6dbf4dbf20,0xbf25bf51bf6fbf7e,0x3ce63ec43f303f67,0xbf7dbf60bf25bea9
.quad 0x3f7f3f6d3f253e64,0xbed13d663f023f59,0x3e48bec4bf55bf80,0x3f0e3f6d3f7b3f35,0xbf74bf6dbeeb3e64,0x3f803f3f3e0fbf08,0xbed13ec43f6f3f67,0x3f02be8ebf63bf72
.quad 0x3f5c3f6d3e80bf20,0xbeebbf7cbf3a3de5,0x3f1abec4bf7dbf20,0xbf7fbf143ed13f7e,0xbf3abf6dbce63f67,0xbf1a3ef83f7f3ea9,0xbf443ec43f7f3e64,0x3eb73f803e80bf59
.quad 0x3f0e3f6dbe48bf80,0x3f7b3ec4bf55bf35,0x3f63bec4bf743e64,0x3f30bf2bbf4d3f08,0xbeb7bf6d3ed13f67,0xbe80bf763e9b3f72,0xbf783ec43f5cbf20,0xbf74be2c3f80bde5
.quad 0x3f7d3f7c3f7b3f7a,0x3f803f803f7f3f7e,0x3f443f2b3f0e3ede,0x3f7d3f763f6a3f59,0x3e9b3d66be48bede,0x3f783f603f3a3f08,0xbe80bf14bf55bf7a,0x3f6f3f3f3eeb3de5
.quad 0xbf3abf76bf7bbf48,0x3f633f143e0fbea9,0xbf7bbf6dbf0e0000,0x3f553ec4be48bf35,0xbf6fbef83e483f48,0x3f443e2cbf02bf72,0xbf1a3e2c3f553f7a,0x3f30bd66bf44bf7e
.quad 0xbdac3f3f3f7b3ede,0x3f1abe8ebf6fbf59,0x3eeb3f803f0ebede,0x3f02bef8bf80bf08,0x3f5c3f51be48bf7a,0x3ed1bf2bbf74bde5,0x3f803e8ebf55bf48,0x3e9bbf51bf4d3ea9
.quad 0x3f55bec4bf7b0000,0x3e48bf6dbf0e3f35,0x3ed1bf60bf0e3f48,0x3dacbf7cbe803f72,0xbe0fbf7c3e483f7a,0xbce6bf803dac3f7e,0xbf25bf2b3f553ede,0xbe0fbf763ed13f59
.quad 0x3f7f3f803f803f80,0x3f7b3f7c3f7d3f7e,0x3f6a3f763f7d3f80,0x3f0e3f2b3f443f59,0x3f3a3f603f783f80,0xbe483d663e9b3f08,0x3eeb3f3f3f6f3f80,0xbf55bf14be803de5
.quad 0x3e0f3f143f633f80,0xbf7bbf76bf3abea9,0xbe483ec43f553f80,0xbf0ebf6dbf7bbf35,0xbf023e2c3f443f80,0x3e48bef8bf6fbf72,0xbf44bd663f303f80,0x3f553e2cbf1abf7e
.quad 0xbf6fbe8e3f1a3f80,0x3f7b3f3fbdacbf59,0xbf80bef83f023f80,0x3f0e3f803eebbf08,0xbf74bf2b3ed13f80,0xbe483f513f5cbde5,0xbf4dbf513e9b3f80,0xbf553e8e3f803ea9
.quad 0xbf0ebf6d3e483f80,0xbf7bbec43f553f35,0xbe80bf7c3dac3f80,0xbf0ebf603ed13f72,0x3dacbf80bce63f80,0x3e48bf7cbe0f3f7e,0x3ed1bf76be0f3f80,0x3f55bf2bbf253f59
.quad 0x3f0b3f113f173f1d,0x3ee53ef13efe3f05,0x3e873e01bc66be1d,0x3f3c3f223f053ecb,0xbf65bf41bf11beb0,0xbf5bbf75bf80bf7a,0x3f6e3f803f703f41,0xbe873dc93ee53f3c
.quad 0xbeb0bf3cbf77bf7a,0x3f803f623f113e01,0xbef13dc93f223f75,0xbe95bf46bf7fbf62,0x3f793f17bd8fbf32,0xbf57be953ecb3f65,0xbf53bf7abf053e87,0x3f413f7f3f1dbe1d
.quad 0x3e013f5e3f6b3e72,0x3ed8bef1bf7dbf38,0x3f28bea2bf7abf2d,0xbf7dbf223eb03f7c,0xbf80becb3f2d3f73,0x3e013f753f28bed8,0x3f2d3f68be01bf7c,0x3f6bbdc9bf7abefe
.quad 0x3dc9bf75bef13f46,0xbf22bf623e953f7f,0xbf4f3f053f65bebd,0xbf113f463f32bf28,0x3f7a3e3abf7dbe01,0x3f733e95bf77be72,0xbefebf4a3f383f17,0x3d2cbf7f3e723f6e
.quad 0x3eb03ebd3ecb3ed8,0x3e723e873e953ea2,0x3f7c3f733f653f53,0x3f6e3f793f7f3f80,0xbc66be87befebf32,0x3f573f2d3ef13e72,0xbf7dbf7abf57bf17,0x3d2cbea2bf22bf5e
.quad 0xbea23e1d3f173f65,0xbf4abf7cbf75bf38,0x3f623f7f3f463e95,0xbf75bf22bdc93ef1,0x3f1dbd2cbf2dbf7e,0xbea23ebd3f623f7a,0xbf2dbf80bf323d2c,0x3f173f7e3f463d8f
.quad 0xbf57bd8f3f413f7a,0x3f803f17be95bf70,0x3ecb3f7e3f1dbebd,0x3f11bed8bf7fbf17,0x3f793e3abf53bf5b,0xbeb0bf7fbef13f1d,0xbd8fbf79bf053f28,0xbf77bf0b3f223f6e
.quad 0xbf7fbe953f623f22,0xbf463ef13f75bdc9,0xbe873f703ed8bf5e,0x3d8f3f803dc9bf7c,0x3f683ecbbf6ebeb0,0x3f5b3efebf62bee5,0x3f11bf65bea23f7c,0x3f6bbf05bf463f3c
.quad 0x3e013e1d3e3a3e56,0x3c663d2c3d8f3dc9,0x3f173f323f4a3f5e,0x3d8f3e563eb03ef1,0x3f683f7c3f7f3f73,0x3e013ebd3f173f46,0x3f7f3f683f323ecb,0x3e3a3f053f4a3f75
.quad 0x3f573efe3d2cbed8,0x3e723f283f6e3f7f,0x3ef1bdc9bf22bf75,0x3e953f463f7f3f62,0xbc66bf28bf7dbf5b,0x3eb03f5e3f7c3f22,0xbefebf79bf57be3a,0x3ecb3f703f653e95
.quad 0xbf5bbf6ebe873f1d,0x3ee53f7c3f3cbdc9,0xbf80bf0b3ee53f7f,0x3efe3f803f05bef1,0xbf653d2c3f6e3f38,0x3f0b3f7d3e87bf46,0xbf113f1d3f70bd2c,0x3f173f73bc66bf75
.quad 0xbdc93f753ef1bf46,0x3f223f62be95bf7f,0x3ecb3f73be72bf7d,0x3f2d3f4abf0bbf62,0x3f4a3f17bf53bf0b,0x3f383f2dbf41bf22,0x3f7d3c66bf7e3e87,0x3f413f0bbf68be95
.quad 0xbdc9bd8fbd2cbc66,0xbe56be3abe1dbe01,0xbef1beb0be56bd8f,0xbf5ebf4abf32bf17,0xbf46bf17bebdbe01,0xbf73bf7fbf7cbf68,0xbf75bf4abf05be3a,0xbecbbf32bf68bf7f
.quad 0xbf7fbf6ebf28be72,0x3ed8bd2cbefebf57,0xbf62bf7fbf46be95,0x3f753f223dc9bef1,0xbf22bf7cbf5ebeb0,0x3f5b3f7d3f283c66,0xbe95bf65bf70becb,0x3e3a3f573f793efe
.quad 0x3dc9bf3cbf7cbee5,0xbf1d3e873f6e3f5b,0x3ef1bf05bf80befe,0xbf7fbee53f0b3f80,0x3f46be87bf7dbf0b,0xbf38bf6ebd2c3f65,0x3f753c66bf73bf17,0x3d2cbf70bf1d3f11
.quad 0x3f7f3e95bf62bf22,0x3f46bef1bf753dc9,0x3f623f0bbf4abf2d,0x3f7d3e72bf73becb,0x3f223f41bf2dbf38,0x3f0b3f53bf17bf4a,0x3e953f68bf0bbf41,0xbe873f7ebc66bf7d
.quad 0x3f573f533f4f3f4a,0x3f653f623f5e3f5b,0xbf77bf7ebf80bf7d,0xbf2dbf46bf5bbf6b,0x3ee53f283f533f70,0xbf05be95bd2c3e56,0x3ebd3c66beb0bf28,0x3f773f7f3f653f2d
.quad 0xbf70bf2dbe873e56,0xbc66bef1bf53bf7e,0x3f623f7f3f463e95,0xbf75bf22bdc93ef1,0xbe72bf4fbf7fbf38,0x3f0b3f753f6b3ee5,0xbf113e563f5b3f77,0x3f28bdc9bf4abf7d
.quad 0x3f7e3efebecbbf79,0xbf68bf62be1d3f32,0xbf41bf73be563f3c,0xbe1d3f463f703e3a,0x3c663f6b3f3cbea2,0x3f7e3e95bf41bf68,0x3f3cbed8bf7ebe3a,0xbecbbf7fbe563f5e
.quad 0xbf7fbe953f623f22,0xbf463ef13f75bdc9,0x3f173f5bbee5bf6e,0x3f533f22bf38bf41,0x3e56bf7cbe1d3f7e,0x3ea2bf75be873f79,0xbf5e3f1d3f32bf4f,0xbf803dc93f79bebd
.quad 0x3f703f6e3f6b3f68,0x3f793f773f753f73,0xbe3abea2bee5bf11,0x3ebd3e723dc9bd2c,0xbf80bf77bf5ebf38,0xbf0bbf3cbf62bf79,0xbe1d3e563f0b3f4f,0xbf80bf73bf46befe
.quad 0x3f733f7d3f4f3ee5,0xbf1dbe3a3e953f32,0x3ef1bdc9bf22bf75,0x3e953f463f7f3f62,0xbf4abf80bf3cbe01,0x3f733f6e3ef1be56,0xbf3cbc663f383f80,0x3f4f3e01bf22bf7f
.quad 0x3f0b3f7f3f28be56,0xbc66bf4fbf75beb0,0x3f6b3e01bf4abf6e,0xbf53bf68bdc93f4f,0xbe72bf7cbf113f05,0xbf70bd8f3f623f4a,0xbf7fbe723f5b3f41,0xbe873f573f46bebd
.quad 0xbdc93f753ef1bf46,0x3f223f62be95bf7f,0x3f773eb0bf68befe,0x3f7f3c66bf7fbe3a,0x3ed8bf6bbebd3f70,0x3f05bf5ebef13f65,0xbf53bee53f733e3a,0xbecbbf5b3f223f2d
.quad 0x3f7e3f7d3f7c3f7a,0x3f803f803f7f3f7f,0x3f4f3f383f1d3efe,0x3f7f3f7a3f703f62,0x3ed83e3abd8fbea2,0x3f7e3f6e3f4f3f22,0xbd8fbed8bf38bf6b,0x3f7c3f5b3f1d3e95
.quad 0xbf0bbf5ebf80bf68,0x3f793f413ebdbdc9,0xbf62bf7fbf46be95,0x3f753f223dc9bef1,0xbf80bf41be1d3f05,0x3f703efebe3abf46,0xbf5ebe723f0b3f7c,0x3f6b3eb0bee5bf75
.quad 0xbf053ebd3f773f4a,0x3f653e3abf2dbf7f,0xbd2c3f573f653d8f,0x3f5e3c66bf5bbf62,0x3ee53f803ebdbf32,0x3f57be1dbf77bf22,0x3f533f4abeb0bf80,0x3f4fbea2bf80be95
.quad 0x3f7f3e95bf62bf22,0x3f46bef1bf753dc9,0x3f6bbea2bf793e1d,0x3f3cbf1dbf573ef1,0x3f1dbf4fbf113f57,0x3f32bf3cbf283f46,0x3e1dbf803e013f77,0x3f28bf57bed83f75
.quad 0x3f7f3f7f3f803f80,0x3f7a3f7c3f7d3f7e,0x3f623f703f7a3f7f,0x3efe3f1d3f383f4f,0x3f223f4f3f6e3f7e,0xbea2bd8f3e3a3ed8,0x3e953f1d3f5b3f7c,0xbf6bbf38bed8bd8f
.quad 0xbdc93ebd3f413f79,0xbf68bf80bf5ebf0b,0xbef13dc93f223f75,0xbe95bf46bf7fbf62,0xbf46be3a3efe3f70,0x3f05be1dbf41bf80,0xbf75bee53eb03f6b,0x3f7c3f0bbe72bf5e
.quad 0xbf7fbf2d3e3a3f65,0x3f4a3f773ebdbf05,0xbf62bf5b3c663f5e,0x3d8f3f653f57bd2c,0xbf22bf77be1d3f57,0xbf323ebd3f803ee5,0xbe95bf80bea23f4f,0xbf80beb03f4a3f53
.quad 0x3dc9bf75bef13f46,0xbf22bf623e953f7f,0x3ef1bf57bf1d3f3c,0x3e1dbf79bea23f6b,0x3f46bf28bf3c3f32,0x3f57bf11bf4f3f1d,0x3f75bed8bf573f28,0x3f773e01bf803e1d
.quad 0xbe9bbe8ebe80be64,0xbed1bec4beb7bea9,0xbf80bf7cbf74bf67,0xbf5cbf6dbf78bf7e,0xbeb7bf14bf44bf67,0x3f1a3ec43e0fbde5,0x3f443ef83e0fbe64,0x3f3a3f6d3f803f72
.quad 0x3f5c3f803f6a3f20,0xbf44bec43dac3f08,0xbe483ec43f553f80,0xbf0ebf6dbf7bbf35,0xbf7dbf2bbce63f20,0x3f633ec4be9bbf59,0xbeebbf76bf5cbe64,0x3eb73f6d3f6a3ea9
.quad 0x3f30be2cbf63bf67,0xbf78bec43f023f7e,0x3f6a3f51bdacbf67,0xbe0fbf6dbf4d3de5,0xbdac3f603f4dbe64,0x3f803ec4bf30bf72,0xbf78bd663f6f3f20,0xbdac3f6d3f25bf08
.quad 0xbf0ebf6d3e483f80,0xbf7bbec43f553f35,0x3f1abf3fbf3a3f20,0x3e9bbf6dbeeb3f59,0x3f743e8ebf78be64,0x3f6a3ec4bf6fbea9,0x3ce63f7cbe9bbf67,0xbf023f6d3e80bf7e
.quad 0xbf02bef8beebbede,0xbf1abf14bf0ebf08,0xbeebbf14bf30bf48,0x3dacbd66be48bea9,0x3f7f3f7c3f6a3f48,0x3eeb3f2b3f553f72,0xbf1abe8e3dac3ede,0xbf5cbf7cbf7bbf59
.quad 0xbeb7bf3fbf78bf7a,0x3f803f603f0e3de5,0x3f7b3f6d3f0e0000,0xbf55bec43e483f35,0xbf30bd663f1a3f7a,0x3ed1be8ebf55bf7e,0xbe80bf60bf74bede,0x3e0f3f513f7b3f08
.quad 0x3f743f513ce6bf48,0xbf25bf80bf0e3ea9,0xbf443e2c3f6f3f48,0x3f743f3fbe48bf72,0xbe0fbf76bf253ede,0xbf78be2c3f553f59,0x3f6a3f2bbf02bf7a,0x3f30bef8bf7bbde5
.quad 0xbf553ec43f7b0000,0xbe483f6d3f0ebf35,0xbce6bf80be0f3f7a,0xbeb7bf763e483f7e,0x3f5c3ef8bf63bede,0x3f4d3f14bf55bf08,0xbf633f143f3abf48,0xbf7f3d663f7bbea9
.quad 0xbf30bf2bbf25bf20,0xbf44bf3fbf3abf35,0x3f1a3ef83eb73e64,0x3f6f3f603f4d3f35,0xbf02be8ebce63e64,0xbf80bf76bf5cbf35,0x3ed13d66be9bbf20,0x3f743f803f6a3f35
.quad 0xbe9b3e2c3f1a3f67,0xbf4dbf7cbf74bf35,0x3e48bec4bf55bf80,0x3f0e3f6d3f7b3f35,0xbdac3f143f783f67,0xbe80bf51bf7fbf35,0xbce6bf3fbf7fbf20,0xbdac3f2b3f803f35
.quad 0x3e0f3f603f6a3e64,0x3ed1bef8bf7dbf35,0xbe80bf76bf3a3e64,0xbf303e8e3f783f35,0x3eb73f803eebbf20,0x3f63bd66bf6fbf35,0xbeebbf7cbe0f3f67,0xbf7dbe2c3f633f35
.quad 0x3f0e3f6dbe48bf80,0x3f7b3ec4bf55bf35,0xbf25bf513f023f67,0xbf5cbf143f443f35,0x3f3a3f2bbf44bf20,0x3f253f3fbf30bf35,0xbf4dbef83f6f3e64,0xbeb7bf603f1a3f35
.quad 0xbf55bf51bf4dbf48,0xbf63bf60bf5cbf59,0x3f7b3f803f7f3f7a,0x3f3a3f513f633f72,0xbf0ebf3fbf63bf7a,0x3ed13e2cbdacbea9,0xbe483e2c3f023f48,0xbf7fbf76bf4dbf08
.quad 0x3f553ef83ce6bede,0x3e803f2b3f6f3f7e,0xbf7bbf6dbf0e0000,0x3f553ec4be48bf35,0x3f0e3f763f6a3ede,0xbf4dbf80bf3abde5,0x3e48bf14bf7dbf48,0xbe9b3ef83f783f59
.quad 0xbf55bd663f443f7a,0x3f803f14be9bbf72,0x3f7b3f2bbe9bbf7a,0xbeb7bf7cbf253ea9,0xbf0ebf7cbe803f48,0xbf443e8e3f7d3f08,0xbe483f603f3abede,0x3f5c3f3fbed1bf7e
.quad 0x3f55bec4bf7b0000,0x3e48bf6dbf0e3f35,0xbf7bbe8e3f6f3ede,0xbf7d3d663f803de5,0x3f0e3f51bf1abf48,0x3eeb3f60bf02bf59,0x3e48bf803dac3f7a,0x3f30bf51beeb3f72
.quad 0x3f743f763f783f7a,0x3f6a3f6d3f6f3f72,0x3ce63e2c3e9b3ede,0xbf02bec4be80bde5,0xbf6fbf51bf25bede,0xbf4dbf6dbf7dbf7e,0xbf25bf60bf7dbf7a,0x3f303ec43ce6bea9
.quad 0x3f023d66bed1bf48,0x3f253f6d3f7f3f59,0x3f7b3f6d3f0e0000,0xbf55bec43e483f35,0x3e0f3f3f3f803f48,0xbeebbf6dbf74bf08,0xbf63be8e3f023f7a,0x3f6f3ec4bed1bf72
.quad 0xbf3abf7cbeeb3ede,0x3e803f6d3f5c3de5,0x3ed1bf14bf7fbede,0xbf7dbec43f1a3f7e,0x3f7f3ef8bf1abf7a,0xbce6bf6dbf3a3ea9,0x3e803f803eb7bf48,0x3f7f3ec4bf44bf59
.quad 0xbf553ec43f7b0000,0xbe483f6d3f0ebf35,0xbf4dbf2b3f303f48,0xbf74bec43f633f08,0x3e9bbf76be803f7a,0x3ed1bf6dbeb73f72,0x3f80be2cbf743ede,0x3f5c3ec4bf78bde5
.quad 0x3f5c3f603f633f67,0x3f4d3f513f553f59,0xbf63bf51bf3abf20,0xbf7fbf80bf7bbf72,0x3dacbe2cbed1bf20,0x3f633f3f3f0e3ea9,0x3f4d3f763f7f3f67,0xbf02be2c3e483f08
.quad 0xbf6fbf2bbe803e64,0xbce6bef8bf55bf7e,0x3e48bec4bf55bf80,0x3f0e3f6d3f7b3f35,0x3f3a3f803f4d3e64,0xbf6abf76bf0e3de5,0xbf78bef83e9b3f67,0x3f7d3f14be48bf59
.quad 0x3e9bbf14bf80bf20,0xbf443d663f553f72,0x3f253f7c3eb7bf20,0x3e9bbf2bbf7bbea9,0xbf7dbe8e3f443f67,0x3e803f7c3f0ebf08,0x3ed1bf3fbf5c3e64,0xbf3abf603e483f7e
.quad 0x3f0e3f6dbe48bf80,0x3f7b3ec4bf55bf35,0xbf80bd663f7d3e64,0xbf6f3e8e3f7bbde5,0x3f02bf60beeb3f67,0x3f1abf51bf0e3f59,0x3eeb3f51bf30bf20,0xbdac3f80be48bf72
.quad 0x3f3a3f3f3f443f48,0x3f253f2b3f303f35,0xbf4dbf60bf6fbf7a,0xbeb7bef8bf1abf35,0x3f5c3f763f803f7a,0x3ce63e8e3f023f35,0xbf6abf80bf74bf48,0x3e9bbd66bed1bf35
.quad 0x3f743f7c3f4d3ede,0xbf1abe2c3e9b3f35,0xbf7bbf6dbf0e0000,0x3f553ec4be48bf35,0x3f7f3f513e80bede,0xbf78bf143dac3f35,0xbf80bf2b3dac3f48,0x3f7f3f3f3ce6bf35
.quad 0x3f7d3ef8bed1bf7a,0xbf6abf60be0f3f35,0xbf78be8e3f303f7a,0x3f3a3f763e80bf35,0x3f6f3d66bf63bf48,0xbeebbf80beb73f35,0xbf633e2c3f7d3ede,0x3e0f3f7c3eebbf35
.quad 0x3f55bec4bf7b0000,0x3e48bf6dbf0e3f35,0xbf443f143f5cbede,0xbf023f513f25bf35,0x3f30bf3fbf253f48,0x3f44bf2bbf3a3f35,0xbf1a3f603eb7bf7a,0xbf6f3ef83f4dbf35
.quad 0x3f0e3f143f1a3f20,0x3eeb3ef83f023f08,0x3e483d66bdacbe64,0x3f303f143eeb3ea9,0xbf55bf2bbeebbe64,0xbf6abf7cbf7fbf72,0x3f7b3f7c3f5c3f20,0xbdac3e8e3f1a3f59
.quad 0xbf0ebf60bf80bf67,0x3f783f3f3eb7bde5,0xbe483ec43f553f80,0xbf0ebf6dbf7bbf35,0x3f553e8ebed1bf67,0xbf1a3d663f303f7e,0xbf7bbf51be0f3f20,0x3f743f603e80bf08
.quad 0x3f0e3f803f25be64,0xbce6bf51bf74bea9,0x3e48bf3fbf74be64,0xbf6fbe2c3f443f72,0xbf553e2c3f783f20,0x3f253f763e0fbf59,0x3f7b3ef8bf30bf67,0x3f02bf2bbf6a3de5
.quad 0xbf0ebf6d3e483f80,0xbf7bbec43f553f35,0xbe483f763eb7bf67,0x3e0f3f803ce6bf7e,0x3f55bf14bf4d3f20,0x3f63bef8bf5c3f08,0xbf7bbd663f7fbe64,0xbf3abf143f633ea9
.quad 0xbea2be95be87be72,0xbed8becbbebdbeb0,0xbf80bf7fbf79bf6e,0xbf53bf65bf73bf7c,0xbe72bef1bf2dbf57,0x3f323efe3e873c66,0x3f5e3f223ea2bd2c,0x3f173f573f7a3f7d
.quad 0x3f383f753f7c3f4a,0xbf65bf17be1d3ea2,0xbef13dc93f223f75,0xbe95bf46bf7fbf62,0xbf7abf62bebd3ea2,0x3f7e3f2d3d2cbf1d,0xbd8fbf46bf7ebf17,0xbd2c3f323f803f2d
.quad 0x3f703e95bf17bf80,0xbf7abf413d8f3f57,0x3f173f7f3ed8bf11,0x3ebdbf1dbf7ebecb,0xbf1d3ef13f7f3eb0,0x3f5b3f53be3abf79,0xbf6ebf223f0b3f77,0xbf283f053f793d8f
.quad 0x3dc9bf75bef13f46,0xbf22bf623e953f7f,0x3f7cbdc9bf80bd8f,0x3f5ebed8bf703e87,0x3ee53f62befebf5b,0x3eb03f6ebecbbf68,0xbf3c3f463f05bf6b,0xbf7c3ea23f65bf11
.quad 0xbf05befebef1bee5,0xbf1dbf17bf11bf0b,0xbecbbf05bf22bf3c,0x3e1d3c66be01be87,0x3f7a3f803f753f5b,0x3eb03f113f413f65,0xbf3cbee5bdc93e87,0xbf41bf70bf80bf6e
.quad 0xbe01bf11bf62bf80,0x3f7a3f773f3c3eb0,0x3f623f7f3f463e95,0xbf75bf22bdc93ef1,0xbf65becb3e953f57,0x3f323d8fbf17bf79,0x3e1dbf1dbf7fbf41,0xbe873f053f7a3f53
.quad 0x3f383f7d3ef1bed8,0xbe72bf6bbf5ebe01,0xbf7cbeb03f223f7d,0x3f2d3f7a3ea2bf28,0x3ed8bf28bf75be01,0xbf73bf2d3ecb3f80,0x3efe3f7a3dc9bf6b,0x3f7c3e01bf68bf2d
.quad 0xbf7fbe953f623f22,0xbf463ef13f75bdc9,0x3f28bf32bf463f11,0x3ebdbf65bf053f4f,0x3e723f77be95bf73,0x3e013f7dbe3abf7a,0xbf6ebe723f7fbd2c,0xbf17bf383f4a3efe
.quad 0xbf32bf2dbf28bf22,0xbf46bf41bf3cbf38,0x3f283f0b3ed83e95,0x3f753f683f573f41,0xbf1dbecbbe1d3dc9,0xbf7fbf7dbf6bbf4a,0x3f113e72be01bef1,0x3f623f7e3f793f53
.quad 0xbf05bd8f3ecb3f46,0xbf22bf6bbf7fbf5b,0x3ef1bdc9bf22bf75,0x3e953f463f7f3f62,0xbed83e873f533f7f,0x3dc9bf11bf77bf68,0x3ebdbed8bf73bf62,0xbef13ea23f683f6e
.quad 0xbea23f113f803f22,0x3f46bd2cbf53bf73,0x3e87bf32bf79be95,0xbf75be723f383f77,0xbe563f4f3f5ebdc9,0x3f7f3efebf17bf7a,0x3e1dbf65bf323ef1,0xbf62bf383ee53f7d
.quad 0xbdc93f753ef1bf46,0x3f223f62be95bf7f,0x3d2cbf7ebe563f75,0xbe95bf7a3e013f80,0x3c663f80bd8fbf7f,0xbdc93f7f3d2cbf80,0xbd8fbf7a3eb03f62,0x3ef1bf70be563f7f
.quad 0xbf57bf53bf4fbf4a,0xbf65bf62bf5ebf5b,0x3f773f7e3f803f7d,0x3f2d3f463f5b3f6b,0xbee5bf28bf53bf70,0x3f053e953d2cbe56,0xbebdbc663eb03f28,0xbf77bf7fbf65bf2d
.quad 0x3f703f2d3e87be56,0x3c663ef13f533f7e,0xbf62bf7fbf46be95,0x3f753f223dc9bef1,0x3e723f4f3f7f3f38,0xbf0bbf75bf6bbee5,0x3f11be56bf5bbf77,0xbf283dc93f4a3f7d
.quad 0xbf7ebefe3ecb3f79,0x3f683f623e1dbf32,0x3f413f733e56bf3c,0x3e1dbf46bf70be3a,0xbc66bf6bbf3c3ea2,0xbf7ebe953f413f68,0xbf3c3ed83f7e3e3a,0x3ecb3f7f3e56bf5e
.quad 0x3f7f3e95bf62bf22,0x3f46bef1bf753dc9,0xbf17bf5b3ee53f6e,0xbf53bf223f383f41,0xbe563f7c3e1dbf7e,0xbea23f753e87bf79,0x3f5ebf1dbf323f4f,0x3f80bdc9bf793ebd
.quad 0x3f733f753f773f79,0x3f683f6b3f6e3f70,0xbd2c3dc93e723ebd,0xbf11bee5bea2be3a,0xbf79bf62bf3cbf0b,0xbf38bf5ebf77bf80,0xbefebf46bf73bf80,0x3f4f3f0b3e56be1d
.quad 0x3f323e95be3abf1d,0x3ee53f4f3f7d3f73,0x3f623f7f3f463e95,0xbf75bf22bdc93ef1,0xbe563ef13f6e3f73,0xbe01bf3cbf80bf4a,0xbf7fbf223e013f4f,0x3f803f38bc66bf3c
.quad 0xbeb0bf75bf4fbc66,0xbe563f283f7f3f0b,0x3f4fbdc9bf68bf53,0xbf6ebf4a3e013f6b,0x3f4a3f62bd8fbf70,0x3f05bf11bf7cbe72,0xbebd3f463f57be87,0x3f413f5bbe72bf7f
.quad 0xbf7fbe953f623f22,0xbf463ef13f75bdc9,0xbe3abf7f3c663f7f,0xbefebf683eb03f77,0x3f65bef1bf5e3f05,0x3f70bebdbf6b3ed8,0x3f2d3f22bf5bbecb,0x3e3a3f73bee5bf53
.quad 0x3f5b3f5e3f623f65,0x3f4a3f4f3f533f57,0xbf6bbf5bbf46bf2d,0xbf7dbf80bf7ebf77,0x3e56bd2cbe95bf05,0x3f703f533f283ee5,0x3f2d3f653f7f3f77,0xbf28beb03c663ebd
.quad 0xbf7ebf53bef1bc66,0x3e56be87bf2dbf70,0x3ef1bdc9bf22bf75,0x3e953f463f7f3f62,0x3ee53f6b3f753f0b,0xbf38bf7fbf4fbe72,0xbf7dbf4abdc93f28,0x3f773f5b3e56bf11
.quad 0x3f32be1dbf62bf68,0xbf79becb3efe3f7e,0x3e3a3f703f46be1d,0x3f3cbe56bf73bf41,0xbf68bf413e953f7e,0xbea23f3c3f6b3c66,0x3f5ebe56bf7fbecb,0xbe3abf7ebed83f3c
.quad 0xbdc93f753ef1bf46,0x3f223f62be95bf7f,0xbf41bf383f223f53,0xbf6ebee53f5b3f17,0x3f79be87bf753ea2,0x3f7ebe1dbf7c3e56,0xbebd3f793dc9bf80,0xbf4f3f323f1dbf5e
.quad 0x3f383f3c3f413f46,0x3f223f283f2d3f32,0xbf41bf57bf68bf75,0xbe95bed8bf0bbf28,0x3f4a3f6b3f7d3f7f,0xbdc93e1d3ecb3f1d,0xbf53bf79bf7ebf62,0x3ef13e01be72bf11
.quad 0x3f5b3f7f3f6b3f22,0xbf46becb3d8f3f05,0xbf62bf7fbf46be95,0x3f753f223dc9bef1,0x3f683f773f11bdc9,0xbf7fbf53be873ed8,0xbf6ebf68bea23ef1,0x3f623f733ed8bebd
.quad 0x3f733f533d2cbf46,0xbf22bf80bf113ea2,0xbf77bf383e723f75,0x3e953f793f32be87,0x3f7a3f17befebf7f,0x3dc9bf5ebf4f3e56,0xbf7dbee53f383f62,0xbef13f323f65be1d
.quad 0x3f7f3e95bf62bf22,0x3f46bef1bf753dc9,0xbf80be013f7a3e95,0xbf753e563f7ebd2c,0x3f80bd2cbf7f3dc9,0x3f7f3d8fbf80bc66,0xbf7f3e563f70bef1,0xbf62beb03f7a3d8f
.quad 0x3f0b3f113f173f1d,0x3ee53ef13efe3f05,0x3e873e01bc66be1d,0x3f3c3f223f053ecb,0xbf65bf41bf11beb0,0xbf5bbf75bf80bf7a,0x3f6e3f803f703f41,0xbe873dc93ee53f3c
.quad 0xbeb0bf3cbf77bf7a,0x3f803f623f113e01,0xbef13dc93f223f75,0xbe95bf46bf7fbf62,0x3f793f17bd8fbf32,0xbf57be953ecb3f65,0xbf53bf7abf053e87,0x3f413f7f3f1dbe1d
.quad 0x3e013f5e3f6b3e72,0x3ed8bef1bf7dbf38,0x3f28bea2bf7abf2d,0xbf7dbf223eb03f7c,0xbf80becb3f2d3f73,0x3e013f753f28bed8,0x3f2d3f68be01bf7c,0x3f6bbdc9bf7abefe
.quad 0x3dc9bf75bef13f46,0xbf22bf623e953f7f,0xbf4f3f053f65bebd,0xbf113f463f32bf28,0x3f7a3e3abf7dbe01,0x3f733e95bf77be72,0xbefebf4a3f383f17,0x3d2cbf7f3e723f6e
.quad 0xbf6fbf6dbf6abf67,0xbf78bf76bf74bf72,0x3e803ec43f023f20,0xbe9bbe2cbce63de5,0x3f7d3f6d3f4d3f20,0x3f253f513f6f3f7e,0xbce6bec4bf30bf67,0x3f7d3f603f253ea9
.quad 0xbf7fbf6dbf25be64,0x3ed1bd66bf02bf59,0xbe483ec43f553f80,0xbf0ebf6dbf7bbf35,0x3f743f6d3eebbe64,0xbf80bf3fbe0f3f08,0x3ed1bec4bf6fbf67,0xbf023e8e3f633f72
.quad 0xbf5cbf6dbe803f20,0x3eeb3f7c3f3abde5,0xbf1a3ec43f7d3f20,0x3f7f3f14bed1bf7e,0x3f3a3f6d3ce6bf67,0x3f1abef8bf7fbea9,0x3f44bec4bf7fbe64,0xbeb7bf80be803f59
.quad 0xbf0ebf6d3e483f80,0xbf7bbec43f553f35,0xbf633ec43f74be64,0xbf303f2b3f4dbf08,0x3eb73f6dbed1bf67,0x3e803f76be9bbf72,0x3f78bec4bf5c3f20,0x3f743e2cbf803de5
.quad 0xbf7dbf7cbf7bbf7a,0xbf80bf80bf7fbf7e,0xbf44bf2bbf0ebede,0xbf7dbf76bf6abf59,0xbe9bbd663e483ede,0xbf78bf60bf3abf08,0x3e803f143f553f7a,0xbf6fbf3fbeebbde5
.quad 0x3f3a3f763f7b3f48,0xbf63bf14be0f3ea9,0x3f7b3f6d3f0e0000,0xbf55bec43e483f35,0x3f6f3ef8be48bf48,0xbf44be2c3f023f72,0x3f1abe2cbf55bf7a,0xbf303d663f443f7e
.quad 0x3dacbf3fbf7bbede,0xbf1a3e8e3f6f3f59,0xbeebbf80bf0e3ede,0xbf023ef83f803f08,0xbf5cbf513e483f7a,0xbed13f2b3f743de5,0xbf80be8e3f553f48,0xbe9b3f513f4dbea9
.quad 0xbf553ec43f7b0000,0xbe483f6d3f0ebf35,0xbed13f603f0ebf48,0xbdac3f7c3e80bf72,0x3e0f3f7cbe48bf7a,0x3ce63f80bdacbf7e,0x3f253f2bbf55bede,0x3e0f3f76bed1bf59
.quad 0x0,0x0,0x0,0x0,0x0,0x0,0x0,0x0
.quad 0x0,0x0,0x0,0x0,0x0,0x0,0x0,0x0
.quad 0x0,0x0,0x0,0x0,0x0,0x0,0x0,0x0
.quad 0x0,0x0,0x0,0x0,0x0,0x0,0x0,0x0
.quad 0x0,0x0,0x0,0x0,0x0,0x0,0x0,0x0
.quad 0x0,0x0,0x0,0x0,0x0,0x0,0x0,0x0
.quad 0x0,0x0,0x0,0x0,0x0,0x0,0x0,0x0
.quad 0x0,0x0,0x0,0x0,0x0,0x0,0x0,0x0
.quad 0x3eb73ec43ed13ede,0x3e803e8e3e9b3ea9,0x3f783f6d3f5c3f48,0x3f743f7c3f803f7e,0xbe0fbec4bf1abf48,0x3f443f143eb73de5,0xbf80bf6dbf3abede,0xbe0fbef8bf44bf72
.quad 0xbdac3ec43f443f7a,0xbf6abf80bf5cbf08,0x3f7b3f6d3f0e0000,0xbf55bec43e483f35,0x3e9bbec4bf63bf7a,0x3ce63f2b3f7d3f59,0xbf6abf6dbeb73ede,0x3f5c3f763eebbea9
.quad 0xbf023ec43f783f48,0x3f633e2cbf30bf7e,0x3f4d3f6d3e0fbf48,0x3dacbf51bf6abde5,0x3f30bec4bf80bede,0xbf4dbf603dac3f72,0xbf25bf6d3dac3f7a,0xbf6f3d663f783f08
.quad 0xbf553ec43f7b0000,0xbe483f6d3f0ebf35,0x3eeb3f6dbe9bbf7a,0x3f3a3f3fbf1abf59,0x3f6fbec4bf6a3ede,0x3f78be8ebf743ea9,0xbe80bf6d3f023f48,0x3e9bbf7cbce63f7e
.quad 0x3e0f3e2c3e483e64,0x3ce63d663dac3de5,0x3f253f3f3f553f67,0x3e0f3e8e3ed13f08,0x3f743f803f7b3f67,0x3e803ef83f303f59,0x3f783f513f0e3e64,0x3eb73f2b3f633f7e
.quad 0x3f303e8ebe48bf20,0x3eeb3f513f7d3f72,0x3e48bec4bf55bf80,0x3f0e3f6d3f7b3f35,0xbeb7bf60bf7bbf20,0x3f253f7c3f5c3ea9,0xbf4dbf7cbf0e3e64,0x3f3a3f803f25bde5
.quad 0xbf7fbf2b3e483f67,0x3f4d3f763eb7bf08,0xbf63bd663f553f67,0x3f5c3f603ce6bf59,0xbf023f143f7b3e64,0x3f6a3f3fbe9bbf7e,0x3ce63f763f0ebf20,0x3f743f14bf1abf72
.quad 0x3f0e3f6dbe48bf80,0x3f7b3ec4bf55bf35,0x3f6a3ef8bf55bf20,0x3f7f3e2cbf78bea9,0x3f7dbe2cbf7b3e64,0x3f80bd66bf7f3de5,0x3f44bf3fbf0e3f67,0x3f7dbe8ebf6a3f08
.quad 0x0,0x0,0x0,0x0,0x0,0x0,0x0,0x0
.quad 0x0,0x0,0x0,0x0,0x0,0x0,0x0,0x0
.quad 0x0,0x0,0x0,0x0,0x0,0x0,0x0,0x0
.quad 0x0,0x0,0x0,0x0,0x0,0x0,0x0,0x0
.quad 0x0,0x0,0x0,0x0,0x0,0x0,0x0,0x0
.quad 0x0,0x0,0x0,0x0,0x0,0x0,0x0,0x0
.quad 0x0,0x0,0x0,0x0,0x0,0x0,0x0,0x0
.quad 0x0,0x0,0x0,0x0,0x0,0x0,0x0,0x0
.quad 0xbf70bf6ebf6bbf68,0xbf79bf77bf75bf73,0x3e3a3ea23ee53f11,0xbebdbe72bdc93d2c,0x3f803f773f5e3f38,0x3f0b3f3c3f623f79,0x3e1dbe56bf0bbf4f,0x3f803f733f463efe
.quad 0xbf73bf7dbf4fbee5,0x3f1d3e3abe95bf32,0xbef13dc93f223f75,0xbe95bf46bf7fbf62,0x3f4a3f803f3c3e01,0xbf73bf6ebef13e56,0x3f3c3c66bf38bf80,0xbf4fbe013f223f7f
.quad 0xbf0bbf7fbf283e56,0x3c663f4f3f753eb0,0xbf6bbe013f4a3f6e,0x3f533f683dc9bf4f,0x3e723f7c3f11bf05,0x3f703d8fbf62bf4a,0x3f7f3e72bf5bbf41,0x3e87bf57bf463ebd
.quad 0x3dc9bf75bef13f46,0xbf22bf623e953f7f,0xbf77beb03f683efe,0xbf7fbc663f7f3e3a,0xbed83f6b3ebdbf70,0xbf053f5e3ef1bf65,0x3f533ee5bf73be3a,0x3ecb3f5bbf22bf2d
.quad 0xbf7ebf7dbf7cbf7a,0xbf80bf80bf7fbf7f,0xbf4fbf38bf1dbefe,0xbf7fbf7abf70bf62,0xbed8be3a3d8f3ea2,0xbf7ebf6ebf4fbf22,0x3d8f3ed83f383f6b,0xbf7cbf5bbf1dbe95
.quad 0x3f0b3f5e3f803f68,0xbf79bf41bebd3dc9,0x3f623f7f3f463e95,0xbf75bf22bdc93ef1,0x3f803f413e1dbf05,0xbf70befe3e3a3f46,0x3f5e3e72bf0bbf7c,0xbf6bbeb03ee53f75
.quad 0x3f05bebdbf77bf4a,0xbf65be3a3f2d3f7f,0x3d2cbf57bf65bd8f,0xbf5ebc663f5b3f62,0xbee5bf80bebd3f32,0xbf573e1d3f773f22,0xbf53bf4a3eb03f80,0xbf4f3ea23f803e95
.quad 0xbf7fbe953f623f22,0xbf463ef13f75bdc9,0xbf6b3ea23f79be1d,0xbf3c3f1d3f57bef1,0xbf1d3f4f3f11bf57,0xbf323f3c3f28bf46,0xbe1d3f80be01bf77,0xbf283f573ed8bf75
.quad 0x0,0x0,0x0,0x0,0x0,0x0,0x0,0x0
.quad 0x0,0x0,0x0,0x0,0x0,0x0,0x0,0x0
.quad 0x0,0x0,0x0,0x0,0x0,0x0,0x0,0x0
.quad 0x0,0x0,0x0,0x0,0x0,0x0,0x0,0x0
.quad 0x0,0x0,0x0,0x0,0x0,0x0,0x0,0x0
.quad 0x0,0x0,0x0,0x0,0x0,0x0,0x0,0x0
.quad 0x0,0x0,0x0,0x0,0x0,0x0,0x0,0x0
.quad 0x0,0x0,0x0,0x0,0x0,0x0,0x0,0x0
.quad 0x3eb03ebd3ecb3ed8,0x3e723e873e953ea2,0x3f7c3f733f653f53,0x3f6e3f793f7f3f80,0xbc66be87befebf32,0x3f573f2d3ef13e72,0xbf7dbf7abf57bf17,0x3d2cbea2bf22bf5e
.quad 0xbea23e1d3f173f65,0xbf4abf7cbf75bf38,0x3f623f7f3f463e95,0xbf75bf22bdc93ef1,0x3f1dbd2cbf2dbf7e,0xbea23ebd3f623f7a,0xbf2dbf80bf323d2c,0x3f173f7e3f463d8f
.quad 0xbf57bd8f3f413f7a,0x3f803f17be95bf70,0x3ecb3f7e3f1dbebd,0x3f11bed8bf7fbf17,0x3f793e3abf53bf5b,0xbeb0bf7fbef13f1d,0xbd8fbf79bf053f28,0xbf77bf0b3f223f6e
.quad 0xbf7fbe953f623f22,0xbf463ef13f75bdc9,0xbe873f703ed8bf5e,0x3d8f3f803dc9bf7c,0x3f683ecbbf6ebeb0,0x3f5b3efebf62bee5,0x3f11bf65bea23f7c,0x3f6bbf05bf463f3c
.quad 0x3e013e1d3e3a3e56,0x3c663d2c3d8f3dc9,0x3f173f323f4a3f5e,0x3d8f3e563eb03ef1,0x3f683f7c3f7f3f73,0x3e013ebd3f173f46,0x3f7f3f683f323ecb,0x3e3a3f053f4a3f75
.quad 0x3f573efe3d2cbed8,0x3e723f283f6e3f7f,0x3ef1bdc9bf22bf75,0x3e953f463f7f3f62,0xbc66bf28bf7dbf5b,0x3eb03f5e3f7c3f22,0xbefebf79bf57be3a,0x3ecb3f703f653e95
.quad 0xbf5bbf6ebe873f1d,0x3ee53f7c3f3cbdc9,0xbf80bf0b3ee53f7f,0x3efe3f803f05bef1,0xbf653d2c3f6e3f38,0x3f0b3f7d3e87bf46,0xbf113f1d3f70bd2c,0x3f173f73bc66bf75
.quad 0xbdc93f753ef1bf46,0x3f223f62be95bf7f,0x3ecb3f73be72bf7d,0x3f2d3f4abf0bbf62,0x3f4a3f17bf53bf0b,0x3f383f2dbf41bf22,0x3f7d3c66bf7e3e87,0x3f413f0bbf68be95
.quad 0x0,0x0,0x0,0x0,0x0,0x0,0x0,0x0
.quad 0x0,0x0,0x0,0x0,0x0,0x0,0x0,0x0
.quad 0x0,0x0,0x0,0x0,0x0,0x0,0x0,0x0
.quad 0x0,0x0,0x0,0x0,0x0,0x0,0x0,0x0
.quad 0x0,0x0,0x0,0x0,0x0,0x0,0x0,0x0
.quad 0x0,0x0,0x0,0x0,0x0,0x0,0x0,0x0
.quad 0x0,0x0,0x0,0x0,0x0,0x0,0x0,0x0
.quad 0x0,0x0,0x0,0x0,0x0,0x0,0x0,0x0
.quad 0x3f783f7c3f7f3f80,0x3f553f603f6a3f72,0x3f553f6d3f7b3f80,0x3e483ec43f0e3f35,0x3f1a3f513f743f80,0xbf0ebe8e3ce63ea9,0x3e9b3f2b3f6a3f80,0xbf7bbf51bf02bde5
.quad 0xbce63ef83f5c3f80,0xbf55bf80bf63bf08,0xbeb73e8e3f4d3f80,0xbe48bf3fbf7fbf59,0xbf253d663f3a3f80,0x3f0ebe2cbf4dbf7e,0xbf5cbe2c3f253f80,0x3f7b3ef8beb7bf72
.quad 0xbf7bbec43f0e3f80,0x3f553f6d3e48bf35,0xbf7dbf143eeb3f80,0x3e483f763f30bea9,0xbf63bf3f3eb73f80,0xbf0e3f143f783de5,0xbf30bf603e803f80,0xbf7bbd663f743f08
.quad 0xbed1bf763e0f3f80,0xbf55bf2b3f253f59,0xbdacbf803ce63f80,0xbe48bf7c3e0f3f7e,0x3e80bf7cbdac3f80,0x3f0ebf60bed13f72,0x3f0ebf6dbe483f80,0x3f7bbec4bf553f35
.quad 0x3f1a3f2b3f3a3f48,0x3e9b3ec43eeb3f08,0xbf0ebec4be480000,0xbf7bbf6dbf55bf35,0xbf78bf80bf6fbf48,0xbdacbec4bf25bf59,0xbdacbef8bf4dbf7a,0x3f803f6d3f303ea9
.quad 0x3f6a3f143dacbede,0xbe0f3ec43f4d3f7e,0x3f303f7c3f633ede,0xbf78bf6dbf023de5,0xbeeb3e8e3f5c3f7a,0x3eb7bec4bf6abf72,0xbf7dbf3f3ce63f48,0x3f633f6d3e9bbf08
.quad 0xbe48bf6dbf550000,0xbf0e3ec43f7b3f35,0x3f5cbd66bf6abf48,0xbf44bf6dbdac3f59,0x3f443f60be0fbf7a,0x3f3abec4bf80bea9,0xbeb73f513f44bede,0x3f1a3f6dbe0fbf7e
.quad 0xbf80be2c3f743ede,0xbf5c3ec43f78bde5,0xbe9bbf763e803f7a,0xbed1bf6d3eb73f72,0x3f4dbf2bbf303f48,0x3f74bec4bf633f08,0x3f553ec4bf7b0000,0x3e483f6dbf0ebf35
.quad 0xbce63d663e0f3e64,0xbeb7be8ebe48bde5,0xbf55bf6dbf7bbf80,0xbe48bec4bf0ebf35,0x3f6a3f3f3f023e64,0x3f303f603f7b3f7e,0xbe0f3e8e3f253f67,0xbf78bf7cbf55bf08
.quad 0xbf44bf7cbf6fbf20,0x3f743f2b3e48bea9,0x3f743f14bce6bf20,0xbf25bd663f0e3f72,0xbe803ef83f743f67,0x3e0fbf14bf7bbf59,0xbf30bf80bf1a3e64,0x3ed13f763f553de5
.quad 0x3f7b3ec4bf0ebf80,0xbf55bf6dbe483f35,0xbeb73f2b3f783e64,0x3f803ef8bf0ebf7e,0xbf1abf76bdac3f67,0xbf5c3e2c3f7b3f08,0x3f7f3e2cbf6abf20,0x3eebbf3fbf553ea9
.quad 0xbeeb3f513f30bf20,0x3dac3f803e48bf72,0xbf02bf603eeb3f67,0xbf1abf513f0e3f59,0x3f80bd66bf7d3e64,0x3f6f3e8ebf7bbde5,0xbf0e3f6d3e48bf80,0xbf7b3ec43f55bf35
.quad 0xbf25bf14bf02bede,0xbf5cbf51bf44bf35,0x3f0e3ec43e480000,0x3f7b3f6d3f553f35,0xbeebbe2c3e0f3ede,0xbf7dbf7cbf63bf35,0x3eb7bd66beebbf48,0x3f633f803f6f3f35
.quad 0xbe803e8e3f3a3f7a,0xbf30bf76bf78bf35,0x3e0fbef8bf6abf7a,0x3ed13f603f7d3f35,0xbce63f2b3f7f3f48,0xbdacbf3fbf80bf35,0xbdacbf51bf78bede,0xbe803f143f7f3f35
.quad 0x3e483f6d3f550000,0x3f0ebec4bf7bbf35,0xbe9bbf7cbf1a3ede,0xbf4d3e2c3f743f35,0x3ed13f803e9bbf48,0x3f743d66bf6abf35,0xbf02bf763ce63f7a,0xbf80be8e3f5c3f35
.quad 0x3f1a3f60beb7bf7a,0x3f6f3ef8bf4dbf35,0xbf30bf3f3f253f48,0xbf44bf2b3f3a3f35,0x3f443f14bf5cbede,0x3f023f51bf25bf35,0xbf55bec43f7b0000,0xbe48bf6d3f0e3f35
.quad 0x3e803e2c3dac0000,0x3f0e3ef83ed13ea9,0x3f0e3ec43e480000,0x3f7b3f6d3f553f35,0x3f4d3f143e9b0000,0x3f553f763f803f72,0x3f743f3f3ed10000,0x3e483f143f5c3f7e
.quad 0x3f803f603f020000,0xbf0ebd663eeb3f59,0x3f6f3f763f1a0000,0xbf7bbf2bbdac3f08,0x3f443f803f300000,0xbf55bf7cbf1a3de5,0x3f023f7c3f440000,0xbe48bf60bf6fbea9
.quad 0x3e483f6d3f550000,0x3f0ebec4bf7bbf35,0xbe0f3f513f630000,0x3f7b3e8ebf3abf72,0xbeeb3f2b3f6f0000,0x3f553f51be80bf7e,0xbf3a3ef83f780000,0x3e483f803e9bbf59
.quad 0xbf6a3e8e3f7d0000,0xbf0e3f3f3f44bf08,0xbf7f3d663f800000,0xbf7b3e2c3f7dbde5,0xbf78be2c3f7f0000,0xbf55bef83f6a3ea9,0xbf55bec43f7b0000,0xbe48bf6d3f0e3f35
.quad 0x3f4d3f3f3f303f20,0x3f743f6d3f633f59,0x3f553f6d3f7b3f80,0x3e483ec43f0e3f35,0xbe803d663eb73f20,0xbf7fbf6dbf44bf08,0xbf7fbf60bf1abe64,0x3ce6bec4bf3abf72
.quad 0xbed1bf51bf7fbf67,0x3f7d3f6d3f1a3de5,0x3f3a3e2cbeebbf67,0xbe803ec43f5c3f7e,0x3f633f763f02be64,0xbf6fbf6dbed13ea9,0xbe0f3f2b3f803f20,0x3eebbec4bf74bf59
.quad 0xbf7bbec43f0e3f80,0x3f553f6d3e48bf35,0xbf02bf80bed13f20,0xbf253ec43f7f3f08,0x3f25bef8bf7dbe64,0xbf30bf6d3ce63f72,0x3f6f3f14bf25bf67,0x3f4dbec4bf7dbde5
.quad 0xbce63f7c3e9bbf67,0x3f023f6dbe80bf7e,0xbf743e8e3f78be64,0xbf6a3ec43f6fbea9,0xbf1abf3f3f3a3f20,0xbe9bbf6d3eeb3f59,0x3f0ebf6dbe483f80,0x3f7bbec4bf553f35
.quad 0x3f803f803f7d3f7a,0x3f6f3f763f7b3f7e,0xbf0ebec4be480000,0xbf7bbf6dbf55bf35,0xbed1bf2bbf5cbf7a,0x3f3a3ef83e48bde5,0x3f7d3f763f443ede,0xbe803e2c3f0e3f59
.quad 0xbf25be2c3eb73f48,0xbe9bbf3fbf7bbf72,0xbe9bbf51bf80bf48,0x3f443f803f553ea9,0x3f783f603e9bbede,0xbf7dbf51be483f08,0xbf3a3d663f4d3f7a,0x3f6a3e8ebf0ebf7e
.quad 0xbe48bf6dbf550000,0xbf0e3ec43f7b3f35,0x3f6f3f3fbe80bf7a,0x3ce6bf60bf553de5,0xbf4d3e8e3f7f3ede,0x3f023f7c3e48bf59,0xbdacbf7cbed13f48,0xbf63bf2b3f0e3f72
.quad 0x3f633f14bf3abf48,0x3f7f3d66bf7bbea9,0xbf5c3ef83f63bede,0xbf4d3f143f55bf08,0x3ce6bf803e0f3f7a,0x3eb7bf76be483f7e,0x3f553ec4bf7b0000,0x3e483f6dbf0ebf35
.quad 0x3f443f513f5c3f67,0x3f023f143f253f35,0xbf55bf6dbf7bbf80,0xbe48bec4bf0ebf35,0x3f633f7c3f7d3f67,0xbe0f3e2c3eeb3f35,0xbf6fbf80bf63bf20,0x3eeb3d66beb7bf35
.quad 0x3f783f763f303e64,0xbf3abe8e3e803f35,0xbf7dbf60bed13e64,0x3f6a3ef8be0fbf35,0x3f803f3f3dacbf20,0xbf7fbf2b3ce63f35,0xbf7fbf143e803f67,0x3f783f513dacbf35
.quad 0x3f7b3ec4bf0ebf80,0xbf55bf6dbe483f35,0xbf74be2c3f4d3f67,0x3f1a3f7c3e9bbf35,0x3f6abd66bf74bf20,0xbe9bbf80bed13f35,0xbf5c3e8e3f803e64,0xbce63f763f02bf35
.quad 0x3f4dbef8bf6f3e64,0x3eb7bf60bf1a3f35,0xbf3a3f2b3f44bf20,0xbf253f3f3f30bf35,0x3f25bf51bf023f67,0x3f5cbf14bf443f35,0xbf0e3f6d3e48bf80,0xbf7b3ec43f55bf35
.quad 0x3f753f7a3f7e3f80,0x3f4f3f5b3f653f6e,0x3f463f623f753f7f,0x3dc93e953ef13f22,0x3ef13f383f653f7d,0xbf2dbed8be013e3a,0x3dc93efe3f4f3f7a,0xbf80bf6bbf2dbea2
.quad 0xbe953e723f323f77,0xbf28bf73bf7abf3c,0xbf22bd2c3f113f73,0x3e01befebf6bbf79,0xbf62bea23ed83f6e,0x3f533e56bf05bf77,0xbf7fbf113e873f68,0x3f793f4f3d8fbf38
.quad 0xbf75bf463dc93f62,0x3ef13f7f3f22be95,0xbf46bf6bbd8f3f5b,0xbeb03f2d3f773e56,0xbef1bf7ebe723f53,0xbf6e3c663f703f28,0xbdc9bf7dbecb3f4a,0xbf65bf283f113f70
.quad 0x3e95bf68bf0b3f41,0xbe87bf7ebc663f7d,0x3f22bf41bf2d3f38,0x3f0bbf53bf173f4a,0x3f62bf0bbf4a3f2d,0x3f7dbe72bf733ecb,0x3f7fbe95bf623f22,0x3f463ef1bf75bdc9
.quad 0x3f113f223f323f41,0x3e873eb03ed83efe,0xbf22bef1be95bdc9,0xbf7fbf75bf62bf46,0xbf6bbf7fbf7abf5e,0x3d8fbe72bf05bf41,0x3e01be95bf28bf68,0x3f793f7c3f533f05
.quad 0x3f7d3f463eb0be3a,0xbecb3e013f1d3f6e,0x3ed83f623f7d3f32,0xbf57bf7fbf41be56,0xbf41bdc93f1d3f7d,0x3f2dbc66bf32bf80,0xbf57bf75becb3ee5,0x3f1d3f803f2dbe01
.quad 0x3e95bf22bf7fbef1,0xbf62bdc93f463f75,0x3f803ef1bf11bf7e,0xbea2bf7dbf173ee5,0x3e873f7f3ee5bf2d,0x3f7d3e56bf57bf4f,0xbf5b3e953f803e56,0xbc663f773efebf38
.quad 0xbf3cbf463f053f6b,0xbf7cbea23f653f11,0x3ee5bf62befe3f5b,0x3eb0bf6ebecb3f68,0x3f7c3dc9bf803d8f,0x3f5e3ed8bf70be87,0x3dc93f75bef1bf46,0xbf223f623e95bf7f
.quad 0xbd8f3c663dc93e3a,0xbecbbea2be72be1d,0xbf46bf62bf75bf7f,0xbdc9be95bef1bf22,0x3f773f573f223ebd,0x3f113f4a3f703f80,0xbeb03d8f3ef13f4a,0xbf65bf80bf6ebf32
.quad 0xbf11bf68bf7fbf4f,0x3f803f573ee5bd8f,0x3f803f4f3e95beb0,0xbf5bbebd3e873f4a,0xbf173e013f463f7f,0x3efebe72bf57bf7c,0xbea2bf6ebf62be56,0xbc663f413f7d3f05
.quad 0x3f753f46bdc9bf62,0xbef1bf7fbf223e95,0xbf4a3e3a3f753f32,0x3f573f5ebd2cbf68,0xbd2cbf73bf223efe,0xbf7fbed83f323f6b,0x3f573f3cbef1bf79,0x3f68be3abf7fbea2
.quad 0xbf6e3e723f7f3d2c,0xbf173f383f4abefe,0x3e72bf77be953f73,0x3e01bf7dbe3a3f7a,0x3f283f32bf46bf11,0x3ebd3f65bf05bf4f,0xbf7f3e953f62bf22,0xbf46bef13f753dc9
.quad 0xbf2dbf1dbf0bbef1,0xbf62bf57bf4abf3c,0x3f223ef13e953dc9,0x3f7f3f753f623f46,0xbf17bea2bc663e95,0xbf75bf80bf73bf4f,0x3f0b3e1dbe87bf22,0x3f463f773f7d3f57
.quad 0xbefe3c663f053f62,0xbef1bf5bbf80bf5e,0x3ee5be3abf3cbf7f,0x3dc93f2d3f7c3f65,0xbecb3eb03f653f75,0x3e95bee5bf70bf6b,0x3eb0befebf7cbf46,0xbf223e3a3f5e3f70
.quad 0xbe953f223f7f3ef1,0x3f623dc9bf46bf75,0x3e72bf41bf6ebdc9,0xbf7fbebd3f283f79,0xbe3a3f5b3f4abe95,0x3f753f1dbf05bf7c,0x3e01bf6ebf173f22,0xbf46bf4f3ebd3f7e
.quad 0xbd8f3f7a3eb0bf62,0x3ef13f70be56bf7f,0x3c66bf80bd8f3f7f,0xbdc9bf7f3d2c3f80,0x3d2c3f7ebe56bf75,0xbe953f7a3e01bf80,0xbdc9bf753ef13f46,0x3f22bf62be953f7f
.quad 0x3e953e563e013d2c,0x3f173f053ee53ebd,0x3f223ef13e953dc9,0x3f7f3f753f623f46,0x3f623f323ee53e1d,0x3f3c3f683f7e3f7c,0x3f7f3f5e3f173e56,0xbc663ecb3f3c3f73
.quad 0x3f753f793f383e87,0xbf41bea23e563f2d,0x3f463f803f533ea2,0xbf7ebf5ebecb3e72,0x3ef13f733f683ebd,0xbf11bf7abf5bbe87,0x3dc93f533f773ed8,0x3e72bf17bf7fbf32
.quad 0xbe953f223f7f3ef1,0x3f623dc9bf46bf75,0xbf223ecb3f7f3f05,0x3f703f3cbe87bf7a,0xbf623e013f793f11,0x3ebd3f803eb0bf41,0xbf7fbe1d3f6b3f1d,0xbee53f413f53beb0
.quad 0xbf75bed83f573f28,0xbf773e013f803e1d,0xbf46bf283f3c3f32,0xbf57bf113f4f3f1d,0xbef1bf573f1d3f3c,0xbe1dbf793ea23f6b,0xbdc9bf753ef13f46,0x3f22bf62be953f7f
.quad 0x3f533f463f383f28,0x3f773f703f683f5e,0x3f463f623f753f7f,0x3dc93e953ef13f22,0xbecbbdc93e563efe,0xbf7fbf79bf5bbf28,0xbf7ebf75bf41bed8,0x3e72be3abf11bf5b
.quad 0xbe1dbf22bf70bf7c,0x3f6b3f7e3f4a3ebd,0x3f683ef1be1dbf38,0xbf0b3d8f3f283f7a,0x3f283f7f3f4a3e1d,0xbf3cbf80bf38bd2c,0xbf0b3e953f6b3f65,0x3f4a3d2cbf3cbf7e
.quad 0xbf75bf463dc93f62,0x3ef13f7f3f22be95,0x3c66bf62bf533e01,0xbf73be1d3f4f3f65,0x3f773dc9bf65bf3c,0xbe1dbf7abf0b3f17,0x3f053f75bd2cbf7a,0x3f803e87bf5ebf32
.quad 0xbf2d3f223f5bbecb,0xbe3a3f733ee5bf53,0xbf65bef13f5e3f05,0xbf70bebd3f6b3ed8,0x3e3abf7fbc663f7f,0x3efebf68beb03f77,0x3f7fbe95bf623f22,0x3f463ef1bf75bdc9
.quad 0x3f7f3f803f7f3f7c,0x3f6b3f733f793f7d,0xbf22bef1be95bdc9,0xbf7fbf75bf62bf46,0xbe87bf0bbf46bf6e,0x3f533f1d3eb03d2c,0x3f703f7f3f623f1d,0xbee5bd2c3ebd3f38
.quad 0xbf53bed83dc93f17,0xbd2cbf0bbf65bf7f,0x3c66bf17bf75bf70,0x3f053f6e3f773f1d,0x3f4f3f7e3f22bd8f,0xbf5ebf79bf0b3e3a,0xbf73bebd3ef13f7a,0x3f803f28be1dbf5b
.quad 0x3e95bf22bf7fbef1,0xbf62bdc93f463f75,0x3f1d3f7c3e95bf38,0x3f0bbefebf80bed8,0xbf80bea23f463f5e,0xbd8f3f683f38becb,0x3f0bbf2dbf623e72,0xbed8bf7cbd8f3f73
.quad 0x3ebd3f79bdc9bf80,0x3f4f3f32bf1dbf5e,0xbf79be873f753ea2,0xbf7ebe1d3f7c3e56,0x3f41bf38bf223f53,0x3f6ebee5bf5b3f17,0x3dc93f75bef1bf46,0xbf223f623e95bf7f
.quad 0x3f3c3f4a3f573f62,0x3ef13f0b3f1d3f2d,0xbf46bf62bf75bf7f,0xbdc9be95bef1bf22,0x3f4f3f733f803f75,0xbe953c663ea23f17,0xbf57bf7dbf77bf46,0x3f223e87be1dbf0b
.quad 0x3f5e3f803f5b3ef1,0xbf62bf05bc663efe,0xbf65bf7cbf2dbdc9,0x3f7f3f3c3e3abee5,0x3f6b3f703ee5be95,0xbf75bf65beb03ecb,0xbf70bf5ebe3a3f22,0x3f463f7c3efebeb0
.quad 0x3f753f46bdc9bf62,0xbef1bf7fbf223e95,0xbf79bf283ebd3f7f,0x3dc93f6e3f41be72,0x3f7c3f05bf1dbf75,0x3e95bf4abf5b3e3a,0xbf7ebebd3f4f3f46,0xbf223f173f6ebe01
.quad 0x3f7f3e56bf70bef1,0x3f62beb0bf7a3d8f,0xbf80bd2c3f7f3dc9,0xbf7f3d8f3f80bc66,0x3f80be01bf7a3e95,0x3f753e56bf7ebd2c,0xbf7f3e953f62bf22,0xbf46bef13f753dc9
.quad 0xbf7bbf76bf6fbf67,0xbf7dbf80bf80bf7e,0x3f553f6d3f7b3f80,0x3e483ec43f0e3f35,0xbe48bef8bf3abf67,0x3f5c3f2b3ed13de5,0xbf0ebe2c3e803f20,0xbf44bf76bf7dbf59
.quad 0x3f7b3f3f3e9bbe64,0xbeb73e2c3f253f72,0xbf55bf80bf44be64,0x3f803f513e9bbea9,0x3e483f513f7d3f20,0xbe9bbf60bf78bf08,0x3f0ebe8ebf6abf67,0xbf4dbd663f3a3f7e
.quad 0xbf7bbec43f0e3f80,0x3f553f6d3e48bf35,0x3f553f60bce6bf67,0x3e80bf3fbf6fbde5,0xbe48bf7cbf023f20,0xbf7fbe8e3f4d3f59,0xbf0e3f2b3f63be64,0x3ed13f7c3dacbf72
.quad 0x3f7bbd66bf7fbe64,0x3f3abf14bf633ea9,0xbf55bf143f4d3f20,0xbf63bef83f5c3f08,0x3e483f76beb7bf67,0xbe0f3f80bce6bf7e,0x3f0ebf6dbe483f80,0x3f7bbec4bf553f35
.quad 0xbf63bf6dbf74bf7a,0xbf30bf3fbf4dbf59,0xbf0ebec4be480000,0xbf7bbf6dbf55bf35,0x3f443f6d3f7f3f7a,0xbeb7bd663e803f08,0x3f3a3ec4bce6bede,0x3f1a3f603f7f3f72
.quad 0xbf1abf6dbf7dbf48,0x3f7f3f513ed1bde5,0xbf5cbec43e803f48,0x3eebbe2cbf3abf7e,0x3ed13f6d3f6f3ede,0xbf02bf76bf63bea9,0x3f743ec4beebbf7a,0xbf80bf2b3e0f3f59
.quad 0xbe48bf6dbf550000,0xbf0e3ec43f7b3f35,0xbf7fbec43f253f7a,0x3ed13f803f02bf08,0xbce63f6d3f30bede,0x3f7d3ef8bf25bf72,0x3f7d3ec4bf4dbf48,0x3f25bf14bf6f3de5
.quad 0x3e80bf6dbf023f48,0xbe9bbf7c3ce63f7e,0xbf6fbec43f6a3ede,0xbf78be8e3f743ea9,0xbeeb3f6d3e9bbf7a,0xbf3a3f3f3f1abf59,0x3f553ec4bf7b0000,0x3e483f6dbf0ebf35
.quad 0xbed1bef8bf0ebf20,0xbdacbe2cbe80bea9,0xbf55bf6dbf7bbf80,0xbe48bec4bf0ebf35,0xbf80bf76bf55bf20,0xbe9bbf14bf4dbf72,0xbf5cbf14be483e64,0xbed1bf3fbf74bf7e
.quad 0xbeeb3d663f0e3f67,0xbf02bf60bf80bf59,0x3dac3f2b3f7b3f67,0xbf1abf76bf6fbf08,0x3f1a3f7c3f553e64,0xbf30bf80bf44bde5,0x3f6f3f603e48bf20,0xbf44bf7cbf023ea9
.quad 0x3f7b3ec4bf0ebf80,0xbf55bf6dbe483f35,0x3f3abe8ebf7bbf20,0xbf63bf513e0f3f72,0x3e80bf51bf553e64,0xbf6fbf2b3eeb3f7e,0xbe9bbf80be483f67,0xbf78bef83f3a3f59
.quad 0xbf44bf3f3f0e3f67,0xbf7dbe8e3f6a3f08,0xbf7dbe2c3f7b3e64,0xbf80bd663f7f3de5,0xbf6a3ef83f55bf20,0xbf7f3e2c3f78bea9,0xbf0e3f6d3e48bf80,0xbf7b3ec43f55bf35
.quad 0x3e803e2c3dac0000,0x3f0e3ef83ed13ea9,0x3f0e3ec43e480000,0x3f7b3f6d3f553f35,0x3f4d3f143e9b0000,0x3f553f763f803f72,0x3f743f3f3ed10000,0x3e483f143f5c3f7e
.quad 0x3f803f603f020000,0xbf0ebd663eeb3f59,0x3f6f3f763f1a0000,0xbf7bbf2bbdac3f08,0x3f443f803f300000,0xbf55bf7cbf1a3de5,0x3f023f7c3f440000,0xbe48bf60bf6fbea9
.quad 0x3e483f6d3f550000,0x3f0ebec4bf7bbf35,0xbe0f3f513f630000,0x3f7b3e8ebf3abf72,0xbeeb3f2b3f6f0000,0x3f553f51be80bf7e,0xbf3a3ef83f780000,0x3e483f803e9bbf59
.quad 0xbf6a3e8e3f7d0000,0xbf0e3f3f3f44bf08,0xbf7f3d663f800000,0xbf7b3e2c3f7dbde5,0xbf78be2c3f7f0000,0xbf55bef83f6a3ea9,0xbf55bec43f7b0000,0xbe48bf6d3f0e3f35
.quad 0x3e483e8e3eb73ede,0xbe0fbd663ce63de5,0x3f0e3ec43e480000,0x3f7b3f6d3f553f35,0xbf7bbf60bf30bede,0xbf02bf3fbf6abf7e,0x3f553f7c3f783f48,0xbf25be8e3e0f3f08
.quad 0xbe48bf2bbf74bf7a,0x3f6f3f7c3f443ea9,0xbf0e3d663f253f7a,0x3ce6bf14bf74bf72,0x3f7b3f14be0fbf48,0xbf74bef83e803f59,0xbf55bf76bed13ede,0x3f1a3f803f30bde5
.quad 0x3e483f6d3f550000,0x3f0ebec4bf7bbf35,0x3f0ebef8bf80bede,0xbf78bf2b3eb73f7e,0xbf7bbe2c3f5c3f48,0x3dac3f763f1abf08,0x3f553f3fbeebbf7a,0x3f6abe2cbf7fbea9
.quad 0xbe48bf80bdac3f7a,0xbf30bf513eeb3f72,0xbf0e3f513f1abf48,0xbeeb3f603f02bf59,0x3f7bbe8ebf6f3ede,0x3f7d3d66bf803de5,0xbf55bec43f7b0000,0xbe48bf6d3f0e3f35
.quad 0xbeebbec4be9bbe64,0xbf3abf2bbf1abf08,0x3f553f6d3f7b3f80,0x3e483ec43f0e3f35,0x3f253ec43dacbe64,0x3f6f3f803f783f59,0xbf30bf6dbf80bf67,0x3f4d3ef83dacbea9
.quad 0xbf4dbec43e0f3f20,0xbdacbf14bf6abf7e,0x3f023f6d3f783f20,0xbf63bf7cbf30bde5,0x3f6a3ec4beb7bf67,0xbf5cbe8e3eeb3f72,0xbe9bbf6dbf63be64,0xbce63f3f3f7d3f08
.quad 0xbf7bbec43f0e3f80,0x3f553f6d3e48bf35,0x3dac3f6d3f44be64,0x3f6a3d66bf5cbf59,0x3f803ec4bf3abf67,0x3e0fbf60bf443ea9,0x3e0fbf6dbf1a3f20,0xbf44bf513eb73f7e
.quad 0xbf78bec43f5c3f20,0xbf743e2c3f803de5,0xbeb73f6d3ed1bf67,0xbe803f763e9bbf72,0x3f633ec4bf74be64,0x3f303f2bbf4dbf08,0x3f0ebf6dbe483f80,0x3f7bbec4bf553f35
.quad 0xbf6abf60bf55bf48,0xbf7fbf7cbf78bf72,0xbf0ebec4be480000,0xbf7bbf6dbf55bf35,0xbce63e8e3f0e3f48,0xbf74bf51bf1abea9,0x3f023f513f7b3f7a,0xbf6abf2bbe9b3de5
.quad 0x3f633f803f553ede,0xbf5cbef83ce63f08,0x3f7f3f3f3e48bede,0xbf4dbe8e3eb73f59,0x3f4d3e2cbf0ebf7a,0xbf3abd663f253f7e,0x3eb7bef8bf7bbf48,0xbf253e2c3f5c3f72
.quad 0xbe48bf6dbf550000,0xbf0e3ec43f7b3f35,0xbf30bf76be483f48,0xbeeb3f143f7d3ea9,0xbf78bf143f0e3f7a,0xbeb73f3f3f63bde5,0xbf743d663f7b3ede,0xbe803f603f30bf08
.quad 0xbf253f2b3f55bede,0xbe0f3f763ed1bf59,0xbe0f3f7c3e48bf7a,0xbce63f803dacbf7e,0x3ed13f60bf0ebf48,0x3dac3f7cbe80bf72,0x3f553ec4bf7b0000,0x3e483f6dbf0ebf35
.quad 0xbf78bf7cbf7fbf80,0xbf55bf60bf6abf72,0xbf55bf6dbf7bbf80,0xbe48bec4bf0ebf35,0xbf1abf51bf74bf80,0x3f0e3e8ebce6bea9,0xbe9bbf2bbf6abf80,0x3f7b3f513f023de5
.quad 0x3ce6bef8bf5cbf80,0x3f553f803f633f08,0x3eb7be8ebf4dbf80,0x3e483f3f3f7f3f59,0x3f25bd66bf3abf80,0xbf0e3e2c3f4d3f7e,0x3f5c3e2cbf25bf80,0xbf7bbef83eb73f72
.quad 0x3f7b3ec4bf0ebf80,0xbf55bf6dbe483f35,0x3f7d3f14beebbf80,0xbe48bf76bf303ea9,0x3f633f3fbeb7bf80,0x3f0ebf14bf78bde5,0x3f303f60be80bf80,0x3f7b3d66bf74bf08
.quad 0x3ed13f76be0fbf80,0x3f553f2bbf25bf59,0x3dac3f80bce6bf80,0x3e483f7cbe0fbf7e,0xbe803f7c3dacbf80,0xbf0e3f603ed1bf72,0xbf0e3f6d3e48bf80,0xbf7b3ec43f55bf35
.quad 0xbf7dbf79bf73bf6b,0xbf7cbf7fbf80bf7f,0x3f463f623f753f7f,0x3dc93e953ef13f22,0xbd2cbeb0bf1dbf53,0x3f6e3f463f0b3e87,0xbf38bebd3d2c3ee5,0xbf1dbf62bf7fbf70
.quad 0x3f7f3f653f0b3d2c,0xbf17bdc93ed83f53,0xbf1dbf77bf6ebf05,0x3f703f753f17bc66,0xbe3a3f0b3f793f5e,0x3d8fbf22bf7ebf4f,0x3f5b3e1dbf28bf80,0xbf7abef13ebd3f73
.quad 0xbf75bf463dc93f62,0x3ef13f7f3f22be95,0x3ed83f803efebf0b,0x3f38be95bf7cbf1d,0x3ecbbf38bf683d8f,0xbf5ebf463ea23f80,0xbf733d8f3f7c3ed8,0xbe723f623f2dbf0b
.quad 0x3f5e3f1dbf32bf4f,0x3f803dc9bf79bebd,0xbe56bf7c3e1d3f7e,0xbea2bf753e873f79,0xbf173f5b3ee5bf6e,0xbf533f223f38bf41,0x3f7fbe95bf623f22,0x3f463ef1bf75bdc9
.quad 0xbf5ebf68bf70bf77,0xbf28bf38bf46bf53,0xbf22bef1be95bdc9,0xbf7fbf75bf62bf46,0x3f283f5b3f793f7f,0xbefebe563dc93ecb,0x3f5b3f113e3abe72,0x3ed83f413f753f7e
.quad 0xbebdbf4abf7ebf6b,0x3f7c3f703f223e1d,0xbf7abf28bd8f3f0b,0x3f383e1dbef1bf68,0x3d2c3f383f803f3c,0xbe1dbf4abf7fbf28,0x3f7e3f3cbd2cbf4a,0xbf65bf6bbe953f0b
.quad 0x3e95bf22bf7fbef1,0xbf62bdc93f463f75,0xbf65bf4f3e1d3f73,0xbe013f533f62bc66,0xbf173f0b3f7a3e1d,0x3f3c3f65bdc9bf77,0x3f323f5ebe87bf80,0x3f7a3d2cbf75bf05
.quad 0x3f53bee5bf733e3a,0x3ecbbf5bbf223f2d,0xbed8bf6b3ebd3f70,0xbf05bf5e3ef13f65,0xbf773eb03f68befe,0xbf7f3c663f7fbe3a,0x3dc93f75bef1bf46,0xbf223f623e95bf7f
.quad 0xbebdbee5bf05bf17,0xbd2cbe01be56be95,0xbf46bf62bf75bf7f,0xbdc9be95bef1bf22,0xbf7cbf7ebf68bf3c,0xbe1dbee5bf32bf62,0xbf73bf3cbecb3c66,0xbe56bf17bf5ebf7f
.quad 0xbf2dbe563ea23f41,0xbe87bf38bf79bf75,0xbe723ecb3f5e3f7e,0xbea2bf53bf80bf46,0x3e873f5b3f7a3f11,0xbebdbf68bf73bef1,0x3f323f7f3f17be72,0xbed8bf77bf53bdc9
.quad 0x3f753f46bdc9bf62,0xbef1bf7fbf223e95,0x3f7a3e87bf3cbf70,0xbf05bf7fbecb3f22,0x3f41beb0bf80bebd,0xbf11bf79be013f62,0x3eb0bf53bf413ee5,0xbf1dbf6b3e1d3f7f
.quad 0xbe1dbf80be013f77,0xbf28bf573ed83f75,0xbf1dbf4f3f113f57,0xbf32bf3c3f283f46,0xbf6bbea23f793e1d,0xbf3cbf1d3f573ef1,0xbf7f3e953f62bf22,0xbf46bef13f753dc9
.quad 0x3e953e563e013d2c,0x3f173f053ee53ebd,0x3f223ef13e953dc9,0x3f7f3f753f623f46,0x3f623f323ee53e1d,0x3f3c3f683f7e3f7c,0x3f7f3f5e3f173e56,0xbc663ecb3f3c3f73
.quad 0x3f753f793f383e87,0xbf41bea23e563f2d,0x3f463f803f533ea2,0xbf7ebf5ebecb3e72,0x3ef13f733f683ebd,0xbf11bf7abf5bbe87,0x3dc93f533f773ed8,0x3e72bf17bf7fbf32
.quad 0xbe953f223f7f3ef1,0x3f623dc9bf46bf75,0xbf223ecb3f7f3f05,0x3f703f3cbe87bf7a,0xbf623e013f793f11,0x3ebd3f803eb0bf41,0xbf7fbe1d3f6b3f1d,0xbee53f413f53beb0
.quad 0xbf75bed83f573f28,0xbf773e013f803e1d,0xbf46bf283f3c3f32,0xbf57bf113f4f3f1d,0xbef1bf573f1d3f3c,0xbe1dbf793ea23f6b,0xbdc9bf753ef13f46,0x3f22bf62be953f7f
.quad 0x3e1d3e723ea23ecb,0xbe3abdc9bc663d8f,0x3f223ef13e953dc9,0x3f7f3f753f623f46,0xbf80bf70bf4abf11,0xbebdbf22bf57bf77,0x3f323f6e3f803f65,0xbf4abef1bd8f3eb0
.quad 0x3d8fbee5bf57bf80,0x3f4f3f7f3f683f11,0xbf4abe873ebd3f5b,0x3eb0be95bf4fbf80,0x3f7c3f573e72befe,0xbf7fbf46be013f17,0xbf05bf7dbf413c66,0x3e563f623f6e3ea2
.quad 0xbe953f223f7f3ef1,0x3f623dc9bf46bf75,0x3f683d2cbf5ebf57,0xbf32bf75be3a3f4a,0xbf6bbf323ed83f7f,0xbefe3f223f733d2c,0x3ea23f7f3e3abf68,0x3f793ef1bf3cbf57
.quad 0x3efebf4abf383f17,0xbd2cbf7fbe723f6e,0xbf7a3e3a3f7dbe01,0xbf733e953f77be72,0x3f4f3f05bf65bebd,0x3f113f46bf32bf28,0xbdc9bf753ef13f46,0x3f22bf62be953f7f
.quad 0xbefebed8beb0be87,0xbf41bf32bf22bf11,0x3f463f623f753f7f,0x3dc93e953ef13f22,0x3f413f053e72bd8f,0x3f5e3f7a3f7f3f6b,0xbf05bf53bf7cbf79,0x3f683f283e95be01
.quad 0xbf6ebf1dbe013ecb,0x3e3abeb0bf46bf7d,0x3e563f413f7f3f57,0xbf32bf7dbf62bed8,0x3f803f323c66bf2d,0xbf7dbf1d3dc93f41,0x3e01bf2dbf80bf1d,0xbee53ecb3f753f57
.quad 0xbf75bf463dc93f62,0x3ef13f7f3f22be95,0xbee53f173f7d3ea2,0x3f7e3f11bef1bf80,0x3f4f3f57be56bf7d,0x3f2dbee5bf7fbe87,0x3f38befebf773c66,0xbe56bf80be953f5b
.quad 0xbf11bf653ea23f7c,0xbf6bbf053f463f3c,0xbf683ecb3f6ebeb0,0xbf5b3efe3f62bee5,0x3e873f70bed8bf5e,0xbd8f3f80bdc9bf7c,0x3f7fbe95bf623f22,0x3f463ef1bf75bdc9
.quad 0xbf6ebf65bf5bbf4f,0xbf80bf7ebf7abf75,0xbf22bef1be95bdc9,0xbf7fbf75bf62bf46,0xbe3a3e013ed83f2d,0xbf7dbf65bf38bef1,0x3ea23f2d3f6b3f80,0xbf7abf4fbefebdc9
.quad 0x3f3c3f7a3f733f28,0xbf77bf32be723e95,0x3f793f6b3efebe01,0xbf73bf113d2c3f22,0x3f773f05be56bf53,0xbf6ebed83ea23f62,0x3f38bd8fbf4fbf79,0xbf68be873f113f7f
.quad 0x3e95bf22bf7fbef1,0xbf62bdc93f463f75,0xbe56bf77bf2d3eb0,0xbf5b3d8f3f6b3f46,0xbf28bf70bc663f6e,0xbf533e723f7e3ef1,0xbf70bf113f283f65,0xbf4a3ecb3f7d3dc9
.quad 0xbf7d3c663f7e3e87,0xbf413f0b3f68be95,0xbf4a3f173f53bf0b,0xbf383f2d3f41bf22,0xbecb3f733e72bf7d,0xbf2d3f4a3f0bbf62,0x3dc93f75bef1bf46,0xbf223f623e95bf7f
.quad 0xbf75bf7abf7ebf80,0xbf4fbf5bbf65bf6e,0xbf46bf62bf75bf7f,0xbdc9be95bef1bf22,0xbef1bf38bf65bf7d,0x3f2d3ed83e01be3a,0xbdc9befebf4fbf7a,0x3f803f6b3f2d3ea2
.quad 0x3e95be72bf32bf77,0x3f283f733f7a3f3c,0x3f223d2cbf11bf73,0xbe013efe3f6b3f79,0x3f623ea2bed8bf6e,0xbf53be563f053f77,0x3f7f3f11be87bf68,0xbf79bf4fbd8f3f38
.quad 0x3f753f46bdc9bf62,0xbef1bf7fbf223e95,0x3f463f6b3d8fbf5b,0x3eb0bf2dbf77be56,0x3ef13f7e3e72bf53,0x3f6ebc66bf70bf28,0x3dc93f7d3ecbbf4a,0x3f653f28bf11bf70
.quad 0xbe953f683f0bbf41,0x3e873f7e3c66bf7d,0xbf223f413f2dbf38,0xbf0b3f533f17bf4a,0xbf623f0b3f4abf2d,0xbf7d3e723f73becb,0xbf7f3e953f62bf22,0xbf46bef13f753dc9
.quad 0x3f4d3f3f3f303f20,0x3f743f6d3f633f59,0x3f553f6d3f7b3f80,0x3e483ec43f0e3f35,0xbe803d663eb73f20,0xbf7fbf6dbf44bf08,0xbf7fbf60bf1abe64,0x3ce6bec4bf3abf72
.quad 0xbed1bf51bf7fbf67,0x3f7d3f6d3f1a3de5,0x3f3a3e2cbeebbf67,0xbe803ec43f5c3f7e,0x3f633f763f02be64,0xbf6fbf6dbed13ea9,0xbe0f3f2b3f803f20,0x3eebbec4bf74bf59
.quad 0xbf7bbec43f0e3f80,0x3f553f6d3e48bf35,0xbf02bf80bed13f20,0xbf253ec43f7f3f08,0x3f25bef8bf7dbe64,0xbf30bf6d3ce63f72,0x3f6f3f14bf25bf67,0x3f4dbec4bf7dbde5
.quad 0xbce63f7c3e9bbf67,0x3f023f6dbe80bf7e,0xbf743e8e3f78be64,0xbf6a3ec43f6fbea9,0xbf1abf3f3f3a3f20,0xbe9bbf6d3eeb3f59,0x3f0ebf6dbe483f80,0x3f7bbec4bf553f35
.quad 0x3f803f803f7d3f7a,0x3f6f3f763f7b3f7e,0xbf0ebec4be480000,0xbf7bbf6dbf55bf35,0xbed1bf2bbf5cbf7a,0x3f3a3ef83e48bde5,0x3f7d3f763f443ede,0xbe803e2c3f0e3f59
.quad 0xbf25be2c3eb73f48,0xbe9bbf3fbf7bbf72,0xbe9bbf51bf80bf48,0x3f443f803f553ea9,0x3f783f603e9bbede,0xbf7dbf51be483f08,0xbf3a3d663f4d3f7a,0x3f6a3e8ebf0ebf7e
.quad 0xbe48bf6dbf550000,0xbf0e3ec43f7b3f35,0x3f6f3f3fbe80bf7a,0x3ce6bf60bf553de5,0xbf4d3e8e3f7f3ede,0x3f023f7c3e48bf59,0xbdacbf7cbed13f48,0xbf63bf2b3f0e3f72
.quad 0x3f633f14bf3abf48,0x3f7f3d66bf7bbea9,0xbf5c3ef83f63bede,0xbf4d3f143f55bf08,0x3ce6bf803e0f3f7a,0x3eb7bf76be483f7e,0x3f553ec4bf7b0000,0x3e483f6dbf0ebf35
.quad 0x3f443f513f5c3f67,0x3f023f143f253f35,0xbf55bf6dbf7bbf80,0xbe48bec4bf0ebf35,0x3f633f7c3f7d3f67,0xbe0f3e2c3eeb3f35,0xbf6fbf80bf63bf20,0x3eeb3d66beb7bf35
.quad 0x3f783f763f303e64,0xbf3abe8e3e803f35,0xbf7dbf60bed13e64,0x3f6a3ef8be0fbf35,0x3f803f3f3dacbf20,0xbf7fbf2b3ce63f35,0xbf7fbf143e803f67,0x3f783f513dacbf35
.quad 0x3f7b3ec4bf0ebf80,0xbf55bf6dbe483f35,0xbf74be2c3f4d3f67,0x3f1a3f7c3e9bbf35,0x3f6abd66bf74bf20,0xbe9bbf80bed13f35,0xbf5c3e8e3f803e64,0xbce63f763f02bf35
.quad 0x3f4dbef8bf6f3e64,0x3eb7bf60bf1a3f35,0xbf3a3f2b3f44bf20,0xbf253f3f3f30bf35,0x3f25bf51bf023f67,0x3f5cbf14bf443f35,0xbf0e3f6d3e48bf80,0xbf7b3ec43f55bf35
.quad 0x3e483e8e3eb73ede,0xbe0fbd663ce63de5,0x3f0e3ec43e480000,0x3f7b3f6d3f553f35,0xbf7bbf60bf30bede,0xbf02bf3fbf6abf7e,0x3f553f7c3f783f48,0xbf25be8e3e0f3f08
.quad 0xbe48bf2bbf74bf7a,0x3f6f3f7c3f443ea9,0xbf0e3d663f253f7a,0x3ce6bf14bf74bf72,0x3f7b3f14be0fbf48,0xbf74bef83e803f59,0xbf55bf76bed13ede,0x3f1a3f803f30bde5
.quad 0x3e483f6d3f550000,0x3f0ebec4bf7bbf35,0x3f0ebef8bf80bede,0xbf78bf2b3eb73f7e,0xbf7bbe2c3f5c3f48,0x3dac3f763f1abf08,0x3f553f3fbeebbf7a,0x3f6abe2cbf7fbea9
.quad 0xbe48bf80bdac3f7a,0xbf30bf513eeb3f72,0xbf0e3f513f1abf48,0xbeeb3f603f02bf59,0x3f7bbe8ebf6f3ede,0x3f7d3d66bf803de5,0xbf55bec43f7b0000,0xbe48bf6d3f0e3f35
.quad 0xbf1abf2bbf3abf48,0xbe9bbec4beebbf08,0x3f0e3ec43e480000,0x3f7b3f6d3f553f35,0x3f783f803f6f3f48,0x3dac3ec43f253f59,0x3dac3ef83f4d3f7a,0xbf80bf6dbf30bea9
.quad 0xbf6abf14bdac3ede,0x3e0fbec4bf4dbf7e,0xbf30bf7cbf63bede,0x3f783f6d3f02bde5,0x3eebbe8ebf5cbf7a,0xbeb73ec43f6a3f72,0x3f7d3f3fbce6bf48,0xbf63bf6dbe9b3f08
.quad 0x3e483f6d3f550000,0x3f0ebec4bf7bbf35,0xbf5c3d663f6a3f48,0x3f443f6d3dacbf59,0xbf44bf603e0f3f7a,0xbf3a3ec43f803ea9,0x3eb7bf51bf443ede,0xbf1abf6d3e0f3f7e
.quad 0x3f803e2cbf74bede,0x3f5cbec4bf783de5,0x3e9b3f76be80bf7a,0x3ed13f6dbeb7bf72,0xbf4d3f2b3f30bf48,0xbf743ec43f63bf08,0xbf55bec43f7b0000,0xbe48bf6d3f0e3f35
.quad 0x3ce6bd66be0fbe64,0x3eb73e8e3e483de5,0x3f553f6d3f7b3f80,0x3e483ec43f0e3f35,0xbf6abf3fbf02be64,0xbf30bf60bf7bbf7e,0x3e0fbe8ebf25bf67,0x3f783f7c3f553f08
.quad 0x3f443f7c3f6f3f20,0xbf74bf2bbe483ea9,0xbf74bf143ce63f20,0x3f253d66bf0ebf72,0x3e80bef8bf74bf67,0xbe0f3f143f7b3f59,0x3f303f803f1abe64,0xbed1bf76bf55bde5
.quad 0xbf7bbec43f0e3f80,0x3f553f6d3e48bf35,0x3eb7bf2bbf78be64,0xbf80bef83f0e3f7e,0x3f1a3f763dacbf67,0x3f5cbe2cbf7bbf08,0xbf7fbe2c3f6a3f20,0xbeeb3f3f3f55bea9
.quad 0x3eebbf51bf303f20,0xbdacbf80be483f72,0x3f023f60beebbf67,0x3f1a3f51bf0ebf59,0xbf803d663f7dbe64,0xbf6fbe8e3f7b3de5,0x3f0ebf6dbe483f80,0x3f7bbec4bf553f35
.quad 0x3f253f143f023ede,0x3f5c3f513f443f35,0xbf0ebec4be480000,0xbf7bbf6dbf55bf35,0x3eeb3e2cbe0fbede,0x3f7d3f7c3f633f35,0xbeb73d663eeb3f48,0xbf63bf80bf6fbf35
.quad 0x3e80be8ebf3abf7a,0x3f303f763f783f35,0xbe0f3ef83f6a3f7a,0xbed1bf60bf7dbf35,0x3ce6bf2bbf7fbf48,0x3dac3f3f3f803f35,0x3dac3f513f783ede,0x3e80bf14bf7fbf35
.quad 0xbe48bf6dbf550000,0xbf0e3ec43f7b3f35,0x3e9b3f7c3f1abede,0x3f4dbe2cbf74bf35,0xbed1bf80be9b3f48,0xbf74bd663f6a3f35,0x3f023f76bce6bf7a,0x3f803e8ebf5cbf35
.quad 0xbf1abf603eb73f7a,0xbf6fbef83f4d3f35,0x3f303f3fbf25bf48,0x3f443f2bbf3abf35,0xbf44bf143f5c3ede,0xbf02bf513f253f35,0x3f553ec4bf7b0000,0x3e483f6dbf0ebf35
.quad 0x3f7b3f763f6f3f67,0x3f7d3f803f803f7e,0xbf55bf6dbf7bbf80,0xbe48bec4bf0ebf35,0x3e483ef83f3a3f67,0xbf5cbf2bbed1bde5,0x3f0e3e2cbe80bf20,0x3f443f763f7d3f59
.quad 0xbf7bbf3fbe9b3e64,0x3eb7be2cbf25bf72,0x3f553f803f443e64,0xbf80bf51be9b3ea9,0xbe48bf51bf7dbf20,0x3e9b3f603f783f08,0xbf0e3e8e3f6a3f67,0x3f4d3d66bf3abf7e
.quad 0x3f7b3ec4bf0ebf80,0xbf55bf6dbe483f35,0xbf55bf603ce63f67,0xbe803f3f3f6f3de5,0x3e483f7c3f02bf20,0x3f7f3e8ebf4dbf59,0x3f0ebf2bbf633e64,0xbed1bf7cbdac3f72
.quad 0xbf7b3d663f7f3e64,0xbf3a3f143f63bea9,0x3f553f14bf4dbf20,0x3f633ef8bf5cbf08,0xbe48bf763eb73f67,0x3e0fbf803ce63f7e,0xbf0e3f6d3e48bf80,0xbf7b3ec43f55bf35
.quad 0x3f533f463f383f28,0x3f773f703f683f5e,0x3f463f623f753f7f,0x3dc93e953ef13f22,0xbecbbdc93e563efe,0xbf7fbf79bf5bbf28,0xbf7ebf75bf41bed8,0x3e72be3abf11bf5b
.quad 0xbe1dbf22bf70bf7c,0x3f6b3f7e3f4a3ebd,0x3f683ef1be1dbf38,0xbf0b3d8f3f283f7a,0x3f283f7f3f4a3e1d,0xbf3cbf80bf38bd2c,0xbf0b3e953f6b3f65,0x3f4a3d2cbf3cbf7e
.quad 0xbf75bf463dc93f62,0x3ef13f7f3f22be95,0x3c66bf62bf533e01,0xbf73be1d3f4f3f65,0x3f773dc9bf65bf3c,0xbe1dbf7abf0b3f17,0x3f053f75bd2cbf7a,0x3f803e87bf5ebf32
.quad 0xbf2d3f223f5bbecb,0xbe3a3f733ee5bf53,0xbf65bef13f5e3f05,0xbf70bebd3f6b3ed8,0x3e3abf7fbc663f7f,0x3efebf68beb03f77,0x3f7fbe95bf623f22,0x3f463ef1bf75bdc9
.quad 0x3f7f3f803f7f3f7c,0x3f6b3f733f793f7d,0xbf22bef1be95bdc9,0xbf7fbf75bf62bf46,0xbe87bf0bbf46bf6e,0x3f533f1d3eb03d2c,0x3f703f7f3f623f1d,0xbee5bd2c3ebd3f38
.quad 0xbf53bed83dc93f17,0xbd2cbf0bbf65bf7f,0x3c66bf17bf75bf70,0x3f053f6e3f773f1d,0x3f4f3f7e3f22bd8f,0xbf5ebf79bf0b3e3a,0xbf73bebd3ef13f7a,0x3f803f28be1dbf5b
.quad 0x3e95bf22bf7fbef1,0xbf62bdc93f463f75,0x3f1d3f7c3e95bf38,0x3f0bbefebf80bed8,0xbf80bea23f463f5e,0xbd8f3f683f38becb,0x3f0bbf2dbf623e72,0xbed8bf7cbd8f3f73
.quad 0x3ebd3f79bdc9bf80,0x3f4f3f32bf1dbf5e,0xbf79be873f753ea2,0xbf7ebe1d3f7c3e56,0x3f41bf38bf223f53,0x3f6ebee5bf5b3f17,0x3dc93f75bef1bf46,0xbf223f623e95bf7f
.quad 0x3f3c3f4a3f573f62,0x3ef13f0b3f1d3f2d,0xbf46bf62bf75bf7f,0xbdc9be95bef1bf22,0x3f4f3f733f803f75,0xbe953c663ea23f17,0xbf57bf7dbf77bf46,0x3f223e87be1dbf0b
.quad 0x3f5e3f803f5b3ef1,0xbf62bf05bc663efe,0xbf65bf7cbf2dbdc9,0x3f7f3f3c3e3abee5,0x3f6b3f703ee5be95,0xbf75bf65beb03ecb,0xbf70bf5ebe3a3f22,0x3f463f7c3efebeb0
.quad 0x3f753f46bdc9bf62,0xbef1bf7fbf223e95,0xbf79bf283ebd3f7f,0x3dc93f6e3f41be72,0x3f7c3f05bf1dbf75,0x3e95bf4abf5b3e3a,0xbf7ebebd3f4f3f46,0xbf223f173f6ebe01
.quad 0x3f7f3e56bf70bef1,0x3f62beb0bf7a3d8f,0xbf80bd2c3f7f3dc9,0xbf7f3d8f3f80bc66,0x3f80be01bf7a3e95,0x3f753e56bf7ebd2c,0xbf7f3e953f62bf22,0xbf46bef13f753dc9
.quad 0x3e1d3e723ea23ecb,0xbe3abdc9bc663d8f,0x3f223ef13e953dc9,0x3f7f3f753f623f46,0xbf80bf70bf4abf11,0xbebdbf22bf57bf77,0x3f323f6e3f803f65,0xbf4abef1bd8f3eb0
.quad 0x3d8fbee5bf57bf80,0x3f4f3f7f3f683f11,0xbf4abe873ebd3f5b,0x3eb0be95bf4fbf80,0x3f7c3f573e72befe,0xbf7fbf46be013f17,0xbf05bf7dbf413c66,0x3e563f623f6e3ea2
.quad 0xbe953f223f7f3ef1,0x3f623dc9bf46bf75,0x3f683d2cbf5ebf57,0xbf32bf75be3a3f4a,0xbf6bbf323ed83f7f,0xbefe3f223f733d2c,0x3ea23f7f3e3abf68,0x3f793ef1bf3cbf57
.quad 0x3efebf4abf383f17,0xbd2cbf7fbe723f6e,0xbf7a3e3a3f7dbe01,0xbf733e953f77be72,0x3f4f3f05bf65bebd,0x3f113f46bf32bf28,0xbdc9bf753ef13f46,0x3f22bf62be953f7f
.quad 0xbf11bf22bf32bf41,0xbe87beb0bed8befe,0x3f223ef13e953dc9,0x3f7f3f753f623f46,0x3f6b3f7f3f7a3f5e,0xbd8f3e723f053f41,0xbe013e953f283f68,0xbf79bf7cbf53bf05
.quad 0xbf7dbf46beb03e3a,0x3ecbbe01bf1dbf6e,0xbed8bf62bf7dbf32,0x3f573f7f3f413e56,0x3f413dc9bf1dbf7d,0xbf2d3c663f323f80,0x3f573f753ecbbee5,0xbf1dbf80bf2d3e01
.quad 0xbe953f223f7f3ef1,0x3f623dc9bf46bf75,0xbf80bef13f113f7e,0x3ea23f7d3f17bee5,0xbe87bf7fbee53f2d,0xbf7dbe563f573f4f,0x3f5bbe95bf80be56,0x3c66bf77befe3f38
.quad 0x3f3c3f46bf05bf6b,0x3f7c3ea2bf65bf11,0xbee53f623efebf5b,0xbeb03f6e3ecbbf68,0xbf7cbdc93f80bd8f,0xbf5ebed83f703e87,0xbdc9bf753ef13f46,0x3f22bf62be953f7f
.quad 0x3d8fbc66bdc9be3a,0x3ecb3ea23e723e1d,0x3f463f623f753f7f,0x3dc93e953ef13f22,0xbf77bf57bf22bebd,0xbf11bf4abf70bf80,0x3eb0bd8fbef1bf4a,0x3f653f803f6e3f32
.quad 0x3f113f683f7f3f4f,0xbf80bf57bee53d8f,0xbf80bf4fbe953eb0,0x3f5b3ebdbe87bf4a,0x3f17be01bf46bf7f,0xbefe3e723f573f7c,0x3ea23f6e3f623e56,0x3c66bf41bf7dbf05
.quad 0xbf75bf463dc93f62,0x3ef13f7f3f22be95,0x3f4abe3abf75bf32,0xbf57bf5e3d2c3f68,0x3d2c3f733f22befe,0x3f7f3ed8bf32bf6b,0xbf57bf3c3ef13f79,0xbf683e3a3f7f3ea2
.quad 0x3f6ebe72bf7fbd2c,0x3f17bf38bf4a3efe,0xbe723f773e95bf73,0xbe013f7d3e3abf7a,0xbf28bf323f463f11,0xbebdbf653f053f4f,0x3f7fbe95bf623f22,0x3f463ef1bf75bdc9
.quad 0x3f2d3f1d3f0b3ef1,0x3f623f573f4a3f3c,0xbf22bef1be95bdc9,0xbf7fbf75bf62bf46,0x3f173ea23c66be95,0x3f753f803f733f4f,0xbf0bbe1d3e873f22,0xbf46bf77bf7dbf57
.quad 0x3efebc66bf05bf62,0x3ef13f5b3f803f5e,0xbee53e3a3f3c3f7f,0xbdc9bf2dbf7cbf65,0x3ecbbeb0bf65bf75,0xbe953ee53f703f6b,0xbeb03efe3f7c3f46,0x3f22be3abf5ebf70
.quad 0x3e95bf22bf7fbef1,0xbf62bdc93f463f75,0xbe723f413f6e3dc9,0x3f7f3ebdbf28bf79,0x3e3abf5bbf4a3e95,0xbf75bf1d3f053f7c,0xbe013f6e3f17bf22,0x3f463f4fbebdbf7e
.quad 0x3d8fbf7abeb03f62,0xbef1bf703e563f7f,0xbc663f803d8fbf7f,0x3dc93f7fbd2cbf80,0xbd2cbf7e3e563f75,0x3e95bf7abe013f80,0x3dc93f75bef1bf46,0xbf223f623e95bf7f
.quad 0x3f7d3f793f733f6b,0x3f7c3f7f3f803f7f,0xbf46bf62bf75bf7f,0xbdc9be95bef1bf22,0x3d2c3eb03f1d3f53,0xbf6ebf46bf0bbe87,0x3f383ebdbd2cbee5,0x3f1d3f623f7f3f70
.quad 0xbf7fbf65bf0bbd2c,0x3f173dc9bed8bf53,0x3f1d3f773f6e3f05,0xbf70bf75bf173c66,0x3e3abf0bbf79bf5e,0xbd8f3f223f7e3f4f,0xbf5bbe1d3f283f80,0x3f7a3ef1bebdbf73
.quad 0x3f753f46bdc9bf62,0xbef1bf7fbf223e95,0xbed8bf80befe3f0b,0xbf383e953f7c3f1d,0xbecb3f383f68bd8f,0x3f5e3f46bea2bf80,0x3f73bd8fbf7cbed8,0x3e72bf62bf2d3f0b
.quad 0xbf5ebf1d3f323f4f,0xbf80bdc93f793ebd,0x3e563f7cbe1dbf7e,0x3ea23f75be87bf79,0x3f17bf5bbee53f6e,0x3f53bf22bf383f41,0xbf7f3e953f62bf22,0xbf46bef13f753dc9
.quad 0xbeebbec4be9bbe64,0xbf3abf2bbf1abf08,0x3f553f6d3f7b3f80,0x3e483ec43f0e3f35,0x3f253ec43dacbe64,0x3f6f3f803f783f59,0xbf30bf6dbf80bf67,0x3f4d3ef83dacbea9
.quad 0xbf4dbec43e0f3f20,0xbdacbf14bf6abf7e,0x3f023f6d3f783f20,0xbf63bf7cbf30bde5,0x3f6a3ec4beb7bf67,0xbf5cbe8e3eeb3f72,0xbe9bbf6dbf63be64,0xbce63f3f3f7d3f08
.quad 0xbf7bbec43f0e3f80,0x3f553f6d3e48bf35,0x3dac3f6d3f44be64,0x3f6a3d66bf5cbf59,0x3f803ec4bf3abf67,0x3e0fbf60bf443ea9,0x3e0fbf6dbf1a3f20,0xbf44bf513eb73f7e
.quad 0xbf78bec43f5c3f20,0xbf743e2c3f803de5,0xbeb73f6d3ed1bf67,0xbe803f763e9bbf72,0x3f633ec4bf74be64,0x3f303f2bbf4dbf08,0x3f0ebf6dbe483f80,0x3f7bbec4bf553f35
.quad 0xbf6abf60bf55bf48,0xbf7fbf7cbf78bf72,0xbf0ebec4be480000,0xbf7bbf6dbf55bf35,0xbce63e8e3f0e3f48,0xbf74bf51bf1abea9,0x3f023f513f7b3f7a,0xbf6abf2bbe9b3de5
.quad 0x3f633f803f553ede,0xbf5cbef83ce63f08,0x3f7f3f3f3e48bede,0xbf4dbe8e3eb73f59,0x3f4d3e2cbf0ebf7a,0xbf3abd663f253f7e,0x3eb7bef8bf7bbf48,0xbf253e2c3f5c3f72
.quad 0xbe48bf6dbf550000,0xbf0e3ec43f7b3f35,0xbf30bf76be483f48,0xbeeb3f143f7d3ea9,0xbf78bf143f0e3f7a,0xbeb73f3f3f63bde5,0xbf743d663f7b3ede,0xbe803f603f30bf08
.quad 0xbf253f2b3f55bede,0xbe0f3f763ed1bf59,0xbe0f3f7c3e48bf7a,0xbce63f803dacbf7e,0x3ed13f60bf0ebf48,0x3dac3f7cbe80bf72,0x3f553ec4bf7b0000,0x3e483f6dbf0ebf35
.quad 0x0,0x0,0x0,0x0,0x0,0x0,0x0,0x0
.quad 0x0,0x0,0x0,0x0,0x0,0x0,0x0,0x0
.quad 0x0,0x0,0x0,0x0,0x0,0x0,0x0,0x0
.quad 0x0,0x0,0x0,0x0,0x0,0x0,0x0,0x0
.quad 0x0,0x0,0x0,0x0,0x0,0x0,0x0,0x0
.quad 0x0,0x0,0x0,0x0,0x0,0x0,0x0,0x0
.quad 0x0,0x0,0x0,0x0,0x0,0x0,0x0,0x0
.quad 0x0,0x0,0x0,0x0,0x0,0x0,0x0,0x0
.quad 0x3f633f6d3f743f7a,0x3f303f3f3f4d3f59,0x3f0e3ec43e480000,0x3f7b3f6d3f553f35,0xbf44bf6dbf7fbf7a,0x3eb73d66be80bf08,0xbf3abec43ce63ede,0xbf1abf60bf7fbf72
.quad 0x3f1a3f6d3f7d3f48,0xbf7fbf51bed13de5,0x3f5c3ec4be80bf48,0xbeeb3e2c3f3a3f7e,0xbed1bf6dbf6fbede,0x3f023f763f633ea9,0xbf74bec43eeb3f7a,0x3f803f2bbe0fbf59
.quad 0x3e483f6d3f550000,0x3f0ebec4bf7bbf35,0x3f7f3ec4bf25bf7a,0xbed1bf80bf023f08,0x3ce6bf6dbf303ede,0xbf7dbef83f253f72,0xbf7dbec43f4d3f48,0xbf253f143f6fbde5
.quad 0xbe803f6d3f02bf48,0x3e9b3f7cbce6bf7e,0x3f6f3ec4bf6abede,0x3f783e8ebf74bea9,0x3eebbf6dbe9b3f7a,0x3f3abf3fbf1a3f59,0xbf55bec43f7b0000,0xbe48bf6d3f0e3f35
.quad 0x3ed13ef83f0e3f20,0x3dac3e2c3e803ea9,0x3f553f6d3f7b3f80,0x3e483ec43f0e3f35,0x3f803f763f553f20,0x3e9b3f143f4d3f72,0x3f5c3f143e48be64,0x3ed13f3f3f743f7e
.quad 0x3eebbd66bf0ebf67,0x3f023f603f803f59,0xbdacbf2bbf7bbf67,0x3f1a3f763f6f3f08,0xbf1abf7cbf55be64,0x3f303f803f443de5,0xbf6fbf60be483f20,0x3f443f7c3f02bea9
.quad 0xbf7bbec43f0e3f80,0x3f553f6d3e48bf35,0xbf3a3e8e3f7b3f20,0x3f633f51be0fbf72,0xbe803f513f55be64,0x3f6f3f2bbeebbf7e,0x3e9b3f803e48bf67,0x3f783ef8bf3abf59
.quad 0x3f443f3fbf0ebf67,0x3f7d3e8ebf6abf08,0x3f7d3e2cbf7bbe64,0x3f803d66bf7fbde5,0x3f6abef8bf553f20,0x3f7fbe2cbf783ea9,0x3f0ebf6dbe483f80,0x3f7bbec4bf553f35
.quad 0x0,0x0,0x0,0x0,0x0,0x0,0x0,0x0
.quad 0x0,0x0,0x0,0x0,0x0,0x0,0x0,0x0
.quad 0x0,0x0,0x0,0x0,0x0,0x0,0x0,0x0
.quad 0x0,0x0,0x0,0x0,0x0,0x0,0x0,0x0
.quad 0x0,0x0,0x0,0x0,0x0,0x0,0x0,0x0
.quad 0x0,0x0,0x0,0x0,0x0,0x0,0x0,0x0
.quad 0x0,0x0,0x0,0x0,0x0,0x0,0x0,0x0
.quad 0x0,0x0,0x0,0x0,0x0,0x0,0x0,0x0
.quad 0xbefebed8beb0be87,0xbf41bf32bf22bf11,0x3f463f623f753f7f,0x3dc93e953ef13f22,0x3f413f053e72bd8f,0x3f5e3f7a3f7f3f6b,0xbf05bf53bf7cbf79,0x3f683f283e95be01
.quad 0xbf6ebf1dbe013ecb,0x3e3abeb0bf46bf7d,0x3e563f413f7f3f57,0xbf32bf7dbf62bed8,0x3f803f323c66bf2d,0xbf7dbf1d3dc93f41,0x3e01bf2dbf80bf1d,0xbee53ecb3f753f57
.quad 0xbf75bf463dc93f62,0x3ef13f7f3f22be95,0xbee53f173f7d3ea2,0x3f7e3f11bef1bf80,0x3f4f3f57be56bf7d,0x3f2dbee5bf7fbe87,0x3f38befebf773c66,0xbe56bf80be953f5b
.quad 0xbf11bf653ea23f7c,0xbf6bbf053f463f3c,0xbf683ecb3f6ebeb0,0xbf5b3efe3f62bee5,0x3e873f70bed8bf5e,0xbd8f3f80bdc9bf7c,0x3f7fbe95bf623f22,0x3f463ef1bf75bdc9
.quad 0xbf6ebf65bf5bbf4f,0xbf80bf7ebf7abf75,0xbf22bef1be95bdc9,0xbf7fbf75bf62bf46,0xbe3a3e013ed83f2d,0xbf7dbf65bf38bef1,0x3ea23f2d3f6b3f80,0xbf7abf4fbefebdc9
.quad 0x3f3c3f7a3f733f28,0xbf77bf32be723e95,0x3f793f6b3efebe01,0xbf73bf113d2c3f22,0x3f773f05be56bf53,0xbf6ebed83ea23f62,0x3f38bd8fbf4fbf79,0xbf68be873f113f7f
.quad 0x3e95bf22bf7fbef1,0xbf62bdc93f463f75,0xbe56bf77bf2d3eb0,0xbf5b3d8f3f6b3f46,0xbf28bf70bc663f6e,0xbf533e723f7e3ef1,0xbf70bf113f283f65,0xbf4a3ecb3f7d3dc9
.quad 0xbf7d3c663f7e3e87,0xbf413f0b3f68be95,0xbf4a3f173f53bf0b,0xbf383f2d3f41bf22,0xbecb3f733e72bf7d,0xbf2d3f4a3f0bbf62,0x3dc93f75bef1bf46,0xbf223f623e95bf7f
.quad 0x0,0x0,0x0,0x0,0x0,0x0,0x0,0x0
.quad 0x0,0x0,0x0,0x0,0x0,0x0,0x0,0x0
.quad 0x0,0x0,0x0,0x0,0x0,0x0,0x0,0x0
.quad 0x0,0x0,0x0,0x0,0x0,0x0,0x0,0x0
.quad 0x0,0x0,0x0,0x0,0x0,0x0,0x0,0x0
.quad 0x0,0x0,0x0,0x0,0x0,0x0,0x0,0x0
.quad 0x0,0x0,0x0,0x0,0x0,0x0,0x0,0x0
.quad 0x0,0x0,0x0,0x0,0x0,0x0,0x0,0x0
.quad 0x3f5e3f683f703f77,0x3f283f383f463f53,0x3f223ef13e953dc9,0x3f7f3f753f623f46,0xbf28bf5bbf79bf7f,0x3efe3e56bdc9becb,0xbf5bbf11be3a3e72,0xbed8bf41bf75bf7e
.quad 0x3ebd3f4a3f7e3f6b,0xbf7cbf70bf22be1d,0x3f7a3f283d8fbf0b,0xbf38be1d3ef13f68,0xbd2cbf38bf80bf3c,0x3e1d3f4a3f7f3f28,0xbf7ebf3c3d2c3f4a,0x3f653f6b3e95bf0b
.quad 0xbe953f223f7f3ef1,0x3f623dc9bf46bf75,0x3f653f4fbe1dbf73,0x3e01bf53bf623c66,0x3f17bf0bbf7abe1d,0xbf3cbf653dc93f77,0xbf32bf5e3e873f80,0xbf7abd2c3f753f05
.quad 0xbf533ee53f73be3a,0xbecb3f5b3f22bf2d,0x3ed83f6bbebdbf70,0x3f053f5ebef1bf65,0x3f77beb0bf683efe,0x3f7fbc66bf7f3e3a,0xbdc9bf753ef13f46,0x3f22bf62be953f7f
.quad 0x3ebd3ee53f053f17,0x3d2c3e013e563e95,0x3f463f623f753f7f,0x3dc93e953ef13f22,0x3f7c3f7e3f683f3c,0x3e1d3ee53f323f62,0x3f733f3c3ecbbc66,0x3e563f173f5e3f7f
.quad 0x3f2d3e56bea2bf41,0x3e873f383f793f75,0x3e72becbbf5ebf7e,0x3ea23f533f803f46,0xbe87bf5bbf7abf11,0x3ebd3f683f733ef1,0xbf32bf7fbf173e72,0x3ed83f773f533dc9
.quad 0xbf75bf463dc93f62,0x3ef13f7f3f22be95,0xbf7abe873f3c3f70,0x3f053f7f3ecbbf22,0xbf413eb03f803ebd,0x3f113f793e01bf62,0xbeb03f533f41bee5,0x3f1d3f6bbe1dbf7f
.quad 0x3e1d3f803e01bf77,0x3f283f57bed8bf75,0x3f1d3f4fbf11bf57,0x3f323f3cbf28bf46,0x3f6b3ea2bf79be1d,0x3f3c3f1dbf57bef1,0x3f7fbe95bf623f22,0x3f463ef1bf75bdc9
.quad 0x0,0x0,0x0,0x0,0x0,0x0,0x0,0x0
.quad 0x0,0x0,0x0,0x0,0x0,0x0,0x0,0x0
.quad 0x0,0x0,0x0,0x0,0x0,0x0,0x0,0x0
.quad 0x0,0x0,0x0,0x0,0x0,0x0,0x0,0x0
.quad 0x0,0x0,0x0,0x0,0x0,0x0,0x0,0x0
.quad 0x0,0x0,0x0,0x0,0x0,0x0,0x0,0x0
.quad 0x0,0x0,0x0,0x0,0x0,0x0,0x0,0x0
.quad 0x0,0x0,0x0,0x0,0x0,0x0,0x0,0x0
.quad 0x3f30bf60be803f80,0x3f7bbd66bf743f08,0x3f63bf3fbeb73f80,0x3f0e3f14bf783de5,0x3f7dbf14beeb3f80,0xbe483f76bf30bea9,0x3f7bbec4bf0e3f80,0xbf553f6dbe48bf35
.quad 0x3f5cbe2cbf253f80,0xbf7b3ef83eb7bf72,0x3f253d66bf3a3f80,0xbf0ebe2c3f4dbf7e,0x3eb73e8ebf4d3f80,0x3e48bf3f3f7fbf59,0x3ce63ef8bf5c3f80,0x3f55bf803f63bf08
.quad 0xbe9b3f2bbf6a3f80,0x3f7bbf513f02bde5,0xbf1a3f51bf743f80,0x3f0ebe8ebce63ea9,0xbf553f6dbf7b3f80,0xbe483ec4bf0e3f35,0xbf783f7cbf7f3f80,0xbf553f60bf6a3f72
.quad 0xbf7f3f80bf803f80,0xbf7b3f7cbf7d3f7e,0xbf6a3f76bf7d3f80,0xbf0e3f2bbf443f59,0xbf3a3f60bf783f80,0x3e483d66be9b3f08,0xbeeb3f3fbf6f3f80,0x3f55bf143e803de5
.quad 0x3eb73f51bf44bede,0xbf1a3f6d3e0fbf7e,0xbf443f603e0fbf7a,0xbf3abec43f80bea9,0xbf5cbd663f6abf48,0x3f44bf6d3dac3f59,0x3e48bf6d3f550000,0x3f0e3ec4bf7b3f35
.quad 0x3f7dbf3fbce63f48,0xbf633f6dbe9bbf08,0x3eeb3e8ebf5c3f7a,0xbeb7bec43f6abf72,0xbf303f7cbf633ede,0x3f78bf6d3f023de5,0xbf6a3f14bdacbede,0x3e0f3ec4bf4d3f7e
.quad 0x3dacbef83f4dbf7a,0xbf803f6dbf303ea9,0x3f78bf803f6fbf48,0x3dacbec43f25bf59,0x3f0ebec43e480000,0x3f7bbf6d3f55bf35,0xbf1a3f2bbf3a3f48,0xbe9b3ec4beeb3f08
.quad 0xbf743f76bf783f7a,0xbf6a3f6dbf6f3f72,0xbce63e2cbe9b3ede,0x3f02bec43e80bde5,0x3f6fbf513f25bede,0x3f4dbf6d3f7dbf7e,0x3f25bf603f7dbf7a,0xbf303ec4bce6bea9
.quad 0xbf7f3e2c3f6abf20,0xbeebbf3f3f553ea9,0x3f1abf763dac3f67,0x3f5c3e2cbf7b3f08,0x3eb73f2bbf783e64,0xbf803ef83f0ebf7e,0xbf7b3ec43f0ebf80,0x3f55bf6d3e483f35
.quad 0x3f30bf803f1a3e64,0xbed13f76bf553de5,0x3e803ef8bf743f67,0xbe0fbf143f7bbf59,0xbf743f143ce6bf20,0x3f25bd66bf0e3f72,0x3f44bf7c3f6fbf20,0xbf743f2bbe48bea9
.quad 0x3e0f3e8ebf253f67,0x3f78bf7c3f55bf08,0xbf6a3f3fbf023e64,0xbf303f60bf7b3f7e,0x3f55bf6d3f7bbf80,0x3e48bec43f0ebf35,0x3ce63d66be0f3e64,0x3eb7be8e3e48bde5
.quad 0xbf5c3f60bf633f67,0xbf4d3f51bf553f59,0x3f63bf513f3abf20,0x3f7fbf803f7bbf72,0xbdacbe2c3ed1bf20,0xbf633f3fbf0e3ea9,0xbf4d3f76bf7f3f67,0x3f02be2cbe483f08
.quad 0x3f02bf76bce63f7a,0x3f80be8ebf5c3f35,0xbed13f80be9bbf48,0xbf743d663f6abf35,0x3e9bbf7c3f1a3ede,0x3f4d3e2cbf743f35,0xbe483f6dbf550000,0xbf0ebec43f7bbf35
.quad 0x3dacbf513f78bede,0x3e803f14bf7f3f35,0x3ce63f2bbf7f3f48,0x3dacbf3f3f80bf35,0xbe0fbef83f6abf7a,0xbed13f60bf7d3f35,0x3e803e8ebf3a3f7a,0x3f30bf763f78bf35
.quad 0xbeb7bd663eebbf48,0xbf633f80bf6f3f35,0x3eebbe2cbe0f3ede,0x3f7dbf7c3f63bf35,0xbf0e3ec4be480000,0xbf7b3f6dbf553f35,0x3f25bf143f02bede,0x3f5cbf513f44bf35
.quad 0xbf3a3f3fbf443f48,0xbf253f2bbf303f35,0x3f4dbf603f6fbf7a,0x3eb7bef83f1abf35,0xbf5c3f76bf803f7a,0xbce63e8ebf023f35,0x3f6abf803f74bf48,0xbe9bbd663ed1bf35
.quad 0xbf3abef83f780000,0x3e48bf803e9b3f59,0xbeebbf2b3f6f0000,0x3f55bf51be803f7e,0xbe0fbf513f630000,0x3f7bbe8ebf3a3f72,0x3e48bf6d3f550000,0x3f0e3ec4bf7b3f35
.quad 0x3f02bf7c3f440000,0xbe483f60bf6f3ea9,0x3f44bf803f300000,0xbf553f7cbf1abde5,0x3f6fbf763f1a0000,0xbf7b3f2bbdacbf08,0x3f80bf603f020000,0xbf0e3d663eebbf59
.quad 0x3f74bf3f3ed10000,0x3e48bf143f5cbf7e,0x3f4dbf143e9b0000,0x3f55bf763f80bf72,0x3f0ebec43e480000,0x3f7bbf6d3f55bf35,0x3e80be2c3dac0000,0x3f0ebef83ed1bea9
.quad 0xbdac3d66bce60000,0xbe483e2cbe0f3de5,0xbed13e8ebe0f0000,0xbf553f3fbf253f08,0xbf303ef8be800000,0xbf7b3f80bf743f59,0xbf633f2bbeb70000,0xbf0e3f51bf783f7e
.quad 0x3f6fbf14bf253f67,0x3f4d3ec4bf7d3de5,0x3f253ef8bf7d3e64,0xbf303f6d3ce6bf72,0xbf023f80bed1bf20,0xbf25bec43f7fbf08,0xbf7b3ec43f0ebf80,0x3f55bf6d3e483f35
.quad 0xbe0fbf2b3f80bf20,0x3eeb3ec4bf743f59,0x3f63bf763f023e64,0xbf6f3f6dbed1bea9,0x3f3abe2cbeeb3f67,0xbe80bec43f5cbf7e,0xbed13f51bf7f3f67,0x3f7dbf6d3f1abde5
.quad 0xbf7f3f60bf1a3e64,0x3ce63ec4bf3a3f72,0xbe80bd663eb7bf20,0xbf7f3f6dbf443f08,0x3f55bf6d3f7bbf80,0x3e48bec43f0ebf35,0x3f4dbf3f3f30bf20,0x3f74bf6d3f63bf59
.quad 0xbe9b3e8ebe803e64,0xbed13ec4beb73ea9,0xbf803f7cbf743f67,0xbf5c3f6dbf783f7e,0xbeb73f14bf443f67,0x3f1abec43e0f3de5,0x3f44bef83e0f3e64,0x3f3abf6d3f80bf72
.quad 0xbdac3f7cbed1bf48,0xbf633f2b3f0ebf72,0xbf4dbe8e3f7fbede,0x3f02bf7c3e483f59,0x3f6fbf3fbe803f7a,0x3ce63f60bf55bde5,0xbe483f6dbf550000,0xbf0ebec43f7bbf35
.quad 0xbf3abd663f4dbf7a,0x3f6abe8ebf0e3f7e,0x3f78bf603e9b3ede,0xbf7d3f51be48bf08,0xbe9b3f51bf803f48,0x3f44bf803f55bea9,0xbf253e2c3eb7bf48,0xbe9b3f3fbf7b3f72
.quad 0x3f7dbf763f44bede,0xbe80be2c3f0ebf59,0xbed13f2bbf5c3f7a,0x3f3abef83e483de5,0xbf0e3ec4be480000,0xbf7b3f6dbf553f35,0x3f80bf803f7dbf7a,0x3f6fbf763f7bbf7e
.quad 0xbf023ef8beeb3ede,0xbf1a3f14bf0e3f08,0xbeeb3f14bf303f48,0x3dac3d66be483ea9,0x3f7fbf7c3f6abf48,0x3eebbf2b3f55bf72,0xbf1a3e8e3dacbede,0xbf5c3f7cbf7b3f59
.quad 0xbf5cbe8e3f80be64,0xbce6bf763f023f35,0x3f6a3d66bf743f20,0xbe9b3f80bed1bf35,0xbf743e2c3f4dbf67,0x3f1abf7c3e9b3f35,0x3f7bbec4bf0e3f80,0xbf553f6dbe48bf35
.quad 0xbf7f3f143e80bf67,0x3f78bf513dac3f35,0x3f80bf3f3dac3f20,0xbf7f3f2b3ce6bf35,0xbf7d3f60bed1be64,0x3f6abef8be0f3f35,0x3f78bf763f30be64,0xbf3a3e8e3e80bf35
.quad 0xbf6f3f80bf633f20,0x3eebbd66beb73f35,0x3f63bf7c3f7dbf67,0xbe0fbe2c3eebbf35,0xbf553f6dbf7b3f80,0xbe483ec4bf0e3f35,0x3f44bf513f5cbf67,0x3f02bf143f25bf35
.quad 0xbf303f2bbf253f20,0xbf443f3fbf3a3f35,0x3f1abef83eb7be64,0x3f6fbf603f4dbf35,0xbf023e8ebce6be64,0xbf803f76bf5c3f35,0x3ed1bd66be9b3f20,0x3f74bf803f6abf35
.quad 0x3f7fbe1dbf6b3f1d,0x3ee53f41bf53beb0,0x3f623e01bf793f11,0xbebd3f80beb0bf41,0x3f223ecbbf7f3f05,0xbf703f3c3e87bf7a,0x3e953f22bf7f3ef1,0xbf623dc93f46bf75
.quad 0xbdc93f53bf773ed8,0xbe72bf173f7fbf32,0xbef13f73bf683ebd,0x3f11bf7a3f5bbe87,0xbf463f80bf533ea2,0x3f7ebf5e3ecb3e72,0xbf753f79bf383e87,0x3f41bea2be563f2d
.quad 0xbf7f3f5ebf173e56,0x3c663ecbbf3c3f73,0xbf623f32bee53e1d,0xbf3c3f68bf7e3f7c,0xbf223ef1be953dc9,0xbf7f3f75bf623f46,0xbe953e56be013d2c,0xbf173f05bee53ebd
.quad 0x3dc9bd8f3d2cbc66,0x3e56be3a3e1dbe01,0x3ef1beb03e56bd8f,0x3f5ebf4a3f32bf17,0x3f46bf173ebdbe01,0x3f73bf7f3f7cbf68,0x3f75bf4a3f05be3a,0x3ecbbf323f68bf7f
.quad 0xbf053f753d2cbf7a,0xbf803e873f5ebf32,0xbf773dc93f65bf3c,0x3e1dbf7a3f0b3f17,0xbc66bf623f533e01,0x3f73be1dbf4f3f65,0x3f75bf46bdc93f62,0xbef13f7fbf22be95
.quad 0x3f0b3e95bf6b3f65,0xbf4a3d2c3f3cbf7e,0xbf283f7fbf4a3e1d,0x3f3cbf803f38bd2c,0xbf683ef13e1dbf38,0x3f0b3d8fbf283f7a,0x3e1dbf223f70bf7c,0xbf6b3f7ebf4a3ebd
.quad 0x3f7ebf753f41bed8,0xbe72be3a3f11bf5b,0x3ecbbdc9be563efe,0x3f7fbf793f5bbf28,0xbf463f62bf753f7f,0xbdc93e95bef13f22,0xbf533f46bf383f28,0xbf773f70bf683f5e
.quad 0x3ea2be953e87be72,0x3ed8becb3ebdbeb0,0x3f80bf7f3f79bf6e,0x3f53bf653f73bf7c,0x3e72bef13f2dbf57,0xbf323efebe873c66,0xbf5e3f22bea2bd2c,0xbf173f57bf7a3f7d
.quad 0xbf0bbf2d3f623e72,0x3ed8bf7c3d8f3f73,0x3f80bea2bf463f5e,0x3d8f3f68bf38becb,0xbf1d3f7cbe95bf38,0xbf0bbefe3f80bed8,0xbe95bf223f7fbef1,0x3f62bdc9bf463f75
.quad 0x3f73bebdbef13f7a,0xbf803f283e1dbf5b,0xbf4f3f7ebf22bd8f,0x3f5ebf793f0b3e3a,0xbc66bf173f75bf70,0xbf053f6ebf773f1d,0x3f53bed8bdc93f17,0x3d2cbf0b3f65bf7f
.quad 0xbf703f7fbf623f1d,0x3ee5bd2cbebd3f38,0x3e87bf0b3f46bf6e,0xbf533f1dbeb03d2c,0x3f22bef13e95bdc9,0x3f7fbf753f62bf46,0xbf7f3f80bf7f3f7c,0xbf6b3f73bf793f7d
.quad 0x3f05befe3ef1bee5,0x3f1dbf173f11bf0b,0x3ecbbf053f22bf3c,0xbe1d3c663e01be87,0xbf7a3f80bf753f5b,0xbeb03f11bf413f65,0x3f3cbee53dc93e87,0x3f41bf703f80bf6e
.quad 0x3f7ebebdbf4f3f46,0x3f223f17bf6ebe01,0xbf7c3f053f1dbf75,0xbe95bf4a3f5b3e3a,0x3f79bf28bebd3f7f,0xbdc93f6ebf41be72,0xbf753f463dc9bf62,0x3ef1bf7f3f223e95
.quad 0x3f70bf5e3e3a3f22,0xbf463f7cbefebeb0,0xbf6b3f70bee5be95,0x3f75bf653eb03ecb,0x3f65bf7c3f2dbdc9,0xbf7f3f3cbe3abee5,0xbf5e3f80bf5b3ef1,0x3f62bf053c663efe
.quad 0x3f57bf7d3f77bf46,0xbf223e873e1dbf0b,0xbf4f3f73bf803f75,0x3e953c66bea23f17,0x3f46bf623f75bf7f,0x3dc9be953ef1bf22,0xbf3c3f4abf573f62,0xbef13f0bbf1d3f2d
.quad 0x3f32bf2d3f28bf22,0x3f46bf413f3cbf38,0xbf283f0bbed83e95,0xbf753f68bf573f41,0x3f1dbecb3e1d3dc9,0x3f7fbf7d3f6bbf4a,0xbf113e723e01bef1,0xbf623f7ebf793f53
.quad 0x3dc9bf7d3ecb3f4a,0x3f65bf28bf113f70,0x3ef1bf7e3e723f53,0x3f6e3c66bf703f28,0x3f46bf6b3d8f3f5b,0x3eb03f2dbf773e56,0x3f75bf46bdc93f62,0xbef13f7fbf22be95
.quad 0x3f7fbf11be873f68,0xbf793f4fbd8fbf38,0x3f62bea2bed83f6e,0xbf533e563f05bf77,0x3f22bd2cbf113f73,0xbe01befe3f6bbf79,0x3e953e72bf323f77,0x3f28bf733f7abf3c
.quad 0xbdc93efebf4f3f7a,0x3f80bf6b3f2dbea2,0xbef13f38bf653f7d,0x3f2dbed83e013e3a,0xbf463f62bf753f7f,0xbdc93e95bef13f22,0xbf753f7abf7e3f80,0xbf4f3f5bbf653f6e
.quad 0xbf7f3f7fbf803f80,0xbf7a3f7cbf7d3f7e,0xbf623f70bf7a3f7f,0xbefe3f1dbf383f4f,0xbf223f4fbf6e3f7e,0x3ea2bd8fbe3a3ed8,0xbe953f1dbf5b3f7c,0x3f6bbf383ed8bd8f
.quad 0x3f5b3e95bf803e56,0x3c663f77befebf38,0xbe873f7fbee5bf2d,0xbf7d3e563f57bf4f,0xbf803ef13f11bf7e,0x3ea2bf7d3f173ee5,0xbe95bf223f7fbef1,0x3f62bdc9bf463f75
.quad 0x3f57bf753ecb3ee5,0xbf1d3f80bf2dbe01,0x3f41bdc9bf1d3f7d,0xbf2dbc663f32bf80,0xbed83f62bf7d3f32,0x3f57bf7f3f41be56,0xbf7d3f46beb0be3a,0x3ecb3e01bf1d3f6e
.quad 0xbe01be953f28bf68,0xbf793f7cbf533f05,0x3f6bbf7f3f7abf5e,0xbd8fbe723f05bf41,0x3f22bef13e95bdc9,0x3f7fbf753f62bf46,0xbf113f22bf323f41,0xbe873eb0bed83efe
.quad 0xbf733f75bf773f79,0xbf683f6bbf6e3f70,0x3d2c3dc9be723ebd,0x3f11bee53ea2be3a,0x3f79bf623f3cbf0b,0x3f38bf5e3f77bf80,0x3efebf463f73bf80,0xbf4f3f0bbe56be1d
.quad 0xbf573f3c3ef1bf79,0xbf68be3a3f7fbea2,0x3d2cbf733f223efe,0x3f7fbed8bf323f6b,0x3f4a3e3abf753f32,0xbf573f5e3d2cbf68,0xbf753f463dc9bf62,0x3ef1bf7f3f223e95
.quad 0x3ea2bf6e3f62be56,0x3c663f41bf7d3f05,0x3f173e01bf463f7f,0xbefebe723f57bf7c,0xbf803f4fbe95beb0,0x3f5bbebdbe873f4a,0x3f11bf683f7fbf4f,0xbf803f57bee5bd8f
.quad 0x3eb03d8fbef13f4a,0x3f65bf803f6ebf32,0xbf773f57bf223ebd,0xbf113f4abf703f80,0x3f46bf623f75bf7f,0x3dc9be953ef1bf22,0x3d8f3c66bdc93e3a,0x3ecbbea23e72be1d
.quad 0xbf5b3f5ebf623f65,0xbf4a3f4fbf533f57,0x3f6bbf5b3f46bf2d,0x3f7dbf803f7ebf77,0xbe56bd2c3e95bf05,0xbf703f53bf283ee5,0xbf2d3f65bf7f3f77,0x3f28beb0bc663ebd
.quad 0xbe01bf6e3f173f22,0x3f46bf4fbebd3f7e,0x3e3a3f5bbf4abe95,0xbf753f1d3f05bf7c,0xbe72bf413f6ebdc9,0x3f7fbebdbf283f79,0x3e953f22bf7f3ef1,0xbf623dc93f46bf75
.quad 0xbeb0befe3f7cbf46,0x3f223e3abf5e3f70,0x3ecb3eb0bf653f75,0xbe95bee53f70bf6b,0xbee5be3a3f3cbf7f,0xbdc93f2dbf7c3f65,0x3efe3c66bf053f62,0x3ef1bf5b3f80bf5e
.quad 0xbf0b3e1d3e87bf22,0xbf463f77bf7d3f57,0x3f17bea23c663e95,0x3f75bf803f73bf4f,0xbf223ef1be953dc9,0xbf7f3f75bf623f46,0x3f2dbf1d3f0bbef1,0x3f62bf573f4abf3c
.quad 0xbf383f3cbf413f46,0xbf223f28bf2d3f32,0x3f41bf573f68bf75,0x3e95bed83f0bbf28,0xbf4a3f6bbf7d3f7f,0x3dc93e1dbecb3f1d,0x3f53bf793f7ebf62,0xbef13e013e72bf11
.quad 0x3f0e3f2bbf63be64,0xbed13f7cbdacbf72,0x3e48bf7c3f023f20,0x3f7fbe8ebf4d3f59,0xbf553f603ce6bf67,0xbe80bf3f3f6fbde5,0x3f7bbec4bf0e3f80,0xbf553f6dbe48bf35
.quad 0xbf0ebe8e3f6abf67,0x3f4dbd66bf3a3f7e,0xbe483f51bf7d3f20,0x3e9bbf603f78bf08,0x3f55bf803f44be64,0xbf803f51be9bbea9,0xbf7b3f3fbe9bbe64,0x3eb73e2cbf253f72
.quad 0x3f0ebe2cbe803f20,0x3f44bf763f7dbf59,0x3e48bef83f3abf67,0xbf5c3f2bbed13de5,0xbf553f6dbf7b3f80,0xbe483ec4bf0e3f35,0x3f7bbf763f6fbf67,0x3f7dbf803f80bf7e
.quad 0xbf0e3f14bf1a3f20,0xbeeb3ef8bf023f08,0xbe483d663dacbe64,0xbf303f14beeb3ea9,0x3f55bf2b3eebbe64,0x3f6abf7c3f7fbf72,0xbf7b3f7cbf5c3f20,0x3dac3e8ebf1a3f59
.quad 0xbf7d3ec43f4dbf48,0xbf25bf143f6f3de5,0x3ce63f6dbf30bede,0xbf7d3ef83f25bf72,0x3f7fbec4bf253f7a,0xbed13f80bf02bf08,0x3e48bf6d3f550000,0x3f0e3ec4bf7b3f35
.quad 0xbf743ec43eebbf7a,0x3f80bf2bbe0f3f59,0xbed13f6dbf6f3ede,0x3f02bf763f63bea9,0x3f5cbec4be803f48,0xbeebbe2c3f3abf7e,0x3f1abf6d3f7dbf48,0xbf7f3f51bed1bde5
.quad 0xbf3a3ec43ce6bede,0xbf1a3f60bf7f3f72,0xbf443f6dbf7f3f7a,0x3eb7bd66be803f08,0x3f0ebec43e480000,0x3f7bbf6d3f55bf35,0x3f63bf6d3f74bf7a,0x3f30bf3f3f4dbf59
.quad 0xbeb73ec4bed13ede,0xbe803e8ebe9b3ea9,0xbf783f6dbf5c3f48,0xbf743f7cbf803f7e,0x3e0fbec43f1abf48,0xbf443f14beb73de5,0x3f80bf6d3f3abede,0x3e0fbef83f44bf72
.quad 0x3e9bbf803e483f67,0x3f78bef8bf3a3f59,0xbe80bf513f553e64,0x3f6fbf2bbeeb3f7e,0xbf3abe8e3f7bbf20,0x3f63bf51be0f3f72,0xbf7b3ec43f0ebf80,0x3f55bf6d3e483f35
.quad 0xbf6f3f60be48bf20,0x3f44bf7c3f023ea9,0xbf1a3f7cbf553e64,0x3f30bf803f44bde5,0xbdac3f2bbf7b3f67,0x3f1abf763f6fbf08,0x3eeb3d66bf0e3f67,0x3f02bf603f80bf59
.quad 0x3f5cbf143e483e64,0x3ed1bf3f3f74bf7e,0x3f80bf763f55bf20,0x3e9bbf143f4dbf72,0x3f55bf6d3f7bbf80,0x3e48bec43f0ebf35,0x3ed1bef83f0ebf20,0x3dacbe2c3e80bea9
.quad 0xbe0f3e2cbe483e64,0xbce63d66bdac3de5,0xbf253f3fbf553f67,0xbe0f3e8ebed13f08,0xbf743f80bf7b3f67,0xbe803ef8bf303f59,0xbf783f51bf0e3e64,0xbeb73f2bbf633f7e
.quad 0x3f3a3ef8bf780000,0xbe483f80be9bbf59,0x3eeb3f2bbf6f0000,0xbf553f513e80bf7e,0x3e0f3f51bf630000,0xbf7b3e8e3f3abf72,0xbe483f6dbf550000,0xbf0ebec43f7bbf35
.quad 0xbf023f7cbf440000,0x3e48bf603f6fbea9,0xbf443f80bf300000,0x3f55bf7c3f1a3de5,0xbf6f3f76bf1a0000,0x3f7bbf2b3dac3f08,0xbf803f60bf020000,0x3f0ebd66beeb3f59
.quad 0xbf743f3fbed10000,0xbe483f14bf5c3f7e,0xbf4d3f14be9b0000,0xbf553f76bf803f72,0xbf0e3ec4be480000,0xbf7b3f6dbf553f35,0xbe803e2cbdac0000,0xbf0e3ef8bed13ea9
.quad 0x3dacbd663ce60000,0x3e48be2c3e0fbde5,0x3ed1be8e3e0f0000,0x3f55bf3f3f25bf08,0x3f30bef83e800000,0x3f7bbf803f74bf59,0x3f63bf2b3eb70000,0x3f0ebf513f78bf7e
.quad 0x3f55bf3fbeeb3f7a,0x3f6a3e2cbf7f3ea9,0xbf7b3e2c3f5cbf48,0x3dacbf763f1a3f08,0x3f0e3ef8bf803ede,0xbf783f2b3eb7bf7e,0x3e48bf6d3f550000,0x3f0e3ec4bf7b3f35
.quad 0xbf553f76bed1bede,0x3f1abf803f303de5,0x3f7bbf14be0f3f48,0xbf743ef83e80bf59,0xbf0ebd663f25bf7a,0x3ce63f14bf743f72,0xbe483f2bbf743f7a,0x3f6fbf7c3f44bea9
.quad 0x3f55bf7c3f78bf48,0xbf253e8e3e0fbf08,0xbf7b3f60bf303ede,0xbf023f3fbf6a3f7e,0x3f0ebec43e480000,0x3f7bbf6d3f55bf35,0x3e48be8e3eb7bede,0xbe0f3d663ce6bde5
.quad 0xbf553f51bf4d3f48,0xbf633f60bf5c3f59,0x3f7bbf803f7fbf7a,0x3f3abf513f63bf72,0xbf0e3f3fbf633f7a,0x3ed1be2cbdac3ea9,0xbe48be2c3f02bf48,0xbf7f3f76bf4d3f08
.quad 0x3e0f3f6dbf1abf20,0xbf443f513eb7bf7e,0x3f80bec4bf3a3f67,0x3e0f3f60bf44bea9,0x3dacbf6d3f443e64,0x3f6abd66bf5c3f59,0xbf7b3ec43f0ebf80,0x3f55bf6d3e483f35
.quad 0xbe9b3f6dbf633e64,0xbce6bf3f3f7dbf08,0x3f6abec4beb73f67,0xbf5c3e8e3eebbf72,0x3f02bf6d3f78bf20,0xbf633f7cbf303de5,0xbf4d3ec43e0fbf20,0xbdac3f14bf6a3f7e
.quad 0xbf303f6dbf803f67,0x3f4dbef83dac3ea9,0x3f25bec43dac3e64,0x3f6fbf803f78bf59,0x3f55bf6d3f7bbf80,0x3e48bec43f0ebf35,0xbeeb3ec4be9b3e64,0xbf3a3f2bbf1a3f08
.quad 0xbf6f3f6dbf6a3f67,0xbf783f76bf743f72,0x3e80bec43f02bf20,0xbe9b3e2cbce6bde5,0x3f7dbf6d3f4dbf20,0x3f25bf513f6fbf7e,0xbce63ec4bf303f67,0x3f7dbf603f25bea9
.quad 0xbf74bd663f7bbede,0xbe80bf603f303f08,0xbf783f143f0ebf7a,0xbeb7bf3f3f633de5,0xbf303f76be48bf48,0xbeebbf143f7dbea9,0xbe483f6dbf550000,0xbf0ebec43f7bbf35
.quad 0x3eb73ef8bf7b3f48,0xbf25be2c3f5cbf72,0x3f4dbe2cbf0e3f7a,0xbf3a3d663f25bf7e,0x3f7fbf3f3e483ede,0xbf4d3e8e3eb7bf59,0x3f63bf803f55bede,0xbf5c3ef83ce6bf08
.quad 0x3f02bf513f7bbf7a,0xbf6a3f2bbe9bbde5,0xbce6be8e3f0ebf48,0xbf743f51bf1a3ea9,0xbf0e3ec4be480000,0xbf7b3f6dbf553f35,0xbf6a3f60bf553f48,0xbf7f3f7cbf783f72
.quad 0xbf7d3f7cbf7b3f7a,0xbf803f80bf7f3f7e,0xbf443f2bbf0e3ede,0xbf7d3f76bf6a3f59,0xbe9b3d663e48bede,0xbf783f60bf3a3f08,0x3e80bf143f55bf7a,0xbf6f3f3fbeeb3de5
.quad 0x3f30bf60be803f80,0x3f7bbd66bf743f08,0x3f63bf3fbeb73f80,0x3f0e3f14bf783de5,0x3f7dbf14beeb3f80,0xbe483f76bf30bea9,0x3f7bbec4bf0e3f80,0xbf553f6dbe48bf35
.quad 0x3f5cbe2cbf253f80,0xbf7b3ef83eb7bf72,0x3f253d66bf3a3f80,0xbf0ebe2c3f4dbf7e,0x3eb73e8ebf4d3f80,0x3e48bf3f3f7fbf59,0x3ce63ef8bf5c3f80,0x3f55bf803f63bf08
.quad 0xbe9b3f2bbf6a3f80,0x3f7bbf513f02bde5,0xbf1a3f51bf743f80,0x3f0ebe8ebce63ea9,0xbf553f6dbf7b3f80,0xbe483ec4bf0e3f35,0xbf783f7cbf7f3f80,0xbf553f60bf6a3f72
.quad 0xbf7f3f80bf803f80,0xbf7b3f7cbf7d3f7e,0xbf6a3f76bf7d3f80,0xbf0e3f2bbf443f59,0xbf3a3f60bf783f80,0x3e483d66be9b3f08,0xbeeb3f3fbf6f3f80,0x3f55bf143e803de5
.quad 0xbea23f7fbe3abf68,0xbf793ef13f3cbf57,0x3f6bbf32bed83f7f,0x3efe3f22bf733d2c,0xbf683d2c3f5ebf57,0x3f32bf753e3a3f4a,0x3e953f22bf7f3ef1,0xbf623dc93f46bf75
.quad 0x3f05bf7d3f413c66,0xbe563f62bf6e3ea2,0xbf7c3f57be72befe,0x3f7fbf463e013f17,0x3f4abe87bebd3f5b,0xbeb0be953f4fbf80,0xbd8fbee53f57bf80,0xbf4f3f7fbf683f11
.quad 0xbf323f6ebf803f65,0x3f4abef13d8f3eb0,0x3f80bf703f4abf11,0x3ebdbf223f57bf77,0xbf223ef1be953dc9,0xbf7f3f75bf623f46,0xbe1d3e72bea23ecb,0x3e3abdc93c663d8f
.quad 0x3f57bf533f4fbf4a,0x3f65bf623f5ebf5b,0xbf773f7ebf803f7d,0xbf2d3f46bf5b3f6b,0x3ee5bf283f53bf70,0xbf053e95bd2cbe56,0x3ebdbc66beb03f28,0x3f77bf7f3f65bf2d
.quad 0xbf38befe3f773c66,0x3e56bf803e953f5b,0xbf4f3f573e56bf7d,0xbf2dbee53f7fbe87,0x3ee53f17bf7d3ea2,0xbf7e3f113ef1bf80,0x3f75bf46bdc93f62,0xbef13f7fbf22be95
.quad 0xbe01bf2d3f80bf1d,0x3ee53ecbbf753f57,0xbf803f32bc66bf2d,0x3f7dbf1dbdc93f41,0xbe563f41bf7f3f57,0x3f32bf7d3f62bed8,0x3f6ebf1d3e013ecb,0xbe3abeb03f46bf7d
.quad 0x3f05bf533f7cbf79,0xbf683f28be95be01,0xbf413f05be72bd8f,0xbf5e3f7abf7f3f6b,0xbf463f62bf753f7f,0xbdc93e95bef13f22,0x3efebed83eb0be87,0x3f41bf323f22bf11
.quad 0x3f70bf6e3f6bbf68,0x3f79bf773f75bf73,0xbe3a3ea2bee53f11,0x3ebdbe723dc93d2c,0xbf803f77bf5e3f38,0xbf0b3f3cbf623f79,0xbe1dbe563f0bbf4f,0xbf803f73bf463efe
.quad 0x3f70bf11bf283f65,0x3f4a3ecbbf7d3dc9,0x3f28bf703c663f6e,0x3f533e72bf7e3ef1,0x3e56bf773f2d3eb0,0x3f5b3d8fbf6b3f46,0xbe95bf223f7fbef1,0x3f62bdc9bf463f75
.quad 0xbf38bd8f3f4fbf79,0x3f68be87bf113f7f,0xbf773f053e56bf53,0x3f6ebed8bea23f62,0xbf793f6bbefebe01,0x3f73bf11bd2c3f22,0xbf3c3f7abf733f28,0x3f77bf323e723e95
.quad 0xbea23f2dbf6b3f80,0x3f7abf4f3efebdc9,0x3e3a3e01bed83f2d,0x3f7dbf653f38bef1,0x3f22bef13e95bdc9,0x3f7fbf753f62bf46,0x3f6ebf653f5bbf4f,0x3f80bf7e3f7abf75
.quad 0x3f7ebf7d3f7cbf7a,0x3f80bf803f7fbf7f,0x3f4fbf383f1dbefe,0x3f7fbf7a3f70bf62,0x3ed8be3abd8f3ea2,0x3f7ebf6e3f4fbf22,0xbd8f3ed8bf383f6b,0x3f7cbf5b3f1dbe95
.quad 0xbdc93f7dbecbbf4a,0xbf653f283f11bf70,0xbef13f7ebe72bf53,0xbf6ebc663f70bf28,0xbf463f6bbd8fbf5b,0xbeb0bf2d3f77be56,0xbf753f463dc9bf62,0x3ef1bf7f3f223e95
.quad 0xbf7f3f113e87bf68,0x3f79bf4f3d8f3f38,0xbf623ea23ed8bf6e,0x3f53be56bf053f77,0xbf223d2c3f11bf73,0x3e013efebf6b3f79,0xbe95be723f32bf77,0xbf283f73bf7a3f3c
.quad 0x3dc9befe3f4fbf7a,0xbf803f6bbf2d3ea2,0x3ef1bf383f65bf7d,0xbf2d3ed8be01be3a,0x3f46bf623f75bf7f,0x3dc9be953ef1bf22,0x3f75bf7a3f7ebf80,0x3f4fbf5b3f65bf6e
.quad 0x3f7fbf7f3f80bf80,0x3f7abf7c3f7dbf7e,0x3f62bf703f7abf7f,0x3efebf1d3f38bf4f,0x3f22bf4f3f6ebf7e,0xbea23d8f3e3abed8,0x3e95bf1d3f5bbf7c,0xbf6b3f38bed83d8f
.quad 0x3f733d8fbf7c3ed8,0x3e723f62bf2dbf0b,0xbecbbf383f683d8f,0x3f5ebf46bea23f80,0xbed83f80befebf0b,0xbf38be953f7cbf1d,0x3f75bf46bdc93f62,0xbef13f7fbf22be95
.quad 0xbf5b3e1d3f28bf80,0x3f7abef1bebd3f73,0x3e3a3f0bbf793f5e,0xbd8fbf223f7ebf4f,0x3f1dbf773f6ebf05,0xbf703f75bf17bc66,0xbf7f3f65bf0b3d2c,0x3f17bdc9bed83f53
.quad 0x3f38bebdbd2c3ee5,0x3f1dbf623f7fbf70,0x3d2cbeb03f1dbf53,0xbf6e3f46bf0b3e87,0xbf463f62bf753f7f,0xbdc93e95bef13f22,0x3f7dbf793f73bf6b,0x3f7cbf7f3f80bf7f
.quad 0xbf0b3f11bf173f1d,0xbee53ef1befe3f05,0xbe873e013c66be1d,0xbf3c3f22bf053ecb,0x3f65bf413f11beb0,0x3f5bbf753f80bf7a,0xbf6e3f80bf703f41,0x3e873dc9bee53f3c
.quad 0xbf323f5e3e87bf80,0xbf7a3d2c3f75bf05,0x3f173f0bbf7a3e1d,0xbf3c3f653dc9bf77,0x3f65bf4fbe1d3f73,0x3e013f53bf62bc66,0xbe95bf223f7fbef1,0x3f62bdc9bf463f75
.quad 0xbf7e3f3c3d2cbf4a,0x3f65bf6b3e953f0b,0xbd2c3f38bf803f3c,0x3e1dbf4a3f7fbf28,0x3f7abf283d8f3f0b,0xbf383e1d3ef1bf68,0x3ebdbf4a3f7ebf6b,0xbf7c3f70bf223e1d
.quad 0xbf5b3f11be3abe72,0xbed83f41bf753f7e,0xbf283f5bbf793f7f,0x3efebe56bdc93ecb,0x3f22bef13e95bdc9,0x3f7fbf753f62bf46,0x3f5ebf683f70bf77,0x3f28bf383f46bf53
.quad 0xbeb03ebdbecb3ed8,0xbe723e87be953ea2,0xbf7c3f73bf653f53,0xbf6e3f79bf7f3f80,0x3c66be873efebf32,0xbf573f2dbef13e72,0x3f7dbf7a3f57bf17,0xbd2cbea23f22bf5e
.quad 0xbeb0bf533f413ee5,0x3f1dbf6bbe1d3f7f,0xbf41beb03f80bebd,0x3f11bf793e013f62,0xbf7a3e873f3cbf70,0x3f05bf7f3ecb3f22,0xbf753f463dc9bf62,0x3ef1bf7f3f223e95
.quad 0xbf323f7fbf17be72,0x3ed8bf773f53bdc9,0xbe873f5bbf7a3f11,0x3ebdbf683f73bef1,0x3e723ecbbf5e3f7e,0x3ea2bf533f80bf46,0x3f2dbe56bea23f41,0x3e87bf383f79bf75
.quad 0x3f73bf3c3ecb3c66,0x3e56bf173f5ebf7f,0x3f7cbf7e3f68bf3c,0x3e1dbee53f32bf62,0x3f46bf623f75bf7f,0x3dc9be953ef1bf22,0x3ebdbee53f05bf17,0x3d2cbe013e56be95
.quad 0xbe013e1dbe3a3e56,0xbc663d2cbd8f3dc9,0xbf173f32bf4a3f5e,0xbd8f3e56beb03ef1,0xbf683f7cbf7f3f73,0xbe013ebdbf173f46,0xbf7f3f68bf323ecb,0xbe3a3f05bf4a3f75
.quad 0x3f7fbe1dbf6b3f1d,0x3ee53f41bf53beb0,0x3f623e01bf793f11,0xbebd3f80beb0bf41,0x3f223ecbbf7f3f05,0xbf703f3c3e87bf7a,0x3e953f22bf7f3ef1,0xbf623dc93f46bf75
.quad 0xbdc93f53bf773ed8,0xbe72bf173f7fbf32,0xbef13f73bf683ebd,0x3f11bf7a3f5bbe87,0xbf463f80bf533ea2,0x3f7ebf5e3ecb3e72,0xbf753f79bf383e87,0x3f41bea2be563f2d
.quad 0xbf7f3f5ebf173e56,0x3c663ecbbf3c3f73,0xbf623f32bee53e1d,0xbf3c3f68bf7e3f7c,0xbf223ef1be953dc9,0xbf7f3f75bf623f46,0xbe953e56be013d2c,0xbf173f05bee53ebd
.quad 0x3dc9bd8f3d2cbc66,0x3e56be3a3e1dbe01,0x3ef1beb03e56bd8f,0x3f5ebf4a3f32bf17,0x3f46bf173ebdbe01,0x3f73bf7f3f7cbf68,0x3f75bf4a3f05be3a,0x3ecbbf323f68bf7f
.quad 0xbf6f3f143f25bf67,0xbf4dbec43f7dbde5,0xbf25bef83f7dbe64,0x3f30bf6dbce63f72,0x3f02bf803ed13f20,0x3f253ec4bf7f3f08,0x3f7bbec4bf0e3f80,0xbf553f6dbe48bf35
.quad 0x3e0f3f2bbf803f20,0xbeebbec43f74bf59,0xbf633f76bf02be64,0x3f6fbf6d3ed13ea9,0xbf3a3e2c3eebbf67,0x3e803ec4bf5c3f7e,0x3ed1bf513f7fbf67,0xbf7d3f6dbf1a3de5
.quad 0x3f7fbf603f1abe64,0xbce6bec43f3abf72,0x3e803d66beb73f20,0x3f7fbf6d3f44bf08,0xbf553f6dbf7b3f80,0xbe483ec4bf0e3f35,0xbf4d3f3fbf303f20,0xbf743f6dbf633f59
.quad 0x3e9bbe8e3e80be64,0x3ed1bec43eb7bea9,0x3f80bf7c3f74bf67,0x3f5cbf6d3f78bf7e,0x3eb7bf143f44bf67,0xbf1a3ec4be0fbde5,0xbf443ef8be0fbe64,0xbf3a3f6dbf803f72
.quad 0x3dacbf7c3ed13f48,0x3f63bf2bbf0e3f72,0x3f4d3e8ebf7f3ede,0xbf023f7cbe48bf59,0xbf6f3f3f3e80bf7a,0xbce6bf603f553de5,0x3e48bf6d3f550000,0x3f0e3ec4bf7b3f35
.quad 0x3f3a3d66bf4d3f7a,0xbf6a3e8e3f0ebf7e,0xbf783f60be9bbede,0x3f7dbf513e483f08,0x3e9bbf513f80bf48,0xbf443f80bf553ea9,0x3f25be2cbeb73f48,0x3e9bbf3f3f7bbf72
.quad 0xbf7d3f76bf443ede,0x3e803e2cbf0e3f59,0x3ed1bf2b3f5cbf7a,0xbf3a3ef8be48bde5,0x3f0ebec43e480000,0x3f7bbf6d3f55bf35,0xbf803f80bf7d3f7a,0xbf6f3f76bf7b3f7e
.quad 0x3f02bef83eebbede,0x3f1abf143f0ebf08,0x3eebbf143f30bf48,0xbdacbd663e48bea9,0xbf7f3f7cbf6a3f48,0xbeeb3f2bbf553f72,0x3f1abe8ebdac3ede,0x3f5cbf7c3f7bbf59
.quad 0x3f5c3e8ebf803e64,0x3ce63f76bf02bf35,0xbf6abd663f74bf20,0x3e9bbf803ed13f35,0x3f74be2cbf4d3f67,0xbf1a3f7cbe9bbf35,0xbf7b3ec43f0ebf80,0x3f55bf6d3e483f35
.quad 0x3f7fbf14be803f67,0xbf783f51bdacbf35,0xbf803f3fbdacbf20,0x3f7fbf2bbce63f35,0x3f7dbf603ed13e64,0xbf6a3ef83e0fbf35,0xbf783f76bf303e64,0x3f3abe8ebe803f35
.quad 0x3f6fbf803f63bf20,0xbeeb3d663eb7bf35,0xbf633f7cbf7d3f67,0x3e0f3e2cbeeb3f35,0x3f55bf6d3f7bbf80,0x3e48bec43f0ebf35,0xbf443f51bf5c3f67,0xbf023f14bf253f35
.quad 0x3f30bf2b3f25bf20,0x3f44bf3f3f3abf35,0xbf1a3ef8beb73e64,0xbf6f3f60bf4d3f35,0x3f02be8e3ce63e64,0x3f80bf763f5cbf35,0xbed13d663e9bbf20,0xbf743f80bf6a3f35
.quad 0xbf553f3f3eebbf7a,0xbf6abe2c3f7fbea9,0x3f7bbe2cbf5c3f48,0xbdac3f76bf1abf08,0xbf0ebef83f80bede,0x3f78bf2bbeb73f7e,0xbe483f6dbf550000,0xbf0ebec43f7bbf35
.quad 0x3f55bf763ed13ede,0xbf1a3f80bf30bde5,0xbf7b3f143e0fbf48,0x3f74bef8be803f59,0x3f0e3d66bf253f7a,0xbce6bf143f74bf72,0x3e48bf2b3f74bf7a,0xbf6f3f7cbf443ea9
.quad 0xbf553f7cbf783f48,0x3f25be8ebe0f3f08,0x3f7bbf603f30bede,0x3f02bf3f3f6abf7e,0xbf0e3ec4be480000,0xbf7b3f6dbf553f35,0xbe483e8ebeb73ede,0x3e0fbd66bce63de5
.quad 0x3f55bf513f4dbf48,0x3f63bf603f5cbf59,0xbf7b3f80bf7f3f7a,0xbf3a3f51bf633f72,0x3f0ebf3f3f63bf7a,0xbed13e2c3dacbea9,0x3e483e2cbf023f48,0x3f7fbf763f4dbf08
.quad 0x3eb73f51bf44bede,0xbf1a3f6d3e0fbf7e,0xbf443f603e0fbf7a,0xbf3abec43f80bea9,0xbf5cbd663f6abf48,0x3f44bf6d3dac3f59,0x3e48bf6d3f550000,0x3f0e3ec4bf7b3f35
.quad 0x3f7dbf3fbce63f48,0xbf633f6dbe9bbf08,0x3eeb3e8ebf5c3f7a,0xbeb7bec43f6abf72,0xbf303f7cbf633ede,0x3f78bf6d3f023de5,0xbf6a3f14bdacbede,0x3e0f3ec4bf4d3f7e
.quad 0x3dacbef83f4dbf7a,0xbf803f6dbf303ea9,0x3f78bf803f6fbf48,0x3dacbec43f25bf59,0x3f0ebec43e480000,0x3f7bbf6d3f55bf35,0xbf1a3f2bbf3a3f48,0xbe9b3ec4beeb3f08
.quad 0xbf743f76bf783f7a,0xbf6a3f6dbf6f3f72,0xbce63e2cbe9b3ede,0x3f02bec43e80bde5,0x3f6fbf513f25bede,0x3f4dbf6d3f7dbf7e,0x3f25bf603f7dbf7a,0xbf303ec4bce6bea9
.quad 0xbf7f3e2c3f6abf20,0xbeebbf3f3f553ea9,0x3f1abf763dac3f67,0x3f5c3e2cbf7b3f08,0x3eb73f2bbf783e64,0xbf803ef83f0ebf7e,0xbf7b3ec43f0ebf80,0x3f55bf6d3e483f35
.quad 0x3f30bf803f1a3e64,0xbed13f76bf553de5,0x3e803ef8bf743f67,0xbe0fbf143f7bbf59,0xbf743f143ce6bf20,0x3f25bd66bf0e3f72,0x3f44bf7c3f6fbf20,0xbf743f2bbe48bea9
.quad 0x3e0f3e8ebf253f67,0x3f78bf7c3f55bf08,0xbf6a3f3fbf023e64,0xbf303f60bf7b3f7e,0x3f55bf6d3f7bbf80,0x3e48bec43f0ebf35,0x3ce63d66be0f3e64,0x3eb7be8e3e48bde5
.quad 0xbf5c3f60bf633f67,0xbf4d3f51bf553f59,0x3f63bf513f3abf20,0x3f7fbf803f7bbf72,0xbdacbe2c3ed1bf20,0xbf633f3fbf0e3ea9,0xbf4d3f76bf7f3f67,0x3f02be2cbe483f08
.quad 0x3f02bf76bce63f7a,0x3f80be8ebf5c3f35,0xbed13f80be9bbf48,0xbf743d663f6abf35,0x3e9bbf7c3f1a3ede,0x3f4d3e2cbf743f35,0xbe483f6dbf550000,0xbf0ebec43f7bbf35
.quad 0x3dacbf513f78bede,0x3e803f14bf7f3f35,0x3ce63f2bbf7f3f48,0x3dacbf3f3f80bf35,0xbe0fbef83f6abf7a,0xbed13f60bf7d3f35,0x3e803e8ebf3a3f7a,0x3f30bf763f78bf35
.quad 0xbeb7bd663eebbf48,0xbf633f80bf6f3f35,0x3eebbe2cbe0f3ede,0x3f7dbf7c3f63bf35,0xbf0e3ec4be480000,0xbf7b3f6dbf553f35,0x3f25bf143f02bede,0x3f5cbf513f44bf35
.quad 0xbf3a3f3fbf443f48,0xbf253f2bbf303f35,0x3f4dbf603f6fbf7a,0x3eb7bef83f1abf35,0xbf5c3f76bf803f7a,0xbce63e8ebf023f35,0x3f6abf803f74bf48,0xbe9bbd663ed1bf35
.quad 0x3f0e3f2bbf63be64,0xbed13f7cbdacbf72,0x3e48bf7c3f023f20,0x3f7fbe8ebf4d3f59,0xbf553f603ce6bf67,0xbe80bf3f3f6fbde5,0x3f7bbec4bf0e3f80,0xbf553f6dbe48bf35
.quad 0xbf0ebe8e3f6abf67,0x3f4dbd66bf3a3f7e,0xbe483f51bf7d3f20,0x3e9bbf603f78bf08,0x3f55bf803f44be64,0xbf803f51be9bbea9,0xbf7b3f3fbe9bbe64,0x3eb73e2cbf253f72
.quad 0x3f0ebe2cbe803f20,0x3f44bf763f7dbf59,0x3e48bef83f3abf67,0xbf5c3f2bbed13de5,0xbf553f6dbf7b3f80,0xbe483ec4bf0e3f35,0x3f7bbf763f6fbf67,0x3f7dbf803f80bf7e
.quad 0xbf0e3f14bf1a3f20,0xbeeb3ef8bf023f08,0xbe483d663dacbe64,0xbf303f14beeb3ea9,0x3f55bf2b3eebbe64,0x3f6abf7c3f7fbf72,0xbf7b3f7cbf5c3f20,0x3dac3e8ebf1a3f59
.quad 0xbf5bbe953f80be56,0xbc66bf773efe3f38,0x3e87bf7f3ee53f2d,0x3f7dbe56bf573f4f,0x3f80bef1bf113f7e,0xbea23f7dbf17bee5,0x3e953f22bf7f3ef1,0xbf623dc93f46bf75
.quad 0xbf573f75becbbee5,0x3f1dbf803f2d3e01,0xbf413dc93f1dbf7d,0x3f2d3c66bf323f80,0x3ed8bf623f7dbf32,0xbf573f7fbf413e56,0x3f7dbf463eb03e3a,0xbecbbe013f1dbf6e
.quad 0x3e013e95bf283f68,0x3f79bf7c3f53bf05,0xbf6b3f7fbf7a3f5e,0x3d8f3e72bf053f41,0xbf223ef1be953dc9,0xbf7f3f75bf623f46,0x3f11bf223f32bf41,0x3e87beb03ed8befe
.quad 0x3f73bf753f77bf79,0x3f68bf6b3f6ebf70,0xbd2cbdc93e72bebd,0xbf113ee5bea23e3a,0xbf793f62bf3c3f0b,0xbf383f5ebf773f80,0xbefe3f46bf733f80,0x3f4fbf0b3e563e1d
.quad 0x3f57bf3cbef13f79,0x3f683e3abf7f3ea2,0xbd2c3f73bf22befe,0xbf7f3ed83f32bf6b,0xbf4abe3a3f75bf32,0x3f57bf5ebd2c3f68,0x3f75bf46bdc93f62,0xbef13f7fbf22be95
.quad 0xbea23f6ebf623e56,0xbc66bf413f7dbf05,0xbf17be013f46bf7f,0x3efe3e72bf573f7c,0x3f80bf4f3e953eb0,0xbf5b3ebd3e87bf4a,0xbf113f68bf7f3f4f,0x3f80bf573ee53d8f
.quad 0xbeb0bd8f3ef1bf4a,0xbf653f80bf6e3f32,0x3f77bf573f22bebd,0x3f11bf4a3f70bf80,0xbf463f62bf753f7f,0xbdc93e95bef13f22,0xbd8fbc663dc9be3a,0xbecb3ea2be723e1d
.quad 0x3f5bbf5e3f62bf65,0x3f4abf4f3f53bf57,0xbf6b3f5bbf463f2d,0xbf7d3f80bf7e3f77,0x3e563d2cbe953f05,0x3f70bf533f28bee5,0x3f2dbf653f7fbf77,0xbf283eb03c66bebd
.quad 0x3e013f6ebf17bf22,0xbf463f4f3ebdbf7e,0xbe3abf5b3f4a3e95,0x3f75bf1dbf053f7c,0x3e723f41bf6e3dc9,0xbf7f3ebd3f28bf79,0xbe95bf223f7fbef1,0x3f62bdc9bf463f75
.quad 0x3eb03efebf7c3f46,0xbf22be3a3f5ebf70,0xbecbbeb03f65bf75,0x3e953ee5bf703f6b,0x3ee53e3abf3c3f7f,0x3dc9bf2d3f7cbf65,0xbefebc663f05bf62,0xbef13f5bbf803f5e
.quad 0x3f0bbe1dbe873f22,0x3f46bf773f7dbf57,0xbf173ea2bc66be95,0xbf753f80bf733f4f,0x3f22bef13e95bdc9,0x3f7fbf753f62bf46,0xbf2d3f1dbf0b3ef1,0xbf623f57bf4a3f3c
.quad 0x3f38bf3c3f41bf46,0x3f22bf283f2dbf32,0xbf413f57bf683f75,0xbe953ed8bf0b3f28,0x3f4abf6b3f7dbf7f,0xbdc9be1d3ecbbf1d,0xbf533f79bf7e3f62,0x3ef1be01be723f11
.quad 0xbf73bd8f3f7cbed8,0xbe72bf623f2d3f0b,0x3ecb3f38bf68bd8f,0xbf5e3f463ea2bf80,0x3ed8bf803efe3f0b,0x3f383e95bf7c3f1d,0xbf753f463dc9bf62,0x3ef1bf7f3f223e95
.quad 0x3f5bbe1dbf283f80,0xbf7a3ef13ebdbf73,0xbe3abf0b3f79bf5e,0x3d8f3f22bf7e3f4f,0xbf1d3f77bf6e3f05,0x3f70bf753f173c66,0x3f7fbf653f0bbd2c,0xbf173dc93ed8bf53
.quad 0xbf383ebd3d2cbee5,0xbf1d3f62bf7f3f70,0xbd2c3eb0bf1d3f53,0x3f6ebf463f0bbe87,0x3f46bf623f75bf7f,0x3dc9be953ef1bf22,0xbf7d3f79bf733f6b,0xbf7c3f7fbf803f7f
.quad 0x3f0bbf113f17bf1d,0x3ee5bef13efebf05,0x3e87be01bc663e1d,0x3f3cbf223f05becb,0xbf653f41bf113eb0,0xbf5b3f75bf803f7a,0x3f6ebf803f70bf41,0xbe87bdc93ee5bf3c
.quad 0xbf053f753d2cbf7a,0xbf803e873f5ebf32,0xbf773dc93f65bf3c,0x3e1dbf7a3f0b3f17,0xbc66bf623f533e01,0x3f73be1dbf4f3f65,0x3f75bf46bdc93f62,0xbef13f7fbf22be95
.quad 0x3f0b3e95bf6b3f65,0xbf4a3d2c3f3cbf7e,0xbf283f7fbf4a3e1d,0x3f3cbf803f38bd2c,0xbf683ef13e1dbf38,0x3f0b3d8fbf283f7a,0x3e1dbf223f70bf7c,0xbf6b3f7ebf4a3ebd
.quad 0x3f7ebf753f41bed8,0xbe72be3a3f11bf5b,0x3ecbbdc9be563efe,0x3f7fbf793f5bbf28,0xbf463f62bf753f7f,0xbdc93e95bef13f22,0xbf533f46bf383f28,0xbf773f70bf683f5e
.quad 0x3ea2be953e87be72,0x3ed8becb3ebdbeb0,0x3f80bf7f3f79bf6e,0x3f53bf653f73bf7c,0x3e72bef13f2dbf57,0xbf323efebe873c66,0xbf5e3f22bea2bd2c,0xbf173f57bf7a3f7d
.quad 0xbf0bbf2d3f623e72,0x3ed8bf7c3d8f3f73,0x3f80bea2bf463f5e,0x3d8f3f68bf38becb,0xbf1d3f7cbe95bf38,0xbf0bbefe3f80bed8,0xbe95bf223f7fbef1,0x3f62bdc9bf463f75
.quad 0x3f73bebdbef13f7a,0xbf803f283e1dbf5b,0xbf4f3f7ebf22bd8f,0x3f5ebf793f0b3e3a,0xbc66bf173f75bf70,0xbf053f6ebf773f1d,0x3f53bed8bdc93f17,0x3d2cbf0b3f65bf7f
.quad 0xbf703f7fbf623f1d,0x3ee5bd2cbebd3f38,0x3e87bf0b3f46bf6e,0xbf533f1dbeb03d2c,0x3f22bef13e95bdc9,0x3f7fbf753f62bf46,0xbf7f3f80bf7f3f7c,0xbf6b3f73bf793f7d
.quad 0x3f05befe3ef1bee5,0x3f1dbf173f11bf0b,0x3ecbbf053f22bf3c,0xbe1d3c663e01be87,0xbf7a3f80bf753f5b,0xbeb03f11bf413f65,0x3f3cbee53dc93e87,0x3f41bf703f80bf6e
.quad 0x3f7ebebdbf4f3f46,0x3f223f17bf6ebe01,0xbf7c3f053f1dbf75,0xbe95bf4a3f5b3e3a,0x3f79bf28bebd3f7f,0xbdc93f6ebf41be72,0xbf753f463dc9bf62,0x3ef1bf7f3f223e95
.quad 0x3f70bf5e3e3a3f22,0xbf463f7cbefebeb0,0xbf6b3f70bee5be95,0x3f75bf653eb03ecb,0x3f65bf7c3f2dbdc9,0xbf7f3f3cbe3abee5,0xbf5e3f80bf5b3ef1,0x3f62bf053c663efe
.quad 0x3f57bf7d3f77bf46,0xbf223e873e1dbf0b,0xbf4f3f73bf803f75,0x3e953c66bea23f17,0x3f46bf623f75bf7f,0x3dc9be953ef1bf22,0xbf3c3f4abf573f62,0xbef13f0bbf1d3f2d
.quad 0x3f32bf2d3f28bf22,0x3f46bf413f3cbf38,0xbf283f0bbed83e95,0xbf753f68bf573f41,0x3f1dbecb3e1d3dc9,0x3f7fbf7d3f6bbf4a,0xbf113e723e01bef1,0xbf623f7ebf793f53
.quad 0xbea23f7fbe3abf68,0xbf793ef13f3cbf57,0x3f6bbf32bed83f7f,0x3efe3f22bf733d2c,0xbf683d2c3f5ebf57,0x3f32bf753e3a3f4a,0x3e953f22bf7f3ef1,0xbf623dc93f46bf75
.quad 0x3f05bf7d3f413c66,0xbe563f62bf6e3ea2,0xbf7c3f57be72befe,0x3f7fbf463e013f17,0x3f4abe87bebd3f5b,0xbeb0be953f4fbf80,0xbd8fbee53f57bf80,0xbf4f3f7fbf683f11
.quad 0xbf323f6ebf803f65,0x3f4abef13d8f3eb0,0x3f80bf703f4abf11,0x3ebdbf223f57bf77,0xbf223ef1be953dc9,0xbf7f3f75bf623f46,0xbe1d3e72bea23ecb,0x3e3abdc93c663d8f
.quad 0x3f57bf533f4fbf4a,0x3f65bf623f5ebf5b,0xbf773f7ebf803f7d,0xbf2d3f46bf5b3f6b,0x3ee5bf283f53bf70,0xbf053e95bd2cbe56,0x3ebdbc66beb03f28,0x3f77bf7f3f65bf2d
.quad 0xbe0fbf6d3f1a3f20,0x3f44bf51beb73f7e,0xbf803ec43f3abf67,0xbe0fbf603f443ea9,0xbdac3f6dbf44be64,0xbf6a3d663f5cbf59,0x3f7bbec4bf0e3f80,0xbf553f6dbe48bf35
.quad 0x3e9bbf6d3f63be64,0x3ce63f3fbf7d3f08,0xbf6a3ec43eb7bf67,0x3f5cbe8ebeeb3f72,0xbf023f6dbf783f20,0x3f63bf7c3f30bde5,0x3f4dbec4be0f3f20,0x3dacbf143f6abf7e
.quad 0x3f30bf6d3f80bf67,0xbf4d3ef8bdacbea9,0xbf253ec4bdacbe64,0xbf6f3f80bf783f59,0xbf553f6dbf7b3f80,0xbe483ec4bf0e3f35,0x3eebbec43e9bbe64,0x3f3abf2b3f1abf08
.quad 0x3f6fbf6d3f6abf67,0x3f78bf763f74bf72,0xbe803ec4bf023f20,0x3e9bbe2c3ce63de5,0xbf7d3f6dbf4d3f20,0xbf253f51bf6f3f7e,0x3ce6bec43f30bf67,0xbf7d3f60bf253ea9
.quad 0x3f743d66bf7b3ede,0x3e803f60bf30bf08,0x3f78bf14bf0e3f7a,0x3eb73f3fbf63bde5,0x3f30bf763e483f48,0x3eeb3f14bf7d3ea9,0x3e48bf6d3f550000,0x3f0e3ec4bf7b3f35
.quad 0xbeb7bef83f7bbf48,0x3f253e2cbf5c3f72,0xbf4d3e2c3f0ebf7a,0x3f3abd66bf253f7e,0xbf7f3f3fbe48bede,0x3f4dbe8ebeb73f59,0xbf633f80bf553ede,0x3f5cbef8bce63f08
.quad 0xbf023f51bf7b3f7a,0x3f6abf2b3e9b3de5,0x3ce63e8ebf0e3f48,0x3f74bf513f1abea9,0x3f0ebec43e480000,0x3f7bbf6d3f55bf35,0x3f6abf603f55bf48,0x3f7fbf7c3f78bf72
.quad 0x3f7dbf7c3f7bbf7a,0x3f80bf803f7fbf7e,0x3f44bf2b3f0ebede,0x3f7dbf763f6abf59,0x3e9bbd66be483ede,0x3f78bf603f3abf08,0xbe803f14bf553f7a,0x3f6fbf3f3eebbde5
.quad 0x0,0x0,0x0,0x0,0x0,0x0,0x0,0x0
.quad 0x0,0x0,0x0,0x0,0x0,0x0,0x0,0x0
.quad 0x0,0x0,0x0,0x0,0x0,0x0,0x0,0x0
.quad 0x0,0x0,0x0,0x0,0x0,0x0,0x0,0x0
.quad 0x0,0x0,0x0,0x0,0x0,0x0,0x0,0x0
.quad 0x0,0x0,0x0,0x0,0x0,0x0,0x0,0x0
.quad 0x0,0x0,0x0,0x0,0x0,0x0,0x0,0x0
.quad 0x0,0x0,0x0,0x0,0x0,0x0,0x0,0x0
.quad 0xbf7d3ec43f4dbf48,0xbf25bf143f6f3de5,0x3ce63f6dbf30bede,0xbf7d3ef83f25bf72,0x3f7fbec4bf253f7a,0xbed13f80bf02bf08,0x3e48bf6d3f550000,0x3f0e3ec4bf7b3f35
.quad 0xbf743ec43eebbf7a,0x3f80bf2bbe0f3f59,0xbed13f6dbf6f3ede,0x3f02bf763f63bea9,0x3f5cbec4be803f48,0xbeebbe2c3f3abf7e,0x3f1abf6d3f7dbf48,0xbf7f3f51bed1bde5
.quad 0xbf3a3ec43ce6bede,0xbf1a3f60bf7f3f72,0xbf443f6dbf7f3f7a,0x3eb7bd66be803f08,0x3f0ebec43e480000,0x3f7bbf6d3f55bf35,0x3f63bf6d3f74bf7a,0x3f30bf3f3f4dbf59
.quad 0xbeb73ec4bed13ede,0xbe803e8ebe9b3ea9,0xbf783f6dbf5c3f48,0xbf743f7cbf803f7e,0x3e0fbec43f1abf48,0xbf443f14beb73de5,0x3f80bf6d3f3abede,0x3e0fbef83f44bf72
.quad 0x3e9bbf803e483f67,0x3f78bef8bf3a3f59,0xbe80bf513f553e64,0x3f6fbf2bbeeb3f7e,0xbf3abe8e3f7bbf20,0x3f63bf51be0f3f72,0xbf7b3ec43f0ebf80,0x3f55bf6d3e483f35
.quad 0xbf6f3f60be48bf20,0x3f44bf7c3f023ea9,0xbf1a3f7cbf553e64,0x3f30bf803f44bde5,0xbdac3f2bbf7b3f67,0x3f1abf763f6fbf08,0x3eeb3d66bf0e3f67,0x3f02bf603f80bf59
.quad 0x3f5cbf143e483e64,0x3ed1bf3f3f74bf7e,0x3f80bf763f55bf20,0x3e9bbf143f4dbf72,0x3f55bf6d3f7bbf80,0x3e48bec43f0ebf35,0x3ed1bef83f0ebf20,0x3dacbe2c3e80bea9
.quad 0xbe0f3e2cbe483e64,0xbce63d66bdac3de5,0xbf253f3fbf553f67,0xbe0f3e8ebed13f08,0xbf743f80bf7b3f67,0xbe803ef8bf303f59,0xbf783f51bf0e3e64,0xbeb73f2bbf633f7e
.quad 0x0,0x0,0x0,0x0,0x0,0x0,0x0,0x0
.quad 0x0,0x0,0x0,0x0,0x0,0x0,0x0,0x0
.quad 0x0,0x0,0x0,0x0,0x0,0x0,0x0,0x0
.quad 0x0,0x0,0x0,0x0,0x0,0x0,0x0,0x0
.quad 0x0,0x0,0x0,0x0,0x0,0x0,0x0,0x0
.quad 0x0,0x0,0x0,0x0,0x0,0x0,0x0,0x0
.quad 0x0,0x0,0x0,0x0,0x0,0x0,0x0,0x0
.quad 0x0,0x0,0x0,0x0,0x0,0x0,0x0,0x0
.quad 0x3f32bf5ebe873f80,0x3f7abd2cbf753f05,0xbf17bf0b3f7abe1d,0x3f3cbf65bdc93f77,0xbf653f4f3e1dbf73,0xbe01bf533f623c66,0x3e953f22bf7f3ef1,0xbf623dc93f46bf75
.quad 0x3f7ebf3cbd2c3f4a,0xbf653f6bbe95bf0b,0x3d2cbf383f80bf3c,0xbe1d3f4abf7f3f28,0xbf7a3f28bd8fbf0b,0x3f38be1dbef13f68,0xbebd3f4abf7e3f6b,0x3f7cbf703f22be1d
.quad 0x3f5bbf113e3a3e72,0x3ed8bf413f75bf7e,0x3f28bf5b3f79bf7f,0xbefe3e563dc9becb,0xbf223ef1be953dc9,0xbf7f3f75bf623f46,0xbf5e3f68bf703f77,0xbf283f38bf463f53
.quad 0x3eb0bebd3ecbbed8,0x3e72be873e95bea2,0x3f7cbf733f65bf53,0x3f6ebf793f7fbf80,0xbc663e87befe3f32,0x3f57bf2d3ef1be72,0xbf7d3f7abf573f17,0x3d2c3ea2bf223f5e
.quad 0x3eb03f53bf41bee5,0xbf1d3f6b3e1dbf7f,0x3f413eb0bf803ebd,0xbf113f79be01bf62,0x3f7abe87bf3c3f70,0xbf053f7fbecbbf22,0x3f75bf46bdc93f62,0xbef13f7fbf22be95
.quad 0x3f32bf7f3f173e72,0xbed83f77bf533dc9,0x3e87bf5b3f7abf11,0xbebd3f68bf733ef1,0xbe72becb3f5ebf7e,0xbea23f53bf803f46,0xbf2d3e563ea2bf41,0xbe873f38bf793f75
.quad 0xbf733f3cbecbbc66,0xbe563f17bf5e3f7f,0xbf7c3f7ebf683f3c,0xbe1d3ee5bf323f62,0xbf463f62bf753f7f,0xbdc93e95bef13f22,0xbebd3ee5bf053f17,0xbd2c3e01be563e95
.quad 0x3e01be1d3e3abe56,0x3c66bd2c3d8fbdc9,0x3f17bf323f4abf5e,0x3d8fbe563eb0bef1,0x3f68bf7c3f7fbf73,0x3e01bebd3f17bf46,0x3f7fbf683f32becb,0x3e3abf053f4abf75
.quad 0x0,0x0,0x0,0x0,0x0,0x0,0x0,0x0
.quad 0x0,0x0,0x0,0x0,0x0,0x0,0x0,0x0
.quad 0x0,0x0,0x0,0x0,0x0,0x0,0x0,0x0
.quad 0x0,0x0,0x0,0x0,0x0,0x0,0x0,0x0
.quad 0x0,0x0,0x0,0x0,0x0,0x0,0x0,0x0
.quad 0x0,0x0,0x0,0x0,0x0,0x0,0x0,0x0
.quad 0x0,0x0,0x0,0x0,0x0,0x0,0x0,0x0
.quad 0x0,0x0,0x0,0x0,0x0,0x0,0x0,0x0
.quad 0xbf38befe3f773c66,0x3e56bf803e953f5b,0xbf4f3f573e56bf7d,0xbf2dbee53f7fbe87,0x3ee53f17bf7d3ea2,0xbf7e3f113ef1bf80,0x3f75bf46bdc93f62,0xbef13f7fbf22be95
.quad 0xbe01bf2d3f80bf1d,0x3ee53ecbbf753f57,0xbf803f32bc66bf2d,0x3f7dbf1dbdc93f41,0xbe563f41bf7f3f57,0x3f32bf7d3f62bed8,0x3f6ebf1d3e013ecb,0xbe3abeb03f46bf7d
.quad 0x3f05bf533f7cbf79,0xbf683f28be95be01,0xbf413f05be72bd8f,0xbf5e3f7abf7f3f6b,0xbf463f62bf753f7f,0xbdc93e95bef13f22,0x3efebed83eb0be87,0x3f41bf323f22bf11
.quad 0x3f70bf6e3f6bbf68,0x3f79bf773f75bf73,0xbe3a3ea2bee53f11,0x3ebdbe723dc93d2c,0xbf803f77bf5e3f38,0xbf0b3f3cbf623f79,0xbe1dbe563f0bbf4f,0xbf803f73bf463efe
.quad 0x3f70bf11bf283f65,0x3f4a3ecbbf7d3dc9,0x3f28bf703c663f6e,0x3f533e72bf7e3ef1,0x3e56bf773f2d3eb0,0x3f5b3d8fbf6b3f46,0xbe95bf223f7fbef1,0x3f62bdc9bf463f75
.quad 0xbf38bd8f3f4fbf79,0x3f68be87bf113f7f,0xbf773f053e56bf53,0x3f6ebed8bea23f62,0xbf793f6bbefebe01,0x3f73bf11bd2c3f22,0xbf3c3f7abf733f28,0x3f77bf323e723e95
.quad 0xbea23f2dbf6b3f80,0x3f7abf4f3efebdc9,0x3e3a3e01bed83f2d,0x3f7dbf653f38bef1,0x3f22bef13e95bdc9,0x3f7fbf753f62bf46,0x3f6ebf653f5bbf4f,0x3f80bf7e3f7abf75
.quad 0x3f7ebf7d3f7cbf7a,0x3f80bf803f7fbf7f,0x3f4fbf383f1dbefe,0x3f7fbf7a3f70bf62,0x3ed8be3abd8f3ea2,0x3f7ebf6e3f4fbf22,0xbd8f3ed8bf383f6b,0x3f7cbf5b3f1dbe95
.quad 0x0,0x0,0x0,0x0,0x0,0x0,0x0,0x0
.quad 0x0,0x0,0x0,0x0,0x0,0x0,0x0,0x0
.quad 0x0,0x0,0x0,0x0,0x0,0x0,0x0,0x0
.quad 0x0,0x0,0x0,0x0,0x0,0x0,0x0,0x0
.quad 0x0,0x0,0x0,0x0,0x0,0x0,0x0,0x0
.quad 0x0,0x0,0x0,0x0,0x0,0x0,0x0,0x0
.quad 0x0,0x0,0x0,0x0,0x0,0x0,0x0,0x0
.quad 0x0,0x0,0x0,0x0,0x0,0x0,0x0,0x0
.quad 0x3f4dbf51be9b3f80,0x3f553e8ebf803ea9,0x3f74bf2bbed13f80,0x3e483f51bf5cbde5,0x3f80bef8bf023f80,0xbf0e3f80beebbf08,0x3f6fbe8ebf1a3f80,0xbf7b3f3f3dacbf59
.quad 0x3f44bd66bf303f80,0xbf553e2c3f1abf7e,0x3f023e2cbf443f80,0xbe48bef83f6fbf72,0x3e483ec4bf553f80,0x3f0ebf6d3f7bbf35,0xbe0f3f14bf633f80,0x3f7bbf763f3abea9
.quad 0xbeeb3f3fbf6f3f80,0x3f55bf143e803de5,0xbf3a3f60bf783f80,0x3e483d66be9b3f08,0xbf6a3f76bf7d3f80,0xbf0e3f2bbf443f59,0xbf7f3f80bf803f80,0xbf7b3f7cbf7d3f7e
.quad 0xbf783f7cbf7f3f80,0xbf553f60bf6a3f72,0xbf553f6dbf7b3f80,0xbe483ec4bf0e3f35,0xbf1a3f51bf743f80,0x3f0ebe8ebce63ea9,0xbe9b3f2bbf6a3f80,0x3f7bbf513f02bde5
.quad 0xbe803f80beb7bf48,0xbf7f3ec43f44bf59,0xbf7f3ef83f1abf7a,0x3ce6bf6d3f3a3ea9,0xbed1bf143f7fbede,0x3f7dbec4bf1a3f7e,0x3f3abf7c3eeb3ede,0xbe803f6dbf5c3de5
.quad 0x3f63be8ebf023f7a,0xbf6f3ec43ed1bf72,0xbe0f3f3fbf803f48,0x3eebbf6d3f74bf08,0xbf7b3f6dbf0e0000,0x3f55bec4be483f35,0xbf023d663ed1bf48,0xbf253f6dbf7f3f59
.quad 0x3f25bf603f7dbf7a,0xbf303ec4bce6bea9,0x3f6fbf513f25bede,0x3f4dbf6d3f7dbf7e,0xbce63e2cbe9b3ede,0x3f02bec43e80bde5,0xbf743f76bf783f7a,0xbf6a3f6dbf6f3f72
.quad 0xbf1a3f2bbf3a3f48,0xbe9b3ec4beeb3f08,0x3f0ebec43e480000,0x3f7bbf6d3f55bf35,0x3f78bf803f6fbf48,0x3dacbec43f25bf59,0x3dacbef83f4dbf7a,0xbf803f6dbf303ea9
.quad 0xbed1bf3f3f5c3e64,0x3f3abf60be483f7e,0x3f7dbe8ebf443f67,0xbe803f7cbf0ebf08,0xbf253f7cbeb7bf20,0xbe9bbf2b3f7bbea9,0xbe9bbf143f80bf20,0x3f443d66bf553f72
.quad 0x3f78bef8be9b3f67,0xbf7d3f143e48bf59,0xbf3a3f80bf4d3e64,0x3f6abf763f0e3de5,0xbe48bec43f55bf80,0xbf0e3f6dbf7b3f35,0x3f6fbf2b3e803e64,0x3ce6bef83f55bf7e
.quad 0xbf4d3f76bf7f3f67,0x3f02be2cbe483f08,0xbdacbe2c3ed1bf20,0xbf633f3fbf0e3ea9,0x3f63bf513f3abf20,0x3f7fbf803f7bbf72,0xbf5c3f60bf633f67,0xbf4d3f51bf553f59
.quad 0x3ce63d66be0f3e64,0x3eb7be8e3e48bde5,0x3f55bf6d3f7bbf80,0x3e48bec43f0ebf35,0xbf6a3f3fbf023e64,0xbf303f60bf7b3f7e,0x3e0f3e8ebf253f67,0x3f78bf7c3f55bf08
.quad 0x3f633e2cbf7d3ede,0xbe0f3f7cbeebbf35,0xbf6f3d663f63bf48,0x3eebbf803eb73f35,0x3f78be8ebf303f7a,0xbf3a3f76be80bf35,0xbf7d3ef83ed1bf7a,0x3f6abf603e0f3f35
.quad 0x3f80bf2bbdac3f48,0xbf7f3f3fbce6bf35,0xbf7f3f51be80bede,0x3f78bf14bdac3f35,0x3f7bbf6d3f0e0000,0xbf553ec43e48bf35,0xbf743f7cbf4d3ede,0x3f1abe2cbe9b3f35
.quad 0x3f6abf803f74bf48,0xbe9bbd663ed1bf35,0xbf5c3f76bf803f7a,0xbce63e8ebf023f35,0x3f4dbf603f6fbf7a,0x3eb7bef83f1abf35,0xbf3a3f3fbf443f48,0xbf253f2bbf303f35
.quad 0x3f25bf143f02bede,0x3f5cbf513f44bf35,0xbf0e3ec4be480000,0xbf7b3f6dbf553f35,0x3eebbe2cbe0f3ede,0x3f7dbf7c3f63bf35,0xbeb7bd663eebbf48,0xbf633f80bf6f3f35
.quad 0xbf1abf143f740000,0x3f0ebf763ce63f72,0xbe9bbf3f3f6a0000,0x3f7bbf14bf023f7e,0x3ce6bf603f5c0000,0x3f553d66bf633f59,0x3eb7bf763f4d0000,0x3e483f2bbf7f3f08
.quad 0x3f25bf803f3a0000,0xbf0e3f7cbf4d3de5,0x3f5cbf7c3f250000,0xbf7b3f60beb7bea9,0x3f7bbf6d3f0e0000,0xbf553ec43e48bf35,0x3f7dbf513eeb0000,0xbe48be8e3f30bf72
.quad 0x3f63bf2b3eb70000,0x3f0ebf513f78bf7e,0x3f30bef83e800000,0x3f7bbf803f74bf59,0x3ed1be8e3e0f0000,0x3f55bf3f3f25bf08,0x3dacbd663ce60000,0x3e48be2c3e0fbde5
.quad 0xbe803e2cbdac0000,0xbf0e3ef8bed13ea9,0xbf0e3ec4be480000,0xbf7b3f6dbf553f35,0xbf4d3f14be9b0000,0xbf553f76bf803f72,0xbf743f3fbed10000,0xbe483f14bf5c3f7e
.quad 0x3f78bd66bf6f3f20,0x3dac3f6dbf25bf08,0x3dac3f60bf4dbe64,0xbf803ec43f30bf72,0xbf6a3f513dacbf67,0x3e0fbf6d3f4d3de5,0xbf30be2c3f63bf67,0x3f78bec4bf023f7e
.quad 0x3eebbf763f5cbe64,0xbeb73f6dbf6a3ea9,0x3f7dbf2b3ce63f20,0xbf633ec43e9bbf59,0x3e483ec4bf553f80,0x3f0ebf6d3f7bbf35,0xbf5c3f80bf6a3f20,0x3f44bec4bdac3f08
.quad 0xbf443ef8be0fbe64,0xbf3a3f6dbf803f72,0x3eb7bf143f44bf67,0xbf1a3ec4be0fbde5,0x3f80bf7c3f74bf67,0x3f5cbf6d3f78bf7e,0x3e9bbe8e3e80be64,0x3ed1bec43eb7bea9
.quad 0xbf4d3f3fbf303f20,0xbf743f6dbf633f59,0xbf553f6dbf7b3f80,0xbe483ec4bf0e3f35,0x3e803d66beb73f20,0x3f7fbf6d3f44bf08,0x3f7fbf603f1abe64,0xbce6bec43f3abf72
.quad 0xbf6a3f2b3f02bf7a,0xbf30bef83f7bbde5,0x3e0fbf763f253ede,0x3f78be2cbf553f59,0x3f443e2cbf6f3f48,0xbf743f3f3e48bf72,0xbf743f51bce6bf48,0x3f25bf803f0e3ea9
.quad 0x3e80bf603f74bede,0xbe0f3f51bf7b3f08,0x3f30bd66bf1a3f7a,0xbed1be8e3f55bf7e,0xbf7b3f6dbf0e0000,0x3f55bec4be483f35,0x3eb7bf3f3f78bf7a,0xbf803f60bf0e3de5
.quad 0x3f1abe8ebdac3ede,0x3f5cbf7c3f7bbf59,0xbf7f3f7cbf6a3f48,0xbeeb3f2bbf553f72,0x3eebbf143f30bf48,0xbdacbd663e48bea9,0x3f02bef83eebbede,0x3f1abf143f0ebf08
.quad 0xbf803f80bf7d3f7a,0xbf6f3f76bf7b3f7e,0x3f0ebec43e480000,0x3f7bbf6d3f55bf35,0x3ed1bf2b3f5cbf7a,0xbf3a3ef8be48bde5,0xbf7d3f76bf443ede,0x3e803e2cbf0e3f59
.quad 0x3eebbf7c3e0f3f67,0x3f7dbe2cbf633f35,0xbeb73f80beebbf20,0xbf63bd663f6fbf35,0x3e80bf763f3a3e64,0x3f303e8ebf783f35,0xbe0f3f60bf6a3e64,0xbed1bef83f7dbf35
.quad 0x3ce6bf3f3f7fbf20,0x3dac3f2bbf803f35,0x3dac3f14bf783f67,0x3e80bf513f7fbf35,0xbe48bec43f55bf80,0xbf0e3f6dbf7b3f35,0x3e9b3e2cbf1a3f67,0x3f4dbf7c3f74bf35
.quad 0xbed13d663e9bbf20,0xbf743f80bf6a3f35,0x3f02be8e3ce63e64,0x3f80bf763f5cbf35,0xbf1a3ef8beb73e64,0xbf6f3f60bf4d3f35,0x3f30bf2b3f25bf20,0x3f44bf3f3f3abf35
.quad 0xbf443f51bf5c3f67,0xbf023f14bf253f35,0x3f55bf6d3f7bbf80,0x3e48bec43f0ebf35,0xbf633f7cbf7d3f67,0x3e0f3e2cbeeb3f35,0x3f6fbf803f63bf20,0xbeeb3d663eb7bf35
.quad 0x3f75bc66bf733f17,0x3d2c3f70bf1dbf11,0x3f463e87bf7d3f0b,0xbf383f6ebd2cbf65,0x3ef13f05bf803efe,0xbf7f3ee53f0bbf80,0x3dc93f3cbf7c3ee5,0xbf1dbe873f6ebf5b
.quad 0xbe953f65bf703ecb,0x3e3abf573f79befe,0xbf223f7cbf5e3eb0,0x3f5bbf7d3f28bc66,0xbf623f7fbf463e95,0x3f75bf223dc93ef1,0xbf7f3f6ebf283e72,0x3ed83d2cbefe3f57
.quad 0xbf753f4abf053e3a,0xbecb3f32bf683f7f,0xbf463f17bebd3e01,0xbf733f7fbf7c3f68,0xbef13eb0be563d8f,0xbf5e3f4abf323f17,0xbdc93d8fbd2c3c66,0xbe563e3abe1d3e01
.quad 0x3e95be563e01bd2c,0x3f17bf053ee5bebd,0x3f22bef13e95bdc9,0x3f7fbf753f62bf46,0x3f62bf323ee5be1d,0x3f3cbf683f7ebf7c,0x3f7fbf5e3f17be56,0xbc66becb3f3cbf73
.quad 0xbf6e3f223f0bbf77,0xbf28bf053f79bd8f,0xbf1dbef13f7fbeb0,0x3f5bbf53be3a3f79,0x3f17bf7f3ed83f11,0x3ebd3f1dbf7e3ecb,0x3f70be95bf173f80,0xbf7a3f413d8fbf57
.quad 0xbd8f3f46bf7e3f17,0xbd2cbf323f80bf2d,0xbf7a3f62bebdbea2,0x3f7ebf2d3d2c3f1d,0xbef1bdc93f22bf75,0xbe953f46bf7f3f62,0x3f38bf753f7cbf4a,0xbf653f17be1dbea2
.quad 0x3f5ebf223ea23d2c,0x3f17bf573f7abf7d,0xbe723ef1bf2d3f57,0x3f32befe3e87bc66,0xbf803f7fbf793f6e,0xbf533f65bf733f7c,0xbea23e95be873e72,0xbed83ecbbebd3eb0
.quad 0x3f53bf463f38bf28,0x3f77bf703f68bf5e,0x3f46bf623f75bf7f,0x3dc9be953ef1bf22,0xbecb3dc93e56befe,0xbf7f3f79bf5b3f28,0xbf7e3f75bf413ed8,0x3e723e3abf113f5b
.quad 0x3efebf7a3dc93f6b,0x3f7cbe01bf683f2d,0x3ed83f28bf753e01,0xbf733f2d3ecbbf80,0xbf7c3eb03f22bf7d,0x3f2dbf7a3ea23f28,0x3f38bf7d3ef13ed8,0xbe723f6bbf5e3e01
.quad 0x3e1d3f1dbf7f3f41,0xbe87bf053f7abf53,0xbf653ecb3e95bf57,0x3f32bd8fbf173f79,0x3f62bf7f3f46be95,0xbf753f22bdc9bef1,0xbe013f11bf623f80,0x3f7abf773f3cbeb0
.quad 0xbf3c3ee5bdc9be87,0xbf413f70bf803f6e,0x3f7abf803f75bf5b,0x3eb0bf113f41bf65,0xbecb3f05bf223f3c,0x3e1dbc66be013e87,0xbf053efebef13ee5,0xbf1d3f17bf113f0b
.quad 0x3f7fbf803f7fbf7c,0x3f6bbf733f79bf7d,0xbf223ef1be953dc9,0xbf7f3f75bf623f46,0xbe873f0bbf463f6e,0x3f53bf1d3eb0bd2c,0x3f70bf7f3f62bf1d,0xbee53d2c3ebdbf38
.quad 0x3e1d3f65bf32bef1,0xbf623f383ee5bf7d,0xbe56bf4f3f5e3dc9,0x3f7fbefebf173f7a,0x3e873f32bf793e95,0xbf753e723f38bf77,0xbea2bf113f80bf22,0x3f463d2cbf533f73
.quad 0x3ebd3ed8bf733f62,0xbef1bea23f68bf6e,0xbed8be873f53bf7f,0x3dc93f11bf773f68,0x3ef13dc9bf223f75,0x3e95bf463f7fbf62,0xbf053d8f3ecbbf46,0xbf223f6bbf7f3f5b
.quad 0x3f11be72be013ef1,0x3f62bf7e3f79bf53,0xbf1d3ecbbe1dbdc9,0xbf7f3f7dbf6b3f4a,0x3f28bf0b3ed8be95,0x3f75bf683f57bf41,0xbf323f2dbf283f22,0xbf463f41bf3c3f38
.quad 0x3f3cbf4a3f57bf62,0x3ef1bf0b3f1dbf2d,0xbf463f62bf753f7f,0xbdc93e95bef13f22,0x3f4fbf733f80bf75,0xbe95bc663ea2bf17,0xbf573f7dbf773f46,0x3f22be87be1d3f0b
.quad 0x3e95bf803ea23f4f,0x3f80beb0bf4a3f53,0x3f22bf773e1d3f57,0x3f323ebdbf803ee5,0x3f62bf5bbc663f5e,0xbd8f3f65bf57bd2c,0x3f7fbf2dbe3a3f65,0xbf4a3f77bebdbf05
.quad 0x3f75bee5beb03f6b,0xbf7c3f0b3e72bf5e,0x3f46be3abefe3f70,0xbf05be1d3f41bf80,0x3ef13dc9bf223f75,0x3e95bf463f7fbf62,0x3dc93ebdbf413f79,0x3f68bf803f5ebf0b
.quad 0xbe953f1dbf5b3f7c,0x3f6bbf383ed8bd8f,0xbf223f4fbf6e3f7e,0x3ea2bd8fbe3a3ed8,0xbf623f70bf7a3f7f,0xbefe3f1dbf383f4f,0xbf7f3f7fbf803f80,0xbf7a3f7cbf7d3f7e
.quad 0xbf753f7abf7e3f80,0xbf4f3f5bbf653f6e,0xbf463f62bf753f7f,0xbdc93e95bef13f22,0xbef13f38bf653f7d,0x3f2dbed83e013e3a,0xbdc93efebf4f3f7a,0x3f80bf6b3f2dbea2
.quad 0x3ebd3f46bf57be87,0xbf413f5b3e72bf7f,0xbf4a3f623d8fbf70,0xbf05bf113f7cbe72,0xbf4fbdc93f68bf53,0x3f6ebf4abe013f6b,0x3eb0bf753f4fbc66,0x3e563f28bf7f3f0b
.quad 0x3f7fbf22be013f4f,0xbf803f383c66bf3c,0x3e563ef1bf6e3f73,0x3e01bf3c3f80bf4a,0xbf623f7fbf463e95,0x3f75bf223dc93ef1,0xbf323e953e3abf1d,0xbee53f4fbf7d3f73
.quad 0x3efebf463f73bf80,0xbf4f3f0bbe56be1d,0x3f79bf623f3cbf0b,0x3f38bf5e3f77bf80,0x3d2c3dc9be723ebd,0x3f11bee53ea2be3a,0xbf733f75bf773f79,0xbf683f6bbf6e3f70
.quad 0xbf113f22bf323f41,0xbe873eb0bed83efe,0x3f22bef13e95bdc9,0x3f7fbf753f62bf46,0x3f6bbf7f3f7abf5e,0xbd8fbe723f05bf41,0xbe01be953f28bf68,0xbf793f7cbf533f05
.quad 0xbf5ebe563f7fbecb,0x3e3abf7e3ed83f3c,0x3f68bf41be953f7e,0x3ea23f3cbf6b3c66,0xbe3a3f70bf46be1d,0xbf3cbe563f73bf41,0xbf32be1d3f62bf68,0x3f79becbbefe3f7e
.quad 0x3f7dbf4a3dc93f28,0xbf773f5bbe56bf11,0xbee53f6bbf753f0b,0x3f38bf7f3f4fbe72,0xbef1bdc93f22bf75,0xbe953f46bf7f3f62,0x3f7ebf533ef1bc66,0xbe56be873f2dbf70
.quad 0xbf2d3f65bf7f3f77,0x3f28beb0bc663ebd,0xbe56bd2c3e95bf05,0xbf703f53bf283ee5,0x3f6bbf5b3f46bf2d,0x3f7dbf803f7ebf77,0xbf5b3f5ebf623f65,0xbf4a3f4fbf533f57
.quad 0x3d8f3c66bdc93e3a,0x3ecbbea23e72be1d,0x3f46bf623f75bf7f,0x3dc9be953ef1bf22,0xbf773f57bf223ebd,0xbf113f4abf703f80,0x3eb03d8fbef13f4a,0x3f65bf803f6ebf32
.quad 0x3f7dbee5bf383f62,0x3ef13f32bf65be1d,0xbf7a3f173efebf7f,0xbdc9bf5e3f4f3e56,0x3f77bf38be723f75,0xbe953f79bf32be87,0xbf733f53bd2cbf46,0x3f22bf803f113ea2
.quad 0x3f6ebf683ea23ef1,0xbf623f73bed8bebd,0xbf683f77bf11bdc9,0x3f7fbf533e873ed8,0x3f62bf7f3f46be95,0xbf753f22bdc9bef1,0xbf5b3f7fbf6b3f22,0x3f46becbbd8f3f05
.quad 0x3f53bf793f7ebf62,0xbef13e013e72bf11,0xbf4a3f6bbf7d3f7f,0x3dc93e1dbecb3f1d,0x3f41bf573f68bf75,0x3e95bed83f0bbf28,0xbf383f3cbf413f46,0xbf223f28bf2d3f32
.quad 0x3f2dbf1d3f0bbef1,0x3f62bf573f4abf3c,0xbf223ef1be953dc9,0xbf7f3f75bf623f46,0x3f17bea23c663e95,0x3f75bf803f73bf4f,0xbf0b3e1d3e87bf22,0xbf463f77bf7d3f57
.quad 0xbf7b3ef83f30bf67,0xbf02bf2b3f6a3de5,0x3f553e2cbf783f20,0xbf253f76be0fbf59,0xbe48bf3f3f74be64,0x3f6fbe2cbf443f72,0xbf0e3f80bf25be64,0x3ce6bf513f74bea9
.quad 0x3f7bbf513e0f3f20,0xbf743f60be80bf08,0xbf553e8e3ed1bf67,0x3f1a3d66bf303f7e,0x3e483ec4bf553f80,0x3f0ebf6d3f7bbf35,0x3f0ebf603f80bf67,0xbf783f3fbeb7bde5
.quad 0xbf7b3f7cbf5c3f20,0x3dac3e8ebf1a3f59,0x3f55bf2b3eebbe64,0x3f6abf7c3f7fbf72,0xbe483d663dacbe64,0xbf303f14beeb3ea9,0xbf0e3f14bf1a3f20,0xbeeb3ef8bf023f08
.quad 0x3f7bbf763f6fbf67,0x3f7dbf803f80bf7e,0xbf553f6dbf7b3f80,0xbe483ec4bf0e3f35,0x3e48bef83f3abf67,0xbf5c3f2bbed13de5,0x3f0ebe2cbe803f20,0x3f44bf763f7dbf59
.quad 0x3f25bf6dbdac3f7a,0x3f6f3d66bf783f08,0xbf30bec43f80bede,0x3f4dbf60bdac3f72,0xbf4d3f6dbe0fbf48,0xbdacbf513f6abde5,0x3f023ec4bf783f48,0xbf633e2c3f30bf7e
.quad 0x3f6abf6d3eb73ede,0xbf5c3f76beebbea9,0xbe9bbec43f63bf7a,0xbce63f2bbf7d3f59,0xbf7b3f6dbf0e0000,0x3f55bec4be483f35,0x3dac3ec4bf443f7a,0x3f6abf803f5cbf08
.quad 0x3f80bf6d3f3abede,0x3e0fbef83f44bf72,0x3e0fbec43f1abf48,0xbf443f14beb73de5,0xbf783f6dbf5c3f48,0xbf743f7cbf803f7e,0xbeb73ec4bed13ede,0xbe803e8ebe9b3ea9
.quad 0x3f63bf6d3f74bf7a,0x3f30bf3f3f4dbf59,0x3f0ebec43e480000,0x3f7bbf6d3f55bf35,0xbf443f6dbf7f3f7a,0x3eb7bd66be803f08,0xbf3a3ec43ce6bede,0xbf1a3f60bf7f3f72
.quad 0xbce63f76bf0ebf20,0xbf743f143f1abf72,0x3f023f14bf7b3e64,0xbf6a3f3f3e9bbf7e,0x3f63bd66bf553f67,0xbf5c3f60bce6bf59,0x3f7fbf2bbe483f67,0xbf4d3f76beb7bf08
.quad 0x3f4dbf7c3f0e3e64,0xbf3a3f80bf25bde5,0x3eb7bf603f7bbf20,0xbf253f7cbf5c3ea9,0xbe48bec43f55bf80,0xbf0e3f6dbf7b3f35,0xbf303e8e3e48bf20,0xbeeb3f51bf7d3f72
.quad 0xbf783f51bf0e3e64,0xbeb73f2bbf633f7e,0xbf743f80bf7b3f67,0xbe803ef8bf303f59,0xbf253f3fbf553f67,0xbe0f3e8ebed13f08,0xbe0f3e2cbe483e64,0xbce63d66bdac3de5
.quad 0x3ed1bef83f0ebf20,0x3dacbe2c3e80bea9,0x3f55bf6d3f7bbf80,0x3e48bec43f0ebf35,0x3f80bf763f55bf20,0x3e9bbf143f4dbf72,0x3f5cbf143e483e64,0x3ed1bf3f3f74bf7e
.quad 0xbf1abf143f740000,0x3f0ebf763ce63f72,0xbe9bbf3f3f6a0000,0x3f7bbf14bf023f7e,0x3ce6bf603f5c0000,0x3f553d66bf633f59,0x3eb7bf763f4d0000,0x3e483f2bbf7f3f08
.quad 0x3f25bf803f3a0000,0xbf0e3f7cbf4d3de5,0x3f5cbf7c3f250000,0xbf7b3f60beb7bea9,0x3f7bbf6d3f0e0000,0xbf553ec43e48bf35,0x3f7dbf513eeb0000,0xbe48be8e3f30bf72
.quad 0x3f63bf2b3eb70000,0x3f0ebf513f78bf7e,0x3f30bef83e800000,0x3f7bbf803f74bf59,0x3ed1be8e3e0f0000,0x3f55bf3f3f25bf08,0x3dacbd663ce60000,0x3e48be2c3e0fbde5
.quad 0xbe803e2cbdac0000,0xbf0e3ef8bed13ea9,0xbf0e3ec4be480000,0xbf7b3f6dbf553f35,0xbf4d3f14be9b0000,0xbf553f76bf803f72,0xbf743f3fbed10000,0xbe483f14bf5c3f7e
.quad 0x3e483f60bf3abede,0xbf5c3f3f3ed1bf7e,0x3f0ebf7c3e803f48,0x3f443e8ebf7d3f08,0xbf7b3f2b3e9bbf7a,0x3eb7bf7c3f253ea9,0x3f55bd66bf443f7a,0xbf803f143e9bbf72
.quad 0xbe48bf143f7dbf48,0x3e9b3ef8bf783f59,0xbf0e3f76bf6a3ede,0x3f4dbf803f3abde5,0x3f7bbf6d3f0e0000,0xbf553ec43e48bf35,0xbf553ef8bce6bede,0xbe803f2bbf6f3f7e
.quad 0x3e483e2cbf023f48,0x3f7fbf763f4dbf08,0x3f0ebf3f3f63bf7a,0xbed13e2c3dacbea9,0xbf7b3f80bf7f3f7a,0xbf3a3f51bf633f72,0x3f55bf513f4dbf48,0x3f63bf603f5cbf59
.quad 0xbe483e8ebeb73ede,0x3e0fbd66bce63de5,0xbf0e3ec4be480000,0xbf7b3f6dbf553f35,0x3f7bbf603f30bede,0x3f02bf3f3f6abf7e,0xbf553f7cbf783f48,0x3f25be8ebe0f3f08
.quad 0xbf44bec43f7fbe64,0x3eb7bf803e803f59,0xbf3a3f6dbce6bf67,0xbf1abef83f7fbea9,0x3f1a3ec4bf7d3f20,0xbf7f3f143ed1bf7e,0x3f5cbf6d3e803f20,0xbeeb3f7cbf3abde5
.quad 0xbed1bec43f6fbf67,0x3f023e8ebf633f72,0xbf743f6dbeebbe64,0x3f80bf3f3e0f3f08,0x3e483ec4bf553f80,0x3f0ebf6d3f7bbf35,0x3f7fbf6d3f25be64,0xbed1bd663f02bf59
.quad 0x3ce6bec43f30bf67,0xbf7d3f60bf253ea9,0xbf7d3f6dbf4d3f20,0xbf253f51bf6f3f7e,0xbe803ec4bf023f20,0x3e9bbe2c3ce63de5,0x3f6fbf6d3f6abf67,0x3f78bf763f74bf72
.quad 0x3eebbec43e9bbe64,0x3f3abf2b3f1abf08,0xbf553f6dbf7b3f80,0xbe483ec4bf0e3f35,0xbf253ec4bdacbe64,0xbf6f3f80bf783f59,0x3f30bf6d3f80bf67,0xbf4d3ef8bdacbea9
.quad 0x3f80be8ebf553f48,0x3e9b3f51bf4dbea9,0x3f5cbf51be483f7a,0x3ed13f2bbf743de5,0x3eebbf803f0e3ede,0x3f023ef8bf803f08,0xbdacbf3f3f7bbede,0x3f1a3e8ebf6f3f59
.quad 0xbf1abe2c3f55bf7a,0x3f303d66bf443f7e,0xbf6f3ef83e48bf48,0x3f44be2cbf023f72,0xbf7b3f6dbf0e0000,0x3f55bec4be483f35,0xbf3a3f76bf7b3f48,0x3f63bf143e0f3ea9
.quad 0xbe803f14bf553f7a,0x3f6fbf3f3eebbde5,0x3e9bbd66be483ede,0x3f78bf603f3abf08,0x3f44bf2b3f0ebede,0x3f7dbf763f6abf59,0x3f7dbf7c3f7bbf7a,0x3f80bf803f7fbf7e
.quad 0x3f6abf603f55bf48,0x3f7fbf7c3f78bf72,0x3f0ebec43e480000,0x3f7bbf6d3f55bf35,0x3ce63e8ebf0e3f48,0x3f74bf513f1abea9,0xbf023f51bf7b3f7a,0x3f6abf2b3e9b3de5
.quad 0xbf4d3f513e9bbf80,0xbf55be8e3f80bea9,0xbf743f2b3ed1bf80,0xbe48bf513f5c3de5,0xbf803ef83f02bf80,0x3f0ebf803eeb3f08,0xbf6f3e8e3f1abf80,0x3f7bbf3fbdac3f59
.quad 0xbf443d663f30bf80,0x3f55be2cbf1a3f7e,0xbf02be2c3f44bf80,0x3e483ef8bf6f3f72,0xbe48bec43f55bf80,0xbf0e3f6dbf7b3f35,0x3e0fbf143f63bf80,0xbf7b3f76bf3a3ea9
.quad 0x3eebbf3f3f6fbf80,0xbf553f14be80bde5,0x3f3abf603f78bf80,0xbe48bd663e9bbf08,0x3f6abf763f7dbf80,0x3f0ebf2b3f44bf59,0x3f7fbf803f80bf80,0x3f7bbf7c3f7dbf7e
.quad 0x3f78bf7c3f7fbf80,0x3f55bf603f6abf72,0x3f55bf6d3f7bbf80,0x3e48bec43f0ebf35,0x3f1abf513f74bf80,0xbf0e3e8e3ce6bea9,0x3e9bbf2b3f6abf80,0xbf7b3f51bf023de5
.quad 0xbf3cbed83f7ebe3a,0x3ecbbf7f3e563f5e,0xbc663f6bbf3cbea2,0xbf7e3e953f41bf68,0x3f41bf733e563f3c,0x3e1d3f46bf703e3a,0xbf7e3efe3ecbbf79,0x3f68bf623e1d3f32
.quad 0x3f113e56bf5b3f77,0xbf28bdc93f4abf7d,0x3e72bf4f3f7fbf38,0xbf0b3f75bf6b3ee5,0xbf623f7fbf463e95,0x3f75bf223dc93ef1,0x3f70bf2d3e873e56,0x3c66bef13f53bf7e
.quad 0xbebd3c663eb0bf28,0xbf773f7fbf653f2d,0xbee53f28bf533f70,0x3f05be953d2c3e56,0x3f77bf7e3f80bf7d,0x3f2dbf463f5bbf6b,0xbf573f53bf4f3f4a,0xbf653f62bf5e3f5b
.quad 0x3e1dbe723ea2becb,0xbe3a3dc9bc66bd8f,0x3f22bef13e95bdc9,0x3f7fbf753f62bf46,0xbf803f70bf4a3f11,0xbebd3f22bf573f77,0x3f32bf6e3f80bf65,0xbf4a3ef1bd8fbeb0
.quad 0x3f7fbe72bf5b3f41,0x3e873f57bf46bebd,0x3e72bf7c3f113f05,0x3f70bd8fbf623f4a,0xbf6b3e013f4abf6e,0x3f53bf683dc93f4f,0xbf0b3f7fbf28be56,0x3c66bf4f3f75beb0
.quad 0x3f3cbc66bf383f80,0xbf4f3e013f22bf7f,0x3f4abf803f3cbe01,0xbf733f6ebef1be56,0xbef1bdc93f22bf75,0xbe953f46bf7f3f62,0xbf733f7dbf4f3ee5,0x3f1dbe3abe953f32
.quad 0x3e1d3e56bf0b3f4f,0x3f80bf733f46befe,0x3f80bf773f5ebf38,0x3f0bbf3c3f62bf79,0x3e3abea23ee5bf11,0xbebd3e72bdc9bd2c,0xbf703f6ebf6b3f68,0xbf793f77bf753f73
.quad 0xbefe3ed8beb03e87,0xbf413f32bf223f11,0x3f46bf623f75bf7f,0x3dc9be953ef1bf22,0x3f41bf053e723d8f,0x3f5ebf7a3f7fbf6b,0xbf053f53bf7c3f79,0x3f68bf283e953e01
.quad 0xbf533f4a3eb0bf80,0xbf4fbea23f80be95,0xbee53f80bebdbf32,0xbf57be1d3f77bf22,0x3d2c3f57bf653d8f,0xbf5e3c663f5bbf62,0x3f053ebdbf773f4a,0xbf653e3a3f2dbf7f
.quad 0x3f5ebe72bf0b3f7c,0xbf6b3eb03ee5bf75,0x3f80bf413e1d3f05,0xbf703efe3e3abf46,0x3f62bf7f3f46be95,0xbf753f22bdc9bef1,0x3f0bbf5e3f80bf68,0xbf793f41bebdbdc9
.quad 0x3d8fbed83f38bf6b,0xbf7c3f5bbf1d3e95,0xbed83e3a3d8fbea2,0xbf7e3f6ebf4f3f22,0xbf4f3f38bf1d3efe,0xbf7f3f7abf703f62,0xbf7e3f7dbf7c3f7a,0xbf803f80bf7f3f7f
.quad 0xbf6e3f65bf5b3f4f,0xbf803f7ebf7a3f75,0xbf223ef1be953dc9,0xbf7f3f75bf623f46,0xbe3abe013ed8bf2d,0xbf7d3f65bf383ef1,0x3ea2bf2d3f6bbf80,0xbf7a3f4fbefe3dc9
.quad 0x3e95bf803ea23f4f,0x3f80beb0bf4a3f53,0x3f22bf773e1d3f57,0x3f323ebdbf803ee5,0x3f62bf5bbc663f5e,0xbd8f3f65bf57bd2c,0x3f7fbf2dbe3a3f65,0xbf4a3f77bebdbf05
.quad 0x3f75bee5beb03f6b,0xbf7c3f0b3e72bf5e,0x3f46be3abefe3f70,0xbf05be1d3f41bf80,0x3ef13dc9bf223f75,0x3e95bf463f7fbf62,0x3dc93ebdbf413f79,0x3f68bf803f5ebf0b
.quad 0xbe953f1dbf5b3f7c,0x3f6bbf383ed8bd8f,0xbf223f4fbf6e3f7e,0x3ea2bd8fbe3a3ed8,0xbf623f70bf7a3f7f,0xbefe3f1dbf383f4f,0xbf7f3f7fbf803f80,0xbf7a3f7cbf7d3f7e
.quad 0xbf753f7abf7e3f80,0xbf4f3f5bbf653f6e,0xbf463f62bf753f7f,0xbdc93e95bef13f22,0xbef13f38bf653f7d,0x3f2dbed83e013e3a,0xbdc93efebf4f3f7a,0x3f80bf6b3f2dbea2
.quad 0xbf2d3f683e01bf7c,0xbf6bbdc93f7abefe,0x3f80becbbf2d3f73,0xbe013f75bf28bed8,0xbf28bea23f7abf2d,0x3f7dbf22beb03f7c,0xbe013f5ebf6b3e72,0xbed8bef13f7dbf38
.quad 0x3f53bf7a3f053e87,0xbf413f7fbf1dbe1d,0xbf793f173d8fbf32,0x3f57be95becb3f65,0x3ef13dc9bf223f75,0x3e95bf463f7fbf62,0x3eb0bf3c3f77bf7a,0xbf803f62bf113e01
.quad 0xbf6e3f80bf703f41,0x3e873dc9bee53f3c,0x3f65bf413f11beb0,0x3f5bbf753f80bf7a,0xbe873e013c66be1d,0xbf3c3f22bf053ecb,0xbf0b3f11bf173f1d,0xbee53ef1befe3f05
.quad 0x3f7dbf793f73bf6b,0x3f7cbf7f3f80bf7f,0xbf463f62bf753f7f,0xbdc93e95bef13f22,0x3d2cbeb03f1dbf53,0xbf6e3f46bf0b3e87,0x3f38bebdbd2c3ee5,0x3f1dbf623f7fbf70
.quad 0x3d8fbf793f053f28,0x3f77bf0bbf223f6e,0xbf793e3a3f53bf5b,0x3eb0bf7f3ef13f1d,0xbecb3f7ebf1dbebd,0xbf11bed83f7fbf17,0x3f57bd8fbf413f7a,0xbf803f173e95bf70
.quad 0x3f2dbf803f323d2c,0xbf173f7ebf463d8f,0xbf1dbd2c3f2dbf7e,0x3ea23ebdbf623f7a,0xbf623f7fbf463e95,0x3f75bf223dc93ef1,0x3ea23e1dbf173f65,0x3f4abf7c3f75bf38
.quad 0x3f7dbf7a3f57bf17,0xbd2cbea23f22bf5e,0x3c66be873efebf32,0xbf573f2dbef13e72,0xbf7c3f73bf653f53,0xbf6e3f79bf7f3f80,0xbeb03ebdbecb3ed8,0xbe723e87be953ea2
.quad 0x3f5ebf683f70bf77,0x3f28bf383f46bf53,0x3f22bef13e95bdc9,0x3f7fbf753f62bf46,0xbf283f5bbf793f7f,0x3efebe56bdc93ecb,0xbf5b3f11be3abe72,0xbed83f41bf753f7e
.quad 0x3f113f1dbf70bd2c,0xbf173f733c66bf75,0x3f653d2cbf6e3f38,0xbf0b3f7dbe87bf46,0x3f80bf0bbee53f7f,0xbefe3f80bf05bef1,0x3f5bbf6e3e873f1d,0xbee53f7cbf3cbdc9
.quad 0x3efebf793f57be3a,0xbecb3f70bf653e95,0x3c66bf283f7dbf5b,0xbeb03f5ebf7c3f22,0xbef1bdc93f22bf75,0xbe953f46bf7f3f62,0xbf573efebd2cbed8,0xbe723f28bf6e3f7f
.quad 0xbf7f3f68bf323ecb,0xbe3a3f05bf4a3f75,0xbf683f7cbf7f3f73,0xbe013ebdbf173f46,0xbf173f32bf4a3f5e,0xbd8f3e56beb03ef1,0xbe013e1dbe3a3e56,0xbc663d2cbd8f3dc9
.quad 0x3ebdbee53f05bf17,0x3d2cbe013e56be95,0x3f46bf623f75bf7f,0x3dc9be953ef1bf22,0x3f7cbf7e3f68bf3c,0x3e1dbee53f32bf62,0x3f73bf3c3ecb3c66,0x3e56bf173f5ebf7f
.quad 0xbf753c663f73bf17,0xbd2cbf703f1d3f11,0xbf46be873f7dbf0b,0x3f38bf6e3d2c3f65,0xbef1bf053f80befe,0x3f7fbee5bf0b3f80,0xbdc9bf3c3f7cbee5,0x3f1d3e87bf6e3f5b
.quad 0x3e95bf653f70becb,0xbe3a3f57bf793efe,0x3f22bf7c3f5ebeb0,0xbf5b3f7dbf283c66,0x3f62bf7f3f46be95,0xbf753f22bdc9bef1,0x3f7fbf6e3f28be72,0xbed8bd2c3efebf57
.quad 0x3f75bf4a3f05be3a,0x3ecbbf323f68bf7f,0x3f46bf173ebdbe01,0x3f73bf7f3f7cbf68,0x3ef1beb03e56bd8f,0x3f5ebf4a3f32bf17,0x3dc9bd8f3d2cbc66,0x3e56be3a3e1dbe01
.quad 0xbe953e56be013d2c,0xbf173f05bee53ebd,0xbf223ef1be953dc9,0xbf7f3f75bf623f46,0xbf623f32bee53e1d,0xbf3c3f68bf7e3f7c,0xbf7f3f5ebf173e56,0x3c663ecbbf3c3f73
.quad 0x3f78bd66bf6f3f20,0x3dac3f6dbf25bf08,0x3dac3f60bf4dbe64,0xbf803ec43f30bf72,0xbf6a3f513dacbf67,0x3e0fbf6d3f4d3de5,0xbf30be2c3f63bf67,0x3f78bec4bf023f7e
.quad 0x3eebbf763f5cbe64,0xbeb73f6dbf6a3ea9,0x3f7dbf2b3ce63f20,0xbf633ec43e9bbf59,0x3e483ec4bf553f80,0x3f0ebf6d3f7bbf35,0xbf5c3f80bf6a3f20,0x3f44bec4bdac3f08
.quad 0xbf443ef8be0fbe64,0xbf3a3f6dbf803f72,0x3eb7bf143f44bf67,0xbf1a3ec4be0fbde5,0x3f80bf7c3f74bf67,0x3f5cbf6d3f78bf7e,0x3e9bbe8e3e80be64,0x3ed1bec43eb7bea9
.quad 0xbf4d3f3fbf303f20,0xbf743f6dbf633f59,0xbf553f6dbf7b3f80,0xbe483ec4bf0e3f35,0x3e803d66beb73f20,0x3f7fbf6d3f44bf08,0x3f7fbf603f1abe64,0xbce6bec43f3abf72
.quad 0xbf6a3f2b3f02bf7a,0xbf30bef83f7bbde5,0x3e0fbf763f253ede,0x3f78be2cbf553f59,0x3f443e2cbf6f3f48,0xbf743f3f3e48bf72,0xbf743f51bce6bf48,0x3f25bf803f0e3ea9
.quad 0x3e80bf603f74bede,0xbe0f3f51bf7b3f08,0x3f30bd66bf1a3f7a,0xbed1be8e3f55bf7e,0xbf7b3f6dbf0e0000,0x3f55bec4be483f35,0x3eb7bf3f3f78bf7a,0xbf803f60bf0e3de5
.quad 0x3f1abe8ebdac3ede,0x3f5cbf7c3f7bbf59,0xbf7f3f7cbf6a3f48,0xbeeb3f2bbf553f72,0x3eebbf143f30bf48,0xbdacbd663e48bea9,0x3f02bef83eebbede,0x3f1abf143f0ebf08
.quad 0xbf803f80bf7d3f7a,0xbf6f3f76bf7b3f7e,0x3f0ebec43e480000,0x3f7bbf6d3f55bf35,0x3ed1bf2b3f5cbf7a,0xbf3a3ef8be48bde5,0xbf7d3f76bf443ede,0x3e803e2cbf0e3f59
.quad 0x3eebbf7c3e0f3f67,0x3f7dbe2cbf633f35,0xbeb73f80beebbf20,0xbf63bd663f6fbf35,0x3e80bf763f3a3e64,0x3f303e8ebf783f35,0xbe0f3f60bf6a3e64,0xbed1bef83f7dbf35
.quad 0x3ce6bf3f3f7fbf20,0x3dac3f2bbf803f35,0x3dac3f14bf783f67,0x3e80bf513f7fbf35,0xbe48bec43f55bf80,0xbf0e3f6dbf7b3f35,0x3e9b3e2cbf1a3f67,0x3f4dbf7c3f74bf35
.quad 0xbed13d663e9bbf20,0xbf743f80bf6a3f35,0x3f02be8e3ce63e64,0x3f80bf763f5cbf35,0xbf1a3ef8beb73e64,0xbf6f3f60bf4d3f35,0x3f30bf2b3f25bf20,0x3f44bf3f3f3abf35
.quad 0xbf443f51bf5c3f67,0xbf023f14bf253f35,0x3f55bf6d3f7bbf80,0x3e48bec43f0ebf35,0xbf633f7cbf7d3f67,0x3e0f3e2cbeeb3f35,0x3f6fbf803f63bf20,0xbeeb3d663eb7bf35
.quad 0x3e483f60bf3abede,0xbf5c3f3f3ed1bf7e,0x3f0ebf7c3e803f48,0x3f443e8ebf7d3f08,0xbf7b3f2b3e9bbf7a,0x3eb7bf7c3f253ea9,0x3f55bd66bf443f7a,0xbf803f143e9bbf72
.quad 0xbe48bf143f7dbf48,0x3e9b3ef8bf783f59,0xbf0e3f76bf6a3ede,0x3f4dbf803f3abde5,0x3f7bbf6d3f0e0000,0xbf553ec43e48bf35,0xbf553ef8bce6bede,0xbe803f2bbf6f3f7e
.quad 0x3e483e2cbf023f48,0x3f7fbf763f4dbf08,0x3f0ebf3f3f63bf7a,0xbed13e2c3dacbea9,0xbf7b3f80bf7f3f7a,0xbf3a3f51bf633f72,0x3f55bf513f4dbf48,0x3f63bf603f5cbf59
.quad 0xbe483e8ebeb73ede,0x3e0fbd66bce63de5,0xbf0e3ec4be480000,0xbf7b3f6dbf553f35,0x3f7bbf603f30bede,0x3f02bf3f3f6abf7e,0xbf553f7cbf783f48,0x3f25be8ebe0f3f08
.quad 0x3e80bf803eb73f48,0x3f7fbec4bf443f59,0x3f7fbef8bf1a3f7a,0xbce63f6dbf3abea9,0x3ed13f14bf7f3ede,0xbf7d3ec43f1abf7e,0xbf3a3f7cbeebbede,0x3e80bf6d3f5cbde5
.quad 0xbf633e8e3f02bf7a,0x3f6fbec4bed13f72,0x3e0fbf3f3f80bf48,0xbeeb3f6dbf743f08,0x3f7bbf6d3f0e0000,0xbf553ec43e48bf35,0x3f02bd66bed13f48,0x3f25bf6d3f7fbf59
.quad 0xbf253f60bf7d3f7a,0x3f30bec43ce63ea9,0xbf6f3f51bf253ede,0xbf4d3f6dbf7d3f7e,0x3ce6be2c3e9bbede,0xbf023ec4be803de5,0x3f74bf763f78bf7a,0x3f6abf6d3f6fbf72
.quad 0x3f1abf2b3f3abf48,0x3e9bbec43eebbf08,0xbf0e3ec4be480000,0xbf7b3f6dbf553f35,0xbf783f80bf6f3f48,0xbdac3ec4bf253f59,0xbdac3ef8bf4d3f7a,0x3f80bf6d3f30bea9
.quad 0x3ed13f3fbf5cbe64,0xbf3a3f603e48bf7e,0xbf7d3e8e3f44bf67,0x3e80bf7c3f0e3f08,0x3f25bf7c3eb73f20,0x3e9b3f2bbf7b3ea9,0x3e9b3f14bf803f20,0xbf44bd663f55bf72
.quad 0xbf783ef83e9bbf67,0x3f7dbf14be483f59,0x3f3abf803f4dbe64,0xbf6a3f76bf0ebde5,0x3e483ec4bf553f80,0x3f0ebf6d3f7bbf35,0xbf6f3f2bbe80be64,0xbce63ef8bf553f7e
.quad 0x3f4dbf763f7fbf67,0xbf023e2c3e48bf08,0x3dac3e2cbed13f20,0x3f63bf3f3f0ebea9,0xbf633f51bf3a3f20,0xbf7f3f80bf7b3f72,0x3f5cbf603f63bf67,0x3f4dbf513f55bf59
.quad 0xbce6bd663e0fbe64,0xbeb73e8ebe483de5,0xbf553f6dbf7b3f80,0xbe483ec4bf0e3f35,0x3f6abf3f3f02be64,0x3f30bf603f7bbf7e,0xbe0fbe8e3f25bf67,0xbf783f7cbf553f08
.quad 0xbf63be2c3f7dbede,0x3e0fbf7c3eeb3f35,0x3f6fbd66bf633f48,0xbeeb3f80beb7bf35,0xbf783e8e3f30bf7a,0x3f3abf763e803f35,0x3f7dbef8bed13f7a,0xbf6a3f60be0fbf35
.quad 0xbf803f2b3dacbf48,0x3f7fbf3f3ce63f35,0x3f7fbf513e803ede,0xbf783f143dacbf35,0xbf7b3f6dbf0e0000,0x3f55bec4be483f35,0x3f74bf7c3f4dbede,0xbf1a3e2c3e9bbf35
.quad 0xbf6a3f80bf743f48,0x3e9b3d66bed13f35,0x3f5cbf763f80bf7a,0x3ce6be8e3f02bf35,0xbf4d3f60bf6f3f7a,0xbeb73ef8bf1a3f35,0x3f3abf3f3f44bf48,0x3f25bf2b3f30bf35
.quad 0xbf253f14bf023ede,0xbf5c3f51bf443f35,0x3f0ebec43e480000,0x3f7bbf6d3f55bf35,0xbeeb3e2c3e0fbede,0xbf7d3f7cbf633f35,0x3eb73d66beeb3f48,0x3f63bf803f6fbf35
.quad 0x3f7bbef8bf303f67,0x3f023f2bbf6abde5,0xbf55be2c3f78bf20,0x3f25bf763e0f3f59,0x3e483f3fbf743e64,0xbf6f3e2c3f44bf72,0x3f0ebf803f253e64,0xbce63f51bf743ea9
.quad 0xbf7b3f51be0fbf20,0x3f74bf603e803f08,0x3f55be8ebed13f67,0xbf1abd663f30bf7e,0xbe48bec43f55bf80,0xbf0e3f6dbf7b3f35,0xbf0e3f60bf803f67,0x3f78bf3f3eb73de5
.quad 0x3f7bbf7c3f5cbf20,0xbdacbe8e3f1abf59,0xbf553f2bbeeb3e64,0xbf6a3f7cbf7f3f72,0x3e48bd66bdac3e64,0x3f30bf143eebbea9,0x3f0ebf143f1abf20,0x3eebbef83f02bf08
.quad 0xbf7b3f76bf6f3f67,0xbf7d3f80bf803f7e,0x3f55bf6d3f7bbf80,0x3e48bec43f0ebf35,0xbe483ef8bf3a3f67,0x3f5cbf2b3ed1bde5,0xbf0e3e2c3e80bf20,0xbf443f76bf7d3f59
.quad 0x3ebd3f46bf57be87,0xbf413f5b3e72bf7f,0xbf4a3f623d8fbf70,0xbf05bf113f7cbe72,0xbf4fbdc93f68bf53,0x3f6ebf4abe013f6b,0x3eb0bf753f4fbc66,0x3e563f28bf7f3f0b
.quad 0x3f7fbf22be013f4f,0xbf803f383c66bf3c,0x3e563ef1bf6e3f73,0x3e01bf3c3f80bf4a,0xbf623f7fbf463e95,0x3f75bf223dc93ef1,0xbf323e953e3abf1d,0xbee53f4fbf7d3f73
.quad 0x3efebf463f73bf80,0xbf4f3f0bbe56be1d,0x3f79bf623f3cbf0b,0x3f38bf5e3f77bf80,0x3d2c3dc9be723ebd,0x3f11bee53ea2be3a,0xbf733f75bf773f79,0xbf683f6bbf6e3f70
.quad 0xbf113f22bf323f41,0xbe873eb0bed83efe,0x3f22bef13e95bdc9,0x3f7fbf753f62bf46,0x3f6bbf7f3f7abf5e,0xbd8fbe723f05bf41,0xbe01be953f28bf68,0xbf793f7cbf533f05
.quad 0xbf5ebe563f7fbecb,0x3e3abf7e3ed83f3c,0x3f68bf41be953f7e,0x3ea23f3cbf6b3c66,0xbe3a3f70bf46be1d,0xbf3cbe563f73bf41,0xbf32be1d3f62bf68,0x3f79becbbefe3f7e
.quad 0x3f7dbf4a3dc93f28,0xbf773f5bbe56bf11,0xbee53f6bbf753f0b,0x3f38bf7f3f4fbe72,0xbef1bdc93f22bf75,0xbe953f46bf7f3f62,0x3f7ebf533ef1bc66,0xbe56be873f2dbf70
.quad 0xbf2d3f65bf7f3f77,0x3f28beb0bc663ebd,0xbe56bd2c3e95bf05,0xbf703f53bf283ee5,0x3f6bbf5b3f46bf2d,0x3f7dbf803f7ebf77,0xbf5b3f5ebf623f65,0xbf4a3f4fbf533f57
.quad 0x3d8f3c66bdc93e3a,0x3ecbbea23e72be1d,0x3f46bf623f75bf7f,0x3dc9be953ef1bf22,0xbf773f57bf223ebd,0xbf113f4abf703f80,0x3eb03d8fbef13f4a,0x3f65bf803f6ebf32
.quad 0x3f7dbee5bf383f62,0x3ef13f32bf65be1d,0xbf7a3f173efebf7f,0xbdc9bf5e3f4f3e56,0x3f77bf38be723f75,0xbe953f79bf32be87,0xbf733f53bd2cbf46,0x3f22bf803f113ea2
.quad 0x3f6ebf683ea23ef1,0xbf623f73bed8bebd,0xbf683f77bf11bdc9,0x3f7fbf533e873ed8,0x3f62bf7f3f46be95,0xbf753f22bdc9bef1,0xbf5b3f7fbf6b3f22,0x3f46becbbd8f3f05
.quad 0x3f53bf793f7ebf62,0xbef13e013e72bf11,0xbf4a3f6bbf7d3f7f,0x3dc93e1dbecb3f1d,0x3f41bf573f68bf75,0x3e95bed83f0bbf28,0xbf383f3cbf413f46,0xbf223f28bf2d3f32
.quad 0x3f2dbf1d3f0bbef1,0x3f62bf573f4abf3c,0xbf223ef1be953dc9,0xbf7f3f75bf623f46,0x3f17bea23c663e95,0x3f75bf803f73bf4f,0xbf0b3e1d3e87bf22,0xbf463f77bf7d3f57
.quad 0xbf2d3f683e01bf7c,0xbf6bbdc93f7abefe,0x3f80becbbf2d3f73,0xbe013f75bf28bed8,0xbf28bea23f7abf2d,0x3f7dbf22beb03f7c,0xbe013f5ebf6b3e72,0xbed8bef13f7dbf38
.quad 0x3f53bf7a3f053e87,0xbf413f7fbf1dbe1d,0xbf793f173d8fbf32,0x3f57be95becb3f65,0x3ef13dc9bf223f75,0x3e95bf463f7fbf62,0x3eb0bf3c3f77bf7a,0xbf803f62bf113e01
.quad 0xbf6e3f80bf703f41,0x3e873dc9bee53f3c,0x3f65bf413f11beb0,0x3f5bbf753f80bf7a,0xbe873e013c66be1d,0xbf3c3f22bf053ecb,0xbf0b3f11bf173f1d,0xbee53ef1befe3f05
.quad 0x3f7dbf793f73bf6b,0x3f7cbf7f3f80bf7f,0xbf463f62bf753f7f,0xbdc93e95bef13f22,0x3d2cbeb03f1dbf53,0xbf6e3f46bf0b3e87,0x3f38bebdbd2c3ee5,0x3f1dbf623f7fbf70
.quad 0x3f6ebf22bf0b3f77,0x3f283f05bf793d8f,0x3f1d3ef1bf7f3eb0,0xbf5b3f533e3abf79,0xbf173f7fbed8bf11,0xbebdbf1d3f7ebecb,0xbf703e953f17bf80,0x3f7abf41bd8f3f57
.quad 0x3d8fbf463f7ebf17,0x3d2c3f32bf803f2d,0x3f7abf623ebd3ea2,0xbf7e3f2dbd2cbf1d,0x3ef13dc9bf223f75,0x3e95bf463f7fbf62,0xbf383f75bf7c3f4a,0x3f65bf173e1d3ea2
.quad 0xbf5e3f22bea2bd2c,0xbf173f57bf7a3f7d,0x3e72bef13f2dbf57,0xbf323efebe873c66,0x3f80bf7f3f79bf6e,0x3f53bf653f73bf7c,0x3ea2be953e87be72,0x3ed8becb3ebdbeb0
.quad 0xbf533f46bf383f28,0xbf773f70bf683f5e,0xbf463f62bf753f7f,0xbdc93e95bef13f22,0x3ecbbdc9be563efe,0x3f7fbf793f5bbf28,0x3f7ebf753f41bed8,0xbe72be3a3f11bf5b
.quad 0xbefe3f7abdc9bf6b,0xbf7c3e013f68bf2d,0xbed8bf283f75be01,0x3f73bf2dbecb3f80,0x3f7cbeb0bf223f7d,0xbf2d3f7abea2bf28,0xbf383f7dbef1bed8,0x3e72bf6b3f5ebe01
.quad 0xbe1dbf1d3f7fbf41,0x3e873f05bf7a3f53,0x3f65becbbe953f57,0xbf323d8f3f17bf79,0xbf623f7fbf463e95,0x3f75bf223dc93ef1,0x3e01bf113f62bf80,0xbf7a3f77bf3c3eb0
.quad 0x3f3cbee53dc93e87,0x3f41bf703f80bf6e,0xbf7a3f80bf753f5b,0xbeb03f11bf413f65,0x3ecbbf053f22bf3c,0xbe1d3c663e01be87,0x3f05befe3ef1bee5,0x3f1dbf173f11bf0b
.quad 0xbf7f3f80bf7f3f7c,0xbf6b3f73bf793f7d,0x3f22bef13e95bdc9,0x3f7fbf753f62bf46,0x3e87bf0b3f46bf6e,0xbf533f1dbeb03d2c,0xbf703f7fbf623f1d,0x3ee5bd2cbebd3f38
.quad 0xbe1dbf653f323ef1,0x3f62bf38bee53f7d,0x3e563f4fbf5ebdc9,0xbf7f3efe3f17bf7a,0xbe87bf323f79be95,0x3f75be72bf383f77,0x3ea23f11bf803f22,0xbf46bd2c3f53bf73
.quad 0xbebdbed83f73bf62,0x3ef13ea2bf683f6e,0x3ed83e87bf533f7f,0xbdc9bf113f77bf68,0xbef1bdc93f22bf75,0xbe953f46bf7f3f62,0x3f05bd8fbecb3f46,0x3f22bf6b3f7fbf5b
.quad 0xbf113e723e01bef1,0xbf623f7ebf793f53,0x3f1dbecb3e1d3dc9,0x3f7fbf7d3f6bbf4a,0xbf283f0bbed83e95,0xbf753f68bf573f41,0x3f32bf2d3f28bf22,0x3f46bf413f3cbf38
.quad 0xbf3c3f4abf573f62,0xbef13f0bbf1d3f2d,0x3f46bf623f75bf7f,0x3dc9be953ef1bf22,0xbf4f3f73bf803f75,0x3e953c66bea23f17,0x3f57bf7d3f77bf46,0xbf223e873e1dbf0b
.quad 0x3f3c3ed8bf7e3e3a,0xbecb3f7fbe56bf5e,0x3c66bf6b3f3c3ea2,0x3f7ebe95bf413f68,0xbf413f73be56bf3c,0xbe1dbf463f70be3a,0x3f7ebefebecb3f79,0xbf683f62be1dbf32
.quad 0xbf11be563f5bbf77,0x3f283dc9bf4a3f7d,0xbe723f4fbf7f3f38,0x3f0bbf753f6bbee5,0x3f62bf7f3f46be95,0xbf753f22bdc9bef1,0xbf703f2dbe87be56,0xbc663ef1bf533f7e
.quad 0x3ebdbc66beb03f28,0x3f77bf7f3f65bf2d,0x3ee5bf283f53bf70,0xbf053e95bd2cbe56,0xbf773f7ebf803f7d,0xbf2d3f46bf5b3f6b,0x3f57bf533f4fbf4a,0x3f65bf623f5ebf5b
.quad 0xbe1d3e72bea23ecb,0x3e3abdc93c663d8f,0xbf223ef1be953dc9,0xbf7f3f75bf623f46,0x3f80bf703f4abf11,0x3ebdbf223f57bf77,0xbf323f6ebf803f65,0x3f4abef13d8f3eb0
.quad 0xbf44bec43f7fbe64,0x3eb7bf803e803f59,0xbf3a3f6dbce6bf67,0xbf1abef83f7fbea9,0x3f1a3ec4bf7d3f20,0xbf7f3f143ed1bf7e,0x3f5cbf6d3e803f20,0xbeeb3f7cbf3abde5
.quad 0xbed1bec43f6fbf67,0x3f023e8ebf633f72,0xbf743f6dbeebbe64,0x3f80bf3f3e0f3f08,0x3e483ec4bf553f80,0x3f0ebf6d3f7bbf35,0x3f7fbf6d3f25be64,0xbed1bd663f02bf59
.quad 0x3ce6bec43f30bf67,0xbf7d3f60bf253ea9,0xbf7d3f6dbf4d3f20,0xbf253f51bf6f3f7e,0xbe803ec4bf023f20,0x3e9bbe2c3ce63de5,0x3f6fbf6d3f6abf67,0x3f78bf763f74bf72
.quad 0x3eebbec43e9bbe64,0x3f3abf2b3f1abf08,0xbf553f6dbf7b3f80,0xbe483ec4bf0e3f35,0xbf253ec4bdacbe64,0xbf6f3f80bf783f59,0x3f30bf6d3f80bf67,0xbf4d3ef8bdacbea9
.quad 0x3f80be8ebf553f48,0x3e9b3f51bf4dbea9,0x3f5cbf51be483f7a,0x3ed13f2bbf743de5,0x3eebbf803f0e3ede,0x3f023ef8bf803f08,0xbdacbf3f3f7bbede,0x3f1a3e8ebf6f3f59
.quad 0xbf1abe2c3f55bf7a,0x3f303d66bf443f7e,0xbf6f3ef83e48bf48,0x3f44be2cbf023f72,0xbf7b3f6dbf0e0000,0x3f55bec4be483f35,0xbf3a3f76bf7b3f48,0x3f63bf143e0f3ea9
.quad 0xbe803f14bf553f7a,0x3f6fbf3f3eebbde5,0x3e9bbd66be483ede,0x3f78bf603f3abf08,0x3f44bf2b3f0ebede,0x3f7dbf763f6abf59,0x3f7dbf7c3f7bbf7a,0x3f80bf803f7fbf7e
.quad 0x3f6abf603f55bf48,0x3f7fbf7c3f78bf72,0x3f0ebec43e480000,0x3f7bbf6d3f55bf35,0x3ce63e8ebf0e3f48,0x3f74bf513f1abea9,0xbf023f51bf7b3f7a,0x3f6abf2b3e9b3de5
.quad 0x0,0x0,0x0,0x0,0x0,0x0,0x0,0x0
.quad 0x0,0x0,0x0,0x0,0x0,0x0,0x0,0x0
.quad 0x0,0x0,0x0,0x0,0x0,0x0,0x0,0x0
.quad 0x0,0x0,0x0,0x0,0x0,0x0,0x0,0x0
.quad 0x0,0x0,0x0,0x0,0x0,0x0,0x0,0x0
.quad 0x0,0x0,0x0,0x0,0x0,0x0,0x0,0x0
.quad 0x0,0x0,0x0,0x0,0x0,0x0,0x0,0x0
.quad 0x0,0x0,0x0,0x0,0x0,0x0,0x0,0x0
.quad 0xbf253f6d3dacbf7a,0xbf6fbd663f78bf08,0x3f303ec4bf803ede,0xbf4d3f603dacbf72,0x3f4dbf6d3e0f3f48,0x3dac3f51bf6a3de5,0xbf02bec43f78bf48,0x3f63be2cbf303f7e
.quad 0xbf6a3f6dbeb7bede,0x3f5cbf763eeb3ea9,0x3e9b3ec4bf633f7a,0x3ce6bf2b3f7dbf59,0x3f7bbf6d3f0e0000,0xbf553ec43e48bf35,0xbdacbec43f44bf7a,0xbf6a3f80bf5c3f08
.quad 0xbf803f6dbf3a3ede,0xbe0f3ef8bf443f72,0xbe0f3ec4bf1a3f48,0x3f44bf143eb7bde5,0x3f78bf6d3f5cbf48,0x3f74bf7c3f80bf7e,0x3eb7bec43ed1bede,0x3e80be8e3e9bbea9
.quad 0xbf633f6dbf743f7a,0xbf303f3fbf4d3f59,0xbf0e3ec4be480000,0xbf7b3f6dbf553f35,0x3f44bf6d3f7fbf7a,0xbeb73d663e80bf08,0x3f3abec4bce63ede,0x3f1abf603f7fbf72
.quad 0x3ce6bf763f0e3f20,0x3f74bf14bf1a3f72,0xbf02bf143f7bbe64,0x3f6abf3fbe9b3f7e,0xbf633d663f55bf67,0x3f5cbf603ce63f59,0xbf7f3f2b3e48bf67,0x3f4dbf763eb73f08
.quad 0xbf4d3f7cbf0ebe64,0x3f3abf803f253de5,0xbeb73f60bf7b3f20,0x3f25bf7c3f5cbea9,0x3e483ec4bf553f80,0x3f0ebf6d3f7bbf35,0x3f30be8ebe483f20,0x3eebbf513f7dbf72
.quad 0x3f78bf513f0ebe64,0x3eb7bf2b3f63bf7e,0x3f74bf803f7bbf67,0x3e80bef83f30bf59,0x3f25bf3f3f55bf67,0x3e0fbe8e3ed1bf08,0x3e0fbe2c3e48be64,0x3ce6bd663dacbde5
.quad 0xbed13ef8bf0e3f20,0xbdac3e2cbe803ea9,0xbf553f6dbf7b3f80,0xbe483ec4bf0e3f35,0xbf803f76bf553f20,0xbe9b3f14bf4d3f72,0xbf5c3f14be48be64,0xbed13f3fbf743f7e
.quad 0x0,0x0,0x0,0x0,0x0,0x0,0x0,0x0
.quad 0x0,0x0,0x0,0x0,0x0,0x0,0x0,0x0
.quad 0x0,0x0,0x0,0x0,0x0,0x0,0x0,0x0
.quad 0x0,0x0,0x0,0x0,0x0,0x0,0x0,0x0
.quad 0x0,0x0,0x0,0x0,0x0,0x0,0x0,0x0
.quad 0x0,0x0,0x0,0x0,0x0,0x0,0x0,0x0
.quad 0x0,0x0,0x0,0x0,0x0,0x0,0x0,0x0
.quad 0x0,0x0,0x0,0x0,0x0,0x0,0x0,0x0
.quad 0x3d8fbf793f053f28,0x3f77bf0bbf223f6e,0xbf793e3a3f53bf5b,0x3eb0bf7f3ef13f1d,0xbecb3f7ebf1dbebd,0xbf11bed83f7fbf17,0x3f57bd8fbf413f7a,0xbf803f173e95bf70
.quad 0x3f2dbf803f323d2c,0xbf173f7ebf463d8f,0xbf1dbd2c3f2dbf7e,0x3ea23ebdbf623f7a,0xbf623f7fbf463e95,0x3f75bf223dc93ef1,0x3ea23e1dbf173f65,0x3f4abf7c3f75bf38
.quad 0x3f7dbf7a3f57bf17,0xbd2cbea23f22bf5e,0x3c66be873efebf32,0xbf573f2dbef13e72,0xbf7c3f73bf653f53,0xbf6e3f79bf7f3f80,0xbeb03ebdbecb3ed8,0xbe723e87be953ea2
.quad 0x3f5ebf683f70bf77,0x3f28bf383f46bf53,0x3f22bef13e95bdc9,0x3f7fbf753f62bf46,0xbf283f5bbf793f7f,0x3efebe56bdc93ecb,0xbf5b3f11be3abe72,0xbed83f41bf753f7e
.quad 0x3f113f1dbf70bd2c,0xbf173f733c66bf75,0x3f653d2cbf6e3f38,0xbf0b3f7dbe87bf46,0x3f80bf0bbee53f7f,0xbefe3f80bf05bef1,0x3f5bbf6e3e873f1d,0xbee53f7cbf3cbdc9
.quad 0x3efebf793f57be3a,0xbecb3f70bf653e95,0x3c66bf283f7dbf5b,0xbeb03f5ebf7c3f22,0xbef1bdc93f22bf75,0xbe953f46bf7f3f62,0xbf573efebd2cbed8,0xbe723f28bf6e3f7f
.quad 0xbf7f3f68bf323ecb,0xbe3a3f05bf4a3f75,0xbf683f7cbf7f3f73,0xbe013ebdbf173f46,0xbf173f32bf4a3f5e,0xbd8f3e56beb03ef1,0xbe013e1dbe3a3e56,0xbc663d2cbd8f3dc9
.quad 0x3ebdbee53f05bf17,0x3d2cbe013e56be95,0x3f46bf623f75bf7f,0x3dc9be953ef1bf22,0x3f7cbf7e3f68bf3c,0x3e1dbee53f32bf62,0x3f73bf3c3ecb3c66,0x3e56bf173f5ebf7f
.quad 0x0,0x0,0x0,0x0,0x0,0x0,0x0,0x0
.quad 0x0,0x0,0x0,0x0,0x0,0x0,0x0,0x0
.quad 0x0,0x0,0x0,0x0,0x0,0x0,0x0,0x0
.quad 0x0,0x0,0x0,0x0,0x0,0x0,0x0,0x0
.quad 0x0,0x0,0x0,0x0,0x0,0x0,0x0,0x0
.quad 0x0,0x0,0x0,0x0,0x0,0x0,0x0,0x0
.quad 0x0,0x0,0x0,0x0,0x0,0x0,0x0,0x0
.quad 0x0,0x0,0x0,0x0,0x0,0x0,0x0,0x0
.quad 0xbf7f3e723f5bbf41,0xbe87bf573f463ebd,0xbe723f7cbf11bf05,0xbf703d8f3f62bf4a,0x3f6bbe01bf4a3f6e,0xbf533f68bdc9bf4f,0x3f0bbf7f3f283e56,0xbc663f4fbf753eb0
.quad 0xbf3c3c663f38bf80,0x3f4fbe01bf223f7f,0xbf4a3f80bf3c3e01,0x3f73bf6e3ef13e56,0x3ef13dc9bf223f75,0x3e95bf463f7fbf62,0x3f73bf7d3f4fbee5,0xbf1d3e3a3e95bf32
.quad 0xbe1dbe563f0bbf4f,0xbf803f73bf463efe,0xbf803f77bf5e3f38,0xbf0b3f3cbf623f79,0xbe3a3ea2bee53f11,0x3ebdbe723dc93d2c,0x3f70bf6e3f6bbf68,0x3f79bf773f75bf73
.quad 0x3efebed83eb0be87,0x3f41bf323f22bf11,0xbf463f62bf753f7f,0xbdc93e95bef13f22,0xbf413f05be72bd8f,0xbf5e3f7abf7f3f6b,0x3f05bf533f7cbf79,0xbf683f28be95be01
.quad 0x3f53bf4abeb03f80,0x3f4f3ea2bf803e95,0x3ee5bf803ebd3f32,0x3f573e1dbf773f22,0xbd2cbf573f65bd8f,0x3f5ebc66bf5b3f62,0xbf05bebd3f77bf4a,0x3f65be3abf2d3f7f
.quad 0xbf5e3e723f0bbf7c,0x3f6bbeb0bee53f75,0xbf803f41be1dbf05,0x3f70befebe3a3f46,0xbf623f7fbf463e95,0x3f75bf223dc93ef1,0xbf0b3f5ebf803f68,0x3f79bf413ebd3dc9
.quad 0xbd8f3ed8bf383f6b,0x3f7cbf5b3f1dbe95,0x3ed8be3abd8f3ea2,0x3f7ebf6e3f4fbf22,0x3f4fbf383f1dbefe,0x3f7fbf7a3f70bf62,0x3f7ebf7d3f7cbf7a,0x3f80bf803f7fbf7f
.quad 0x3f6ebf653f5bbf4f,0x3f80bf7e3f7abf75,0x3f22bef13e95bdc9,0x3f7fbf753f62bf46,0x3e3a3e01bed83f2d,0x3f7dbf653f38bef1,0xbea23f2dbf6b3f80,0x3f7abf4f3efebdc9
.quad 0x0,0x0,0x0,0x0,0x0,0x0,0x0,0x0
.quad 0x0,0x0,0x0,0x0,0x0,0x0,0x0,0x0
.quad 0x0,0x0,0x0,0x0,0x0,0x0,0x0,0x0
.quad 0x0,0x0,0x0,0x0,0x0,0x0,0x0,0x0
.quad 0x0,0x0,0x0,0x0,0x0,0x0,0x0,0x0
.quad 0x0,0x0,0x0,0x0,0x0,0x0,0x0,0x0
.quad 0x0,0x0,0x0,0x0,0x0,0x0,0x0,0x0
.quad 0x0,0x0,0x0,0x0,0x0,0x0,0x0,0x0
.quad 0x3f803f803f803f80,0x3f803f803f803f80,0xbf803f80bf803f80,0xbf803f80bf803f80,0x3f753f7b3f7f3f80,0xbe95be48bdc9248d,0x3e953e483dc90000,0x3f753f7b3f7f3f80
.quad 0x3f553f6d3f7b3f80,0xbf55bf6dbf7bbf80,0x3f0e3ec43e480000,0xbf0ebec4be48250d,0x3f223f553f753f80,0x3f463f0e3e95a554,0x3f463f0e3e950000,0xbf22bf55bf75bf80
.quad 0x3ec43f353f6d3f80,0x3ec43f353f6d3f80,0x3f6d3f353ec40000,0x3f6d3f353ec40000,0x3dc93f0e3f623f80,0xbf7fbf55bef1248d,0x3f7f3f553ef10000,0x3dc93f0e3f623f80
.quad 0xbe483ec43f553f80,0x3e48bec4bf55bf80,0x3f7b3f6d3f0e0000,0xbf7bbf6dbf0e250d,0xbef13e483f463f80,0x3f623f7b3f22a554,0x3f623f7b3f220000,0x3ef1be48bf46bf80
.quad 0x3f803f803f803f80,0x3f803f803f803f80,0xbf803f80bf803f80,0xbf803f80bf803f80,0x3f463f553f623f6d,0xbf22bf0ebef1bec4,0x3f223f0e3ef13ec4,0x3f463f553f623f6d
.quad 0x3e483ec43f0e3f35,0xbe48bec4bf0ebf35,0x3f7b3f6d3f553f35,0xbf7bbf6dbf55bf35,0xbef1be483dc93ec4,0x3f623f7b3f7f3f6d,0x3f623f7b3f7f3f6d,0x3ef13e48bdc9bec4
.quad 0xbf6dbf35bec4248d,0xbf6dbf35bec4248d,0x3ec43f353f6d3f80,0x3ec43f353f6d3f80,0xbf75bf7bbf46bec4,0x3e95be48bf22bf6d,0xbe953e483f223f6d,0xbf75bf7bbf46bec4
.quad 0xbf0ebf6dbf7bbf35,0x3f0e3f6d3f7b3f35,0xbf55bec43e483f35,0x3f553ec4be48bf35,0x3dc9bf0ebf75bf6d,0xbf7fbf55be953ec4,0xbf7fbf55be953ec4,0xbdc93f0e3f753f6d
.quad 0x3f803f803f803f80,0x3f803f803f803f80,0xbf803f80bf803f80,0xbf803f80bf803f80,0x3ef13f0e3f223f35,0xbf62bf55bf46bf35,0x3f623f553f463f35,0x3ef13f0e3f223f35
.quad 0xbf0ebec4be48248d,0x3f0e3ec43e48a554,0x3f553f6d3f7b3f80,0xbf55bf6dbf7bbf80,0xbf7fbf7bbf62bf35,0xbdc93e483ef13f35,0xbdc93e483ef13f35,0x3f7f3f7b3f623f35
.quad 0xbec4bf35bf6dbf80,0xbec4bf35bf6dbf80,0xbf6dbf35bec4250d,0xbf6dbf35bec4250d,0x3f223e48be95bf35,0x3f463f7b3f753f35,0xbf46bf7bbf75bf35,0x3f223e48be95bf35
.quad 0x3f7b3f6d3f0ea554,0xbf7bbf6dbf0e248d,0x3e48bec4bf55bf80,0xbe483ec43f553f80,0x3e953f553f7f3f35,0x3f753f0ebdc9bf35,0x3f753f0ebdc9bf35,0xbe95bf55bf7fbf35
.quad 0x3f803f803f803f80,0x3f803f803f803f80,0xbf803f80bf803f80,0xbf803f80bf803f80,0x3dc93e483e953ec4,0xbf7fbf7bbf75bf6d,0x3f7f3f7b3f753f6d,0x3dc93e483e953ec4
.quad 0xbf7bbf6dbf55bf35,0x3f7b3f6d3f553f35,0x3e483ec43f0e3f35,0xbe48bec4bf0ebf35,0xbe95bf0ebf46bf6d,0xbf75bf55bf22bec4,0xbf75bf55bf22bec4,0x3e953f0e3f463f6d
.quad 0x3f6d3f353ec4a554,0x3f6d3f353ec4a554,0xbec4bf35bf6dbf80,0xbec4bf35bf6dbf80,0x3ef13f553f7f3f6d,0xbf62bf0ebdc93ec4,0x3f623f0e3dc9bec4,0x3ef13f553f7f3f6d
.quad 0xbf55bec43e483f35,0x3f553ec4be48bf35,0x3f0e3f6d3f7b3f35,0xbf0ebf6dbf7bbf35,0xbf22bf7bbf62bec4,0xbf46be483ef13f6d,0xbf46be483ef13f6d,0x3f223f7b3f623ec4
.quad 0x3f803f803f803f80,0x3f803f803f803f80,0xbf803f80bf803f80,0xbf803f80bf803f80,0xbf75bf7bbf7fbf80,0x3e953e483dc9a554,0xbe95be48bdc9250d,0xbf75bf7bbf7fbf80
.quad 0x3f553f6d3f7b3f80,0xbf55bf6dbf7bbf80,0x3f0e3ec43e480000,0xbf0ebec4be48250d,0xbf22bf55bf75bf80,0xbf46bf0ebe95248d,0xbf46bf0ebe95250d,0x3f223f553f753f80
.quad 0x3ec43f353f6d3f80,0x3ec43f353f6d3f80,0x3f6d3f353ec40000,0x3f6d3f353ec40000,0xbdc9bf0ebf62bf80,0x3f7f3f553ef1a554,0xbf7fbf55bef1250d,0xbdc9bf0ebf62bf80
.quad 0xbe483ec43f553f80,0x3e48bec4bf55bf80,0x3f7b3f6d3f0e0000,0xbf7bbf6dbf0e250d,0x3ef1be48bf46bf80,0xbf62bf7bbf22248d,0xbf62bf7bbf22250d,0xbef13e483f463f80
.quad 0x3f803f803f803f80,0x3f803f803f803f80,0xbf803f80bf803f80,0xbf803f80bf803f80,0xbf46bf55bf62bf6d,0x3f223f0e3ef13ec4,0xbf22bf0ebef1bec4,0xbf46bf55bf62bf6d
.quad 0x3e483ec43f0e3f35,0xbe48bec4bf0ebf35,0x3f7b3f6d3f553f35,0xbf7bbf6dbf55bf35,0x3ef13e48bdc9bec4,0xbf62bf7bbf7fbf6d,0xbf62bf7bbf7fbf6d,0xbef1be483dc93ec4
.quad 0xbf6dbf35bec4248d,0xbf6dbf35bec4248d,0x3ec43f353f6d3f80,0x3ec43f353f6d3f80,0x3f753f7b3f463ec4,0xbe953e483f223f6d,0x3e95be48bf22bf6d,0x3f753f7b3f463ec4
.quad 0xbf0ebf6dbf7bbf35,0x3f0e3f6d3f7b3f35,0xbf55bec43e483f35,0x3f553ec4be48bf35,0xbdc93f0e3f753f6d,0x3f7f3f553e95bec4,0x3f7f3f553e95bec4,0x3dc9bf0ebf75bf6d
.quad 0x3f803f803f803f80,0x3f803f803f803f80,0xbf803f80bf803f80,0xbf803f80bf803f80,0xbef1bf0ebf22bf35,0x3f623f553f463f35,0xbf62bf55bf46bf35,0xbef1bf0ebf22bf35
.quad 0xbf0ebec4be48248d,0x3f0e3ec43e48a554,0x3f553f6d3f7b3f80,0xbf55bf6dbf7bbf80,0x3f7f3f7b3f623f35,0x3dc9be48bef1bf35,0x3dc9be48bef1bf35,0xbf7fbf7bbf62bf35
.quad 0xbec4bf35bf6dbf80,0xbec4bf35bf6dbf80,0xbf6dbf35bec4250d,0xbf6dbf35bec4250d,0xbf22be483e953f35,0xbf46bf7bbf75bf35,0x3f463f7b3f753f35,0xbf22be483e953f35
.quad 0x3f7b3f6d3f0ea554,0xbf7bbf6dbf0e248d,0x3e48bec4bf55bf80,0xbe483ec43f553f80,0xbe95bf55bf7fbf35,0xbf75bf0e3dc93f35,0xbf75bf0e3dc93f35,0x3e953f553f7f3f35
.quad 0x3f803f803f803f80,0x3f803f803f803f80,0xbf803f80bf803f80,0xbf803f80bf803f80,0xbdc9be48be95bec4,0x3f7f3f7b3f753f6d,0xbf7fbf7bbf75bf6d,0xbdc9be48be95bec4
.quad 0xbf7bbf6dbf55bf35,0x3f7b3f6d3f553f35,0x3e483ec43f0e3f35,0xbe48bec4bf0ebf35,0x3e953f0e3f463f6d,0x3f753f553f223ec4,0x3f753f553f223ec4,0xbe95bf0ebf46bf6d
.quad 0x3f6d3f353ec4a554,0x3f6d3f353ec4a554,0xbec4bf35bf6dbf80,0xbec4bf35bf6dbf80,0xbef1bf55bf7fbf6d,0x3f623f0e3dc9bec4,0xbf62bf0ebdc93ec4,0xbef1bf55bf7fbf6d
.quad 0xbf55bec43e483f35,0x3f553ec4be48bf35,0x3f0e3f6d3f7b3f35,0xbf0ebf6dbf7bbf35,0x3f223f7b3f623ec4,0x3f463e48bef1bf6d,0x3f463e48bef1bf6d,0xbf22bf7bbf62bec4
.quad 0xbf35248d3f353f80,0xbf35248d3f353f80,0x3f353f803f350000,0x3f353f803f350000,0xbf62be483f223f80,0xbef1bf7bbf46248d,0x3ef13f7b3f460000,0xbf62be483f223f80
.quad 0xbf7bbec43f0e3f80,0x3f7b3ec4bf0ebf80,0x3e483f6d3f550000,0xbe48bf6dbf55250d,0xbf7fbf0e3ef13f80,0xbdc93f553f62a554,0xbdc93f553f620000,0x3f7f3f0ebef1bf80
.quad 0xbf6dbf353ec43f80,0xbf6dbf353ec43f80,0xbec43f353f6d0000,0xbec43f353f6d0000,0xbf46bf553e953f80,0x3f22bf0ebf75248d,0xbf223f0e3f750000,0xbf46bf553e953f80
.quad 0xbf0ebf6d3e483f80,0x3f0e3f6dbe48bf80,0xbf553ec43f7b0000,0x3f55bec4bf7b250d,0xbe95bf7b3dc93f80,0xbf753e483f7fa554,0xbf753e483f7f0000,0x3e953f7bbdc9bf80
.quad 0x3f35a554bf35bf80,0x3f35a554bf35bf80,0xbf35bf80bf35250d,0xbf35bf80bf35250d,0x3f7f3f0ebe95bf6d,0x3dc93f553f753ec4,0xbdc9bf55bf75bec4,0x3f7f3f0ebe95bf6d
.quad 0x3f553f6d3e48bf35,0xbf55bf6dbe483f35,0x3f0ebec4bf7bbf35,0xbf0e3ec43f7b3f35,0x3e953f7b3f22bec4,0x3f753e48bf46bf6d,0x3f753e48bf46bf6d,0xbe95bf7bbf223ec4
.quad 0xbec43f353f6da554,0xbec43f353f6da554,0x3f6d3f35bec4bf80,0x3f6d3f35bec4bf80,0xbf623e483f7f3ec4,0xbef1bf7bbdc93f6d,0x3ef13f7b3dc9bf6d,0xbf623e483f7f3ec4
.quad 0xbf7bbec43f553f35,0x3f7b3ec4bf55bf35,0xbe483f6d3f0ebf35,0x3e48bf6dbf0e3f35,0xbf22bf553ef13f6d,0xbf463f0e3f62bec4,0xbf463f0e3f62bec4,0x3f223f55bef1bf6d
.quad 0xbf35248d3f353f80,0xbf35248d3f353f80,0x3f353f803f350000,0x3f353f803f350000,0xbf75bf55bdc93f35,0x3e95bf0ebf7fbf35,0xbe953f0e3f7f3f35,0xbf75bf55bdc93f35
.quad 0xbe48bf6dbf55248d,0x3e483f6d3f55a554,0xbf7bbec43f0e3f80,0x3f7b3ec4bf0ebf80,0x3f46be48bf75bf35,0xbf22bf7bbe953f35,0xbf22bf7bbe953f35,0xbf463e483f753f35
.quad 0x3f6d3f35bec4bf80,0x3f6d3f35bec4bf80,0x3ec4bf35bf6d250d,0x3ec4bf35bf6d250d,0x3dc93f7b3ef1bf35,0xbf7fbe483f623f35,0x3f7f3e48bf62bf35,0x3dc93f7b3ef1bf35
.quad 0xbf553ec43f7ba554,0x3f55bec4bf7b248d,0x3f0e3f6dbe48bf80,0xbf0ebf6d3e483f80,0xbf62bf0e3f463f35,0xbef13f553f22bf35,0xbef13f553f22bf35,0x3f623f0ebf46bf35
.quad 0x3f35a554bf35bf80,0x3f35a554bf35bf80,0xbf35bf80bf35250d,0xbf35bf80bf35250d,0x3f463f7b3ef1bec4,0xbf223e483f623f6d,0x3f22be48bf62bf6d,0x3f463f7b3ef1bec4
.quad 0xbf0e3ec43f7b3f35,0x3f0ebec4bf7bbf35,0x3f553f6d3e48bf35,0xbf55bf6dbe483f35,0xbf62bf553dc93f6d,0xbef13f0e3f7f3ec4,0xbef13f0e3f7f3ec4,0x3f623f55bdc9bf6d
.quad 0x3ec4bf35bf6d248d,0x3ec4bf35bf6d248d,0xbf6dbf353ec43f80,0xbf6dbf353ec43f80,0x3f753f0ebf22bf6d,0xbe953f553f46bec4,0x3e95bf55bf463ec4,0x3f753f0ebf22bf6d
.quad 0xbe483f6d3f0ebf35,0x3e48bf6dbf0e3f35,0x3f7b3ec4bf55bf35,0xbf7bbec43f553f35,0xbf7fbe483f753ec4,0xbdc93f7b3e95bf6d,0xbdc93f7b3e95bf6d,0x3f7f3e48bf75bec4
.quad 0xbf35248d3f353f80,0xbf35248d3f353f80,0x3f353f803f350000,0x3f353f803f350000,0x3f623e48bf22bf80,0x3ef13f7b3f46a554,0xbef1bf7bbf46250d,0x3f623e48bf22bf80
.quad 0xbf7bbec43f0e3f80,0x3f7b3ec4bf0ebf80,0x3e483f6d3f550000,0xbe48bf6dbf55250d,0x3f7f3f0ebef1bf80,0x3dc9bf55bf62248d,0x3dc9bf55bf62250d,0xbf7fbf0e3ef13f80
.quad 0xbf6dbf353ec43f80,0xbf6dbf353ec43f80,0xbec43f353f6d0000,0xbec43f353f6d0000,0x3f463f55be95bf80,0xbf223f0e3f75a554,0x3f22bf0ebf75250d,0x3f463f55be95bf80
.quad 0xbf0ebf6d3e483f80,0x3f0e3f6dbe48bf80,0xbf553ec43f7b0000,0x3f55bec4bf7b250d,0x3e953f7bbdc9bf80,0x3f75be48bf7f248d,0x3f75be48bf7f250d,0xbe95bf7b3dc93f80
.quad 0x3f35a554bf35bf80,0x3f35a554bf35bf80,0xbf35bf80bf35250d,0xbf35bf80bf35250d,0xbf7fbf0e3e953f6d,0xbdc9bf55bf75bec4,0x3dc93f553f753ec4,0xbf7fbf0e3e953f6d
.quad 0x3f553f6d3e48bf35,0xbf55bf6dbe483f35,0x3f0ebec4bf7bbf35,0xbf0e3ec43f7b3f35,0xbe95bf7bbf223ec4,0xbf75be483f463f6d,0xbf75be483f463f6d,0x3e953f7b3f22bec4
.quad 0xbec43f353f6da554,0xbec43f353f6da554,0x3f6d3f35bec4bf80,0x3f6d3f35bec4bf80,0x3f62be48bf7fbec4,0x3ef13f7b3dc9bf6d,0xbef1bf7bbdc93f6d,0x3f62be48bf7fbec4
.quad 0xbf7bbec43f553f35,0x3f7b3ec4bf55bf35,0xbe483f6d3f0ebf35,0x3e48bf6dbf0e3f35,0x3f223f55bef1bf6d,0x3f46bf0ebf623ec4,0x3f46bf0ebf623ec4,0xbf22bf553ef13f6d
.quad 0xbf35248d3f353f80,0xbf35248d3f353f80,0x3f353f803f350000,0x3f353f803f350000,0x3f753f553dc9bf35,0xbe953f0e3f7f3f35,0x3e95bf0ebf7fbf35,0x3f753f553dc9bf35
.quad 0xbe48bf6dbf55248d,0x3e483f6d3f55a554,0xbf7bbec43f0e3f80,0x3f7b3ec4bf0ebf80,0xbf463e483f753f35,0x3f223f7b3e95bf35,0x3f223f7b3e95bf35,0x3f46be48bf75bf35
.quad 0x3f6d3f35bec4bf80,0x3f6d3f35bec4bf80,0x3ec4bf35bf6d250d,0x3ec4bf35bf6d250d,0xbdc9bf7bbef13f35,0x3f7f3e48bf62bf35,0xbf7fbe483f623f35,0xbdc9bf7bbef13f35
.quad 0xbf553ec43f7ba554,0x3f55bec4bf7b248d,0x3f0e3f6dbe48bf80,0xbf0ebf6d3e483f80,0x3f623f0ebf46bf35,0x3ef1bf55bf223f35,0x3ef1bf55bf223f35,0xbf62bf0e3f463f35
.quad 0x3f35a554bf35bf80,0x3f35a554bf35bf80,0xbf35bf80bf35250d,0xbf35bf80bf35250d,0xbf46bf7bbef13ec4,0x3f22be48bf62bf6d,0xbf223e483f623f6d,0xbf46bf7bbef13ec4
.quad 0xbf0e3ec43f7b3f35,0x3f0ebec4bf7bbf35,0x3f553f6d3e48bf35,0xbf55bf6dbe483f35,0x3f623f55bdc9bf6d,0x3ef1bf0ebf7fbec4,0x3ef1bf0ebf7fbec4,0xbf62bf553dc93f6d
.quad 0x3ec4bf35bf6d248d,0x3ec4bf35bf6d248d,0xbf6dbf353ec43f80,0xbf6dbf353ec43f80,0xbf75bf0e3f223f6d,0x3e95bf55bf463ec4,0xbe953f553f46bec4,0xbf75bf0e3f223f6d
.quad 0xbe483f6d3f0ebf35,0x3e48bf6dbf0e3f35,0x3f7b3ec4bf55bf35,0xbf7bbec43f553f35,0x3f7f3e48bf75bec4,0x3dc9bf7bbe953f6d,0x3dc9bf7bbe953f6d,0xbf7fbe483f753ec4
.quad 0xa554bf80248d3f80,0xa554bf80248d3f80,0xbf80250d3f800000,0xbf80250d3f800000,0x3e95bf7bbdc93f80,0x3f753e48bf7f248d,0xbf75be483f7f0000,0x3e95bf7bbdc93f80
.quad 0x3f0ebf6dbe483f80,0xbf0e3f6d3e48bf80,0xbf55bec43f7b0000,0x3f553ec4bf7b250d,0x3f46bf55be953f80,0xbf22bf0e3f75a554,0xbf22bf0e3f750000,0xbf463f553e95bf80
.quad 0x3f6dbf35bec43f80,0x3f6dbf35bec43f80,0xbec4bf353f6d0000,0xbec4bf353f6d0000,0x3f7fbf0ebef13f80,0x3dc93f55bf62248d,0xbdc9bf553f620000,0x3f7fbf0ebef13f80
.quad 0x3f7bbec4bf0e3f80,0xbf7b3ec43f0ebf80,0x3e48bf6d3f550000,0xbe483f6dbf55250d,0x3f62be48bf223f80,0x3ef1bf7b3f46a554,0x3ef1bf7b3f460000,0xbf623e483f22bf80
.quad 0xa554bf80248d3f80,0xa554bf80248d3f80,0xbf80250d3f800000,0xbf80250d3f800000,0x3f22bf55bef13f6d,0x3f463f0ebf62bec4,0xbf46bf0e3f623ec4,0x3f22bf55bef13f6d
.quad 0x3f7bbec4bf553f35,0xbf7b3ec43f55bf35,0xbe48bf6d3f0e3f35,0x3e483f6dbf0ebf35,0x3f623e48bf7f3ec4,0x3ef1bf7b3dc93f6d,0x3ef1bf7b3dc93f6d,0xbf62be483f7fbec4
.quad 0x3ec43f35bf6d248d,0x3ec43f35bf6d248d,0x3f6dbf35bec43f80,0x3f6dbf35bec43f80,0xbe953f7bbf22bec4,0xbf753e483f46bf6d,0x3f75be48bf463f6d,0xbe953f7bbf22bec4
.quad 0xbf553f6dbe48bf35,0x3f55bf6d3e483f35,0x3f0e3ec4bf7b3f35,0xbf0ebec43f7bbf35,0xbf7f3f0e3e95bf6d,0xbdc93f55bf753ec4,0xbdc93f55bf753ec4,0x3f7fbf0ebe953f6d
.quad 0xa554bf80248d3f80,0xa554bf80248d3f80,0xbf80250d3f800000,0xbf80250d3f800000,0x3f62bf0ebf463f35,0x3ef13f55bf22bf35,0xbef1bf553f223f35,0x3f62bf0ebf463f35
.quad 0x3f553ec4bf7b248d,0xbf55bec43f7ba554,0x3f0ebf6dbe483f80,0xbf0e3f6d3e48bf80,0xbdc93f7bbef1bf35,0x3f7fbe48bf623f35,0x3f7fbe48bf623f35,0x3dc9bf7b3ef13f35
.quad 0xbf6d3f353ec4bf80,0xbf6d3f353ec4bf80,0x3ec43f35bf6d250d,0x3ec43f35bf6d250d,0xbf46be483f75bf35,0x3f22bf7b3e953f35,0xbf223f7bbe95bf35,0xbf46be483f75bf35
.quad 0x3e48bf6d3f55a554,0xbe483f6dbf55248d,0xbf7b3ec43f0ebf80,0x3f7bbec4bf0e3f80,0x3f75bf553dc93f35,0xbe95bf0e3f7fbf35,0xbe95bf0e3f7fbf35,0xbf753f55bdc9bf35
.quad 0xa554bf80248d3f80,0xa554bf80248d3f80,0xbf80250d3f800000,0xbf80250d3f800000,0x3f7fbe48bf753ec4,0x3dc93f7bbe95bf6d,0xbdc9bf7b3e953f6d,0x3f7fbe48bf753ec4
.quad 0x3e483f6dbf0ebf35,0xbe48bf6d3f0e3f35,0x3f7bbec4bf553f35,0xbf7b3ec43f55bf35,0xbf753f0e3f22bf6d,0x3e953f55bf46bec4,0x3e953f55bf46bec4,0x3f75bf0ebf223f6d
.quad 0xbec4bf353f6da554,0xbec4bf353f6da554,0xbf6d3f353ec4bf80,0xbf6d3f353ec4bf80,0x3f62bf55bdc93f6d,0x3ef13f0ebf7f3ec4,0xbef1bf0e3f7fbec4,0x3f62bf55bdc93f6d
.quad 0x3f0e3ec4bf7b3f35,0xbf0ebec43f7bbf35,0x3f55bf6d3e483f35,0xbf553f6dbe48bf35,0xbf463f7bbef1bec4,0x3f223e48bf623f6d,0x3f223e48bf623f6d,0x3f46bf7b3ef13ec4
.quad 0xa554bf80248d3f80,0xa554bf80248d3f80,0xbf80250d3f800000,0xbf80250d3f800000,0xbe953f7b3dc9bf80,0xbf75be483f7fa554,0x3f753e48bf7f250d,0xbe953f7b3dc9bf80
.quad 0x3f0ebf6dbe483f80,0xbf0e3f6d3e48bf80,0xbf55bec43f7b0000,0x3f553ec4bf7b250d,0xbf463f553e95bf80,0x3f223f0ebf75248d,0x3f223f0ebf75250d,0x3f46bf55be953f80
.quad 0x3f6dbf35bec43f80,0x3f6dbf35bec43f80,0xbec4bf353f6d0000,0xbec4bf353f6d0000,0xbf7f3f0e3ef1bf80,0xbdc9bf553f62a554,0x3dc93f55bf62250d,0xbf7f3f0e3ef1bf80
.quad 0x3f7bbec4bf0e3f80,0xbf7b3ec43f0ebf80,0x3e48bf6d3f550000,0xbe483f6dbf55250d,0xbf623e483f22bf80,0xbef13f7bbf46248d,0xbef13f7bbf46250d,0x3f62be48bf223f80
.quad 0xa554bf80248d3f80,0xa554bf80248d3f80,0xbf80250d3f800000,0xbf80250d3f800000,0xbf223f553ef1bf6d,0xbf46bf0e3f623ec4,0x3f463f0ebf62bec4,0xbf223f553ef1bf6d
.quad 0x3f7bbec4bf553f35,0xbf7b3ec43f55bf35,0xbe48bf6d3f0e3f35,0x3e483f6dbf0ebf35,0xbf62be483f7fbec4,0xbef13f7bbdc9bf6d,0xbef13f7bbdc9bf6d,0x3f623e48bf7f3ec4
.quad 0x3ec43f35bf6d248d,0x3ec43f35bf6d248d,0x3f6dbf35bec43f80,0x3f6dbf35bec43f80,0x3e95bf7b3f223ec4,0x3f75be48bf463f6d,0xbf753e483f46bf6d,0x3e95bf7b3f223ec4
.quad 0xbf553f6dbe48bf35,0x3f55bf6d3e483f35,0x3f0e3ec4bf7b3f35,0xbf0ebec43f7bbf35,0x3f7fbf0ebe953f6d,0x3dc9bf553f75bec4,0x3dc9bf553f75bec4,0xbf7f3f0e3e95bf6d
.quad 0xa554bf80248d3f80,0xa554bf80248d3f80,0xbf80250d3f800000,0xbf80250d3f800000,0xbf623f0e3f46bf35,0xbef1bf553f223f35,0x3ef13f55bf22bf35,0xbf623f0e3f46bf35
.quad 0x3f553ec4bf7b248d,0xbf55bec43f7ba554,0x3f0ebf6dbe483f80,0xbf0e3f6d3e48bf80,0x3dc9bf7b3ef13f35,0xbf7f3e483f62bf35,0xbf7f3e483f62bf35,0xbdc93f7bbef1bf35
.quad 0xbf6d3f353ec4bf80,0xbf6d3f353ec4bf80,0x3ec43f35bf6d250d,0x3ec43f35bf6d250d,0x3f463e48bf753f35,0xbf223f7bbe95bf35,0x3f22bf7b3e953f35,0x3f463e48bf753f35
.quad 0x3e48bf6d3f55a554,0xbe483f6dbf55248d,0xbf7b3ec43f0ebf80,0x3f7bbec4bf0e3f80,0xbf753f55bdc9bf35,0x3e953f0ebf7f3f35,0x3e953f0ebf7f3f35,0x3f75bf553dc93f35
.quad 0xa554bf80248d3f80,0xa554bf80248d3f80,0xbf80250d3f800000,0xbf80250d3f800000,0xbf7f3e483f75bec4,0xbdc9bf7b3e953f6d,0x3dc93f7bbe95bf6d,0xbf7f3e483f75bec4
.quad 0x3e483f6dbf0ebf35,0xbe48bf6d3f0e3f35,0x3f7bbec4bf553f35,0xbf7b3ec43f55bf35,0x3f75bf0ebf223f6d,0xbe95bf553f463ec4,0xbe95bf553f463ec4,0xbf753f0e3f22bf6d
.quad 0xbec4bf353f6da554,0xbec4bf353f6da554,0xbf6d3f353ec4bf80,0xbf6d3f353ec4bf80,0xbf623f553dc9bf6d,0xbef1bf0e3f7fbec4,0x3ef13f0ebf7f3ec4,0xbf623f553dc9bf6d
.quad 0x3f0e3ec4bf7b3f35,0xbf0ebec43f7bbf35,0x3f55bf6d3e483f35,0xbf553f6dbe48bf35,0x3f46bf7b3ef13ec4,0xbf22be483f62bf6d,0xbf22be483f62bf6d,0xbf463f7bbef1bec4
.quad 0x3f35a554bf353f80,0x3f35a554bf353f80,0x3f35bf803f350000,0x3f35bf803f350000,0x3ef13e48bf463f80,0xbf623f7bbf22248d,0x3f62bf7b3f220000,0x3ef13e48bf463f80
.quad 0x3e483ec4bf553f80,0xbe48bec43f55bf80,0x3f7bbf6d3f0e0000,0xbf7b3f6dbf0e250d,0xbdc93f0ebf623f80,0x3f7fbf553ef1a554,0x3f7fbf553ef10000,0x3dc9bf0e3f62bf80
.quad 0xbec43f35bf6d3f80,0xbec43f35bf6d3f80,0x3f6dbf353ec40000,0x3f6dbf353ec40000,0xbf223f55bf753f80,0xbf463f0ebe95248d,0x3f46bf0e3e950000,0xbf223f55bf753f80
.quad 0xbf553f6dbf7b3f80,0x3f55bf6d3f7bbf80,0x3f0ebec43e480000,0xbf0e3ec4be48250d,0xbf753f7bbf7f3f80,0x3e95be483dc9a554,0x3e95be483dc90000,0x3f75bf7b3f7fbf80
.quad 0xbf35248d3f35bf80,0xbf35248d3f35bf80,0xbf353f80bf35250d,0xbf353f80bf35250d,0xbdc9bf0e3f75bf6d,0x3f7fbf553e953ec4,0xbf7f3f55be95bec4,0xbdc9bf0e3f75bf6d
.quad 0x3f0ebf6d3f7bbf35,0xbf0e3f6dbf7b3f35,0xbf553ec43e48bf35,0x3f55bec4be483f35,0x3f75bf7b3f46bec4,0xbe95be483f22bf6d,0xbe95be483f22bf6d,0xbf753f7bbf463ec4
.quad 0x3f6dbf353ec4a554,0x3f6dbf353ec4a554,0x3ec4bf353f6dbf80,0x3ec4bf353f6dbf80,0x3ef1be48bdc93ec4,0xbf623f7bbf7f3f6d,0x3f62bf7b3f7fbf6d,0x3ef1be48bdc93ec4
.quad 0xbe483ec4bf0e3f35,0x3e48bec43f0ebf35,0x3f7bbf6d3f55bf35,0xbf7b3f6dbf553f35,0xbf463f55bf623f6d,0x3f22bf0e3ef1bec4,0x3f22bf0e3ef1bec4,0x3f46bf553f62bf6d
.quad 0x3f35a554bf353f80,0x3f35a554bf353f80,0x3f35bf803f350000,0x3f35bf803f350000,0xbe953f55bf7f3f35,0xbf753f0e3dc9bf35,0x3f75bf0ebdc93f35,0xbe953f55bf7f3f35
.quad 0xbf7b3f6dbf0e248d,0x3f7bbf6d3f0ea554,0x3e483ec4bf553f80,0xbe48bec43f55bf80,0xbf223e483e95bf35,0xbf463f7bbf753f35,0xbf463f7bbf753f35,0x3f22be48be953f35
.quad 0x3ec4bf353f6dbf80,0x3ec4bf353f6dbf80,0xbf6d3f35bec4250d,0xbf6d3f35bec4250d,0x3f7fbf7b3f62bf35,0x3dc93e48bef13f35,0xbdc9be483ef1bf35,0x3f7fbf7b3f62bf35
.quad 0x3f0ebec43e48a554,0xbf0e3ec4be48248d,0x3f55bf6d3f7bbf80,0xbf553f6dbf7b3f80,0xbef13f0ebf223f35,0x3f62bf553f46bf35,0x3f62bf553f46bf35,0x3ef1bf0e3f22bf35
.quad 0xbf35248d3f35bf80,0xbf35248d3f35bf80,0xbf353f80bf35250d,0xbf353f80bf35250d,0x3f22bf7b3f62bec4,0x3f46be48bef13f6d,0xbf463e483ef1bf6d,0x3f22bf7b3f62bec4
.quad 0x3f55bec4be483f35,0xbf553ec43e48bf35,0x3f0ebf6d3f7bbf35,0xbf0e3f6dbf7b3f35,0xbef13f55bf7f3f6d,0x3f62bf0e3dc93ec4,0x3f62bf0e3dc93ec4,0x3ef1bf553f7fbf6d
.quad 0xbf6d3f35bec4248d,0xbf6d3f35bec4248d,0xbec43f35bf6d3f80,0xbec43f35bf6d3f80,0x3e95bf0e3f46bf6d,0x3f75bf553f22bec4,0xbf753f55bf223ec4,0x3e95bf0e3f46bf6d
.quad 0x3f7bbf6d3f55bf35,0xbf7b3f6dbf553f35,0x3e48bec43f0ebf35,0xbe483ec4bf0e3f35,0xbdc93e48be953ec4,0x3f7fbf7b3f75bf6d,0x3f7fbf7b3f75bf6d,0x3dc9be483e95bec4
.quad 0x3f35a554bf353f80,0x3f35a554bf353f80,0x3f35bf803f350000,0x3f35bf803f350000,0xbef1be483f46bf80,0x3f62bf7b3f22a554,0xbf623f7bbf22250d,0xbef1be483f46bf80
.quad 0x3e483ec4bf553f80,0xbe48bec43f55bf80,0x3f7bbf6d3f0e0000,0xbf7b3f6dbf0e250d,0x3dc9bf0e3f62bf80,0xbf7f3f55bef1248d,0xbf7f3f55bef1250d,0xbdc93f0ebf623f80
.quad 0xbec43f35bf6d3f80,0xbec43f35bf6d3f80,0x3f6dbf353ec40000,0x3f6dbf353ec40000,0x3f22bf553f75bf80,0x3f46bf0e3e95a554,0xbf463f0ebe95250d,0x3f22bf553f75bf80
.quad 0xbf553f6dbf7b3f80,0x3f55bf6d3f7bbf80,0x3f0ebec43e480000,0xbf0e3ec4be48250d,0x3f75bf7b3f7fbf80,0xbe953e48bdc9248d,0xbe953e48bdc9250d,0xbf753f7bbf7f3f80
.quad 0xbf35248d3f35bf80,0xbf35248d3f35bf80,0xbf353f80bf35250d,0xbf353f80bf35250d,0x3dc93f0ebf753f6d,0xbf7f3f55be95bec4,0x3f7fbf553e953ec4,0x3dc93f0ebf753f6d
.quad 0x3f0ebf6d3f7bbf35,0xbf0e3f6dbf7b3f35,0xbf553ec43e48bf35,0x3f55bec4be483f35,0xbf753f7bbf463ec4,0x3e953e48bf223f6d,0x3e953e48bf223f6d,0x3f75bf7b3f46bec4
.quad 0x3f6dbf353ec4a554,0x3f6dbf353ec4a554,0x3ec4bf353f6dbf80,0x3ec4bf353f6dbf80,0xbef13e483dc9bec4,0x3f62bf7b3f7fbf6d,0xbf623f7bbf7f3f6d,0xbef13e483dc9bec4
.quad 0xbe483ec4bf0e3f35,0x3e48bec43f0ebf35,0x3f7bbf6d3f55bf35,0xbf7b3f6dbf553f35,0x3f46bf553f62bf6d,0xbf223f0ebef13ec4,0xbf223f0ebef13ec4,0xbf463f55bf623f6d
.quad 0x3f35a554bf353f80,0x3f35a554bf353f80,0x3f35bf803f350000,0x3f35bf803f350000,0x3e95bf553f7fbf35,0x3f75bf0ebdc93f35,0xbf753f0e3dc9bf35,0x3e95bf553f7fbf35
.quad 0xbf7b3f6dbf0e248d,0x3f7bbf6d3f0ea554,0x3e483ec4bf553f80,0xbe48bec43f55bf80,0x3f22be48be953f35,0x3f46bf7b3f75bf35,0x3f46bf7b3f75bf35,0xbf223e483e95bf35
.quad 0x3ec4bf353f6dbf80,0x3ec4bf353f6dbf80,0xbf6d3f35bec4250d,0xbf6d3f35bec4250d,0xbf7f3f7bbf623f35,0xbdc9be483ef1bf35,0x3dc93e48bef13f35,0xbf7f3f7bbf623f35
.quad 0x3f0ebec43e48a554,0xbf0e3ec4be48248d,0x3f55bf6d3f7bbf80,0xbf553f6dbf7b3f80,0x3ef1bf0e3f22bf35,0xbf623f55bf463f35,0xbf623f55bf463f35,0xbef13f0ebf223f35
.quad 0xbf35248d3f35bf80,0xbf35248d3f35bf80,0xbf353f80bf35250d,0xbf353f80bf35250d,0xbf223f7bbf623ec4,0xbf463e483ef1bf6d,0x3f46be48bef13f6d,0xbf223f7bbf623ec4
.quad 0x3f55bec4be483f35,0xbf553ec43e48bf35,0x3f0ebf6d3f7bbf35,0xbf0e3f6dbf7b3f35,0x3ef1bf553f7fbf6d,0xbf623f0ebdc9bec4,0xbf623f0ebdc9bec4,0xbef13f55bf7f3f6d
.quad 0xbf6d3f35bec4248d,0xbf6d3f35bec4248d,0xbec43f35bf6d3f80,0xbec43f35bf6d3f80,0xbe953f0ebf463f6d,0xbf753f55bf223ec4,0x3f75bf553f22bec4,0xbe953f0ebf463f6d
.quad 0x3f7bbf6d3f55bf35,0xbf7b3f6dbf553f35,0x3e48bec43f0ebf35,0xbe483ec4bf0e3f35,0x3dc9be483e95bec4,0xbf7f3f7bbf753f6d,0xbf7f3f7bbf753f6d,0xbdc93e48be953ec4
```
